```python
import torch

def _softmax(x, axis=-1):
    return torch.softmax(x, dim=axis)
def _gelu(x):
    return torch.nn.functional.gelu(x, approximate="tanh")
def _silu(x):
    return torch.nn.functional.silu(x)
def _sigmoid(x):
    return torch.sigmoid(x)
def _layernorm(x, axis=-1, eps=1e-5):
    m = x.mean(dim=axis, keepdim=True)
    v = x.var(dim=axis, keepdim=True, unbiased=False)
    return (x - m) / torch.sqrt(v + eps)
def _scatter_add(tgt, idx, src, axis=0):
    return tgt.clone().index_add_(axis, idx, src)
def _segment_sum(src, seg, n):
    out = torch.zeros((n,) + src.shape[1:], dtype=src.dtype)
    return out.index_add_(0, seg, src)
def _pad(x, pw):
    flat = tuple(v for pair in reversed(pw) for v in pair)
    return torch.nn.functional.pad(x, flat)

kernel_name = 'concat_heads__gqa_block_cached__mha_block_cached__near_ridge'

def setup_inputs():

    _w = (lambda a: (lambda t: t.to(torch.bfloat16) if t.is_floating_point() else t)(torch.as_tensor(a)))
    def _A_setup():
        B, Sq, D = 16, 128, 640
        Hq, Hkv, Sk, Dh = 32, 32, 512, 192
        assert Hq % Hkv == 0, (Hq, Hkv)
        return {
            "x": _w((lambda *s: torch.randn(*s, dtype=torch.bfloat16) * 0.8)(B, Sq, D)),
            "k_cache": _w((lambda *s: torch.randn(*s, dtype=torch.bfloat16) * 0.8)(B, Hkv, Sk, Dh)),
            "v_cache": _w((lambda *s: torch.randn(*s, dtype=torch.bfloat16) * 0.05)(B, Hkv, Sk, Dh)),
            "wq": _w((lambda *s: torch.randn(*s, dtype=torch.bfloat16) * 0.8)(D, Hq * Dh) * (D ** -0.5)),
            "wo": _w((lambda *s: torch.randn(*s, dtype=torch.bfloat16) * 0.05)(Hq * Dh, D) * ((Hq * Dh) ** -0.5)),
        }
    _A_in = _A_setup()

    def _B_setup():
        B, Sq, D = 16, 128, 640
        H, Sk, Dh = 32, 512, 192
        return {
            "x": _w((lambda *s: torch.randn(*s, dtype=torch.bfloat16) * 0.8)(B, Sq, D)),
            "k_cache": _w((lambda *s: torch.randn(*s, dtype=torch.bfloat16) * 0.8)(B, H, Sk, Dh)),
            "v_cache": _w((lambda *s: torch.randn(*s, dtype=torch.bfloat16) * 0.05)(B, H, Sk, Dh)),
            "wq": _w((lambda *s: torch.randn(*s, dtype=torch.bfloat16) * 0.8)(D, H * Dh) * (D ** -0.5)),
            "wo": _w((lambda *s: torch.randn(*s, dtype=torch.bfloat16) * 0.05)(H * Dh, D) * ((H * Dh) ** -0.5)),
        }
    _B_in = _B_setup()

    return {
        "A_x": _A_in["x"],
        "A_k_cache": _A_in["k_cache"],
        "A_v_cache": _A_in["v_cache"],
        "A_wq": _A_in["wq"],
        "A_wo": _A_in["wo"],
        "B_x": _B_in["x"],
        "B_k_cache": _B_in["k_cache"],
        "B_v_cache": _B_in["v_cache"],
        "B_wq": _B_in["wq"],
        "B_wo": _B_in["wo"],
    }

def reference(A_x, A_k_cache, A_v_cache, A_wq, A_wo, B_x, B_k_cache, B_v_cache, B_wq, B_wo):
    def _A_ref(x, k_cache, v_cache, wq, wo):
        B, Sq, D = x.shape
        Hq, Dh = 32, 192
        Hkv = k_cache.shape[1]
        rep = Hq // Hkv
        q = (lambda x, *d: x.permute(*d))((x @ wq).reshape(B, Sq, Hq, Dh), 0, 2, 1, 3)
        k = (lambda x, n, axis: torch.repeat_interleave(x, n, dim=axis))(k_cache, rep, axis=1)
        v = (lambda x, n, axis: torch.repeat_interleave(x, n, dim=axis))(v_cache, rep, axis=1)
        scores = torch.einsum("bhqd,bhkd->bhqk", q, k) * (Dh ** -0.5)
        p = _softmax(scores, axis=-1)
        o = torch.einsum("bhqk,bhkd->bhqd", p, v)
        return (lambda x, *d: x.permute(*d))(o, 0, 2, 1, 3).reshape(B, Sq, Hq * Dh) @ wo

    def _B_ref(x, k_cache, v_cache, wq, wo):
        B, Sq, D = x.shape
        H, Dh = 32, 192
        q = (lambda x, *d: x.permute(*d))((x @ wq).reshape(B, Sq, H, Dh), 0, 2, 1, 3)
        scores = torch.einsum("bhqd,bhkd->bhqk", q, k_cache) * (Dh ** -0.5)
        p = _softmax(scores, axis=-1)
        o = torch.einsum("bhqk,bhkd->bhqd", p, v_cache)
        return (lambda x, *d: x.permute(*d))(o, 0, 2, 1, 3).reshape(B, Sq, H * Dh) @ wo

    a = _A_ref(A_x, A_k_cache, A_v_cache, A_wq, A_wo)
    b = _B_ref(B_x, B_k_cache, B_v_cache, B_wq, B_wo)
    return torch.concatenate([a, b], axis=-1)
```

```asm
; @launch kernel=attn_kernel grid=(256,1,1) block=(256,1,1) lds=163840
.amdgcn_target "amdgcn-amd-amdhsa--gfx950"
.text
.p2align 12
.macro Mvaa d,a,b
v_mfma_f32_16x16x32_bf16 v[\d:\d+3], a[\a:\a+3], a[\b:\b+3], v[\d:\d+3]
.endm
.macro TR d,a,o
ds_read_b64_tr_b16 a[\d:\d+1], v\a offset:\o
.endm
.macro Mvav d,a,b
v_mfma_f32_16x16x32_bf16 v[\d:\d+3], a[\a:\a+3], v[\b:\b+3], v[\d:\d+3]
.endm
.macro Mvvv d,a,b
v_mfma_f32_16x16x32_bf16 v[\d:\d+3], v[\a:\a+3], v[\b:\b+3], v[\d:\d+3]
.endm
.macro Mvva d,a,b
v_mfma_f32_16x16x32_bf16 v[\d:\d+3], v[\a:\a+3], a[\b:\b+3], v[\d:\d+3]
.endm
L_B:
Tc19:
s_cbranch_execz Tw19
s_cmpk_eq_u32 s88, 22
s_cselect_b64 exec, 0, -1
s_cbranch_execz Tc22
Tr22:
s_mov_b64 exec, -1
v_mul_f32 v93, v8, v93
v_mul_f32 v94, v8, v94
Mvaa 56,244,8
s_waitcnt lgkmcnt(3)
ds_read_b128 a[244:247], v9 offset:27136
v_mul_f32 v95, v8, v95
Mvaa 48,224,12
buffer_load_dwordx4 v4, s[8:11], s43 offen nt lds
Mvaa 56,224,16
s_add_u32 m0, s38, 3840
ds_read_b128 a[224:227], v9 offset:43008
v_cvt_pk_bf16_f32 v84, v84, v85
Mvaa 48,228,20
v_cvt_pk_bf16_f32 v85, v86, v87
v_cvt_pk_bf16_f32 v86, v92, v93
Mvaa 56,228,24
s_waitcnt lgkmcnt(3)
ds_read_b128 a[228:231], v9 offset:43520
v_cvt_pk_bf16_f32 v87, v94, v95
v_mfma_f32_16x16x32_bf16 v[52:55], a[232:235], a[208:211], 0
v_accvgpr_write_b32 a164, v84
v_accvgpr_write_b32 a165, v85
v_mfma_f32_16x16x32_bf16 v[60:63], a[232:235], a[212:215], 0
TR 232,19,57344
TR 234,19,59392
Mvaa 52,236,216
buffer_load_dwordx4 v4, s[8:11], s32 offen offset:256 nt lds
Mvaa 60,236,220
s_waitcnt lgkmcnt(4)
TR 236,20,57344
TR 238,20,59392
Mvaa 52,240,248
s_add_u32 s32, s32, 6144
v_accvgpr_write_b32 a166, v86
v_accvgpr_write_b32 a167, v87
Mvaa 60,240,0
s_sub_u32 s45, s32, 98304
TR 240,19,57856
TR 242,19,59904
Mvaa 52,244,4
s_min_u32 s32, s32, s45
v_mul_f32 v98, v12, v98
v_mul_f32 v99, v12, v99
Mvaa 60,244,8
s_waitcnt lgkmcnt(6)
TR 244,20,57856
TR 246,20,59904
Mvaa 52,224,12
s_add_u32 s43, s54, 204800
v_mul_f32 v104, v12, v104
v_mul_f32 v105, v12, v105
Mvaa 60,224,16
s_add_u32 m0, s38, 8192
TR 224,19,36864
TR 226,19,38912
Mvaa 52,228,20
buffer_load_dwordx4 v7, s[20:23], s43 offen lds
Mvaa 60,228,24
s_waitcnt lgkmcnt(6)
TR 228,20,36864
TR 230,20,38912
Mvaa 224,232,160
v_mul_f32 v106, v12, v106
v_mul_f32 v107, v12, v107
Mvaa 228,232,164
TR 232,19,37376
TR 234,19,39424
Mvaa 232,236,160
v_cvt_pk_bf16_f32 v96, v96, v97
v_cvt_pk_bf16_f32 v97, v98, v99
Mvaa 236,236,164
s_waitcnt lgkmcnt(6)
TR 236,20,37376
TR 238,20,39424
Mvaa 240,240,160
v_cvt_pk_bf16_f32 v98, v104, v105
v_cvt_pk_bf16_f32 v99, v106, v107
Mvaa 244,240,164
TR 240,19,40960
TR 242,19,43008
Mvaa 248,244,160
v_accvgpr_write_b32 a168, v96
v_accvgpr_write_b32 a169, v97
Mvaa 252,244,164
s_waitcnt lgkmcnt(6)
TR 244,20,40960
TR 246,20,43008
v_accvgpr_write_b32 a170, v98
v_accvgpr_write_b32 a171, v99
s_nop 1
Mvaa 224,224,168
v_mul_f32 v100, v8, v100
v_mul_f32 v101, v8, v101
v_mul_f32 v102, v8, v102
v_mul_f32 v103, v8, v103
v_pk_mul_f32 v[108:109], v[108:109], v[8:9] op_sel_hi:[1,0]
v_pk_mul_f32 v[110:111], v[110:111], v[8:9] op_sel_hi:[1,0]
v_cvt_pk_bf16_f32 v100, v100, v101
v_cvt_pk_bf16_f32 v101, v102, v103
v_cvt_pk_bf16_f32 v102, v108, v109
v_cvt_pk_bf16_f32 v103, v110, v111
v_accvgpr_write_b32 a172, v100
v_accvgpr_write_b32 a173, v101
v_accvgpr_write_b32 a174, v102
v_accvgpr_write_b32 a175, v103
s_nop 1
Mvaa 228,224,172
TR 224,19,41472
TR 226,19,43520
Mvaa 232,228,168
v_mul_f32 v112, v12, v112
v_mul_f32 v113, v12, v113
Mvaa 236,228,172
s_waitcnt lgkmcnt(6)
TR 228,20,41472
TR 230,20,43520
Mvaa 240,232,168
v_mul_f32 v114, v12, v114
v_mul_f32 v115, v12, v115
Mvaa 244,232,172
TR 232,19,28672
TR 234,19,30720
Mvaa 248,236,168
v_mul_f32 v120, v12, v120
v_mul_f32 v121, v12, v121
Mvaa 252,236,172
s_waitcnt lgkmcnt(6)
TR 236,20,28672
TR 238,20,30720
v_mul_f32 v122, v12, v122
v_mul_f32 v123, v12, v123
v_cvt_pk_bf16_f32 v112, v112, v113
v_cvt_pk_bf16_f32 v113, v114, v115
v_cvt_pk_bf16_f32 v114, v120, v121
v_cvt_pk_bf16_f32 v115, v122, v123
v_accvgpr_write_b32 a176, v112
v_accvgpr_write_b32 a177, v113
v_accvgpr_write_b32 a178, v114
v_accvgpr_write_b32 a179, v115
s_nop 1
Mvaa 224,240,176
v_mul_f32 v116, v8, v116
v_mul_f32 v117, v8, v117
v_mul_f32 v118, v8, v118
v_mul_f32 v119, v8, v119
v_pk_mul_f32 v[124:125], v[124:125], v[8:9] op_sel_hi:[1,0]
v_pk_mul_f32 v[126:127], v[126:127], v[8:9] op_sel_hi:[1,0]
v_cvt_pk_bf16_f32 v116, v116, v117
v_cvt_pk_bf16_f32 v117, v118, v119
v_cvt_pk_bf16_f32 v118, v124, v125
v_cvt_pk_bf16_f32 v119, v126, v127
v_accvgpr_write_b32 a180, v116
v_accvgpr_write_b32 a181, v117
v_accvgpr_write_b32 a182, v118
v_accvgpr_write_b32 a183, v119
s_nop 1
Mvaa 228,240,180
TR 240,19,29184
TR 242,19,31232
Mvaa 232,244,176
v_mul_f32 v128, v12, v128
v_mul_f32 v129, v12, v129
Mvaa 236,244,180
s_waitcnt lgkmcnt(6)
TR 244,20,29184
TR 246,20,31232
Mvaa 240,224,176
v_mul_f32 v130, v12, v130
v_mul_f32 v131, v12, v131
Mvaa 244,224,180
s_add_u32 s43, s54, 245760
TR 224,15,16384
TR 226,15,18432
Mvaa 248,228,176
s_add_u32 m0, s38, 32768
v_mul_f32 v136, v12, v136
v_mul_f32 v137, v12, v137
Mvaa 252,228,180
s_waitcnt lgkmcnt(6)
TR 228,16,16384
TR 230,16,18432
v_mul_f32 v138, v12, v138
v_mul_f32 v139, v12, v139
v_cvt_pk_bf16_f32 v128, v128, v129
v_cvt_pk_bf16_f32 v129, v130, v131
v_cvt_pk_bf16_f32 v130, v136, v137
v_cvt_pk_bf16_f32 v131, v138, v139
v_accvgpr_write_b32 a184, v128
v_accvgpr_write_b32 a185, v129
v_accvgpr_write_b32 a186, v130
v_accvgpr_write_b32 a187, v131
s_nop 1
Mvaa 224,232,184
buffer_load_dwordx4 v7, s[20:23], s43 offen lds
v_mul_f32 v132, v8, v132
v_mul_f32 v133, v8, v133
v_mul_f32 v134, v8, v134
v_mul_f32 v135, v8, v135
v_pk_mul_f32 v[140:141], v[140:141], v[8:9] op_sel_hi:[1,0]
v_pk_mul_f32 v[142:143], v[142:143], v[8:9] op_sel_hi:[1,0]
v_cvt_pk_bf16_f32 v132, v132, v133
v_cvt_pk_bf16_f32 v133, v134, v135
v_cvt_pk_bf16_f32 v134, v140, v141
v_cvt_pk_bf16_f32 v135, v142, v143
v_accvgpr_write_b32 a188, v132
v_accvgpr_write_b32 a189, v133
v_accvgpr_write_b32 a190, v134
v_accvgpr_write_b32 a191, v135
s_nop 1
Mvaa 228,232,188
s_add_u32 s43, s54, 286720
TR 232,19,49152
TR 234,19,51200
Mvaa 232,236,184
s_add_u32 m0, s38, 36864
v_mul_f32 v144, v12, v144
v_mul_f32 v145, v12, v145
Mvaa 236,236,188
s_waitcnt lgkmcnt(6)
TR 236,20,49152
TR 238,20,51200
Mvaa 240,240,184
buffer_load_dwordx4 v7, s[20:23], s43 offen lds
Mvaa 244,240,188
s_add_u32 m0, s38, 53248
TR 240,15,16896
TR 242,15,18944
Mvaa 248,244,184
v_mul_f32 v146, v12, v146
v_mul_f32 v147, v12, v147
Mvaa 252,244,188
s_waitcnt lgkmcnt(6)
TR 244,16,16896
TR 246,16,18944
v_mul_f32 v152, v12, v152
v_mul_f32 v153, v12, v153
v_pk_mul_f32 v[154:155], v[154:155], v[12:13] op_sel_hi:[1,0]
v_cvt_pk_bf16_f32 v144, v144, v145
v_cvt_pk_bf16_f32 v145, v146, v147
v_cvt_pk_bf16_f32 v146, v152, v153
v_cvt_pk_bf16_f32 v147, v154, v155
v_accvgpr_write_b32 a192, v144
v_accvgpr_write_b32 a193, v145
v_accvgpr_write_b32 a194, v146
v_accvgpr_write_b32 a195, v147
s_nop 1
Mvaa 224,224,192
v_mul_f32 v148, v8, v148
v_mul_f32 v149, v8, v149
v_mul_f32 v150, v8, v150
v_mul_f32 v151, v8, v151
v_pk_mul_f32 v[156:157], v[156:157], v[8:9] op_sel_hi:[1,0]
v_pk_mul_f32 v[158:159], v[158:159], v[8:9] op_sel_hi:[1,0]
v_cvt_pk_bf16_f32 v148, v148, v149
v_cvt_pk_bf16_f32 v149, v150, v151
v_cvt_pk_bf16_f32 v150, v156, v157
v_cvt_pk_bf16_f32 v151, v158, v159
v_accvgpr_write_b32 a196, v148
v_accvgpr_write_b32 a197, v149
v_accvgpr_write_b32 a198, v150
v_accvgpr_write_b32 a199, v151
s_nop 1
Mvaa 228,224,196
TR 224,19,49664
TR 226,19,51712
Mvaa 232,228,192
buffer_load_dwordx4 v5, s[12:15], s33 offen nt lds
Mvaa 236,228,196
s_waitcnt vmcnt(10) lgkmcnt(6)
TR 228,20,49664
TR 230,20,51712
v_mul_f32 v160, v12, v160
v_mul_f32 v161, v12, v161
v_pk_mul_f32 v[162:163], v[162:163], v[12:13] op_sel_hi:[1,0]
v_pk_mul_f32 v[168:169], v[168:169], v[12:13] op_sel_hi:[1,0]
v_pk_mul_f32 v[170:171], v[170:171], v[12:13] op_sel_hi:[1,0]
v_cvt_pk_bf16_f32 v160, v160, v161
v_cvt_pk_bf16_f32 v161, v162, v163
v_cvt_pk_bf16_f32 v162, v168, v169
v_cvt_pk_bf16_f32 v163, v170, v171
v_accvgpr_write_b32 a200, v160
v_accvgpr_write_b32 a201, v161
v_accvgpr_write_b32 a202, v162
v_accvgpr_write_b32 a203, v163
s_nop 1
Mvaa 224,232,200
s_barrier
v_mul_f32 v164, v8, v164
v_mul_f32 v165, v8, v165
v_mul_f32 v166, v8, v166
v_mul_f32 v167, v8, v167
v_pk_mul_f32 v[172:173], v[172:173], v[8:9] op_sel_hi:[1,0]
v_pk_mul_f32 v[174:175], v[174:175], v[8:9] op_sel_hi:[1,0]
v_cvt_pk_bf16_f32 v164, v164, v165
v_cvt_pk_bf16_f32 v165, v166, v167
v_cvt_pk_bf16_f32 v166, v172, v173
v_cvt_pk_bf16_f32 v167, v174, v175
v_accvgpr_write_b32 a204, v164
v_accvgpr_write_b32 a205, v165
v_accvgpr_write_b32 a206, v166
v_accvgpr_write_b32 a207, v167
s_nop 1
Mvaa 228,232,204
s_add_u32 m0, s38, 155520
ds_read_b128 a[232:235], v9 offset:45056
Mvaa 232,236,200
v_cvt_pk_bf16_f32 v224, v224, v225
v_cvt_pk_bf16_f32 v225, v226, v227
Mvaa 236,236,204
s_waitcnt lgkmcnt(5)
ds_read_b128 a[236:239], v9 offset:45568
v_accvgpr_write_b32 a76, v224
Mvaa 240,240,192
buffer_load_dwordx4 v5, s[12:15], s33 offen offset:128 nt lds
Mvaa 244,240,196
s_add_u32 m0, s38, 134912
ds_read_b128 a[240:243], v10 offset:0
v_cvt_pk_bf16_f32 v226, v232, v233
Mvaa 248,244,192
v_cvt_pk_bf16_f32 v227, v234, v235
v_accvgpr_write_b32 a77, v225
Mvaa 252,244,196
s_waitcnt lgkmcnt(3)
ds_read_b128 a[244:247], v10 offset:512
v_accvgpr_write_b32 a78, v226
Mvaa 240,224,200
v_accvgpr_write_b32 a79, v227
v_cvt_pk_bf16_f32 v228, v228, v229
Mvaa 244,224,204
ds_read_b128 a[224:227], v11 offset:45056
v_cvt_pk_bf16_f32 v229, v230, v231
Mvaa 248,228,200
buffer_load_dwordx4 v5, s[12:15], s33 offen offset:256 nt lds
Mvaa 252,228,204
s_waitcnt lgkmcnt(3)
ds_read_b128 a[228:231], v11 offset:45568
v_cvt_pk_bf16_f32 v230, v236, v237
v_mfma_f32_16x16x32_bf16 v[64:67], a[232:235], a[208:211], 0
s_add_u32 s33, s33, 6144
v_cvt_pk_bf16_f32 v231, v238, v239
v_accvgpr_write_b32 a80, v228
v_mfma_f32_16x16x32_bf16 v[72:75], a[232:235], a[212:215], 0
s_sub_u32 s45, s33, 98304
ds_read_b128 a[232:235], v9 offset:47104
v_accvgpr_write_b32 a81, v229
Mvaa 64,236,216
s_min_u32 s33, s33, s45
v_accvgpr_write_b32 a82, v230
v_accvgpr_write_b32 a83, v231
Mvaa 72,236,220
s_waitcnt lgkmcnt(3)
ds_read_b128 a[236:239], v9 offset:47616
v_cvt_pk_bf16_f32 v240, v240, v241
Mvaa 64,240,248
s_add_u32 m0, s38, 139264
v_cvt_pk_bf16_f32 v241, v242, v243
v_cvt_pk_bf16_f32 v242, v248, v249
Mvaa 72,240,0
ds_read_b128 a[240:243], v10 offset:2048
v_cvt_pk_bf16_f32 v243, v250, v251
Mvaa 64,244,4
buffer_load_dwordx4 v4, s[8:11], s32 offen nt lds
Mvaa 72,244,8
s_waitcnt lgkmcnt(3)
ds_read_b128 a[244:247], v10 offset:2560
v_accvgpr_write_b32 a84, v240
Mvaa 64,224,12
s_add_u32 m0, s38, 126848
v_accvgpr_write_b32 a85, v241
v_accvgpr_write_b32 a86, v242
Mvaa 72,224,16
ds_read_b128 a[224:227], v11 offset:47104
v_accvgpr_write_b32 a87, v243
Mvaa 64,228,20
v_cvt_pk_bf16_f32 v244, v244, v245
v_cvt_pk_bf16_f32 v245, v246, v247
Mvaa 72,228,24
s_waitcnt lgkmcnt(3)
ds_read_b128 a[228:231], v11 offset:47616
v_cvt_pk_bf16_f32 v246, v252, v253
v_mfma_f32_16x16x32_bf16 v[68:71], a[232:235], a[208:211], 0
buffer_load_dwordx4 v4, s[8:11], s32 offen offset:128 nt lds
v_mfma_f32_16x16x32_bf16 v[76:79], a[232:235], a[212:215], 0
s_add_u32 m0, s38, 12032
TR 232,19,32768
TR 234,19,34816
Mvaa 68,236,216
v_cvt_pk_bf16_f32 v247, v254, v255
v_accvgpr_write_b32 a88, v244
Mvaa 76,236,220
s_waitcnt lgkmcnt(4)
TR 236,20,32768
TR 238,20,34816
Mvaa 68,240,248
v_accvgpr_write_b32 a89, v245
v_accvgpr_write_b32 a90, v246
Mvaa 76,240,0
TR 240,19,20480
TR 242,19,22528
Mvaa 68,244,4
buffer_load_dwordx4 v4, s[8:11], s32 offen offset:256 nt lds
Mvaa 76,244,8
s_waitcnt lgkmcnt(6)
TR 244,20,20480
TR 246,20,22528
Mvaa 68,224,12
s_add_u32 s32, s32, 6144
v_accvgpr_write_b32 a91, v247
s_sub_u32 s45, s32, 98304
Mvaa 76,224,16
s_min_u32 s32, s32, s45
TR 224,19,33280
TR 226,19,35328
Mvaa 68,228,20
s_add_u32 s43, s54, 327680
v_exp_f32 v24, v48
Mvaa 76,228,24
s_waitcnt lgkmcnt(6)
TR 228,20,33280
TR 230,20,35328
v_mfma_f32_16x16x32_bf16 v[224:227], a[232:235], v[176:179], 0
s_add_u32 m0, s38, 20480
v_exp_f32 v25, v49
v_mfma_f32_16x16x32_bf16 v[228:231], a[232:235], v[180:183], 0
TR 232,19,20992
TR 234,19,23040
v_mfma_f32_16x16x32_bf16 v[232:235], a[236:239], v[176:179], 0
buffer_load_dwordx4 v7, s[20:23], s43 offen lds
v_mfma_f32_16x16x32_bf16 v[236:239], a[236:239], v[180:183], 0
s_waitcnt lgkmcnt(6)
TR 236,20,20992
TR 238,20,23040
Mvav 224,240,184
v_exp_f32 v26, v50
Mvav 228,240,188
TR 240,19,61440
TR 242,19,63488
Mvav 232,244,184
v_cvt_pk_bf16_f32 v40, v24, v25
Mvav 236,244,188
s_waitcnt lgkmcnt(6)
TR 244,20,61440
TR 246,20,63488
v_mfma_f32_16x16x32_bf16 v[240:243], a[224:227], v[176:179], 0
v_exp_f32 v27, v51
v_mfma_f32_16x16x32_bf16 v[244:247], a[224:227], v[180:183], 0
TR 224,19,61952
TR 226,19,64000
v_mfma_f32_16x16x32_bf16 v[248:251], a[228:231], v[176:179], 0
v_exp_f32 v24, v56
v_mfma_f32_16x16x32_bf16 v[252:255], a[228:231], v[180:183], 0
s_waitcnt lgkmcnt(6)
TR 228,20,61952
TR 230,20,64000
Mvav 240,232,184
v_cvt_pk_bf16_f32 v41, v26, v27
Mvav 244,232,188
TR 232,19,24576
TR 234,19,26624
Mvav 248,236,184
v_exp_f32 v25, v57
Mvav 252,236,188
s_waitcnt lgkmcnt(6)
TR 236,20,24576
TR 238,20,26624
Mvav 224,240,192
v_exp_f32 v26, v58
Mvav 228,240,196
TR 240,19,25088
TR 242,19,27136
Mvav 232,244,192
v_cvt_pk_bf16_f32 v44, v24, v25
Mvav 236,244,196
s_waitcnt lgkmcnt(6)
TR 244,20,25088
TR 246,20,27136
Mvav 240,224,192
v_exp_f32 v27, v59
Mvav 244,224,196
TR 224,19,12288
TR 226,19,14336
Mvav 248,228,192
v_exp_f32 v24, v52
Mvav 252,228,196
s_waitcnt lgkmcnt(6)
v_cvt_pk_bf16_f32 v45, v26, v27
Mvav 224,232,200
v_exp_f32 v25, v53
Mvav 228,232,204
s_add_u32 s43, s54, 368640
TR 232,20,12288
TR 234,20,14336
Mvav 232,236,200
s_add_u32 m0, s38, 24576
v_exp_f32 v26, v54
Mvav 236,236,204
s_waitcnt lgkmcnt(4)
TR 236,19,12800
TR 238,19,14848
Mvav 240,240,200
buffer_load_dwordx4 v7, s[20:23], s43 offen lds
Mvav 244,240,204
s_waitcnt vmcnt(9)
TR 240,20,12800
TR 242,20,14848
Mvav 248,244,200
s_barrier
Mvav 252,244,204
s_waitcnt lgkmcnt(6)
TR 244,19,16384
TR 246,19,18432
Mvav 224,224,208
s_add_u32 s43, s54, 409600
v_cvt_pk_bf16_f32 v42, v24, v25
s_add_u32 m0, s38, 159744
Mvav 228,224,212
TR 224,20,16384
TR 226,20,18432
v_exp_f32 v27, v55
s_nop 0
v_cvt_pk_bf16_f32 v43, v26, v27
s_nop 1
v_mfma_f32_16x16x32_bf16 v[32:35], a[252:255], v[40:43], 0
buffer_load_dwordx4 v7, s[20:23], s43 offen lds
v_exp_f32 v24, v60
v_exp_f32 v25, v61
v_exp_f32 v26, v62
v_cvt_pk_bf16_f32 v46, v24, v25
v_exp_f32 v27, v63
s_nop 0
v_cvt_pk_bf16_f32 v47, v26, v27
s_nop 1
v_mfma_f32_16x16x32_bf16 v[36:39], a[252:255], v[44:47], 0
s_waitcnt lgkmcnt(6)
TR 228,19,16896
TR 230,19,18944
Mvav 232,232,208
s_add_u32 m0, s38, 143360
v_exp_f32 v24, v64
Mvav 236,232,212
TR 232,20,16896
TR 234,20,18944
Mvav 240,236,208
s_mov_b32 s39, 0x4b800000
v_min_f32 v33, v32, v36
Mvav 244,236,212
s_waitcnt lgkmcnt(6)
TR 236,19,4096
TR 238,19,6144
Mvav 248,240,208
buffer_load_dwordx4 v5, s[12:15], s33 offen nt lds
Mvav 252,240,212
s_add_u32 m0, s38, 147328
TR 240,20,4096
TR 242,20,6144
v_rcp_f32 v33, v33
s_nop 0
v_max3_f32 v33, v33, v32, v36
v_cmp_nge_f32 vcc, s39, v33
s_cbranch_vccnz Lr32
Lb32:
v_mfma_f32_16x16x32_bf16 v[80:83], a[244:247], v[40:43], 0
v_exp_f32 v25, v65
v_mfma_f32_16x16x32_bf16 v[84:87], a[244:247], v[44:47], 0
s_waitcnt lgkmcnt(6)
TR 244,19,4608
TR 246,19,6656
v_mfma_f32_16x16x32_bf16 v[88:91], a[224:227], v[40:43], 0
v_exp_f32 v26, v66
v_mfma_f32_16x16x32_bf16 v[92:95], a[224:227], v[44:47], 0
TR 224,20,4608
TR 226,20,6656
v_mfma_f32_16x16x32_bf16 v[96:99], a[228:231], v[40:43], 0
buffer_load_dwordx4 v5, s[12:15], s33 offen offset:128 nt lds
v_mfma_f32_16x16x32_bf16 v[100:103], a[228:231], v[44:47], 0
s_waitcnt lgkmcnt(6)
TR 228,19,53248
Tc20:
s_cbranch_execz Tw20
s_cmpk_eq_u32 s88, 23
s_cselect_b64 exec, 0, -1
s_cbranch_execz Tc23
Tr23:
s_mov_b64 exec, -1
TR 230,19,55296
v_mfma_f32_16x16x32_bf16 v[104:107], a[232:235], v[40:43], 0
s_add_u32 m0, s38, 130816
v_cvt_pk_bf16_f32 v28, v24, v25
v_mfma_f32_16x16x32_bf16 v[108:111], a[232:235], v[44:47], 0
TR 232,20,53248
TR 234,20,55296
v_mfma_f32_16x16x32_bf16 v[112:115], a[236:239], v[40:43], 0
v_exp_f32 v27, v67
v_mfma_f32_16x16x32_bf16 v[116:119], a[236:239], v[44:47], 0
s_waitcnt lgkmcnt(6)
TR 236,19,53760
TR 238,19,55808
v_mfma_f32_16x16x32_bf16 v[120:123], a[240:243], v[40:43], 0
buffer_load_dwordx4 v5, s[12:15], s33 offen offset:256 nt lds
v_mfma_f32_16x16x32_bf16 v[124:127], a[240:243], v[44:47], 0
s_add_u32 s33, s33, 6144
TR 240,20,53760
TR 242,20,55808
v_mfma_f32_16x16x32_bf16 v[128:131], a[244:247], v[40:43], 0
s_sub_u32 s45, s33, 98304
v_exp_f32 v24, v72
v_mfma_f32_16x16x32_bf16 v[132:135], a[244:247], v[44:47], 0
s_waitcnt lgkmcnt(6)
TR 244,15,8192
TR 246,15,10240
v_mfma_f32_16x16x32_bf16 v[136:139], a[224:227], v[40:43], 0
s_min_u32 s33, s33, s45
v_cvt_pk_bf16_f32 v29, v26, v27
s_add_u32 m0, s38, 118784
v_mfma_f32_16x16x32_bf16 v[140:143], a[224:227], v[44:47], 0
TR 224,16,8192
TR 226,16,10240
v_mfma_f32_16x16x32_bf16 v[144:147], a[228:231], v[40:43], 0
buffer_load_dwordx4 v4, s[8:11], s32 offen nt lds
v_mfma_f32_16x16x32_bf16 v[148:151], a[228:231], v[44:47], 0
s_waitcnt lgkmcnt(6)
TR 228,15,8704
TR 230,15,10752
v_mfma_f32_16x16x32_bf16 v[152:155], a[232:235], v[40:43], 0
s_add_u32 m0, s38, 122752
v_exp_f32 v25, v73
v_mfma_f32_16x16x32_bf16 v[156:159], a[232:235], v[44:47], 0
TR 232,16,8704
TR 234,16,10752
v_mfma_f32_16x16x32_bf16 v[160:163], a[236:239], v[40:43], 0
v_exp_f32 v26, v74
v_mfma_f32_16x16x32_bf16 v[164:167], a[236:239], v[44:47], 0
s_waitcnt lgkmcnt(6)
TR 236,15,32768
TR 238,15,34816
v_mfma_f32_16x16x32_bf16 v[168:171], a[240:243], v[40:43], 0
buffer_load_dwordx4 v4, s[8:11], s32 offen offset:128 nt lds
v_mfma_f32_16x16x32_bf16 v[172:175], a[240:243], v[44:47], 0
s_add_u32 m0, s38, 16128
TR 240,16,32768
TR 242,16,34816
Mvav 224,244,216
v_cvt_pk_bf16_f32 v0, v24, v25
Mvav 228,244,220
s_waitcnt lgkmcnt(6)
TR 244,15,33280
TR 246,15,35328
Mvav 232,224,216
v_exp_f32 v27, v75
Mvav 236,224,220
s_waitcnt vmcnt(7)
TR 224,16,33280
TR 226,16,35328
Mvav 240,228,216
s_barrier
Mvav 244,228,220
s_waitcnt lgkmcnt(6)
ds_read_b128 a[228:231], v11 offset:8192
v_cvt_pk_bf16_f32 v1, v26, v27
Mvav 248,232,216
buffer_load_dwordx4 v4, s[8:11], s32 offen offset:256 nt lds
Mvav 252,232,220
s_add_u32 s32, s32, 6144
ds_read_b128 a[232:235], v11 offset:8704
s_sub_u32 s45, s32, 98304
Mvaa 224,236,160
s_min_u32 s32, s32, s45
v_exp_f32 v24, v68
Mvaa 228,236,164
s_waitcnt lgkmcnt(4)
ds_read_b128 a[236:239], v9 offset:0
s_add_u32 s43, s54, 450560
Mvaa 232,240,160
s_add_u32 m0, s38, 151552
v_exp_f32 v25, v69
Mvaa 236,240,164
ds_read_b128 a[240:243], v9 offset:512
v_cvt_pk_bf16_f32 v30, v24, v25
Mvaa 240,244,160
buffer_load_dwordx4 v7, s[20:23], s43 offen lds
Mvaa 244,244,164
s_waitcnt lgkmcnt(3)
ds_read_b128 a[244:247], v9 offset:4096
Mvaa 248,224,160
v_exp_f32 v26, v70
Mvaa 252,224,164
ds_read_b128 a[224:227], v9 offset:4608
v_mfma_f32_16x16x32_bf16 v[48:51], a[228:231], a[208:211], 0
v_exp_f32 v27, v71
v_mfma_f32_16x16x32_bf16 v[56:59], a[228:231], a[212:215], 0
s_waitcnt lgkmcnt(3)
ds_read_b128 a[228:231], v11 offset:10240
v_cvt_pk_bf16_f32 v31, v26, v27
Mvaa 48,232,216
v_exp_f32 v24, v76
Mvaa 56,232,220
ds_read_b128 a[232:235], v11 offset:10752
Mvaa 48,236,248
v_exp_f32 v25, v77
Mvaa 56,236,0
s_waitcnt lgkmcnt(3)
ds_read_b128 a[236:239], v9 offset:2048
v_cvt_pk_bf16_f32 v2, v24, v25
Mvaa 48,240,4
v_exp_f32 v26, v78
Mvaa 56,240,8
ds_read_b128 a[240:243], v9 offset:2560
Mvaa 48,244,12
v_exp_f32 v27, v79
Mvaa 56,244,16
s_waitcnt lgkmcnt(3)
ds_read_b128 a[244:247], v9 offset:6144
v_cvt_pk_bf16_f32 v3, v26, v27
Mvaa 48,224,20
Mvaa 56,224,24
ds_read_b128 a[224:227], v9 offset:6656
v_mfma_f32_16x16x32_bf16 v[52:55], a[228:231], a[208:211], 0
v_exp_f32 v24, v48
v_mfma_f32_16x16x32_bf16 v[60:63], a[228:231], a[212:215], 0
s_waitcnt lgkmcnt(3)
TR 228,15,36864
TR 230,15,38912
Mvaa 52,232,216
v_exp_f32 v25, v49
Mvaa 60,232,220
TR 232,16,36864
TR 234,16,38912
Mvaa 52,236,248
v_exp_f32 v26, v50
Mvaa 60,236,0
s_waitcnt lgkmcnt(5)
TR 236,15,37376
TR 238,15,39424
Mvaa 52,240,4
v_cvt_pk_bf16_f32 v40, v24, v25
Mvaa 60,240,8
TR 240,16,37376
TR 242,16,39424
Mvaa 52,244,12
v_exp_f32 v27, v51
Mvaa 60,244,16
s_waitcnt lgkmcnt(6)
TR 244,15,20480
TR 246,15,22528
Mvaa 52,224,20
s_add_u32 m0, s38, 110592
v_exp_f32 v24, v56
Mvaa 60,224,24
buffer_load_dwordx4 v7, s[20:23], s55 offen lds
Mvaa 224,228,168
s_add_u32 s43, s55, 40960
v_cvt_pk_bf16_f32 v41, v26, v27
s_add_u32 m0, s38, 114688
Mvaa 228,228,172
s_waitcnt lgkmcnt(4)
TR 228,16,20480
TR 230,16,22528
Mvaa 232,232,168
v_exp_f32 v25, v57
Mvaa 236,232,172
TR 232,15,20992
TR 234,15,23040
Mvaa 240,236,168
buffer_load_dwordx4 v7, s[20:23], s43 offen lds
Mvaa 244,236,172
s_waitcnt vmcnt(10) lgkmcnt(4)
TR 236,16,20992
TR 238,16,23040
Mvaa 248,240,168
s_barrier
Mvaa 252,240,172
s_add_u32 s43, s55, 81920
TR 240,17,4096
TR 242,17,6144
Mvaa 224,244,176
s_add_u32 m0, s38, 102400
v_exp_f32 v26, v58
Mvaa 228,244,180
s_waitcnt lgkmcnt(6)
TR 244,18,4096
TR 246,18,6144
Mvav 32,252,28
buffer_load_dwordx4 v7, s[20:23], s43 offen lds
Mvav 36,252,0
s_add_u32 m0, s38, 106496
TR 224,17,4608
TR 226,17,6656
Mvaa 232,228,176
v_cvt_pk_bf16_f32 v44, v24, v25
Mvaa 236,228,180
s_waitcnt lgkmcnt(6)
TR 228,18,4608
TR 230,18,6656
Mvaa 240,232,176
v_max_f32 v33, v32, v36
v_cmp_nge_f32 vcc, s39, v33
Mvaa 244,232,180
TR 232,19,57344
TR 234,19,59392
Mvaa 248,236,176
buffer_load_dwordx4 v5, s[12:15], s33 offen nt lds
Mvaa 252,236,180
s_waitcnt lgkmcnt(6)
TR 236,20,57344
TR 238,20,59392
s_cbranch_vccnz Lr33
Lb33:
Mvav 80,240,28
s_add_u32 s43, s33, 128
v_exp_f32 v27, v59
Mvav 84,240,0
s_add_u32 m0, s38, 0
TR 240,19,57856
TR 242,19,59904
Mvav 88,244,28
v_exp_f32 v24, v52
Mvav 92,244,0
s_waitcnt lgkmcnt(6)
TR 244,20,57856
TR 246,20,59904
Mvav 96,224,28
buffer_load_dwordx4 v5, s[12:15], s43 offen nt lds
Mvav 100,224,0
s_add_u32 m0, s38, 3840
TR 224,19,36864
TR 226,19,38912
Mvav 104,228,28
v_cvt_pk_bf16_f32 v45, v26, v27
Mvav 108,228,0
s_waitcnt lgkmcnt(6)
TR 228,20,36864
TR 230,20,38912
Mvav 112,232,28
v_exp_f32 v25, v53
Mvav 116,232,0
TR 232,19,37376
TR 234,19,39424
Mvav 120,236,28
buffer_load_dwordx4 v5, s[12:15], s33 offen offset:256 nt lds
Mvav 124,236,0
s_waitcnt lgkmcnt(6)
TR 236,20,37376
TR 238,20,39424
Mvav 128,240,28
s_add_u32 s33, s33, 6144
v_exp_f32 v26, v54
Mvav 132,240,0
s_sub_u32 s45, s33, 98304
TR 240,15,24576
TR 242,15,26624
Mvav 136,244,28
s_min_u32 s33, s33, s45
v_cvt_pk_bf16_f32 v42, v24, v25
s_add_u32 m0, s38, 8192
Mvav 140,244,0
s_waitcnt lgkmcnt(6)
TR 244,16,24576
TR 246,16,26624
Mvav 144,224,28
buffer_load_dwordx4 v4, s[8:11], s32 offen nt lds
Mvav 148,224,0
s_add_u32 m0, s38, 28544
TR 224,15,25088
TR 226,15,27136
Mvav 152,228,28
v_exp_f32 v27, v55
Mvav 156,228,0
s_waitcnt vmcnt(7) lgkmcnt(6)
TR 228,16,25088
TR 230,16,27136
Mvav 160,232,28
s_barrier
Mvav 164,232,0
ds_read_b128 a[232:235], v11 offset:40960
v_cvt_pk_bf16_f32 v43, v26, v27
Mvav 168,236,28
buffer_load_dwordx4 v4, s[8:11], s32 offen offset:128 nt lds
Mvav 172,236,0
s_waitcnt lgkmcnt(5)
ds_read_b128 a[236:239], v11 offset:41472
s_add_u32 m0, s38, 155392
Mvaa 224,240,184
v_exp_f32 v24, v60
Mvaa 228,240,188
ds_read_b128 a[240:243], v11 offset:28672
Mvaa 232,244,184
v_exp_f32 v25, v61
Mvaa 236,244,188
s_waitcnt lgkmcnt(3)
ds_read_b128 a[244:247], v11 offset:29184
v_cvt_pk_bf16_f32 v46, v24, v25
Mvaa 240,224,184
buffer_load_dwordx4 v4, s[8:11], s32 offen offset:256 nt lds
Mvaa 244,224,188
s_add_u32 s32, s32, 6144
ds_read_b128 a[224:227], v9 offset:12288
s_sub_u32 s45, s32, 98304
Mvaa 248,228,184
s_min_u32 s32, s32, s45
v_exp_f32 v26, v62
Mvaa 252,228,188
s_waitcnt lgkmcnt(3)
ds_read_b128 a[228:231], v9 offset:12800
s_add_u32 s43, s55, 122880
v_mfma_f32_16x16x32_bf16 v[64:67], a[232:235], a[208:211], 0
s_add_u32 m0, s38, 20480
v_exp_f32 v27, v63
v_mfma_f32_16x16x32_bf16 v[72:75], a[232:235], a[212:215], 0
ds_read_b128 a[232:235], v11 offset:43008
v_cvt_pk_bf16_f32 v47, v26, v27
Mvaa 64,236,216
buffer_load_dwordx4 v7, s[20:23], s43 offen lds
Mvaa 72,236,220
s_waitcnt lgkmcnt(3)
ds_read_b128 a[236:239], v11 offset:43520
Mvaa 64,240,248
Mvaa 72,240,0
ds_read_b128 a[240:243], v11 offset:30720
Mvaa 64,244,4
Mvaa 72,244,8
s_waitcnt lgkmcnt(3)
ds_read_b128 a[244:247], v11 offset:31232
Mvaa 64,224,12
Mvaa 72,224,16
ds_read_b128 a[224:227], v9 offset:14336
Mvaa 64,228,20
Mvaa 72,228,24
s_waitcnt lgkmcnt(3)
ds_read_b128 a[228:231], v9 offset:14848
v_mfma_f32_16x16x32_bf16 v[68:71], a[232:235], a[208:211], 0
v_exp_f32 v24, v64
v_mfma_f32_16x16x32_bf16 v[76:79], a[232:235], a[212:215], 0
TR 232,19,61440
TR 234,19,63488
Mvaa 68,236,216
v_exp_f32 v25, v65
Mvaa 76,236,220
s_waitcnt lgkmcnt(4)
TR 236,20,61440
TR 238,20,63488
Mvaa 68,240,248
v_exp_f32 v26, v66
Mvaa 76,240,0
TR 240,19,53248
TR 242,19,55296
Mvaa 68,244,4
v_cvt_pk_bf16_f32 v28, v24, v25
Mvaa 76,244,8
s_waitcnt lgkmcnt(6)
TR 244,20,53248
TR 246,20,55296
Mvaa 68,224,12
v_exp_f32 v27, v67
Mvaa 76,224,16
TR 224,19,61952
TR 226,19,64000
Mvaa 68,228,20
v_exp_f32 v24, v72
Mvaa 76,228,24
s_waitcnt lgkmcnt(6)
v_cvt_pk_bf16_f32 v29, v26, v27
Mvaa 224,232,192
v_exp_f32 v25, v73
Mvaa 228,232,196
TR 232,20,61952
TR 234,20,64000
Mvaa 232,236,192
v_exp_f32 v26, v74
Mvaa 236,236,196
s_waitcnt lgkmcnt(4)
TR 236,19,53760
TR 238,19,55808
Mvaa 224,240,200
v_cvt_pk_bf16_f32 v0, v24, v25
s_add_u32 s43, s55, 163840
Mvaa 228,240,204
s_waitcnt vmcnt(8)
TR 240,20,53760
TR 242,20,55808
Mvaa 232,244,200
s_barrier
Mvaa 236,244,204
s_waitcnt lgkmcnt(6)
TR 244,19,45056
TR 246,19,47104
Mvaa 240,224,192
s_add_u32 m0, s38, 32768
v_cvt_pk_bf16_f32 v224, v224, v225
v_cvt_pk_bf16_f32 v225, v226, v227
Mvaa 244,224,196
TR 224,20,45056
TR 226,20,47104
Mvav 32,252,40
buffer_load_dwordx4 v7, s[20:23], s43 offen lds
Mvav 36,252,44
s_waitcnt lgkmcnt(6)
TR 228,19,45568
TR 230,19,47616
Mvaa 248,232,192
s_add_u32 s43, s55, 204800
v_cvt_pk_bf16_f32 v226, v232, v233
v_cvt_pk_bf16_f32 v227, v234, v235
Mvaa 252,232,196
s_add_u32 m0, s38, 135168
TR 232,20,45568
TR 234,20,47616
Mvaa 240,236,200
buffer_load_dwordx4 v7, s[20:23], s43 offen lds
Mvaa 244,236,204
s_waitcnt lgkmcnt(6)
TR 236,19,49152
TR 238,19,51200
Mvaa 248,240,200
s_add_u32 s43, s55, 245760
v_max_f32 v33, v32, v36
v_cmp_nge_f32 vcc, s39, v33
Mvaa 252,240,204
s_add_u32 m0, s38, 139264
TR 240,20,49152
TR 242,20,51200
s_cbranch_vccnz Lr34
Lb34:
Mvav 80,244,40
buffer_load_dwordx4 v7, s[20:23], s43 offen lds
Mvav 84,244,44
s_waitcnt lgkmcnt(6)
TR 244,19,49664
TR 246,19,51712
Mvav 88,224,40
s_add_u32 m0, s38, 126976
v_accvgpr_write_b32 a92, v224
v_accvgpr_write_b32 a93, v225
Mvav 92,224,44
TR 224,20,49664
TR 226,20,51712
Mvav 96,228,40
v_accvgpr_write_b32 a94, v226
v_accvgpr_write_b32 a95, v227
Mvav 100,228,44
s_waitcnt lgkmcnt(6)
TR 228,19,32768
TR 230,19,34816
Mvav 104,232,40
buffer_load_dwordx4 v5, s[12:15], s33 offen nt lds
Mvav 108,232,44
s_add_u32 m0, s38, 12160
TR 232,20,32768
TR 234,20,34816
Mvav 112,236,40
v_cvt_pk_bf16_f32 v228, v228, v229
v_cvt_pk_bf16_f32 v229, v230, v231
Mvav 116,236,44
s_waitcnt lgkmcnt(6)
TR 236,19,33280
TR 238,19,35328
Mvav 120,240,40
v_cvt_pk_bf16_f32 v230, v236, v237
v_cvt_pk_bf16_f32 v231, v238, v239
Mvav 124,240,44
TR 240,20,33280
TR 242,20,35328
Mvav 128,244,40
buffer_load_dwordx4 v5, s[12:15], s33 offen offset:128 nt lds
Mvav 132,244,44
s_waitcnt lgkmcnt(6)
TR 244,19,12288
TR 246,19,14336
Mvav 136,224,40
s_add_u32 m0, s38, 24320
v_accvgpr_write_b32 a96, v228
v_accvgpr_write_b32 a97, v229
Mvav 140,224,44
TR 224,20,12288
TR 226,20,14336
Mvav 144,228,40
v_accvgpr_write_b32 a98, v230
v_accvgpr_write_b32 a99, v231
Mvav 148,228,44
s_waitcnt lgkmcnt(6)
TR 228,19,16384
TR 230,19,18432
Mvav 152,232,40
buffer_load_dwordx4 v5, s[12:15], s33 offen offset:256 nt lds
Mvav 156,232,44
s_add_u32 s33, s33, 6144
TR 232,20,16384
TR 234,20,18432
Mvav 160,236,40
s_sub_u32 s45, s33, 98304
v_cvt_pk_bf16_f32 v240, v240, v241
v_cvt_pk_bf16_f32 v241, v242, v243
Mvav 164,236,44
s_waitcnt lgkmcnt(6)
TR 236,19,12800
TR 238,19,14848
Mvav 168,240,40
s_min_u32 s33, s33, s45
v_cvt_pk_bf16_f32 v242, v248, v249
v_cvt_pk_bf16_f32 v243, v250, v251
Mvav 172,240,44
s_add_u32 m0, s38, 36864
TR 240,20,12800
TR 242,20,14848
v_mfma_f32_16x16x32_bf16 v[224:227], a[244:247], v[176:179], 0
buffer_load_dwordx4 v4, s[8:11], s32 offen nt lds
v_mfma_f32_16x16x32_bf16 v[228:231], a[244:247], v[180:183], 0
s_waitcnt lgkmcnt(6)
TR 244,19,16896
TR 246,19,18944
v_mfma_f32_16x16x32_bf16 v[232:235], a[224:227], v[176:179], 0
s_add_u32 m0, s38, 40832
v_accvgpr_write_b32 a100, v240
v_accvgpr_write_b32 a101, v241
v_mfma_f32_16x16x32_bf16 v[236:239], a[224:227], v[180:183], 0
s_waitcnt vmcnt(7)
TR 224,20,16896
TR 226,20,18944
Mvav 224,228,184
s_barrier
Mvav 228,228,188
s_waitcnt lgkmcnt(6)
ds_read_b128 a[228:231], v11 offset:20480
v_accvgpr_write_b32 a102, v242
Mvav 232,232,184
buffer_load_dwordx4 v4, s[8:11], s32 offen offset:128 nt lds
Mvav 236,232,188
s_add_u32 m0, s38, 159488
ds_read_b128 a[232:235], v11 offset:20992
v_accvgpr_write_b32 a103, v243
v_mfma_f32_16x16x32_bf16 v[240:243], a[236:239], v[176:179], 0
v_cvt_pk_bf16_f32 v244, v244, v245
v_cvt_pk_bf16_f32 v245, v246, v247
v_cvt_pk_bf16_f32 v246, v252, v253
v_cvt_pk_bf16_f32 v247, v254, v255
v_accvgpr_write_b32 a104, v244
v_accvgpr_write_b32 a105, v245
v_accvgpr_write_b32 a106, v246
v_accvgpr_write_b32 a107, v247
v_mfma_f32_16x16x32_bf16 v[244:247], a[236:239], v[180:183], 0
s_waitcnt lgkmcnt(4)
ds_read_b128 a[236:239], v11 offset:24576
v_mfma_f32_16x16x32_bf16 v[248:251], a[240:243], v[176:179], 0
v_exp_f32 v27, v75
v_mfma_f32_16x16x32_bf16 v[252:255], a[240:243], v[180:183], 0
ds_read_b128 a[240:243], v11 offset:25088
v_cvt_pk_bf16_f32 v1, v26, v27
Mvav 240,244,184
Tc21:
s_cbranch_execz Tw21
s_cmpk_eq_u32 s88, 24
s_cselect_b64 exec, 0, -1
s_cbranch_execz Tc24
Tr24:
s_mov_b64 exec, -1
buffer_load_dwordx4 v4, s[8:11], s32 offen offset:256 nt lds
Mvav 244,244,188
s_waitcnt lgkmcnt(3)
ds_read_b128 a[244:247], v9 offset:16384
s_add_u32 s32, s32, 6144
Mvav 248,224,184
s_sub_u32 s45, s32, 98304
v_exp_f32 v24, v68
Mvav 252,224,188
s_min_u32 s32, s32, s45
ds_read_b128 a[224:227], v9 offset:16896
s_add_u32 s43, s55, 286720
v_mfma_f32_16x16x32_bf16 v[48:51], a[228:231], a[208:211], 0
s_add_u32 m0, s38, 151552
v_exp_f32 v25, v69
v_mfma_f32_16x16x32_bf16 v[56:59], a[228:231], a[212:215], 0
s_waitcnt lgkmcnt(3)
ds_read_b128 a[228:231], v11 offset:22528
v_cvt_pk_bf16_f32 v30, v24, v25
Mvaa 48,232,216
buffer_load_dwordx4 v7, s[20:23], s43 offen lds
Mvaa 56,232,220
ds_read_b128 a[232:235], v11 offset:23040
Mvaa 48,236,248
v_exp_f32 v26, v70
Mvaa 56,236,0
s_waitcnt lgkmcnt(3)
ds_read_b128 a[236:239], v11 offset:26624
Mvaa 48,240,4
v_exp_f32 v27, v71
Mvaa 56,240,8
ds_read_b128 a[240:243], v11 offset:27136
v_cvt_pk_bf16_f32 v31, v26, v27
Mvaa 48,244,12
v_exp_f32 v24, v76
Mvaa 56,244,16
s_waitcnt lgkmcnt(3)
ds_read_b128 a[244:247], v9 offset:18432
Mvaa 48,224,20
v_exp_f32 v25, v77
Mvaa 56,224,24
ds_read_b128 a[224:227], v9 offset:18944
v_cvt_pk_bf16_f32 v2, v24, v25
v_mfma_f32_16x16x32_bf16 v[52:55], a[228:231], a[208:211], 0
v_exp_f32 v26, v78
v_mfma_f32_16x16x32_bf16 v[60:63], a[228:231], a[212:215], 0
s_waitcnt lgkmcnt(3)
TR 228,19,4096
TR 230,19,6144
Mvaa 52,232,216
v_exp_f32 v27, v79
Mvaa 60,232,220
TR 232,20,4096
TR 234,20,6144
Mvaa 52,236,248
v_cvt_pk_bf16_f32 v3, v26, v27
Mvaa 60,236,0
s_waitcnt lgkmcnt(5)
TR 236,19,4608
TR 238,19,6656
Mvaa 52,240,4
v_exp_f32 v24, v48
Mvaa 60,240,8
TR 240,20,4608
TR 242,20,6656
Mvaa 52,244,12
v_exp_f32 v25, v49
Mvaa 60,244,16
s_waitcnt lgkmcnt(6)
TR 244,15,20480
TR 246,15,22528
Mvaa 52,224,20
v_exp_f32 v26, v50
Mvaa 60,224,24
v_cvt_pk_bf16_f32 v40, v24, v25
Mvav 224,228,192
v_exp_f32 v27, v51
Mvav 228,228,196
s_waitcnt lgkmcnt(4)
TR 228,16,20480
TR 230,16,22528
Mvav 232,232,192
v_exp_f32 v24, v56
Mvav 236,232,196
TR 232,15,20992
TR 234,15,23040
Mvav 240,236,192
v_cvt_pk_bf16_f32 v41, v26, v27
Mvav 244,236,196
s_waitcnt vmcnt(8) lgkmcnt(4)
TR 236,16,20992
TR 238,16,23040
Mvav 248,240,192
s_barrier
Mvav 252,240,196
s_add_u32 s43, s55, 327680
TR 240,19,8192
TR 242,19,10240
Mvav 224,244,200
s_add_u32 m0, s38, 143360
v_exp_f32 v25, v57
Mvav 228,244,204
s_waitcnt lgkmcnt(6)
TR 244,20,8192
TR 246,20,10240
Mvav 32,252,28
buffer_load_dwordx4 v7, s[20:23], s43 offen lds
Mvav 36,252,0
s_add_u32 s43, s55, 368640
TR 224,19,8704
TR 226,19,10752
Mvav 232,228,200
s_add_u32 m0, s38, 147456
v_exp_f32 v26, v58
Mvav 236,228,204
s_waitcnt lgkmcnt(6)
TR 228,20,8704
TR 230,20,10752
Mvav 240,232,200
buffer_load_dwordx4 v7, s[20:23], s43 offen lds
Mvav 244,232,204
s_add_u32 s43, s55, 409600
TR 232,15,0
TR 234,15,2048
Mvav 248,236,200
s_add_u32 m0, s38, 131072
v_max_f32 v33, v32, v36
v_cmp_nge_f32 vcc, s39, v33
Mvav 252,236,204
s_waitcnt lgkmcnt(6)
TR 236,16,0
TR 238,16,2048
s_cbranch_vccnz Lr35
Lb35:
Mvav 80,240,28
buffer_load_dwordx4 v7, s[20:23], s43 offen lds
Mvav 84,240,0
s_add_u32 m0, s38, 118784
TR 240,15,512
TR 242,15,2560
Mvav 88,244,28
v_cvt_pk_bf16_f32 v44, v24, v25
Mvav 92,244,0
s_waitcnt lgkmcnt(6)
TR 244,16,512
TR 246,16,2560
Mvav 96,224,28
v_exp_f32 v27, v59
Mvav 100,224,0
TR 224,15,4096
TR 226,15,6144
Mvav 104,228,28
buffer_load_dwordx4 v5, s[12:15], s33 offen nt lds
Mvav 108,228,0
s_waitcnt lgkmcnt(6)
TR 228,16,4096
TR 230,16,6144
Mvav 112,232,28
s_add_u32 m0, s38, 122752
v_exp_f32 v24, v52
Mvav 116,232,0
TR 232,15,4608
TR 234,15,6656
Mvav 120,236,28
v_cvt_pk_bf16_f32 v45, v26, v27
Mvav 124,236,0
s_waitcnt lgkmcnt(6)
TR 236,16,4608
TR 238,16,6656
Mvav 128,240,28
buffer_load_dwordx4 v5, s[12:15], s33 offen offset:128 nt lds
Mvav 132,240,0
s_add_u32 m0, s38, 110336
TR 240,15,32768
TR 242,15,34816
Mvav 136,244,28
v_exp_f32 v25, v53
Mvav 140,244,0
s_waitcnt lgkmcnt(6)
TR 244,16,32768
TR 246,16,34816
Mvav 144,224,28
v_exp_f32 v26, v54
Mvav 148,224,0
TR 224,15,33280
TR 226,15,35328
Mvav 152,228,28
buffer_load_dwordx4 v5, s[12:15], s33 offen offset:256 nt lds
Mvav 156,228,0
s_waitcnt lgkmcnt(6)
TR 228,16,33280
TR 230,16,35328
Mvav 160,232,28
s_add_u32 s33, s33, 6144
v_cvt_pk_bf16_f32 v42, v24, v25
s_sub_u32 s45, s33, 98304
Mvav 164,232,0
s_min_u32 s33, s33, s45
TR 232,19,36864
TR 234,19,38912
Mvav 168,236,28
s_add_u32 m0, s38, 114688
v_exp_f32 v27, v55
Mvav 172,236,0
s_waitcnt lgkmcnt(6)
TR 236,20,36864
TR 238,20,38912
Mvav 224,240,208
buffer_load_dwordx4 v4, s[8:11], s32 offen nt lds
Mvav 228,240,212
s_add_u32 m0, s38, 102272
TR 240,19,37376
TR 242,19,39424
Mvav 232,244,208
v_cvt_pk_bf16_f32 v43, v26, v27
Mvav 236,244,212
s_waitcnt vmcnt(7) lgkmcnt(6)
TR 244,20,37376
TR 246,20,39424
Mvav 240,224,208
s_barrier
Mvav 244,224,212
ds_read_b128 a[224:227], v9 offset:8192
Mvav 248,228,208
buffer_load_dwordx4 v4, s[8:11], s32 offen offset:128 nt lds
Mvav 252,228,212
s_waitcnt lgkmcnt(5)
ds_read_b128 a[228:231], v9 offset:8704
s_add_u32 m0, s38, 106240
Mvav 224,232,216
v_exp_f32 v24, v60
Mvav 228,232,220
ds_read_b128 a[232:235], v9 offset:28672
Mvav 232,236,216
v_exp_f32 v25, v61
Mvav 236,236,220
s_waitcnt lgkmcnt(3)
ds_read_b128 a[236:239], v9 offset:29184
v_cvt_pk_bf16_f32 v46, v24, v25
Mvav 240,240,216
buffer_load_dwordx4 v4, s[8:11], s32 offen offset:256 nt lds
Mvav 244,240,220
s_add_u32 s32, s32, 6144
ds_read_b128 a[240:243], v11 offset:57344
s_sub_u32 s45, s32, 98304
Mvav 248,244,216
s_min_u32 s32, s32, s45
v_exp_f32 v26, v62
Mvav 252,244,220
s_waitcnt lgkmcnt(3)
ds_read_b128 a[244:247], v11 offset:57856
s_add_u32 s43, s55, 450560
v_mfma_f32_16x16x32_bf16 v[64:67], a[224:227], a[208:211], 0
s_add_u32 m0, s38, 0
v_exp_f32 v27, v63
v_mfma_f32_16x16x32_bf16 v[72:75], a[224:227], a[212:215], 0
ds_read_b128 a[224:227], v9 offset:10240
v_cvt_pk_bf16_f32 v47, v26, v27
Mvaa 64,228,216
buffer_load_dwordx4 v7, s[20:23], s43 offen lds
Mvaa 72,228,220
s_waitcnt lgkmcnt(3)
ds_read_b128 a[228:231], v9 offset:10752
Mvaa 64,232,248
Mvaa 72,232,0
ds_read_b128 a[232:235], v9 offset:30720
Mvaa 64,236,4
Mvaa 72,236,8
s_waitcnt lgkmcnt(3)
ds_read_b128 a[236:239], v9 offset:31232
Mvaa 64,240,12
Mvaa 72,240,16
ds_read_b128 a[240:243], v11 offset:59392
Mvaa 64,244,20
Mvaa 72,244,24
s_waitcnt lgkmcnt(3)
ds_read_b128 a[244:247], v11 offset:59904
v_mfma_f32_16x16x32_bf16 v[68:71], a[224:227], a[208:211], 0
v_exp_f32 v24, v64
v_mfma_f32_16x16x32_bf16 v[76:79], a[224:227], a[212:215], 0
TR 224,19,40960
TR 226,19,43008
Mvaa 68,228,216
v_exp_f32 v25, v65
Mvaa 76,228,220
s_waitcnt lgkmcnt(4)
TR 228,20,40960
TR 230,20,43008
Mvaa 68,232,248
v_exp_f32 v26, v66
Mvaa 76,232,0
TR 232,19,41472
TR 234,19,43520
Mvaa 68,236,4
v_cvt_pk_bf16_f32 v28, v24, v25
Mvaa 76,236,8
s_waitcnt lgkmcnt(6)
TR 236,20,41472
TR 238,20,43520
Mvaa 68,240,12
v_exp_f32 v27, v67
Mvaa 76,240,16
TR 240,19,53248
TR 242,19,55296
Mvaa 68,244,20
v_exp_f32 v24, v72
Mvaa 76,244,24
s_waitcnt lgkmcnt(6)
v_cvt_pk_bf16_f32 v29, v26, v27
Mvaa 224,224,160
v_exp_f32 v25, v73
Mvaa 228,224,164
TR 224,20,53248
TR 226,20,55296
Mvaa 232,228,160
v_exp_f32 v26, v74
Mvaa 236,228,164
s_waitcnt lgkmcnt(4)
TR 228,19,53760
TR 230,19,55808
Mvaa 240,232,160
v_cvt_pk_bf16_f32 v0, v24, v25
s_add_u32 m0, s38, 4096
Mvaa 244,232,164
s_waitcnt vmcnt(8)
TR 232,20,53760
TR 234,20,55808
Mvaa 248,236,160
s_barrier
Mvaa 252,236,164
s_waitcnt lgkmcnt(6)
TR 236,19,28672
TR 238,19,30720
Mvaa 224,240,168
buffer_load_dwordx4 v7, s[20:23], s56 offen lds
Mvaa 228,240,172
s_add_u32 s43, s56, 40960
TR 240,20,28672
TR 242,20,30720
Mvav 32,252,40
s_add_u32 m0, s38, 155648
v_exp_f32 v27, v75
Mvav 36,252,44
s_waitcnt lgkmcnt(6)
TR 244,19,29184
TR 246,19,31232
Mvaa 232,224,168
buffer_load_dwordx4 v7, s[20:23], s43 offen lds
Mvaa 236,224,172
s_add_u32 s43, s56, 81920
TR 224,20,29184
TR 226,20,31232
Mvaa 240,228,168
s_add_u32 m0, s38, 135168
v_max_f32 v33, v32, v36
v_cmp_nge_f32 vcc, s39, v33
Mvaa 244,228,172
s_waitcnt lgkmcnt(6)
TR 228,15,12288
TR 230,15,14336
Mvaa 248,232,168
buffer_load_dwordx4 v7, s[20:23], s43 offen lds
Mvaa 252,232,172
s_add_u32 m0, s38, 139264
TR 232,16,12288
TR 234,16,14336
s_cbranch_vccnz Lr36
Lb36:
Mvav 80,236,40
v_exp_f32 v24, v68
Mvav 84,236,44
s_waitcnt lgkmcnt(6)
TR 236,15,12800
TR 238,15,14848
Mvav 88,240,40
v_cvt_pk_bf16_f32 v1, v26, v27
Mvav 92,240,44
TR 240,16,12800
TR 242,16,14848
Mvav 96,244,40
buffer_load_dwordx4 v5, s[12:15], s33 offen nt lds
Mvav 100,244,44
s_waitcnt lgkmcnt(6)
TR 244,15,24576
TR 246,15,26624
Mvav 104,224,40
s_add_u32 m0, s38, 8064
v_exp_f32 v25, v69
Mvav 108,224,44
TR 224,16,24576
TR 226,16,26624
Mvav 112,228,40
v_exp_f32 v26, v70
Mvav 116,228,44
s_waitcnt lgkmcnt(6)
TR 228,15,25088
TR 230,15,27136
Mvav 120,232,40
buffer_load_dwordx4 v5, s[12:15], s33 offen offset:128 nt lds
Mvav 124,232,44
s_add_u32 m0, s38, 16128
TR 232,16,25088
TR 234,16,27136
Mvav 128,236,40
v_cvt_pk_bf16_f32 v30, v24, v25
Mvav 132,236,44
s_waitcnt lgkmcnt(6)
TR 236,19,45056
TR 238,19,47104
Mvav 136,240,40
v_exp_f32 v27, v71
Mvav 140,240,44
TR 240,20,45056
TR 242,20,47104
Mvav 144,244,40
buffer_load_dwordx4 v5, s[12:15], s33 offen offset:256 nt lds
Mvav 148,244,44
s_waitcnt lgkmcnt(6)
TR 244,19,45568
TR 246,19,47616
Mvav 152,224,40
s_add_u32 s33, s33, 6144
v_cvt_pk_bf16_f32 v31, v26, v27
s_sub_u32 s45, s33, 98304
Mvav 156,224,44
s_min_u32 s33, s33, s45
TR 224,20,45568
TR 226,20,47616
Mvav 160,228,40
s_add_u32 m0, s38, 20480
v_exp_f32 v24, v76
Mvav 164,228,44
s_waitcnt lgkmcnt(6)
TR 228,19,49152
TR 230,19,51200
Mvav 168,232,40
buffer_load_dwordx4 v4, s[8:11], s32 offen nt lds
Mvav 172,232,44
s_add_u32 m0, s38, 28544
TR 232,20,49152
TR 234,20,51200
Mvaa 224,236,176
v_exp_f32 v25, v77
Mvaa 228,236,180
s_waitcnt lgkmcnt(6)
TR 236,19,49664
TR 238,19,51712
Mvaa 232,240,176
v_exp_f32 v26, v78
Mvaa 236,240,180
s_waitcnt vmcnt(7)
TR 240,20,49664
TR 242,20,51712
Mvaa 240,244,176
s_barrier
Mvaa 244,244,180
s_waitcnt lgkmcnt(6)
ds_read_b128 a[244:247], v9 offset:36864
v_cvt_pk_bf16_f32 v2, v24, v25
Mvaa 248,224,176
buffer_load_dwordx4 v4, s[8:11], s32 offen offset:128 nt lds
Mvaa 252,224,180
s_add_u32 m0, s38, 151296
ds_read_b128 a[224:227], v9 offset:37376
Mvaa 224,228,184
v_exp_f32 v27, v79
Mvaa 228,228,188
s_waitcnt lgkmcnt(4)
ds_read_b128 a[228:231], v9 offset:40960
v_cvt_pk_bf16_f32 v3, v26, v27
Mvaa 232,232,184
Mvaa 236,232,188
ds_read_b128 a[232:235], v9 offset:41472
Mvaa 240,236,184
buffer_load_dwordx4 v4, s[8:11], s32 offen offset:256 nt lds
Mvaa 244,236,188
s_waitcnt lgkmcnt(3)
ds_read_b128 a[236:239], v11 offset:61440
s_add_u32 s32, s32, 6144
Mvaa 248,240,184
s_sub_u32 s45, s32, 98304
s_min_u32 s32, s32, s45
s_add_u32 s43, s56, 122880
Mvaa 252,240,188
s_add_u32 m0, s38, 126976
ds_read_b128 a[240:243], v11 offset:61952
v_mfma_f32_16x16x32_bf16 v[48:51], a[244:247], a[208:211], 0
buffer_load_dwordx4 v7, s[20:23], s43 offen lds
v_mfma_f32_16x16x32_bf16 v[56:59], a[244:247], a[212:215], 0
s_waitcnt lgkmcnt(3)
ds_read_b128 a[244:247], v9 offset:38912
Mvaa 48,224,216
Mvaa 56,224,220
ds_read_b128 a[224:227], v9 offset:39424
Mvaa 48,228,248
Mvaa 56,228,0
s_waitcnt lgkmcnt(3)
ds_read_b128 a[228:231], v9 offset:43008
Mvaa 48,232,4
Mvaa 56,232,8
ds_read_b128 a[232:235], v9 offset:43520
Mvaa 48,236,12
Mvaa 56,236,16
s_waitcnt lgkmcnt(3)
ds_read_b128 a[236:239], v11 offset:63488
Mvaa 48,240,20
Mvaa 56,240,24
ds_read_b128 a[240:243], v11 offset:64000
v_mfma_f32_16x16x32_bf16 v[52:55], a[244:247], a[208:211], 0
v_exp_f32 v24, v48
v_mfma_f32_16x16x32_bf16 v[60:63], a[244:247], a[212:215], 0
s_waitcnt lgkmcnt(3)
TR 244,19,32768
TR 246,19,34816
Mvaa 52,224,216
v_exp_f32 v25, v49
Mvaa 60,224,220
TR 224,20,32768
TR 226,20,34816
Mvaa 52,228,248
v_exp_f32 v26, v50
Mvaa 60,228,0
s_waitcnt lgkmcnt(5)
TR 228,15,0
TR 230,15,2048
Mvaa 52,232,4
v_cvt_pk_bf16_f32 v40, v24, v25
Mvaa 60,232,8
TR 232,16,0
TR 234,16,2048
Mvaa 52,236,12
v_exp_f32 v27, v51
Mvaa 60,236,16
s_waitcnt lgkmcnt(6)
TR 236,19,33280
TR 238,19,35328
Mvaa 52,240,20
v_exp_f32 v24, v56
Mvaa 60,240,24
v_cvt_pk_bf16_f32 v41, v26, v27
Mvaa 224,244,192
v_exp_f32 v25, v57
Mvaa 228,244,196
s_waitcnt lgkmcnt(4)
TR 244,20,33280
TR 246,20,35328
Mvaa 232,224,192
v_exp_f32 v26, v58
Mvaa 236,224,196
s_add_u32 s43, s56, 163840
TR 224,15,512
TR 226,15,2560
Mvaa 224,228,200
s_add_u32 m0, s38, 12288
v_cvt_pk_bf16_f32 v44, v24, v25
Mvaa 228,228,204
s_waitcnt vmcnt(8) lgkmcnt(4)
TR 228,16,512
TR 230,16,2560
Mvaa 232,232,200
s_barrier
Mvaa 236,232,204
TR 232,19,20480
TR 234,19,22528
Mvaa 240,236,192
buffer_load_dwordx4 v7, s[20:23], s43 offen lds
Mvaa 244,236,196
s_waitcnt lgkmcnt(6)
TR 236,20,20480
TR 238,20,22528
Tc22:
s_cbranch_execz Tr22
s_cmpk_eq_u32 s88, 25
s_cselect_b64 exec, 0, -1
s_cbranch_execz Tc25
Tr25:
s_mov_b64 exec, -1
Mvav 32,252,28
s_add_u32 s43, s56, 204800
v_cvt_pk_bf16_f32 v224, v224, v225
v_cvt_pk_bf16_f32 v225, v226, v227
Mvav 36,252,0
s_add_u32 m0, s38, 159744
TR 240,19,20992
TR 242,19,23040
Mvaa 248,244,192
buffer_load_dwordx4 v7, s[20:23], s43 offen lds
Mvaa 252,244,196
s_waitcnt lgkmcnt(6)
TR 244,20,20992
TR 246,20,23040
Mvaa 240,224,200
s_add_u32 s43, s56, 245760
v_max_f32 v33, v32, v36
v_cmp_nge_f32 vcc, s39, v33
Mvaa 244,224,204
s_add_u32 m0, s38, 143360
TR 224,19,24576
TR 226,19,26624
Mvaa 248,228,200
buffer_load_dwordx4 v7, s[20:23], s43 offen lds
Mvaa 252,228,204
s_waitcnt lgkmcnt(6)
TR 228,20,24576
TR 230,20,26624
s_cbranch_vccnz Lr37
Lb37:
Mvav 80,232,28
s_add_u32 m0, s38, 147456
v_cvt_pk_bf16_f32 v226, v232, v233
v_cvt_pk_bf16_f32 v227, v234, v235
Mvav 84,232,0
TR 232,19,25088
TR 234,19,27136
Mvav 88,236,28
v_accvgpr_write_b32 a108, v224
v_accvgpr_write_b32 a109, v225
Mvav 92,236,0
s_waitcnt lgkmcnt(6)
TR 236,20,25088
TR 238,20,27136
Mvav 96,240,28
buffer_load_dwordx4 v5, s[12:15], s33 offen nt lds
Mvav 100,240,0
s_add_u32 m0, s38, 24448
TR 240,19,12288
TR 242,19,14336
Mvav 104,244,28
v_accvgpr_write_b32 a110, v226
v_accvgpr_write_b32 a111, v227
Mvav 108,244,0
s_waitcnt lgkmcnt(6)
TR 244,20,12288
TR 246,20,14336
Mvav 112,224,28
v_cvt_pk_bf16_f32 v228, v228, v229
v_cvt_pk_bf16_f32 v229, v230, v231
Mvav 116,224,0
TR 224,19,12800
TR 226,19,14848
Mvav 120,228,28
buffer_load_dwordx4 v5, s[12:15], s33 offen offset:128 nt lds
Mvav 124,228,0
s_waitcnt lgkmcnt(6)
TR 228,20,12800
TR 230,20,14848
Mvav 128,232,28
s_add_u32 m0, s38, 32512
v_cvt_pk_bf16_f32 v230, v236, v237
v_cvt_pk_bf16_f32 v231, v238, v239
Mvav 132,232,0
TR 232,15,4096
TR 234,15,6144
Mvav 136,236,28
v_accvgpr_write_b32 a112, v228
v_accvgpr_write_b32 a113, v229
Mvav 140,236,0
s_waitcnt lgkmcnt(6)
TR 236,16,4096
TR 238,16,6144
Mvav 144,240,28
buffer_load_dwordx4 v5, s[12:15], s33 offen offset:256 nt lds
Mvav 148,240,0
s_add_u32 s33, s33, 6144
TR 240,19,57344
TR 242,19,59392
Mvav 152,244,28
s_sub_u32 s45, s33, 98304
v_accvgpr_write_b32 a114, v230
v_accvgpr_write_b32 a115, v231
Mvav 156,244,0
s_waitcnt lgkmcnt(6)
TR 244,20,57344
TR 246,20,59392
Mvav 160,224,28
s_min_u32 s33, s33, s45
v_cvt_pk_bf16_f32 v240, v240, v241
v_cvt_pk_bf16_f32 v241, v242, v243
Mvav 164,224,0
s_add_u32 m0, s38, 36864
TR 224,15,4608
TR 226,15,6656
Mvav 168,228,28
buffer_load_dwordx4 v4, s[8:11], s32 offen nt lds
Mvav 172,228,0
s_waitcnt lgkmcnt(6)
TR 228,16,4608
TR 230,16,6656
v_mfma_f32_16x16x32_bf16 v[224:227], a[232:235], v[176:179], 0
s_add_u32 m0, s38, 40832
v_cvt_pk_bf16_f32 v242, v248, v249
v_cvt_pk_bf16_f32 v243, v250, v251
v_mfma_f32_16x16x32_bf16 v[228:231], a[232:235], v[180:183], 0
TR 232,19,57856
TR 234,19,59904
v_mfma_f32_16x16x32_bf16 v[232:235], a[236:239], v[176:179], 0
v_accvgpr_write_b32 a116, v240
v_accvgpr_write_b32 a117, v241
v_mfma_f32_16x16x32_bf16 v[236:239], a[236:239], v[180:183], 0
s_waitcnt vmcnt(7) lgkmcnt(6)
TR 236,20,57856
TR 238,20,59904
Mvav 224,240,184
s_barrier
Mvav 228,240,188
ds_read_b128 a[240:243], v11 offset:16384
v_accvgpr_write_b32 a118, v242
Mvav 232,244,184
buffer_load_dwordx4 v4, s[8:11], s32 offen offset:128 nt lds
Mvav 236,244,188
s_waitcnt lgkmcnt(5)
ds_read_b128 a[244:247], v11 offset:16896
v_accvgpr_write_b32 a119, v243
v_mfma_f32_16x16x32_bf16 v[240:243], a[224:227], v[176:179], 0
s_add_u32 m0, s38, 130816
v_cvt_pk_bf16_f32 v244, v244, v245
v_cvt_pk_bf16_f32 v245, v246, v247
v_cvt_pk_bf16_f32 v246, v252, v253
v_cvt_pk_bf16_f32 v247, v254, v255
v_accvgpr_write_b32 a120, v244
v_accvgpr_write_b32 a121, v245
v_accvgpr_write_b32 a122, v246
v_accvgpr_write_b32 a123, v247
v_mfma_f32_16x16x32_bf16 v[244:247], a[224:227], v[180:183], 0
ds_read_b128 a[224:227], v11 offset:4096
v_mfma_f32_16x16x32_bf16 v[248:251], a[228:231], v[176:179], 0
v_exp_f32 v27, v59
v_mfma_f32_16x16x32_bf16 v[252:255], a[228:231], v[180:183], 0
s_waitcnt lgkmcnt(3)
ds_read_b128 a[228:231], v11 offset:4608
v_cvt_pk_bf16_f32 v45, v26, v27
Mvav 240,232,184
buffer_load_dwordx4 v4, s[8:11], s32 offen offset:256 nt lds
Mvav 244,232,188
s_add_u32 s32, s32, 6144
ds_read_b128 a[232:235], v11 offset:8192
s_sub_u32 s45, s32, 98304
Mvav 248,236,184
s_min_u32 s32, s32, s45
v_exp_f32 v24, v52
Mvav 252,236,188
s_waitcnt lgkmcnt(3)
ds_read_b128 a[236:239], v11 offset:8704
s_add_u32 s43, s56, 286720
v_mfma_f32_16x16x32_bf16 v[64:67], a[240:243], a[208:211], 0
s_add_u32 m0, s38, 118784
v_exp_f32 v25, v53
v_mfma_f32_16x16x32_bf16 v[72:75], a[240:243], a[212:215], 0
ds_read_b128 a[240:243], v11 offset:18432
v_cvt_pk_bf16_f32 v42, v24, v25
Mvaa 64,244,216
buffer_load_dwordx4 v7, s[20:23], s43 offen lds
Mvaa 72,244,220
s_waitcnt lgkmcnt(3)
ds_read_b128 a[244:247], v11 offset:18944
Mvaa 64,224,248
v_exp_f32 v26, v54
Mvaa 72,224,0
ds_read_b128 a[224:227], v11 offset:6144
Mvaa 64,228,4
v_exp_f32 v27, v55
Mvaa 72,228,8
s_waitcnt lgkmcnt(3)
ds_read_b128 a[228:231], v11 offset:6656
v_cvt_pk_bf16_f32 v43, v26, v27
Mvaa 64,232,12
v_exp_f32 v24, v60
Mvaa 72,232,16
ds_read_b128 a[232:235], v11 offset:10240
Mvaa 64,236,20
v_exp_f32 v25, v61
Mvaa 72,236,24
s_waitcnt lgkmcnt(3)
ds_read_b128 a[236:239], v11 offset:10752
v_cvt_pk_bf16_f32 v46, v24, v25
v_mfma_f32_16x16x32_bf16 v[68:71], a[240:243], a[208:211], 0
v_exp_f32 v26, v62
v_mfma_f32_16x16x32_bf16 v[76:79], a[240:243], a[212:215], 0
TR 240,19,36864
TR 242,19,38912
Mvaa 68,244,216
v_exp_f32 v27, v63
Mvaa 76,244,220
s_waitcnt lgkmcnt(4)
TR 244,20,36864
TR 246,20,38912
Mvaa 68,224,248
v_cvt_pk_bf16_f32 v47, v26, v27
Mvaa 76,224,0
TR 224,19,37376
TR 226,19,39424
Mvaa 68,228,4
v_exp_f32 v24, v64
Mvaa 76,228,8
s_waitcnt lgkmcnt(6)
TR 228,20,37376
TR 230,20,39424
Mvaa 68,232,12
v_exp_f32 v25, v65
Mvaa 76,232,16
TR 232,19,28672
TR 234,19,30720
Mvaa 68,236,20
v_exp_f32 v26, v66
Mvaa 76,236,24
s_waitcnt lgkmcnt(6)
v_cvt_pk_bf16_f32 v28, v24, v25
Mvav 224,240,192
v_exp_f32 v27, v67
Mvav 228,240,196
TR 240,20,28672
TR 242,20,30720
Mvav 232,244,192
v_exp_f32 v24, v72
Mvav 236,244,196
s_waitcnt lgkmcnt(4)
TR 244,19,29184
TR 246,19,31232
Mvav 240,224,192
s_add_u32 s43, s56, 327680
v_cvt_pk_bf16_f32 v29, v26, v27
s_add_u32 m0, s38, 122880
Mvav 244,224,196
s_waitcnt vmcnt(8)
TR 224,20,29184
TR 226,20,31232
Mvav 248,228,192
s_barrier
Mvav 252,228,196
s_waitcnt lgkmcnt(6)
TR 228,19,40960
TR 230,19,43008
Mvav 224,232,200
buffer_load_dwordx4 v7, s[20:23], s43 offen lds
Mvav 228,232,204
s_add_u32 s43, s56, 368640
TR 232,20,40960
TR 234,20,43008
Mvav 32,252,40
s_add_u32 m0, s38, 155648
v_exp_f32 v25, v73
Mvav 36,252,44
s_waitcnt lgkmcnt(6)
TR 236,19,41472
TR 238,19,43520
Mvav 232,240,200
buffer_load_dwordx4 v7, s[20:23], s43 offen lds
Mvav 236,240,204
s_add_u32 s43, s56, 409600
TR 240,20,41472
TR 242,20,43520
Mvav 240,244,200
s_add_u32 m0, s38, 135168
v_max_f32 v33, v32, v36
v_cmp_nge_f32 vcc, s39, v33
Mvav 244,244,204
s_waitcnt lgkmcnt(6)
TR 244,15,8192
TR 246,15,10240
Mvav 248,224,200
buffer_load_dwordx4 v7, s[20:23], s43 offen lds
Mvav 252,224,204
s_add_u32 m0, s38, 110592
TR 224,16,8192
TR 226,16,10240
s_cbranch_vccnz Lr38
Lb38:
Mvav 80,228,40
v_exp_f32 v26, v74
Mvav 84,228,44
s_waitcnt lgkmcnt(6)
TR 228,15,8704
TR 230,15,10752
Mvav 88,232,40
v_cvt_pk_bf16_f32 v0, v24, v25
Mvav 92,232,44
TR 232,16,8704
TR 234,16,10752
Mvav 96,236,40
buffer_load_dwordx4 v5, s[12:15], s33 offen nt lds
Mvav 100,236,44
s_waitcnt lgkmcnt(6)
TR 236,15,16384
TR 238,15,18432
Mvav 104,240,40
s_add_u32 m0, s38, 114560
v_exp_f32 v27, v75
Mvav 108,240,44
TR 240,16,16384
TR 242,16,18432
Mvav 112,244,40
v_exp_f32 v24, v68
Mvav 116,244,44
s_waitcnt lgkmcnt(6)
TR 244,15,16896
TR 246,15,18944
Mvav 120,224,40
buffer_load_dwordx4 v5, s[12:15], s33 offen offset:128 nt lds
Mvav 124,224,44
s_add_u32 m0, s38, 102144
TR 224,16,16896
TR 226,16,18944
Mvav 128,228,40
v_cvt_pk_bf16_f32 v1, v26, v27
Mvav 132,228,44
s_waitcnt lgkmcnt(6)
TR 228,15,12288
TR 230,15,14336
Mvav 136,232,40
v_exp_f32 v25, v69
Mvav 140,232,44
TR 232,16,12288
TR 234,16,14336
Mvav 144,236,40
buffer_load_dwordx4 v5, s[12:15], s33 offen offset:256 nt lds
Mvav 148,236,44
s_waitcnt lgkmcnt(6)
TR 236,15,12800
TR 238,15,14848
Mvav 152,240,40
s_add_u32 s33, s33, 6144
v_exp_f32 v26, v70
Mvav 156,240,44
s_sub_u32 s45, s33, 98304
TR 240,16,12800
TR 242,16,14848
Mvav 160,244,40
s_min_u32 s33, s33, s45
v_cvt_pk_bf16_f32 v30, v24, v25
s_add_u32 m0, s38, 106496
Mvav 164,244,44
s_waitcnt lgkmcnt(6)
TR 244,19,61440
TR 246,19,63488
Mvav 168,224,40
buffer_load_dwordx4 v4, s[8:11], s32 offen nt lds
Mvav 172,224,44
s_add_u32 s43, s32, 128
TR 224,20,61440
TR 226,20,63488
Mvav 224,228,208
s_add_u32 m0, s38, 0
v_exp_f32 v27, v71
Mvav 228,228,212
s_waitcnt lgkmcnt(6)
TR 228,19,61952
TR 230,19,64000
Mvav 232,232,208
v_cvt_pk_bf16_f32 v31, v26, v27
Mvav 236,232,212
s_waitcnt vmcnt(7)
TR 232,20,61952
TR 234,20,64000
Mvav 240,236,208
s_barrier
Mvav 244,236,212
s_waitcnt lgkmcnt(6)
ds_read_b128 a[236:239], v9 offset:20480
Mvav 248,240,208
buffer_load_dwordx4 v4, s[8:11], s43 offen nt lds
Mvav 252,240,212
s_add_u32 m0, s38, 139008
ds_read_b128 a[240:243], v9 offset:20992
Mvav 224,244,216
v_exp_f32 v24, v76
Mvav 228,244,220
s_waitcnt lgkmcnt(4)
ds_read_b128 a[244:247], v9 offset:28672
Mvav 232,224,216
v_exp_f32 v25, v77
Mvav 236,224,220
ds_read_b128 a[224:227], v9 offset:29184
v_cvt_pk_bf16_f32 v2, v24, v25
Mvav 240,228,216
buffer_load_dwordx4 v4, s[8:11], s32 offen offset:256 nt lds
Mvav 244,228,220
s_waitcnt lgkmcnt(3)
ds_read_b128 a[228:231], v11 offset:53248
s_add_u32 s32, s32, 6144
Mvav 248,232,216
s_sub_u32 s45, s32, 98304
v_exp_f32 v26, v78
Mvav 252,232,220
s_min_u32 s32, s32, s45
ds_read_b128 a[232:235], v11 offset:53760
s_add_u32 s43, s56, 450560
v_mfma_f32_16x16x32_bf16 v[48:51], a[236:239], a[208:211], 0
s_add_u32 m0, s38, 126976
v_exp_f32 v27, v79
v_mfma_f32_16x16x32_bf16 v[56:59], a[236:239], a[212:215], 0
s_waitcnt lgkmcnt(3)
ds_read_b128 a[236:239], v9 offset:22528
v_cvt_pk_bf16_f32 v3, v26, v27
Mvaa 48,240,216
buffer_load_dwordx4 v7, s[20:23], s43 offen lds
Mvaa 56,240,220
ds_read_b128 a[240:243], v9 offset:23040
Mvaa 48,244,248
Mvaa 56,244,0
s_waitcnt lgkmcnt(3)
ds_read_b128 a[244:247], v9 offset:30720
Mvaa 48,224,4
Mvaa 56,224,8
ds_read_b128 a[224:227], v9 offset:31232
Mvaa 48,228,12
Mvaa 56,228,16
s_waitcnt lgkmcnt(3)
ds_read_b128 a[228:231], v11 offset:55296
Mvaa 48,232,20
Mvaa 56,232,24
ds_read_b128 a[232:235], v11 offset:55808
v_mfma_f32_16x16x32_bf16 v[52:55], a[236:239], a[208:211], 0
v_exp_f32 v24, v48
v_mfma_f32_16x16x32_bf16 v[60:63], a[236:239], a[212:215], 0
s_waitcnt lgkmcnt(3)
TR 236,19,45056
TR 238,19,47104
Mvaa 52,240,216
v_exp_f32 v25, v49
Mvaa 60,240,220
TR 240,20,45056
TR 242,20,47104
Mvaa 52,244,248
v_exp_f32 v26, v50
Mvaa 60,244,0
s_waitcnt lgkmcnt(5)
TR 244,19,45568
TR 246,19,47616
Mvaa 52,224,4
v_cvt_pk_bf16_f32 v40, v24, v25
Mvaa 60,224,8
TR 224,20,45568
TR 226,20,47616
Mvaa 52,228,12
v_exp_f32 v27, v51
Mvaa 60,228,16
s_waitcnt lgkmcnt(6)
TR 228,19,20480
TR 230,19,22528
Mvaa 52,232,20
v_exp_f32 v24, v56
Mvaa 60,232,24
v_cvt_pk_bf16_f32 v41, v26, v27
Mvaa 224,236,160
v_exp_f32 v25, v57
Mvaa 228,236,164
s_waitcnt lgkmcnt(4)
TR 236,20,20480
TR 238,20,22528
Mvaa 232,240,160
v_exp_f32 v26, v58
Mvaa 236,240,164
s_add_u32 m0, s38, 4096
TR 240,19,20992
TR 242,19,23040
Mvaa 240,244,160
buffer_load_dwordx4 v7, s[20:23], s57 offen lds
Mvaa 244,244,164
s_waitcnt vmcnt(9) lgkmcnt(4)
TR 244,20,20992
TR 246,20,23040
Mvaa 248,224,160
s_barrier
Mvaa 252,224,164
s_add_u32 s43, s57, 40960
TR 224,19,49152
TR 226,19,51200
Mvaa 224,228,168
s_add_u32 m0, s38, 159744
v_cvt_pk_bf16_f32 v44, v24, v25
Mvaa 228,228,172
s_waitcnt lgkmcnt(6)
TR 228,20,49152
TR 230,20,51200
Mvav 32,252,28
buffer_load_dwordx4 v7, s[20:23], s43 offen lds
Mvav 36,252,0
s_add_u32 m0, s38, 151552
TR 232,19,49664
TR 234,19,51712
Mvaa 232,236,168
v_exp_f32 v27, v59
Mvaa 236,236,172
s_waitcnt lgkmcnt(6)
TR 236,20,49664
TR 238,20,51712
Mvaa 240,240,168
v_max_f32 v33, v32, v36
v_cmp_nge_f32 vcc, s39, v33
Mvaa 244,240,172
TR 240,15,24576
TR 242,15,26624
Mvaa 248,244,168
buffer_load_dwordx4 v5, s[12:15], s33 offen nt lds
Mvaa 252,244,172
s_waitcnt lgkmcnt(6)
TR 244,16,24576
TR 246,16,26624
s_cbranch_vccnz Lr39
Lb39:
Mvav 80,224,28
s_add_u32 m0, s38, 143232
v_exp_f32 v24, v52
Mvav 84,224,0
TR 224,15,25088
TR 226,15,27136
Mvav 88,228,28
v_cvt_pk_bf16_f32 v45, v26, v27
Mvav 92,228,0
s_waitcnt lgkmcnt(6)
TR 228,16,25088
TR 230,16,27136
Mvav 96,232,28
buffer_load_dwordx4 v5, s[12:15], s33 offen offset:128 nt lds
Mvav 100,232,0
s_add_u32 m0, s38, 7936
TR 232,15,32768
TR 234,15,34816
Mvav 104,236,28
v_exp_f32 v25, v53
Mvav 108,236,0
s_waitcnt lgkmcnt(6)
TR 236,16,32768
TR 238,16,34816
Mvav 112,240,28
v_exp_f32 v26, v54
Mvav 116,240,0
TR 240,15,33280
TR 242,15,35328
Mvav 120,244,28
buffer_load_dwordx4 v5, s[12:15], s33 offen offset:256 nt lds
Mvav 124,244,0
s_waitcnt lgkmcnt(6)
TR 244,16,33280
TR 246,16,35328
Mvav 128,224,28
s_add_u32 s33, s33, 6144
v_cvt_pk_bf16_f32 v42, v24, v25
s_sub_u32 s45, s33, 98304
Mvav 132,224,0
Tc23:
s_cbranch_execz Tr23
s_cmpk_eq_u32 s88, 26
s_cselect_b64 exec, 0, -1
s_cbranch_execz Tc26
Tr26:
s_mov_b64 exec, -1
s_min_u32 s33, s33, s45
TR 224,19,24576
TR 226,19,26624
Mvav 136,228,28
s_add_u32 m0, s38, 12288
v_exp_f32 v27, v55
Mvav 140,228,0
s_waitcnt lgkmcnt(6)
TR 228,20,24576
TR 230,20,26624
Mvav 144,232,28
buffer_load_dwordx4 v4, s[8:11], s32 offen nt lds
Mvav 148,232,0
s_add_u32 m0, s38, 16256
TR 232,19,25088
TR 234,19,27136
Mvav 152,236,28
v_cvt_pk_bf16_f32 v43, v26, v27
Mvav 156,236,0
s_waitcnt lgkmcnt(6)
TR 236,20,25088
TR 238,20,27136
Mvav 160,240,28
v_exp_f32 v24, v60
Mvav 164,240,0
TR 240,19,57344
TR 242,19,59392
Mvav 168,244,28
buffer_load_dwordx4 v4, s[8:11], s32 offen offset:128 nt lds
Mvav 172,244,0
s_waitcnt lgkmcnt(6)
TR 244,20,57344
TR 246,20,59392
Mvaa 224,224,176
s_add_u32 m0, s38, 20224
v_exp_f32 v25, v61
Mvaa 228,224,180
TR 224,19,57856
TR 226,19,59904
Mvaa 232,228,176
v_exp_f32 v26, v62
Mvaa 236,228,180
s_waitcnt vmcnt(7) lgkmcnt(6)
TR 228,20,57856
TR 230,20,59904
Mvaa 240,232,176
s_barrier
Mvaa 244,232,180
ds_read_b128 a[232:235], v9 offset:36864
v_cvt_pk_bf16_f32 v46, v24, v25
Mvaa 248,236,176
buffer_load_dwordx4 v4, s[8:11], s32 offen offset:256 nt lds
Mvaa 252,236,180
s_waitcnt lgkmcnt(5)
ds_read_b128 a[236:239], v9 offset:37376
s_add_u32 s32, s32, 6144
Mvaa 224,240,184
s_sub_u32 s45, s32, 98304
v_exp_f32 v27, v63
Mvaa 228,240,188
s_min_u32 s32, s32, s45
ds_read_b128 a[240:243], v9 offset:40960
v_cvt_pk_bf16_f32 v47, v26, v27
Mvaa 232,244,184
s_add_u32 s43, s57, 81920
s_add_u32 m0, s38, 147456
Mvaa 236,244,188
s_waitcnt lgkmcnt(3)
ds_read_b128 a[244:247], v9 offset:41472
Mvaa 240,224,184
buffer_load_dwordx4 v7, s[20:23], s43 offen lds
Mvaa 244,224,188
ds_read_b128 a[224:227], v11 offset:32768
Mvaa 248,228,184
Mvaa 252,228,188
s_waitcnt lgkmcnt(3)
ds_read_b128 a[228:231], v11 offset:33280
v_mfma_f32_16x16x32_bf16 v[64:67], a[232:235], a[208:211], 0
v_mfma_f32_16x16x32_bf16 v[72:75], a[232:235], a[212:215], 0
ds_read_b128 a[232:235], v9 offset:38912
Mvaa 64,236,216
Mvaa 72,236,220
s_waitcnt lgkmcnt(3)
ds_read_b128 a[236:239], v9 offset:39424
Mvaa 64,240,248
Mvaa 72,240,0
ds_read_b128 a[240:243], v9 offset:43008
Mvaa 64,244,4
Mvaa 72,244,8
s_waitcnt lgkmcnt(3)
ds_read_b128 a[244:247], v9 offset:43520
Mvaa 64,224,12
Mvaa 72,224,16
ds_read_b128 a[224:227], v11 offset:34816
Mvaa 64,228,20
Mvaa 72,228,24
s_waitcnt lgkmcnt(3)
ds_read_b128 a[228:231], v11 offset:35328
v_mfma_f32_16x16x32_bf16 v[68:71], a[232:235], a[208:211], 0
v_exp_f32 v24, v64
v_mfma_f32_16x16x32_bf16 v[76:79], a[232:235], a[212:215], 0
TR 232,19,36864
TR 234,19,38912
Mvaa 68,236,216
v_exp_f32 v25, v65
Mvaa 76,236,220
s_waitcnt lgkmcnt(4)
TR 236,20,36864
TR 238,20,38912
Mvaa 68,240,248
v_exp_f32 v26, v66
Mvaa 76,240,0
TR 240,19,28672
TR 242,19,30720
Mvaa 68,244,4
v_cvt_pk_bf16_f32 v28, v24, v25
Mvaa 76,244,8
s_waitcnt lgkmcnt(6)
TR 244,20,28672
TR 246,20,30720
Mvaa 68,224,12
v_exp_f32 v27, v67
Mvaa 76,224,16
s_add_u32 s43, s57, 122880
TR 224,19,37376
TR 226,19,39424
Mvaa 68,228,20
s_add_u32 m0, s38, 118784
v_exp_f32 v24, v72
Mvaa 76,228,24
s_waitcnt lgkmcnt(6)
v_cvt_pk_bf16_f32 v29, v26, v27
Mvaa 224,232,192
buffer_load_dwordx4 v7, s[20:23], s43 offen lds
Mvaa 228,232,196
s_add_u32 s43, s57, 163840
TR 232,20,37376
TR 234,20,39424
Mvaa 232,236,192
s_add_u32 m0, s38, 24576
v_exp_f32 v25, v73
Mvaa 236,236,196
s_waitcnt lgkmcnt(4)
TR 236,19,29184
TR 238,19,31232
Mvaa 224,240,200
buffer_load_dwordx4 v7, s[20:23], s43 offen lds
Mvaa 228,240,204
s_waitcnt vmcnt(9)
TR 240,20,29184
TR 242,20,31232
Mvaa 232,244,200
s_barrier
Mvaa 236,244,204
s_waitcnt lgkmcnt(6)
TR 244,19,12288
TR 246,19,14336
Mvaa 240,224,192
s_add_u32 s43, s57, 204800
v_cvt_pk_bf16_f32 v224, v224, v225
v_cvt_pk_bf16_f32 v225, v226, v227
Mvaa 244,224,196
s_add_u32 m0, s38, 155648
TR 224,20,12288
TR 226,20,14336
Mvav 32,252,40
buffer_load_dwordx4 v7, s[20:23], s43 offen lds
Mvav 36,252,44
s_waitcnt lgkmcnt(6)
TR 228,19,12800
TR 230,19,14848
Mvaa 248,232,192
s_add_u32 m0, s38, 131072
v_cvt_pk_bf16_f32 v226, v232, v233
v_cvt_pk_bf16_f32 v227, v234, v235
Mvaa 252,232,196
TR 232,20,12800
TR 234,20,14848
Mvaa 240,236,200
v_max_f32 v33, v32, v36
v_cmp_nge_f32 vcc, s39, v33
Mvaa 244,236,204
s_waitcnt lgkmcnt(6)
TR 236,19,16384
TR 238,19,18432
Mvaa 248,240,200
buffer_load_dwordx4 v5, s[12:15], s33 offen nt lds
Mvaa 252,240,204
s_add_u32 m0, s38, 122752
TR 240,20,16384
TR 242,20,18432
s_cbranch_vccnz Lr40
Lb40:
Mvav 80,244,40
v_accvgpr_write_b32 a124, v224
v_accvgpr_write_b32 a125, v225
Mvav 84,244,44
s_waitcnt lgkmcnt(6)
TR 244,19,16896
TR 246,19,18944
Mvav 88,224,40
v_accvgpr_write_b32 a126, v226
v_accvgpr_write_b32 a127, v227
Mvav 92,224,44
TR 224,20,16896
TR 226,20,18944
Mvav 96,228,40
buffer_load_dwordx4 v5, s[12:15], s33 offen offset:128 nt lds
Mvav 100,228,44
s_waitcnt lgkmcnt(6)
TR 228,19,4096
TR 230,19,6144
Mvav 104,232,40
s_add_u32 m0, s38, 28416
v_cvt_pk_bf16_f32 v228, v228, v229
v_cvt_pk_bf16_f32 v229, v230, v231
Mvav 108,232,44
TR 232,20,4096
TR 234,20,6144
Mvav 112,236,40
v_cvt_pk_bf16_f32 v230, v236, v237
v_cvt_pk_bf16_f32 v231, v238, v239
Mvav 116,236,44
s_waitcnt lgkmcnt(6)
TR 236,19,4608
TR 238,19,6656
Mvav 120,240,40
buffer_load_dwordx4 v5, s[12:15], s33 offen offset:256 nt lds
Mvav 124,240,44
s_add_u32 s33, s33, 6144
TR 240,20,4608
TR 242,20,6656
Mvav 128,244,40
s_sub_u32 s45, s33, 98304
v_accvgpr_write_b32 a128, v228
v_accvgpr_write_b32 a129, v229
Mvav 132,244,44
s_waitcnt lgkmcnt(6)
TR 244,15,4096
TR 246,15,6144
Mvav 136,224,40
s_min_u32 s33, s33, s45
v_accvgpr_write_b32 a130, v230
v_accvgpr_write_b32 a131, v231
Mvav 140,224,44
s_add_u32 m0, s38, 32768
TR 224,16,4096
TR 226,16,6144
Mvav 144,228,40
buffer_load_dwordx4 v4, s[8:11], s32 offen nt lds
Mvav 148,228,44
s_waitcnt lgkmcnt(6)
TR 228,19,61440
TR 230,19,63488
Mvav 152,232,40
s_add_u32 m0, s38, 36736
v_cvt_pk_bf16_f32 v240, v240, v241
v_cvt_pk_bf16_f32 v241, v242, v243
Mvav 156,232,44
TR 232,20,61440
TR 234,20,63488
Mvav 160,236,40
v_cvt_pk_bf16_f32 v242, v248, v249
v_cvt_pk_bf16_f32 v243, v250, v251
Mvav 164,236,44
s_waitcnt lgkmcnt(6)
TR 236,15,4608
TR 238,15,6656
Mvav 168,240,40
buffer_load_dwordx4 v4, s[8:11], s32 offen offset:128 nt lds
Mvav 172,240,44
s_add_u32 m0, s38, 40704
TR 240,16,4608
TR 242,16,6656
v_mfma_f32_16x16x32_bf16 v[224:227], a[244:247], v[176:179], 0
v_accvgpr_write_b32 a132, v240
v_accvgpr_write_b32 a133, v241
v_mfma_f32_16x16x32_bf16 v[228:231], a[244:247], v[180:183], 0
s_waitcnt lgkmcnt(6)
TR 244,19,61952
TR 246,19,64000
v_mfma_f32_16x16x32_bf16 v[232:235], a[224:227], v[176:179], 0
v_accvgpr_write_b32 a134, v242
v_accvgpr_write_b32 a135, v243
v_mfma_f32_16x16x32_bf16 v[236:239], a[224:227], v[180:183], 0
s_waitcnt vmcnt(8)
TR 224,20,61952
TR 226,20,64000
Mvav 224,228,184
s_barrier
Mvav 228,228,188
s_waitcnt lgkmcnt(6)
ds_read_b128 a[228:231], v11 offset:8192
v_cvt_pk_bf16_f32 v244, v244, v245
Mvav 232,232,184
buffer_load_dwordx4 v4, s[8:11], s32 offen offset:256 nt lds
Mvav 236,232,188
s_add_u32 s32, s32, 6144
ds_read_b128 a[232:235], v11 offset:8704
v_cvt_pk_bf16_f32 v245, v246, v247
v_mfma_f32_16x16x32_bf16 v[240:243], a[236:239], v[176:179], 0
s_sub_u32 s45, s32, 98304
v_cvt_pk_bf16_f32 v246, v252, v253
v_cvt_pk_bf16_f32 v247, v254, v255
v_accvgpr_write_b32 a136, v244
v_accvgpr_write_b32 a137, v245
v_accvgpr_write_b32 a138, v246
v_accvgpr_write_b32 a139, v247
v_mfma_f32_16x16x32_bf16 v[244:247], a[236:239], v[180:183], 0
s_waitcnt lgkmcnt(4)
ds_read_b128 a[236:239], v9 offset:0
v_cvt_pk_bf16_f32 v0, v24, v25
v_mfma_f32_16x16x32_bf16 v[248:251], a[240:243], v[176:179], 0
s_min_u32 s32, s32, s45
v_exp_f32 v26, v74
v_mfma_f32_16x16x32_bf16 v[252:255], a[240:243], v[180:183], 0
s_add_u32 s43, s57, 245760
ds_read_b128 a[240:243], v9 offset:512
s_add_u32 m0, s38, 135168
Mvav 240,244,184
buffer_load_dwordx4 v7, s[20:23], s43 offen lds
Mvav 244,244,188
s_waitcnt lgkmcnt(3)
ds_read_b128 a[244:247], v11 offset:40960
Mvav 248,224,184
v_exp_f32 v27, v75
Mvav 252,224,188
ds_read_b128 a[224:227], v11 offset:41472
v_cvt_pk_bf16_f32 v1, v26, v27
v_mfma_f32_16x16x32_bf16 v[48:51], a[228:231], a[208:211], 0
v_exp_f32 v24, v68
v_mfma_f32_16x16x32_bf16 v[56:59], a[228:231], a[212:215], 0
s_waitcnt lgkmcnt(3)
ds_read_b128 a[228:231], v11 offset:10240
Mvaa 48,232,216
v_exp_f32 v25, v69
Mvaa 56,232,220
ds_read_b128 a[232:235], v11 offset:10752
v_cvt_pk_bf16_f32 v30, v24, v25
Mvaa 48,236,248
v_exp_f32 v26, v70
Mvaa 56,236,0
s_waitcnt lgkmcnt(3)
ds_read_b128 a[236:239], v9 offset:2048
Mvaa 48,240,4
v_exp_f32 v27, v71
Mvaa 56,240,8
ds_read_b128 a[240:243], v9 offset:2560
v_cvt_pk_bf16_f32 v31, v26, v27
Mvaa 48,244,12
v_exp_f32 v24, v76
Mvaa 56,244,16
s_waitcnt lgkmcnt(3)
ds_read_b128 a[244:247], v11 offset:43008
Mvaa 48,224,20
v_exp_f32 v25, v77
Mvaa 56,224,24
ds_read_b128 a[224:227], v11 offset:43520
v_cvt_pk_bf16_f32 v2, v24, v25
v_mfma_f32_16x16x32_bf16 v[52:55], a[228:231], a[208:211], 0
v_exp_f32 v26, v78
v_mfma_f32_16x16x32_bf16 v[60:63], a[228:231], a[212:215], 0
s_waitcnt lgkmcnt(3)
TR 228,19,49152
TR 230,19,51200
Mvaa 52,232,216
v_exp_f32 v27, v79
Mvaa 60,232,220
v_cvt_pk_bf16_f32 v3, v26, v27
Mvaa 52,236,248
v_exp_f32 v24, v48
Mvaa 60,236,0
s_waitcnt lgkmcnt(3)
TR 236,20,49152
TR 238,20,51200
Mvaa 52,240,4
v_exp_f32 v25, v49
Mvaa 60,240,8
TR 240,19,49664
TR 242,19,51712
Mvaa 52,244,12
v_exp_f32 v26, v50
Mvaa 60,244,16
s_waitcnt vmcnt(8) lgkmcnt(4)
TR 244,20,49664
TR 246,20,51712
Mvaa 52,224,20
s_barrier
Mvaa 60,224,24
s_add_u32 s43, s57, 286720
TR 224,19,53248
TR 226,19,55296
Mvav 224,228,192
s_add_u32 m0, s38, 159744
v_cvt_pk_bf16_f32 v40, v24, v25
Mvav 228,228,196
s_waitcnt lgkmcnt(6)
TR 228,20,53248
TR 230,20,55296
Mvav 32,252,28
buffer_load_dwordx4 v7, s[20:23], s43 offen lds
Mvav 36,252,0
s_add_u32 s43, s57, 327680
TR 232,19,53760
TR 234,19,55808
Mvav 232,236,192
s_add_u32 m0, s38, 139264
v_exp_f32 v27, v51
Mvav 236,236,196
s_waitcnt lgkmcnt(6)
TR 236,20,53760
TR 238,20,55808
Mvav 240,240,192
buffer_load_dwordx4 v7, s[20:23], s43 offen lds
Mvav 244,240,196
s_add_u32 m0, s38, 126976
TR 240,19,45056
TR 242,19,47104
Mvav 248,244,192
v_max_f32 v33, v32, v36
v_cmp_nge_f32 vcc, s39, v33
Mvav 252,244,196
s_waitcnt lgkmcnt(6)
TR 244,20,45056
TR 246,20,47104
s_cbranch_vccnz Lr41
Lb41:
Mvav 80,224,28
v_exp_f32 v24, v56
Mvav 84,224,0
TR 224,19,45568
TR 226,19,47616
Mvav 88,228,28
buffer_load_dwordx4 v5, s[12:15], s33 offen nt lds
Mvav 92,228,0
s_waitcnt lgkmcnt(6)
TR 228,20,45568
TR 230,20,47616
Mvav 96,232,28
s_add_u32 m0, s38, 110464
v_cvt_pk_bf16_f32 v41, v26, v27
Mvav 100,232,0
TR 232,15,8192
TR 234,15,10240
Mvav 104,236,28
v_exp_f32 v25, v57
Mvav 108,236,0
s_waitcnt lgkmcnt(6)
TR 236,16,8192
TR 238,16,10240
Mvav 112,240,28
buffer_load_dwordx4 v5, s[12:15], s33 offen offset:128 nt lds
Mvav 116,240,0
s_add_u32 m0, s38, 114432
TR 240,15,8704
TR 242,15,10752
Mvav 120,244,28
v_exp_f32 v26, v58
Mvav 124,244,0
s_waitcnt lgkmcnt(6)
TR 244,16,8704
TR 246,16,10752
Mvav 128,224,28
v_cvt_pk_bf16_f32 v44, v24, v25
Mvav 132,224,0
TR 224,19,20480
TR 226,19,22528
Mvav 136,228,28
buffer_load_dwordx4 v5, s[12:15], s33 offen offset:256 nt lds
Mvav 140,228,0
s_waitcnt lgkmcnt(6)
TR 228,20,20480
TR 230,20,22528
Mvav 144,232,28
s_add_u32 s33, s33, 6144
v_exp_f32 v27, v59
Mvav 148,232,0
s_sub_u32 s45, s33, 98304
TR 232,19,20992
TR 234,19,23040
Mvav 152,236,28
s_min_u32 s33, s33, s45
v_exp_f32 v24, v52
Mvav 156,236,0
s_waitcnt lgkmcnt(6)
TR 236,20,20992
TR 238,20,23040
Mvav 160,240,28
s_add_u32 m0, s38, 102400
v_cvt_pk_bf16_f32 v45, v26, v27
Mvav 164,240,0
TR 240,15,24576
TR 242,15,26624
Mvav 168,244,28
buffer_load_dwordx4 v4, s[8:11], s32 offen nt lds
Mvav 172,244,0
s_waitcnt lgkmcnt(6)
TR 244,16,24576
TR 246,16,26624
Mvav 224,224,200
s_add_u32 m0, s38, 106368
v_exp_f32 v25, v53
Mvav 228,224,204
TR 224,15,25088
TR 226,15,27136
Mvav 232,228,200
v_exp_f32 v26, v54
Mvav 236,228,204
s_waitcnt vmcnt(6) lgkmcnt(6)
TR 228,16,25088
TR 230,16,27136
Mvav 240,232,200
s_barrier
Mvav 244,232,204
ds_read_b128 a[232:235], v9 offset:12288
v_cvt_pk_bf16_f32 v42, v24, v25
Mvav 248,236,200
buffer_load_dwordx4 v4, s[8:11], s32 offen offset:128 nt lds
Mvav 252,236,204
s_waitcnt lgkmcnt(5)
ds_read_b128 a[236:239], v9 offset:12800
s_add_u32 m0, s38, 151296
Mvav 224,240,208
v_exp_f32 v27, v55
Mvav 228,240,212
ds_read_b128 a[240:243], v9 offset:16384
v_cvt_pk_bf16_f32 v43, v26, v27
Mvav 232,244,208
v_exp_f32 v24, v60
Mvav 236,244,212
s_waitcnt lgkmcnt(3)
ds_read_b128 a[244:247], v9 offset:16896
Mvav 240,224,208
buffer_load_dwordx4 v4, s[8:11], s32 offen offset:256 nt lds
Mvav 244,224,212
s_add_u32 s32, s32, 6144
ds_read_b128 a[224:227], v9 offset:20480
s_sub_u32 s45, s32, 98304
Mvav 248,228,208
s_min_u32 s32, s32, s45
v_exp_f32 v25, v61
Mvav 252,228,212
s_waitcnt lgkmcnt(3)
ds_read_b128 a[228:231], v9 offset:20992
v_cvt_pk_bf16_f32 v46, v24, v25
v_mfma_f32_16x16x32_bf16 v[64:67], a[232:235], a[208:211], 0
s_add_u32 s43, s57, 368640
v_exp_f32 v26, v62
v_mfma_f32_16x16x32_bf16 v[72:75], a[232:235], a[212:215], 0
s_add_u32 m0, s38, 143360
ds_read_b128 a[232:235], v9 offset:14336
Mvaa 64,236,216
buffer_load_dwordx4 v7, s[20:23], s43 offen lds
Mvaa 72,236,220
s_waitcnt lgkmcnt(3)
ds_read_b128 a[236:239], v9 offset:14848
Mvaa 64,240,248
v_exp_f32 v27, v63
Mvaa 72,240,0
ds_read_b128 a[240:243], v9 offset:18432
v_cvt_pk_bf16_f32 v47, v26, v27
Mvaa 64,244,4
Mvaa 72,244,8
Tc24:
s_cbranch_execz Tr24
s_cmpk_eq_u32 s88, 27
s_cselect_b64 exec, 0, -1
s_cbranch_execz Tc27
Tr27:
s_mov_b64 exec, -1
s_waitcnt lgkmcnt(3)
ds_read_b128 a[244:247], v9 offset:18944
Mvaa 64,224,12
Mvaa 72,224,16
ds_read_b128 a[224:227], v9 offset:22528
Mvaa 64,228,20
Mvaa 72,228,24
s_waitcnt lgkmcnt(3)
ds_read_b128 a[228:231], v9 offset:23040
v_mfma_f32_16x16x32_bf16 v[68:71], a[232:235], a[208:211], 0
v_exp_f32 v24, v64
v_mfma_f32_16x16x32_bf16 v[76:79], a[232:235], a[212:215], 0
TR 232,19,57344
TR 234,19,59392
Mvaa 68,236,216
v_exp_f32 v25, v65
Mvaa 76,236,220
s_waitcnt lgkmcnt(4)
TR 236,20,57344
TR 238,20,59392
Mvaa 68,240,248
v_exp_f32 v26, v66
Mvaa 76,240,0
TR 240,19,57856
TR 242,19,59904
Mvaa 68,244,4
v_cvt_pk_bf16_f32 v28, v24, v25
Mvaa 76,244,8
s_waitcnt lgkmcnt(6)
TR 244,20,57856
TR 246,20,59904
Mvaa 68,224,12
v_exp_f32 v27, v67
Mvaa 76,224,16
TR 224,19,36864
TR 226,19,38912
Mvaa 68,228,20
v_exp_f32 v24, v72
Mvaa 76,228,24
s_waitcnt lgkmcnt(6)
v_cvt_pk_bf16_f32 v29, v26, v27
Mvav 224,232,216
v_exp_f32 v25, v73
Mvav 228,232,220
s_add_u32 s43, s57, 409600
TR 232,20,36864
TR 234,20,38912
Mvav 232,236,216
s_add_u32 m0, s38, 147456
v_exp_f32 v26, v74
Mvav 236,236,220
s_waitcnt lgkmcnt(4)
TR 236,19,37376
TR 238,19,39424
Mvav 240,240,216
buffer_load_dwordx4 v7, s[20:23], s43 offen lds
Mvav 244,240,220
s_waitcnt vmcnt(8)
TR 240,20,37376
TR 242,20,39424
Mvav 248,244,216
s_barrier
Mvav 252,244,220
s_waitcnt lgkmcnt(6)
TR 244,19,32768
TR 246,19,34816
Mvaa 224,224,160
s_add_u32 s43, s57, 450560
v_cvt_pk_bf16_f32 v0, v24, v25
s_add_u32 m0, s38, 155648
Mvaa 228,224,164
TR 224,20,32768
TR 226,20,34816
Mvav 32,252,40
buffer_load_dwordx4 v7, s[20:23], s43 offen lds
Mvav 36,252,44
s_waitcnt lgkmcnt(6)
TR 228,19,33280
TR 230,19,35328
Mvaa 232,232,160
s_add_u32 m0, s38, 118784
v_exp_f32 v27, v75
Mvaa 236,232,164
TR 232,20,33280
TR 234,20,35328
Mvaa 240,236,160
buffer_load_dwordx4 v7, s[20:23], s50 offen lds
Mvaa 244,236,164
s_waitcnt lgkmcnt(6)
TR 236,19,24576
TR 238,19,26624
Mvaa 248,240,160
s_add_u32 m0, s38, 0
v_max_f32 v33, v32, v36
v_cmp_nge_f32 vcc, s39, v33
Mvaa 252,240,164
TR 240,20,24576
TR 242,20,26624
s_cbranch_vccnz Lr42
Lb42:
Mvav 80,244,40
v_exp_f32 v24, v68
Mvav 84,244,44
s_waitcnt lgkmcnt(6)
TR 244,19,25088
TR 246,19,27136
Mvav 88,224,40
buffer_load_dwordx4 v5, s[12:15], s33 offen nt lds
Mvav 92,224,44
s_add_u32 m0, s38, 3968
TR 224,20,25088
TR 226,20,27136
Mvav 96,228,40
v_cvt_pk_bf16_f32 v1, v26, v27
Mvav 100,228,44
s_waitcnt lgkmcnt(6)
TR 228,15,28672
TR 230,15,30720
Mvav 104,232,40
v_exp_f32 v25, v69
Mvav 108,232,44
TR 232,16,28672
TR 234,16,30720
Mvav 112,236,40
buffer_load_dwordx4 v5, s[12:15], s33 offen offset:128 nt lds
Mvav 116,236,44
s_waitcnt lgkmcnt(6)
TR 236,15,29184
TR 238,15,31232
Mvav 120,240,40
s_add_u32 m0, s38, 7936
v_exp_f32 v26, v70
Mvav 124,240,44
TR 240,16,29184
TR 242,16,31232
Mvav 128,244,40
v_cvt_pk_bf16_f32 v30, v24, v25
Mvav 132,244,44
s_waitcnt lgkmcnt(6)
TR 244,19,61440
TR 246,19,63488
Mvav 136,224,40
buffer_load_dwordx4 v5, s[12:15], s33 offen offset:256 nt lds
Mvav 140,224,44
s_add_u32 s33, s33, 6144
TR 224,20,61440
TR 226,20,63488
Mvav 144,228,40
s_sub_u32 s45, s33, 98304
v_exp_f32 v27, v71
Mvav 148,228,44
s_waitcnt lgkmcnt(6)
TR 228,19,61952
TR 230,19,64000
Mvav 152,232,40
s_min_u32 s33, s33, s45
v_cvt_pk_bf16_f32 v31, v26, v27
s_add_u32 m0, s38, 12288
Mvav 156,232,44
TR 232,20,61952
TR 234,20,64000
Mvav 160,236,40
buffer_load_dwordx4 v4, s[8:11], s32 offen nt lds
Mvav 164,236,44
s_waitcnt lgkmcnt(6)
TR 236,19,40960
TR 238,19,43008
Mvav 168,240,40
s_add_u32 m0, s38, 16256
v_exp_f32 v24, v76
Mvav 172,240,44
TR 240,20,40960
TR 242,20,43008
Mvaa 224,244,168
v_exp_f32 v25, v77
Mvaa 228,244,172
s_waitcnt lgkmcnt(6)
TR 244,19,41472
TR 246,19,43520
Mvaa 232,224,168
buffer_load_dwordx4 v4, s[8:11], s32 offen offset:128 nt lds
Mvaa 236,224,172
s_waitcnt vmcnt(8)
TR 224,20,41472
TR 226,20,43520
Mvaa 240,228,168
s_barrier
Mvaa 244,228,172
s_waitcnt lgkmcnt(6)
ds_read_b128 a[228:231], v9 offset:32768
v_cvt_pk_bf16_f32 v2, v24, v25
Mvaa 248,232,168
s_add_u32 m0, s38, 134912
v_exp_f32 v26, v78
Mvaa 252,232,172
ds_read_b128 a[232:235], v9 offset:33280
Mvaa 224,236,176
buffer_load_dwordx4 v4, s[8:11], s32 offen offset:256 nt lds
Mvaa 228,236,180
s_waitcnt lgkmcnt(4)
ds_read_b128 a[236:239], v9 offset:36864
s_add_u32 s32, s32, 6144
Mvaa 232,240,176
s_sub_u32 s45, s32, 98304
v_exp_f32 v27, v79
Mvaa 236,240,180
s_min_u32 s32, s32, s45
ds_read_b128 a[240:243], v9 offset:37376
v_cvt_pk_bf16_f32 v3, v26, v27
Mvaa 240,244,176
s_add_u32 s43, s50, 40960
s_add_u32 m0, s38, 131072
Mvaa 244,244,180
s_waitcnt lgkmcnt(3)
ds_read_b128 a[244:247], v9 offset:40960
Mvaa 248,224,176
buffer_load_dwordx4 v7, s[20:23], s43 offen lds
Mvaa 252,224,180
ds_read_b128 a[224:227], v9 offset:41472
v_mfma_f32_16x16x32_bf16 v[48:51], a[228:231], a[208:211], 0
v_mfma_f32_16x16x32_bf16 v[56:59], a[228:231], a[212:215], 0
s_waitcnt lgkmcnt(3)
ds_read_b128 a[228:231], v9 offset:34816
Mvaa 48,232,216
Mvaa 56,232,220
ds_read_b128 a[232:235], v9 offset:35328
Mvaa 48,236,248
Mvaa 56,236,0
s_waitcnt lgkmcnt(3)
ds_read_b128 a[236:239], v9 offset:38912
Mvaa 48,240,4
Mvaa 56,240,8
ds_read_b128 a[240:243], v9 offset:39424
Mvaa 48,244,12
Mvaa 56,244,16
s_waitcnt lgkmcnt(3)
ds_read_b128 a[244:247], v9 offset:43008
Mvaa 48,224,20
Mvaa 56,224,24
ds_read_b128 a[224:227], v9 offset:43520
v_mfma_f32_16x16x32_bf16 v[52:55], a[228:231], a[208:211], 0
v_exp_f32 v24, v48
v_mfma_f32_16x16x32_bf16 v[60:63], a[228:231], a[212:215], 0
s_waitcnt lgkmcnt(3)
TR 228,19,45056
TR 230,19,47104
Mvaa 52,232,216
v_exp_f32 v25, v49
Mvaa 60,232,220
v_exp_f32 v26, v50
Mvaa 52,236,248
v_cvt_pk_bf16_f32 v40, v24, v25
Mvaa 60,236,0
s_waitcnt lgkmcnt(3)
TR 236,20,45056
TR 238,20,47104
Mvaa 52,240,4
v_exp_f32 v27, v51
Mvaa 60,240,8
TR 240,19,45568
TR 242,19,47616
Mvaa 52,244,12
v_exp_f32 v24, v56
Mvaa 60,244,16
s_waitcnt vmcnt(8) lgkmcnt(4)
TR 244,20,45568
TR 246,20,47616
Mvaa 52,224,20
s_barrier
Mvaa 60,224,24
TR 224,19,28672
TR 226,19,30720
Mvaa 224,228,184
v_cvt_pk_bf16_f32 v41, v26, v27
Mvaa 228,228,188
s_waitcnt lgkmcnt(6)
TR 228,20,28672
TR 230,20,30720
Mvav 32,252,28
s_add_u32 s43, s50, 81920
v_exp_f32 v25, v57
Mvav 36,252,0
s_add_u32 m0, s38, 159744
TR 232,19,29184
TR 234,19,31232
Mvaa 232,236,184
buffer_load_dwordx4 v7, s[20:23], s43 offen lds
Mvaa 236,236,188
s_waitcnt lgkmcnt(6)
TR 236,20,29184
TR 238,20,31232
Mvaa 240,240,184
s_add_u32 s43, s50, 122880
v_max_f32 v33, v32, v36
v_cmp_nge_f32 vcc, s39, v33
Mvaa 244,240,188
s_add_u32 m0, s38, 139264
TR 240,19,12288
TR 242,19,14336
Mvaa 248,244,184
buffer_load_dwordx4 v7, s[20:23], s43 offen lds
Mvaa 252,244,188
s_waitcnt lgkmcnt(6)
TR 244,20,12288
TR 246,20,14336
s_cbranch_vccnz Lr43
Lb43:
Mvav 80,224,28
s_add_u32 s43, s50, 163840
v_exp_f32 v26, v58
Mvav 84,224,0
s_add_u32 m0, s38, 122880
TR 224,19,12800
TR 226,19,14848
Mvav 88,228,28
buffer_load_dwordx4 v7, s[20:23], s43 offen lds
Mvav 92,228,0
s_waitcnt lgkmcnt(6)
TR 228,20,12800
TR 230,20,14848
Mvav 96,232,28
s_add_u32 m0, s38, 20480
v_cvt_pk_bf16_f32 v44, v24, v25
Mvav 100,232,0
TR 232,19,16384
TR 234,19,18432
Mvav 104,236,28
v_exp_f32 v27, v59
Mvav 108,236,0
s_waitcnt lgkmcnt(6)
TR 236,20,16384
TR 238,20,18432
Mvav 112,240,28
buffer_load_dwordx4 v5, s[12:15], s33 offen nt lds
Mvav 116,240,0
s_add_u32 m0, s38, 24448
TR 240,19,16896
TR 242,19,18944
Mvav 120,244,28
v_exp_f32 v24, v52
Mvav 124,244,0
s_waitcnt lgkmcnt(6)
TR 244,20,16896
TR 246,20,18944
Mvav 128,224,28
v_cvt_pk_bf16_f32 v45, v26, v27
Mvav 132,224,0
TR 224,19,49152
TR 226,19,51200
Mvav 136,228,28
buffer_load_dwordx4 v5, s[12:15], s33 offen offset:128 nt lds
Mvav 140,228,0
s_waitcnt lgkmcnt(6)
TR 228,20,49152
TR 230,20,51200
Mvav 144,232,28
s_add_u32 m0, s38, 28416
v_exp_f32 v25, v53
Mvav 148,232,0
TR 232,19,57344
TR 234,19,59392
Mvav 152,236,28
v_exp_f32 v26, v54
Mvav 156,236,0
s_waitcnt lgkmcnt(6)
TR 236,20,57344
TR 238,20,59392
Mvav 160,240,28
buffer_load_dwordx4 v5, s[12:15], s33 offen offset:256 nt lds
Mvav 164,240,0
s_add_u32 s33, s33, 6144
TR 240,19,49664
TR 242,19,51712
Mvav 168,244,28
s_sub_u32 s45, s33, 98304
v_cvt_pk_bf16_f32 v42, v24, v25
s_min_u32 s33, s33, s45
Mvav 172,244,0
s_waitcnt lgkmcnt(6)
TR 244,20,49664
TR 246,20,51712
Mvaa 224,224,192
s_add_u32 m0, s38, 32768
v_exp_f32 v27, v55
Mvaa 228,224,196
TR 224,19,57856
TR 226,19,59904
Mvaa 232,228,192
buffer_load_dwordx4 v4, s[8:11], s32 offen nt lds
Mvaa 236,228,196
s_waitcnt vmcnt(7) lgkmcnt(6)
TR 228,20,57856
TR 230,20,59904
Mvaa 224,232,200
s_barrier
Mvaa 228,232,204
s_add_u32 m0, s38, 143232
ds_read_b128 a[232:235], v11 offset:4096
v_cvt_pk_bf16_f32 v43, v26, v27
Mvaa 232,236,200
v_cvt_pk_bf16_f32 v224, v224, v225
v_cvt_pk_bf16_f32 v225, v226, v227
Mvaa 236,236,204
s_waitcnt lgkmcnt(5)
ds_read_b128 a[236:239], v11 offset:4608
v_accvgpr_write_b32 a140, v224
Mvaa 240,240,192
buffer_load_dwordx4 v4, s[8:11], s32 offen offset:128 nt lds
Mvaa 244,240,196
s_add_u32 m0, s38, 126720
ds_read_b128 a[240:243], v11 offset:8192
v_cvt_pk_bf16_f32 v226, v232, v233
Mvaa 248,244,192
v_cvt_pk_bf16_f32 v227, v234, v235
v_accvgpr_write_b32 a141, v225
Mvaa 252,244,196
s_waitcnt lgkmcnt(3)
ds_read_b128 a[244:247], v11 offset:8704
v_accvgpr_write_b32 a142, v226
Mvaa 240,224,200
v_accvgpr_write_b32 a143, v227
v_cvt_pk_bf16_f32 v228, v228, v229
Mvaa 244,224,204
ds_read_b128 a[224:227], v11 offset:53248
v_cvt_pk_bf16_f32 v229, v230, v231
Mvaa 248,228,200
buffer_load_dwordx4 v4, s[8:11], s32 offen offset:256 nt lds
Mvaa 252,228,204
s_waitcnt lgkmcnt(3)
ds_read_b128 a[228:231], v11 offset:53760
v_cvt_pk_bf16_f32 v230, v236, v237
v_mfma_f32_16x16x32_bf16 v[64:67], a[232:235], a[208:211], 0
s_add_u32 s32, s32, 6144
v_cvt_pk_bf16_f32 v231, v238, v239
v_accvgpr_write_b32 a144, v228
v_mfma_f32_16x16x32_bf16 v[72:75], a[232:235], a[212:215], 0
s_sub_u32 s45, s32, 98304
ds_read_b128 a[232:235], v11 offset:6144
v_accvgpr_write_b32 a145, v229
Mvaa 64,236,216
s_min_u32 s32, s32, s45
v_add_u32 v4, 196608, v4
v_accvgpr_write_b32 a146, v230
Mvaa 72,236,220
s_waitcnt lgkmcnt(3)
ds_read_b128 a[236:239], v11 offset:6656
v_accvgpr_write_b32 a147, v231
Mvaa 64,240,248
s_add_u32 s43, s50, 204800
v_cvt_pk_bf16_f32 v240, v240, v241
v_cvt_pk_bf16_f32 v241, v242, v243
Mvaa 72,240,0
s_add_u32 m0, s38, 110592
ds_read_b128 a[240:243], v11 offset:10240
v_cvt_pk_bf16_f32 v242, v248, v249
Mvaa 64,244,4
buffer_load_dwordx4 v7, s[20:23], s43 offen lds
Mvaa 72,244,8
s_waitcnt lgkmcnt(3)
ds_read_b128 a[244:247], v11 offset:10752
v_cvt_pk_bf16_f32 v243, v250, v251
Mvaa 64,224,12
v_accvgpr_write_b32 a148, v240
v_accvgpr_write_b32 a149, v241
Mvaa 72,224,16
ds_read_b128 a[224:227], v11 offset:55296
v_accvgpr_write_b32 a150, v242
Mvaa 64,228,20
v_accvgpr_write_b32 a151, v243
v_cvt_pk_bf16_f32 v244, v244, v245
Mvaa 72,228,24
s_waitcnt lgkmcnt(3)
ds_read_b128 a[228:231], v11 offset:55808
v_cvt_pk_bf16_f32 v245, v246, v247
v_mfma_f32_16x16x32_bf16 v[68:71], a[232:235], a[208:211], 0
v_cvt_pk_bf16_f32 v246, v252, v253
v_cvt_pk_bf16_f32 v247, v254, v255
v_mfma_f32_16x16x32_bf16 v[76:79], a[232:235], a[212:215], 0
TR 232,19,20480
TR 234,19,22528
Mvaa 68,236,216
v_accvgpr_write_b32 a152, v244
v_accvgpr_write_b32 a153, v245
Mvaa 76,236,220
s_waitcnt lgkmcnt(4)
TR 236,20,20480
TR 238,20,22528
Mvaa 68,240,248
v_accvgpr_write_b32 a154, v246
v_accvgpr_write_b32 a155, v247
Mvaa 76,240,0
TR 240,19,32768
TR 242,19,34816
Mvaa 68,244,4
v_exp_f32 v24, v60
Mvaa 76,244,8
s_waitcnt lgkmcnt(6)
TR 244,20,32768
TR 246,20,34816
Mvaa 68,224,12
v_exp_f32 v25, v61
Mvaa 76,224,16
TR 224,19,20992
TR 226,19,23040
Mvaa 68,228,20
v_exp_f32 v26, v62
Mvaa 76,228,24
s_waitcnt lgkmcnt(6)
v_cvt_pk_bf16_f32 v46, v24, v25
v_mfma_f32_16x16x32_bf16 v[224:227], a[232:235], v[176:179], 0
v_exp_f32 v27, v63
v_mfma_f32_16x16x32_bf16 v[228:231], a[232:235], v[180:183], 0
TR 232,20,20992
TR 234,20,23040
v_mfma_f32_16x16x32_bf16 v[232:235], a[236:239], v[176:179], 0
v_cvt_pk_bf16_f32 v47, v26, v27
v_mfma_f32_16x16x32_bf16 v[236:239], a[236:239], v[180:183], 0
s_waitcnt lgkmcnt(4)
TR 236,19,33280
TR 238,19,35328
Mvav 224,240,184
v_exp_f32 v24, v64
Mvav 228,240,188
s_waitcnt vmcnt(8)
TR 240,20,33280
TR 242,20,35328
Mvav 232,244,184
s_barrier
Mvav 236,244,188
s_waitcnt lgkmcnt(6)
TR 244,15,0
TR 246,15,2048
v_mfma_f32_16x16x32_bf16 v[240:243], a[224:227], v[176:179], 0
s_add_u32 s43, s50, 245760
v_exp_f32 v25, v65
v_mfma_f32_16x16x32_bf16 v[244:247], a[224:227], v[180:183], 0
s_add_u32 m0, s38, 151552
TR 224,16,0
TR 226,16,2048
Mvav 32,252,40
buffer_load_dwordx4 v7, s[20:23], s43 offen lds
Mvav 36,252,44
s_waitcnt lgkmcnt(6)
TR 228,15,512
TR 230,15,2560
v_mfma_f32_16x16x32_bf16 v[248:251], a[232:235], v[176:179], 0
s_add_u32 s43, s50, 286720
v_exp_f32 v26, v66
v_mfma_f32_16x16x32_bf16 v[252:255], a[232:235], v[180:183], 0
s_add_u32 m0, s38, 155648
TR 232,16,512
TR 234,16,2560
Mvav 240,236,184
buffer_load_dwordx4 v7, s[20:23], s43 offen lds
Mvav 244,236,188
s_waitcnt lgkmcnt(6)
TR 236,15,4096
TR 238,15,6144
Mvav 248,240,184
s_add_u32 s43, s50, 327680
v_max_f32 v33, v32, v36
v_cmp_nge_f32 vcc, s39, v33
Mvav 252,240,188
s_add_u32 m0, s38, 147456
Tc25:
s_cbranch_execz Tr25
s_cmpk_eq_u32 s88, 28
s_cselect_b64 exec, 0, -1
s_cbranch_execz Tc28
Tr28:
s_mov_b64 exec, -1
TR 240,16,4096
TR 242,16,6144
s_cbranch_vccnz Lr44
Lb44:
Mvav 80,244,40
buffer_load_dwordx4 v7, s[20:23], s43 offen lds
Mvav 84,244,44
s_waitcnt lgkmcnt(6)
TR 244,15,4608
TR 246,15,6656
Mvav 88,224,40
s_add_u32 m0, s38, 114688
v_cvt_pk_bf16_f32 v28, v24, v25
Mvav 92,224,44
TR 224,16,4608
TR 226,16,6656
Mvav 96,228,40
v_exp_f32 v27, v67
Mvav 100,228,44
s_waitcnt lgkmcnt(6)
TR 228,15,8192
TR 230,15,10240
Mvav 104,232,40
buffer_load_dwordx4 v5, s[12:15], s33 offen nt lds
Mvav 108,232,44
s_add_u32 m0, s38, 102272
TR 232,16,8192
TR 234,16,10240
Mvav 112,236,40
v_exp_f32 v24, v72
Mvav 116,236,44
s_waitcnt lgkmcnt(6)
TR 236,15,8704
TR 238,15,10752
Mvav 120,240,40
v_cvt_pk_bf16_f32 v29, v26, v27
Mvav 124,240,44
TR 240,16,8704
TR 242,16,10752
Mvav 128,244,40
buffer_load_dwordx4 v5, s[12:15], s33 offen offset:128 nt lds
Mvav 132,244,44
s_waitcnt lgkmcnt(6)
TR 244,19,61440
TR 246,19,63488
Mvav 136,224,40
s_add_u32 m0, s38, 106240
v_exp_f32 v25, v73
Mvav 140,224,44
TR 224,20,61440
TR 226,20,63488
Mvav 144,228,40
v_exp_f32 v26, v74
Mvav 148,228,44
s_waitcnt lgkmcnt(6)
TR 228,19,61952
TR 230,19,64000
Mvav 152,232,40
buffer_load_dwordx4 v5, s[12:15], s33 offen offset:256 nt lds
Mvav 156,232,44
s_add_u32 s33, s33, 6144
TR 232,20,61952
TR 234,20,64000
Mvav 160,236,40
s_sub_u32 s45, s33, 98304
v_cvt_pk_bf16_f32 v0, v24, v25
s_min_u32 s33, s33, s45
Mvav 164,236,44
s_waitcnt lgkmcnt(6)
TR 236,19,40960
TR 238,19,43008
Mvav 168,240,40
s_add_u32 m0, s38, 36864
v_exp_f32 v27, v75
Mvav 172,240,44
TR 240,20,40960
TR 242,20,43008
Mvav 224,244,192
buffer_load_dwordx4 v5, s[12:15], s33 offen nt lds
Mvav 228,244,196
s_waitcnt lgkmcnt(6)
TR 244,19,41472
TR 246,19,43520
Mvav 232,224,192
s_add_u32 m0, s38, 130944
v_exp_f32 v24, v68
Mvav 236,224,196
s_waitcnt vmcnt(7)
TR 224,20,41472
TR 226,20,43520
Mvav 240,228,192
s_barrier
Mvav 244,228,196
s_waitcnt lgkmcnt(6)
ds_read_b128 a[228:231], v9 offset:12288
v_cvt_pk_bf16_f32 v1, v26, v27
Mvav 248,232,192
buffer_load_dwordx4 v5, s[12:15], s33 offen offset:128 nt lds
Mvav 252,232,196
s_add_u32 m0, s38, 118528
ds_read_b128 a[232:235], v9 offset:12800
Mvav 224,236,200
v_exp_f32 v25, v69
Mvav 228,236,204
s_waitcnt lgkmcnt(4)
ds_read_b128 a[236:239], v9 offset:16384
v_cvt_pk_bf16_f32 v30, v24, v25
Mvav 232,240,200
v_exp_f32 v26, v70
Mvav 236,240,204
ds_read_b128 a[240:243], v9 offset:16896
Mvav 240,244,200
buffer_load_dwordx4 v5, s[12:15], s33 offen offset:256 nt lds
Mvav 244,244,204
s_waitcnt lgkmcnt(3)
ds_read_b128 a[244:247], v11 offset:36864
s_add_u32 s33, s33, 6144
Mvav 248,224,200
s_sub_u32 s45, s33, 98304
v_exp_f32 v27, v71
Mvav 252,224,204
s_min_u32 s33, s33, s45
ds_read_b128 a[224:227], v11 offset:37376
v_add_u32 v5, 196608, v5
v_mfma_f32_16x16x32_bf16 v[48:51], a[228:231], a[208:211], 0
s_add_u32 s43, s50, 368640
v_cvt_pk_bf16_f32 v31, v26, v27
s_add_u32 m0, s38, 0
v_mfma_f32_16x16x32_bf16 v[56:59], a[228:231], a[212:215], 0
s_waitcnt lgkmcnt(3)
ds_read_b128 a[228:231], v9 offset:14336
Mvaa 48,232,216
buffer_load_dwordx4 v7, s[20:23], s43 offen lds
Mvaa 56,232,220
ds_read_b128 a[232:235], v9 offset:14848
Mvaa 48,236,248
v_exp_f32 v24, v76
Mvaa 56,236,0
s_waitcnt lgkmcnt(3)
ds_read_b128 a[236:239], v9 offset:18432
Mvaa 48,240,4
v_exp_f32 v25, v77
Mvaa 56,240,8
ds_read_b128 a[240:243], v9 offset:18944
v_cvt_pk_bf16_f32 v2, v24, v25
Mvaa 48,244,12
v_exp_f32 v26, v78
Mvaa 56,244,16
s_waitcnt lgkmcnt(3)
ds_read_b128 a[244:247], v11 offset:38912
Mvaa 48,224,20
v_exp_f32 v27, v79
Mvaa 56,224,24
ds_read_b128 a[224:227], v11 offset:39424
v_cvt_pk_bf16_f32 v3, v26, v27
v_mfma_f32_16x16x32_bf16 v[52:55], a[228:231], a[208:211], 0
v_exp_f32 v24, v48
v_mfma_f32_16x16x32_bf16 v[60:63], a[228:231], a[212:215], 0
s_waitcnt lgkmcnt(3)
TR 228,19,24576
TR 230,19,26624
Mvaa 52,232,216
v_exp_f32 v25, v49
Mvaa 60,232,220
TR 232,20,24576
TR 234,20,26624
Mvaa 52,236,248
v_exp_f32 v26, v50
Mvaa 60,236,0
s_waitcnt lgkmcnt(5)
TR 236,19,25088
TR 238,19,27136
Mvaa 52,240,4
v_cvt_pk_bf16_f32 v40, v24, v25
Mvaa 60,240,8
TR 240,20,25088
TR 242,20,27136
Mvaa 52,244,12
v_exp_f32 v27, v51
Mvaa 60,244,16
s_waitcnt lgkmcnt(6)
TR 244,19,12288
TR 246,19,14336
Mvaa 52,224,20
v_exp_f32 v24, v56
Mvaa 60,224,24
v_cvt_pk_bf16_f32 v41, v26, v27
Mvav 224,228,208
v_exp_f32 v25, v57
Mvav 228,228,212
s_waitcnt lgkmcnt(4)
TR 228,20,12288
TR 230,20,14336
Mvav 232,232,208
v_exp_f32 v26, v58
Mvav 236,232,212
TR 232,19,12800
TR 234,19,14848
Mvav 240,236,208
v_cvt_pk_bf16_f32 v44, v24, v25
Mvav 244,236,212
s_waitcnt vmcnt(8) lgkmcnt(4)
TR 236,20,12800
TR 238,20,14848
Mvav 248,240,208
s_barrier
Mvav 252,240,212
s_add_u32 s43, s50, 409600
TR 240,15,20480
TR 242,15,22528
Mvav 224,244,216
s_add_u32 m0, s38, 135168
v_exp_f32 v27, v59
Mvav 228,244,220
s_waitcnt lgkmcnt(6)
TR 244,16,20480
TR 246,16,22528
Mvav 32,252,28
buffer_load_dwordx4 v7, s[20:23], s43 offen lds
Mvav 36,252,0
s_add_u32 s43, s50, 450560
TR 224,15,20992
TR 226,15,23040
Mvav 232,228,216
s_add_u32 m0, s38, 139264
v_exp_f32 v24, v52
Mvav 236,228,220
s_waitcnt lgkmcnt(6)
TR 228,16,20992
TR 230,16,23040
Mvav 240,232,216
buffer_load_dwordx4 v7, s[20:23], s43 offen lds
Mvav 244,232,220
TR 232,15,24576
TR 234,15,26624
Mvav 248,236,216
v_max_f32 v33, v32, v36
v_cmp_nge_f32 vcc, s39, v33
Mvav 252,236,220
s_waitcnt lgkmcnt(6)
TR 236,16,24576
TR 238,16,26624
s_cbranch_vccnz Lr45
Lb45:
Mvav 80,240,28
v_cvt_pk_bf16_f32 v45, v26, v27
Mvav 84,240,0
TR 240,15,25088
TR 242,15,27136
Mvav 88,244,28
v_exp_f32 v25, v53
Mvav 92,244,0
s_waitcnt lgkmcnt(6)
TR 244,16,25088
TR 246,16,27136
Mvav 96,224,28
v_exp_f32 v26, v54
Mvav 100,224,0
TR 224,15,28672
TR 226,15,30720
Mvav 104,228,28
v_cvt_pk_bf16_f32 v42, v24, v25
Mvav 108,228,0
s_waitcnt lgkmcnt(6)
TR 228,16,28672
TR 230,16,30720
Mvav 112,232,28
v_exp_f32 v27, v55
Mvav 116,232,0
TR 232,15,29184
TR 234,15,31232
Mvav 120,236,28
v_cvt_pk_bf16_f32 v43, v26, v27
Mvav 124,236,0
s_waitcnt lgkmcnt(6)
TR 236,16,29184
TR 238,16,31232
Mvav 128,240,28
v_exp_f32 v24, v60
Mvav 132,240,0
TR 240,19,53248
TR 242,19,55296
Mvav 136,244,28
s_add_u32 m0, s38, 122880
v_exp_f32 v25, v61
Mvav 140,244,0
s_waitcnt lgkmcnt(6)
TR 244,20,53248
TR 246,20,55296
Mvav 144,224,28
buffer_load_dwordx4 v7, s[20:23], s59 offen lds
Mvav 148,224,0
s_add_u32 s43, s59, 40960
TR 224,19,53760
TR 226,19,55808
Mvav 152,228,28
s_add_u32 m0, s38, 4096
v_exp_f32 v26, v62
Mvav 156,228,0
s_waitcnt lgkmcnt(6)
TR 228,20,53760
TR 230,20,55808
Mvav 160,232,28
buffer_load_dwordx4 v7, s[20:23], s43 offen lds
Mvav 164,232,0
s_add_u32 s43, s59, 81920
TR 232,19,57344
TR 234,19,59392
Mvav 168,236,28
s_add_u32 m0, s38, 8192
v_cvt_pk_bf16_f32 v46, v24, v25
Mvav 172,236,0
s_waitcnt lgkmcnt(6)
TR 236,20,57344
TR 238,20,59392
Mvaa 224,240,160
buffer_load_dwordx4 v7, s[20:23], s43 offen lds
Mvaa 228,240,164
s_add_u32 s43, s59, 122880
TR 240,19,57856
TR 242,19,59904
Mvaa 232,244,160
s_add_u32 m0, s38, 12288
v_exp_f32 v27, v63
Mvaa 236,244,164
s_waitcnt vmcnt(5) lgkmcnt(6)
TR 244,20,57856
TR 246,20,59904
Mvaa 240,224,160
s_barrier
Mvaa 244,224,164
ds_read_b128 a[224:227], v9 offset:32768
v_cvt_pk_bf16_f32 v47, v26, v27
Mvaa 248,228,160
buffer_load_dwordx4 v7, s[20:23], s43 offen lds
Mvaa 252,228,164
s_waitcnt lgkmcnt(5)
ds_read_b128 a[228:231], v9 offset:33280
s_add_u32 m0, s38, 110592
Mvaa 224,232,168
Mvaa 228,232,172
ds_read_b128 a[232:235], v11 offset:45056
Mvaa 232,236,168
Mvaa 236,236,172
s_waitcnt lgkmcnt(3)
ds_read_b128 a[236:239], v11 offset:45568
Mvaa 240,240,168
buffer_load_dwordx4 v4, s[8:11], s32 offen nt lds
Mvaa 244,240,172
s_add_u32 m0, s38, 16256
ds_read_b128 a[240:243], v11 offset:28672
Mvaa 248,244,168
Mvaa 252,244,172
s_waitcnt lgkmcnt(3)
ds_read_b128 a[244:247], v11 offset:29184
v_mfma_f32_16x16x32_bf16 v[64:67], a[224:227], a[208:211], 0
v_mfma_f32_16x16x32_bf16 v[72:75], a[224:227], a[212:215], 0
ds_read_b128 a[224:227], v9 offset:34816
Mvaa 64,228,216
buffer_load_dwordx4 v4, s[8:11], s32 offen offset:128 nt lds
Mvaa 72,228,220
s_waitcnt lgkmcnt(3)
ds_read_b128 a[228:231], v9 offset:35328
s_add_u32 m0, s38, 20224
Mvaa 64,232,248
Mvaa 72,232,0
ds_read_b128 a[232:235], v11 offset:47104
Mvaa 64,236,4
Mvaa 72,236,8
s_waitcnt lgkmcnt(3)
ds_read_b128 a[236:239], v11 offset:47616
Mvaa 64,240,12
buffer_load_dwordx4 v4, s[8:11], s32 offen offset:256 nt lds
Mvaa 72,240,16
s_add_u32 s32, s32, 6144
ds_read_b128 a[240:243], v11 offset:30720
s_sub_u32 s45, s32, 98304
Mvaa 64,244,20
s_min_u32 s32, s32, s45
s_add_u32 m0, s38, 24576
Mvaa 72,244,24
s_waitcnt lgkmcnt(3)
ds_read_b128 a[244:247], v11 offset:31232
v_mfma_f32_16x16x32_bf16 v[68:71], a[224:227], a[208:211], 0
v_exp_f32 v24, v64
v_mfma_f32_16x16x32_bf16 v[76:79], a[224:227], a[212:215], 0
TR 224,19,49152
TR 226,19,51200
Mvaa 68,228,216
buffer_load_dwordx4 v4, s[8:11], s32 offen nt lds
Mvaa 76,228,220
s_waitcnt lgkmcnt(4)
TR 228,20,49152
TR 230,20,51200
Mvaa 68,232,248
s_add_u32 m0, s38, 28544
v_exp_f32 v25, v65
Mvaa 76,232,0
TR 232,19,49664
TR 234,19,51712
Mvaa 68,236,4
v_exp_f32 v26, v66
Mvaa 76,236,8
s_waitcnt lgkmcnt(6)
TR 236,20,49664
TR 238,20,51712
Mvaa 68,240,12
buffer_load_dwordx4 v4, s[8:11], s32 offen offset:128 nt lds
Mvaa 76,240,16
s_add_u32 m0, s38, 40704
TR 240,15,0
TR 242,15,2048
Mvaa 68,244,20
v_cvt_pk_bf16_f32 v28, v24, v25
Mvaa 76,244,24
s_waitcnt lgkmcnt(6)
v_exp_f32 v27, v67
Mvaa 224,224,176
v_exp_f32 v24, v72
Mvaa 228,224,180
TR 224,16,0
TR 226,16,2048
Mvaa 232,228,176
buffer_load_dwordx4 v4, s[8:11], s32 offen offset:256 nt lds
Mvaa 236,228,180
s_waitcnt lgkmcnt(4)
TR 228,15,512
TR 230,15,2560
Mvaa 240,232,176
s_add_u32 s32, s32, 6144
v_cvt_pk_bf16_f32 v29, v26, v27
s_sub_u32 s45, s32, 98304
Mvaa 244,232,180
s_waitcnt vmcnt(10)
TR 232,16,512
TR 234,16,2560
Mvaa 248,236,176
s_barrier
Mvaa 252,236,180
s_waitcnt lgkmcnt(6)
TR 236,19,16384
TR 238,19,18432
Mvaa 224,240,184
s_min_u32 s32, s32, s45
v_exp_f32 v25, v73
Mvaa 228,240,188
s_add_u32 s43, s59, 163840
TR 240,20,16384
TR 242,20,18432
Mvav 32,252,40
s_add_u32 m0, s38, 143360
v_exp_f32 v26, v74
Mvav 36,252,44
s_waitcnt lgkmcnt(6)
TR 244,19,16896
TR 246,19,18944
Mvaa 232,224,184
buffer_load_dwordx4 v7, s[20:23], s43 offen lds
Mvaa 236,224,188
TR 224,20,16896
TR 226,20,18944
Mvaa 240,228,184
v_max_f32 v33, v32, v36
v_cmp_nge_f32 vcc, s39, v33
Mvaa 244,228,188
s_waitcnt lgkmcnt(6)
TR 228,19,4096
TR 230,19,6144
Mvaa 248,232,184
v_cvt_pk_bf16_f32 v0, v24, v25
Mvaa 252,232,188
TR 232,20,4096
TR 234,20,6144
s_cbranch_vccnz Lr46
Lb46:
Mvav 80,236,40
v_exp_f32 v27, v75
Mvav 84,236,44
s_waitcnt lgkmcnt(6)
TR 236,19,4608
TR 238,19,6656
Mvav 88,240,40
v_exp_f32 v24, v68
Mvav 92,240,44
TR 240,20,4608
TR 242,20,6656
Mvav 96,244,40
v_cvt_pk_bf16_f32 v1, v26, v27
Mvav 100,244,44
s_waitcnt lgkmcnt(6)
TR 244,19,8192
TR 246,19,10240
Mvav 104,224,40
v_exp_f32 v25, v69
Mvav 108,224,44
TR 224,20,8192
TR 226,20,10240
Mvav 112,228,40
v_exp_f32 v26, v70
Mvav 116,228,44
s_waitcnt lgkmcnt(6)
TR 228,19,8704
TR 230,19,10752
Mvav 120,232,40
v_cvt_pk_bf16_f32 v30, v24, v25
Mvav 124,232,44
TR 232,20,8704
TR 234,20,10752
Mvav 128,236,40
v_exp_f32 v27, v71
Mvav 132,236,44
s_waitcnt lgkmcnt(6)
TR 236,19,36864
TR 238,19,38912
Mvav 136,240,40
v_cvt_pk_bf16_f32 v31, v26, v27
Mvav 140,240,44
TR 240,20,36864
TR 242,20,38912
Mvav 144,244,40
v_exp_f32 v24, v76
Mvav 148,244,44
s_waitcnt lgkmcnt(6)
TR 244,19,40960
TR 246,19,43008
Mvav 152,224,40
s_add_u32 s43, s59, 204800
v_exp_f32 v25, v77
Mvav 156,224,44
s_add_u32 m0, s38, 147456
TR 224,20,40960
TR 226,20,43008
Mvav 160,228,40
buffer_load_dwordx4 v7, s[20:23], s43 offen lds
Mvav 164,228,44
s_waitcnt lgkmcnt(6)
TR 228,19,37376
TR 230,19,39424
Mvav 168,232,40
s_add_u32 s43, s59, 245760
v_exp_f32 v26, v78
Mvav 172,232,44
s_add_u32 m0, s38, 126976
v_cvt_pk_bf16_f32 v2, v24, v25
Mvaa 224,236,192
buffer_load_dwordx4 v7, s[20:23], s43 offen lds
Mvaa 228,236,196
s_waitcnt lgkmcnt(4)
TR 236,20,37376
TR 238,20,39424
Mvaa 232,240,192
s_add_u32 s43, s59, 286720
v_exp_f32 v27, v79
Mvaa 236,240,196
s_add_u32 m0, s38, 32768
TR 240,19,41472
TR 242,19,43520
Mvaa 224,244,200
buffer_load_dwordx4 v7, s[20:23], s43 offen lds
Mvaa 228,244,204
s_waitcnt lgkmcnt(4)
TR 244,20,41472
TR 246,20,43520
Mvaa 232,224,200
s_barrier
Mvaa 236,224,204
s_add_u32 s43, s59, 327680
TR 224,15,36864
TR 226,15,38912
Tc26:
s_cbranch_execz Tr26
s_cmpk_eq_u32 s88, 29
s_cselect_b64 exec, 0, -1
s_cbranch_execz Tc29
Tr29:
s_mov_b64 exec, -1
Mvaa 240,228,192
s_add_u32 m0, s38, 114688
v_cvt_pk_bf16_f32 v3, v26, v27
v_cvt_pk_bf16_f32 v224, v224, v225
Mvaa 244,228,196
s_waitcnt lgkmcnt(6)
TR 228,16,36864
TR 230,16,38912
Mvav 32,252,28
buffer_load_dwordx4 v7, s[20:23], s43 offen lds
Mvav 36,252,0
s_add_u32 s43, s59, 368640
TR 232,15,37376
TR 234,15,39424
Mvaa 248,236,192
s_add_u32 m0, s38, 102400
v_cvt_pk_bf16_f32 v225, v226, v227
v_cvt_pk_bf16_f32 v226, v232, v233
Mvaa 252,236,196
s_waitcnt lgkmcnt(6)
TR 236,16,37376
TR 238,16,39424
Mvaa 240,240,200
buffer_load_dwordx4 v7, s[20:23], s43 offen lds
Mvaa 244,240,204
s_add_u32 s43, s59, 409600
TR 240,19,32768
TR 242,19,34816
Mvaa 248,244,200
s_add_u32 m0, s38, 106496
v_max_f32 v33, v32, v36
v_cmp_nge_f32 vcc, s39, v33
Mvaa 252,244,204
s_waitcnt lgkmcnt(6)
TR 244,20,32768
TR 246,20,34816
s_cbranch_vccnz Lr47
Lb47:
Mvav 80,224,28
buffer_load_dwordx4 v7, s[20:23], s43 offen lds
Mvav 84,224,0
s_add_u32 m0, s38, 0
TR 224,19,33280
TR 226,19,35328
Mvav 88,228,28
v_cvt_pk_bf16_f32 v227, v234, v235
v_accvgpr_write_b32 a156, v224
Mvav 92,228,0
s_waitcnt lgkmcnt(6)
TR 228,20,33280
TR 230,20,35328
Mvav 96,232,28
v_accvgpr_write_b32 a157, v225
v_accvgpr_write_b32 a158, v226
Mvav 100,232,0
TR 232,19,20480
TR 234,19,22528
Mvav 104,236,28
buffer_load_dwordx4 v5, s[12:15], s33 offen nt lds
Mvav 108,236,0
s_waitcnt lgkmcnt(6)
TR 236,20,20480
TR 238,20,22528
Mvav 112,240,28
s_add_u32 m0, s38, 44928
v_accvgpr_write_b32 a159, v227
v_cvt_pk_bf16_f32 v228, v228, v229
Mvav 116,240,0
TR 240,19,20992
TR 242,19,23040
Mvav 120,244,28
v_cvt_pk_bf16_f32 v229, v230, v231
v_cvt_pk_bf16_f32 v230, v236, v237
Mvav 124,244,0
s_waitcnt vmcnt(7) lgkmcnt(6)
TR 244,20,20992
TR 246,20,23040
Mvav 128,224,28
s_barrier
Mvav 132,224,0
ds_read_b128 a[224:227], v11 offset:12288
v_cvt_pk_bf16_f32 v231, v238, v239
Mvav 136,228,28
buffer_load_dwordx4 v5, s[12:15], s33 offen offset:128 nt lds
Mvav 140,228,0
s_waitcnt lgkmcnt(5)
ds_read_b128 a[228:231], v11 offset:12800
ds_write_b128 v13, v[228:231] offset:61440
Mvav 144,232,28
s_add_u32 m0, s38, 134912
v_cvt_pk_bf16_f32 v240, v240, v241
v_cvt_pk_bf16_f32 v241, v242, v243
Mvav 148,232,0
ds_read_b128 a[232:235], v9 offset:16384
v_cvt_pk_bf16_f32 v242, v248, v249
Mvav 152,236,28
v_cvt_pk_bf16_f32 v243, v250, v251
ds_write_b128 v13, v[240:243] offset:57344
Mvav 156,236,0
s_waitcnt lgkmcnt(5)
ds_read_b128 a[236:239], v9 offset:16896
v_cvt_pk_bf16_f32 v244, v244, v245
Mvav 160,240,28
buffer_load_dwordx4 v5, s[12:15], s33 offen offset:256 nt lds
Mvav 164,240,0
s_add_u32 s33, s33, 6144
ds_read_b128 a[240:243], v9 offset:20480
v_cvt_pk_bf16_f32 v245, v246, v247
Mvav 168,244,28
s_sub_u32 s45, s33, 98304
v_cvt_pk_bf16_f32 v246, v252, v253
v_cvt_pk_bf16_f32 v247, v254, v255
Mvav 172,244,0
s_waitcnt lgkmcnt(5)
ds_read_b128 a[244:247], v9 offset:20992
ds_write_b128 v13, v[244:247] offset:53248
v_mfma_f32_16x16x32_bf16 v[48:51], a[224:227], a[28:31], 0
s_min_u32 s33, s33, s45
v_rcp_f32 v12, v32
v_mfma_f32_16x16x32_bf16 v[56:59], a[224:227], a[32:35], 0
s_add_u32 m0, s38, 139264
ds_read_b128 a[224:227], v11 offset:14336
v_mul_f32 v80, v12, v80
Mvaa 48,228,36
buffer_load_dwordx4 v4, s[8:11], s32 offen nt lds
Mvaa 56,228,40
s_waitcnt lgkmcnt(4)
ds_read_b128 a[228:231], v11 offset:14848
v_mul_f32 v81, v12, v81
Mvaa 48,232,44
s_add_u32 m0, s38, 36736
v_rcp_f32 v8, v36
Mvaa 56,232,48
ds_read_b128 a[232:235], v9 offset:18432
v_mul_f32 v82, v12, v82
Mvaa 48,236,52
v_mul_f32 v83, v12, v83
v_mul_f32 v88, v12, v88
Mvaa 56,236,56
s_waitcnt lgkmcnt(4)
ds_read_b128 a[236:239], v9 offset:18944
v_mul_f32 v89, v12, v89
Mvaa 48,240,60
buffer_load_dwordx4 v4, s[8:11], s32 offen offset:128 nt lds
Mvaa 56,240,64
s_add_u32 m0, s38, 48896
ds_read_b128 a[240:243], v9 offset:22528
v_mul_f32 v90, v12, v90
Mvaa 48,244,68
v_mul_f32 v91, v12, v91
v_cvt_pk_bf16_f32 v80, v80, v81
Mvaa 56,244,72
s_waitcnt lgkmcnt(3)
ds_read_b128 a[244:247], v9 offset:23040
v_cvt_pk_bf16_f32 v81, v82, v83
v_mfma_f32_16x16x32_bf16 v[52:55], a[224:227], a[28:31], 0
v_exp_f32 v24, v48
v_mfma_f32_16x16x32_bf16 v[60:63], a[224:227], a[32:35], 0
TR 224,19,24576
TR 226,19,26624
Mvaa 52,228,36
buffer_load_dwordx4 v4, s[8:11], s32 offen offset:256 nt lds
Mvaa 60,228,40
s_waitcnt lgkmcnt(4)
TR 228,20,24576
TR 230,20,26624
Mvaa 52,232,44
s_add_u32 s32, s32, 6144
v_exp_f32 v25, v49
Mvaa 60,232,48
s_sub_u32 s45, s32, 98304
TR 232,15,4096
TR 234,15,6144
Mvaa 52,236,52
s_min_u32 s32, s32, s45
v_exp_f32 v26, v50
Mvaa 60,236,56
s_waitcnt lgkmcnt(6)
TR 236,16,4096
TR 238,16,6144
Mvaa 52,240,60
s_add_u32 s43, s59, 450560
v_cvt_pk_bf16_f32 v40, v24, v25
v_cvt_pk_bf16_f32 v82, v88, v89
Mvaa 60,240,64
s_add_u32 m0, s38, 53248
TR 240,19,25088
TR 242,19,27136
Mvaa 52,244,68
buffer_load_dwordx4 v7, s[20:23], s43 offen lds
Mvaa 60,244,72
s_waitcnt lgkmcnt(6)
TR 244,20,25088
TR 246,20,27136
v_mfma_f32_16x16x32_bf16 v[224:227], a[224:227], v[176:179], 0
v_exp_f32 v27, v51
v_mfma_f32_16x16x32_bf16 v[228:231], a[224:227], v[180:183], 0
TR 224,15,4608
TR 226,15,6656
v_mfma_f32_16x16x32_bf16 v[232:235], a[228:231], v[176:179], 0
v_exp_f32 v24, v56
v_mfma_f32_16x16x32_bf16 v[236:239], a[228:231], v[180:183], 0
s_waitcnt lgkmcnt(6)
TR 228,16,4608
TR 230,16,6656
Mvav 224,232,184
v_cvt_pk_bf16_f32 v41, v26, v27
v_cvt_pk_bf16_f32 v83, v90, v91
Mvav 228,232,188
TR 232,15,8192
TR 234,15,10240
Mvav 232,236,184
v_exp_f32 v25, v57
Mvav 236,236,188
s_waitcnt lgkmcnt(6)
TR 236,16,8192
TR 238,16,10240
v_mfma_f32_16x16x32_bf16 v[240:243], a[240:243], v[176:179], 0
v_exp_f32 v26, v58
v_mfma_f32_16x16x32_bf16 v[244:247], a[240:243], v[180:183], 0
TR 240,15,8704
TR 242,15,10752
v_mfma_f32_16x16x32_bf16 v[248:251], a[244:247], v[176:179], 0
v_cvt_pk_bf16_f32 v44, v24, v25
v_accvgpr_write_b32 a208, v80
v_mfma_f32_16x16x32_bf16 v[252:255], a[244:247], v[180:183], 0
s_waitcnt lgkmcnt(6)
TR 244,16,8704
TR 246,16,10752
Mvav 240,224,184
v_exp_f32 v27, v59
Mvav 244,224,188
TR 224,15,12288
TR 226,15,14336
Mvav 248,228,184
v_exp_f32 v24, v52
Mvav 252,228,188
s_waitcnt lgkmcnt(6)
TR 228,16,12288
TR 230,16,14336
Mvav 224,232,192
v_cvt_pk_bf16_f32 v45, v26, v27
v_accvgpr_write_b32 a209, v81
Mvav 228,232,196
TR 232,15,12800
TR 234,15,14848
Mvav 232,236,192
v_exp_f32 v25, v53
Mvav 236,236,196
s_waitcnt lgkmcnt(6)
TR 236,16,12800
TR 238,16,14848
Mvav 240,240,192
v_exp_f32 v26, v54
Mvav 244,240,196
s_add_u32 s43, s59, 491520
TR 240,19,45056
TR 242,19,47104
Mvav 248,244,192
s_add_u32 m0, s38, 57344
v_cvt_pk_bf16_f32 v42, v24, v25
v_accvgpr_write_b32 a210, v82
Mvav 252,244,196
s_waitcnt lgkmcnt(6)
TR 244,20,45056
TR 246,20,47104
Mvav 224,224,200
buffer_load_dwordx4 v7, s[20:23], s43 offen lds
Mvav 228,224,204
s_add_u32 m0, s38, 61440
TR 224,19,45568
TR 226,19,47616
Mvav 232,228,200
v_exp_f32 v27, v55
Mvav 236,228,204
s_waitcnt vmcnt(8) lgkmcnt(6)
TR 228,20,45568
TR 230,20,47616
Mvav 240,232,200
s_barrier
Mvav 244,232,204
ds_read_b128 a[232:235], v9 offset:24576
v_cvt_pk_bf16_f32 v43, v26, v27
Mvav 248,236,200
buffer_load_dwordx4 v5, s[12:15], s33 offen nt lds
Mvav 252,236,204
s_waitcnt lgkmcnt(5)
ds_read_b128 a[236:239], v9 offset:25088
v_accvgpr_write_b32 a211, v83
Mvav 224,240,208
s_add_u32 m0, s38, 130944
v_exp_f32 v24, v60
Mvav 228,240,212
ds_read_b128 a[240:243], v9 offset:28672
v_mul_f32 v84, v8, v84
Mvav 232,244,208
v_exp_f32 v25, v61
Mvav 236,244,212
s_waitcnt lgkmcnt(3)
ds_read_b128 a[244:247], v9 offset:29184
v_cvt_pk_bf16_f32 v46, v24, v25
Mvav 240,224,208
buffer_load_dwordx4 v5, s[12:15], s33 offen offset:128 nt lds
Mvav 244,224,212
s_add_u32 m0, s38, 118528
ds_read_b128 a[224:227], v9 offset:40960
v_mul_f32 v85, v8, v85
Mvav 248,228,208
v_exp_f32 v26, v62
Mvav 252,228,212
s_waitcnt lgkmcnt(3)
ds_read_b128 a[228:231], v9 offset:41472
v_mul_f32 v86, v8, v86
v_mfma_f32_16x16x32_bf16 v[64:67], a[232:235], a[28:31], 0
v_exp_f32 v27, v63
v_mfma_f32_16x16x32_bf16 v[72:75], a[232:235], a[32:35], 0
ds_read_b128 a[232:235], v9 offset:26624
v_cvt_pk_bf16_f32 v47, v26, v27
Mvaa 64,236,36
buffer_load_dwordx4 v5, s[12:15], s33 offen offset:256 nt lds
Mvaa 72,236,40
s_waitcnt lgkmcnt(3)
ds_read_b128 a[236:239], v9 offset:27136
v_mul_f32 v87, v8, v87
Mvaa 64,240,44
s_add_u32 s33, s33, 6144
v_mul_f32 v92, v8, v92
v_mul_f32 v93, v8, v93
Mvaa 72,240,48
s_sub_u32 s45, s33, 98304
ds_read_b128 a[240:243], v9 offset:30720
v_mul_f32 v94, v8, v94
Mvaa 64,244,52
s_min_u32 s33, s33, s45
v_mul_f32 v95, v8, v95
v_cvt_pk_bf16_f32 v84, v84, v85
Mvaa 72,244,56
s_waitcnt lgkmcnt(3)
ds_read_b128 a[244:247], v9 offset:31232
v_cvt_pk_bf16_f32 v85, v86, v87
Mvaa 64,224,60
s_add_u32 m0, s38, 122880
v_cvt_pk_bf16_f32 v86, v92, v93
v_cvt_pk_bf16_f32 v87, v94, v95
Mvaa 72,224,64
ds_read_b128 a[224:227], v9 offset:43008
v_accvgpr_write_b32 a212, v84
Mvaa 64,228,68
buffer_load_dwordx4 v4, s[8:11], s32 offen nt lds
Mvaa 72,228,72
s_waitcnt lgkmcnt(3)
ds_read_b128 a[228:231], v9 offset:43520
v_accvgpr_write_b32 a213, v85
v_mfma_f32_16x16x32_bf16 v[68:71], a[232:235], a[28:31], 0
s_add_u32 m0, s38, 110464
v_accvgpr_write_b32 a214, v86
v_accvgpr_write_b32 a215, v87
v_mfma_f32_16x16x32_bf16 v[76:79], a[232:235], a[32:35], 0
TR 232,19,49152
TR 234,19,51200
Mvaa 68,236,36
v_mul_f32 v96, v12, v96
v_mul_f32 v97, v12, v97
Mvaa 76,236,40
s_waitcnt lgkmcnt(4)
TR 236,20,49152
TR 238,20,51200
Mvaa 68,240,44
buffer_load_dwordx4 v4, s[8:11], s32 offen offset:128 nt lds
Mvaa 76,240,48
s_add_u32 m0, s38, 3840
TR 240,19,49664
TR 242,19,51712
Mvaa 68,244,52
v_mul_f32 v98, v12, v98
v_mul_f32 v99, v12, v99
Mvaa 76,244,56
s_waitcnt lgkmcnt(6)
TR 244,20,49664
TR 246,20,51712
Mvaa 68,224,60
v_mul_f32 v104, v12, v104
v_mul_f32 v105, v12, v105
Mvaa 76,224,64
TR 224,19,28672
TR 226,19,30720
Mvaa 68,228,68
buffer_load_dwordx4 v4, s[8:11], s32 offen offset:256 nt lds
Mvaa 76,228,72
s_waitcnt lgkmcnt(6)
TR 228,20,28672
TR 230,20,30720
Mvav 224,232,216
s_add_u32 s32, s32, 6144
v_mul_f32 v106, v12, v106
v_mul_f32 v107, v12, v107
Mvav 228,232,220
s_sub_u32 s45, s32, 98304
TR 232,19,29184
TR 234,19,31232
Mvav 232,236,216
s_min_u32 s32, s32, s45
v_cvt_pk_bf16_f32 v96, v96, v97
v_cvt_pk_bf16_f32 v97, v98, v99
Mvav 236,236,220
s_waitcnt lgkmcnt(6)
TR 236,20,29184
TR 238,20,31232
Mvav 240,240,216
s_add_u32 s43, s59, 532480
v_cvt_pk_bf16_f32 v98, v104, v105
v_cvt_pk_bf16_f32 v99, v106, v107
Mvav 244,240,220
s_add_u32 m0, s38, 8192
TR 240,15,32768
TR 242,15,34816
Mvav 248,244,216
buffer_load_dwordx4 v7, s[20:23], s43 offen lds
Mvav 252,244,220
s_waitcnt lgkmcnt(6)
TR 244,16,32768
TR 246,16,34816
Mvaa 224,224,160
v_accvgpr_write_b32 a216, v96
v_accvgpr_write_b32 a217, v97
Mvaa 228,224,164
TR 224,15,33280
TR 226,15,35328
Mvaa 232,228,160
v_accvgpr_write_b32 a218, v98
v_accvgpr_write_b32 a219, v99
Mvaa 236,228,164
s_waitcnt lgkmcnt(6)
TR 228,16,33280
TR 230,16,35328
Mvaa 240,232,160
v_mul_f32 v100, v8, v100
v_mul_f32 v101, v8, v101
Mvaa 244,232,164
TR 232,19,16384
TR 234,19,18432
Mvaa 248,236,160
v_mul_f32 v102, v8, v102
v_mul_f32 v103, v8, v103
Mvaa 252,236,164
s_waitcnt lgkmcnt(6)
TR 236,20,16384
TR 238,20,18432
Mvaa 224,240,168
v_mul_f32 v108, v8, v108
v_mul_f32 v109, v8, v109
Mvaa 228,240,172
TR 240,19,16896
TR 242,19,18944
Mvaa 232,244,168
v_mul_f32 v110, v8, v110
v_mul_f32 v111, v8, v111
Mvaa 236,244,172
s_waitcnt lgkmcnt(6)
TR 244,20,16896
TR 246,20,18944
Mvaa 240,224,168
v_cvt_pk_bf16_f32 v100, v100, v101
v_cvt_pk_bf16_f32 v101, v102, v103
Mvaa 244,224,172
TR 224,19,4096
TR 226,19,6144
Mvaa 248,228,168
v_cvt_pk_bf16_f32 v102, v108, v109
v_cvt_pk_bf16_f32 v103, v110, v111
Mvaa 252,228,172
s_waitcnt lgkmcnt(6)
TR 228,20,4096
TR 230,20,6144
Mvaa 224,232,176
v_accvgpr_write_b32 a220, v100
v_accvgpr_write_b32 a221, v101
Mvaa 228,232,180
TR 232,19,4608
TR 234,19,6656
Mvaa 232,236,176
v_accvgpr_write_b32 a222, v102
v_accvgpr_write_b32 a223, v103
Mvaa 236,236,180
s_waitcnt lgkmcnt(6)
TR 236,20,4608
TR 238,20,6656
Mvaa 240,240,176
v_mul_f32 v112, v12, v112
v_mul_f32 v113, v12, v113
Mvaa 244,240,180
s_add_u32 s43, s59, 573440
TR 240,19,8192
TR 242,19,10240
Mvaa 248,244,176
s_add_u32 m0, s38, 16384
v_mul_f32 v114, v12, v114
v_mul_f32 v115, v12, v115
Mvaa 252,244,180
s_waitcnt lgkmcnt(6)
v_mul_f32 v120, v12, v120
v_mul_f32 v121, v12, v121
Mvaa 224,224,184
buffer_load_dwordx4 v7, s[20:23], s43 offen lds
Mvaa 228,224,188
s_add_u32 s43, s59, 614400
TR 224,20,8192
TR 226,20,10240
Mvaa 232,228,184
s_add_u32 m0, s38, 20480
v_mul_f32 v122, v12, v122
v_mul_f32 v123, v12, v123
Mvaa 236,228,188
s_waitcnt lgkmcnt(4)
TR 228,19,8704
TR 230,19,10752
Mvaa 240,232,184
buffer_load_dwordx4 v7, s[20:23], s43 offen lds
Mvaa 244,232,188
s_waitcnt vmcnt(9)
TR 232,20,8704
TR 234,20,10752
Mvaa 248,236,184
s_barrier
Mvaa 252,236,188
s_waitcnt lgkmcnt(6)
TR 236,15,0
TR 238,15,2048
Mvaa 224,240,192
s_add_u32 s43, s59, 655360
v_cvt_pk_bf16_f32 v112, v112, v113
v_cvt_pk_bf16_f32 v113, v114, v115
Mvaa 228,240,196
s_add_u32 m0, s38, 126976
TR 240,16,0
TR 242,16,2048
v_mfma_f32_16x16x32_bf16 v[32:35], a[252:255], v[40:43], 0
buffer_load_dwordx4 v7, s[20:23], s43 offen lds
v_mfma_f32_16x16x32_bf16 v[36:39], a[252:255], v[44:47], 0
s_waitcnt lgkmcnt(6)
TR 244,15,512
TR 246,15,2560
Mvaa 232,224,192
s_add_u32 m0, s38, 114688
v_cvt_pk_bf16_f32 v114, v120, v121
v_cvt_pk_bf16_f32 v115, v122, v123
Mvaa 236,224,196
TR 224,16,512
TR 226,16,2560
Mvaa 240,228,192
s_mov_b32 s39, 0x4b800000
v_min_f32 v33, v32, v36
v_accvgpr_write_b32 a248, v112
Mvaa 244,228,196
s_waitcnt lgkmcnt(6)
TR 228,15,45056
TR 230,15,47104
Mvaa 248,232,192
buffer_load_dwordx4 v5, s[12:15], s33 offen nt lds
Mvaa 252,232,196
s_add_u32 m0, s38, 102272
TR 232,16,45056
TR 234,16,47104
v_rcp_f32 v33, v33
s_nop 0
v_max3_f32 v33, v33, v32, v36
v_cmp_nge_f32 vcc, s39, v33
s_cbranch_vccnz Lr48
Lb48:
v_mfma_f32_16x16x32_bf16 v[80:83], a[236:239], v[40:43], 0
Tc27:
s_cbranch_execz Tr27
s_cmpk_eq_u32 s88, 30
s_cselect_b64 exec, 0, -1
s_cbranch_execz Tc30
Tr30:
s_mov_b64 exec, -1
v_accvgpr_write_b32 a249, v113
v_accvgpr_write_b32 a250, v114
v_mfma_f32_16x16x32_bf16 v[84:87], a[236:239], v[44:47], 0
s_waitcnt lgkmcnt(6)
TR 236,15,45568
TR 238,15,47616
v_mfma_f32_16x16x32_bf16 v[88:91], a[240:243], v[40:43], 0
v_accvgpr_write_b32 a251, v115
v_mul_f32 v116, v8, v116
v_mfma_f32_16x16x32_bf16 v[92:95], a[240:243], v[44:47], 0
TR 240,16,45568
TR 242,16,47616
v_mfma_f32_16x16x32_bf16 v[96:99], a[244:247], v[40:43], 0
buffer_load_dwordx4 v5, s[12:15], s33 offen offset:128 nt lds
v_mfma_f32_16x16x32_bf16 v[100:103], a[244:247], v[44:47], 0
s_waitcnt lgkmcnt(6)
TR 244,19,36864
TR 246,19,38912
v_mfma_f32_16x16x32_bf16 v[104:107], a[224:227], v[40:43], 0
s_add_u32 m0, s38, 12032
v_mul_f32 v117, v8, v117
v_mul_f32 v118, v8, v118
v_mfma_f32_16x16x32_bf16 v[108:111], a[224:227], v[44:47], 0
TR 224,20,36864
TR 226,20,38912
v_mfma_f32_16x16x32_bf16 v[112:115], a[228:231], v[40:43], 0
v_mul_f32 v119, v8, v119
v_mul_f32 v124, v8, v124
v_mul_f32 v125, v8, v125
v_pk_mul_f32 v[126:127], v[126:127], v[8:9] op_sel_hi:[1,0]
v_cvt_pk_bf16_f32 v116, v116, v117
v_cvt_pk_bf16_f32 v117, v118, v119
v_cvt_pk_bf16_f32 v118, v124, v125
v_cvt_pk_bf16_f32 v119, v126, v127
v_accvgpr_write_b32 a0, v116
v_accvgpr_write_b32 a1, v117
v_accvgpr_write_b32 a2, v118
v_accvgpr_write_b32 a3, v119
v_mfma_f32_16x16x32_bf16 v[116:119], a[228:231], v[44:47], 0
s_waitcnt lgkmcnt(6)
TR 228,19,37376
TR 230,19,39424
v_mfma_f32_16x16x32_bf16 v[120:123], a[232:235], v[40:43], 0
buffer_load_dwordx4 v5, s[12:15], s33 offen offset:256 nt lds
v_mfma_f32_16x16x32_bf16 v[124:127], a[232:235], v[44:47], 0
s_add_u32 s33, s33, 6144
TR 232,20,37376
TR 234,20,39424
v_mul_f32 v128, v12, v128
v_mul_f32 v129, v12, v129
v_pk_mul_f32 v[130:131], v[130:131], v[12:13] op_sel_hi:[1,0]
v_pk_mul_f32 v[136:137], v[136:137], v[12:13] op_sel_hi:[1,0]
v_pk_mul_f32 v[138:139], v[138:139], v[12:13] op_sel_hi:[1,0]
v_cvt_pk_bf16_f32 v128, v128, v129
v_cvt_pk_bf16_f32 v129, v130, v131
v_cvt_pk_bf16_f32 v130, v136, v137
v_cvt_pk_bf16_f32 v131, v138, v139
v_accvgpr_write_b32 a4, v128
v_accvgpr_write_b32 a5, v129
v_accvgpr_write_b32 a6, v130
v_accvgpr_write_b32 a7, v131
v_mfma_f32_16x16x32_bf16 v[128:131], a[236:239], v[40:43], 0
s_sub_u32 s45, s33, 98304
v_mul_f32 v132, v8, v132
v_mul_f32 v133, v8, v133
v_mul_f32 v134, v8, v134
v_mul_f32 v135, v8, v135
v_pk_mul_f32 v[140:141], v[140:141], v[8:9] op_sel_hi:[1,0]
v_pk_mul_f32 v[142:143], v[142:143], v[8:9] op_sel_hi:[1,0]
v_cvt_pk_bf16_f32 v132, v132, v133
v_cvt_pk_bf16_f32 v133, v134, v135
v_cvt_pk_bf16_f32 v134, v140, v141
v_cvt_pk_bf16_f32 v135, v142, v143
v_accvgpr_write_b32 a8, v132
v_accvgpr_write_b32 a9, v133
v_accvgpr_write_b32 a10, v134
v_accvgpr_write_b32 a11, v135
v_mfma_f32_16x16x32_bf16 v[132:135], a[236:239], v[44:47], 0
s_waitcnt lgkmcnt(6)
TR 236,17,4096
TR 238,17,6144
v_mfma_f32_16x16x32_bf16 v[136:139], a[240:243], v[40:43], 0
s_min_u32 s33, s33, s45
v_mul_f32 v144, v12, v144
v_mul_f32 v145, v12, v145
v_mfma_f32_16x16x32_bf16 v[140:143], a[240:243], v[44:47], 0
s_add_u32 m0, s38, 24576
TR 240,18,4096
TR 242,18,6144
v_mul_f32 v146, v12, v146
v_mul_f32 v147, v12, v147
v_pk_mul_f32 v[152:153], v[152:153], v[12:13] op_sel_hi:[1,0]
v_pk_mul_f32 v[154:155], v[154:155], v[12:13] op_sel_hi:[1,0]
v_cvt_pk_bf16_f32 v144, v144, v145
v_cvt_pk_bf16_f32 v145, v146, v147
v_cvt_pk_bf16_f32 v146, v152, v153
v_cvt_pk_bf16_f32 v147, v154, v155
v_accvgpr_write_b32 a12, v144
v_accvgpr_write_b32 a13, v145
v_accvgpr_write_b32 a14, v146
v_accvgpr_write_b32 a15, v147
v_mfma_f32_16x16x32_bf16 v[144:147], a[244:247], v[40:43], 0
buffer_load_dwordx4 v4, s[8:11], s32 offen nt lds
v_mul_f32 v148, v8, v148
v_mul_f32 v149, v8, v149
v_mul_f32 v150, v8, v150
v_mul_f32 v151, v8, v151
v_pk_mul_f32 v[156:157], v[156:157], v[8:9] op_sel_hi:[1,0]
v_pk_mul_f32 v[158:159], v[158:159], v[8:9] op_sel_hi:[1,0]
v_cvt_pk_bf16_f32 v148, v148, v149
v_cvt_pk_bf16_f32 v149, v150, v151
v_cvt_pk_bf16_f32 v150, v156, v157
v_cvt_pk_bf16_f32 v151, v158, v159
v_accvgpr_write_b32 a16, v148
v_accvgpr_write_b32 a17, v149
v_accvgpr_write_b32 a18, v150
v_accvgpr_write_b32 a19, v151
v_mfma_f32_16x16x32_bf16 v[148:151], a[244:247], v[44:47], 0
s_waitcnt lgkmcnt(6)
TR 244,17,4608
TR 246,17,6656
v_mfma_f32_16x16x32_bf16 v[152:155], a[224:227], v[40:43], 0
s_add_u32 m0, s38, 28544
v_mul_f32 v160, v12, v160
v_mul_f32 v161, v12, v161
v_mfma_f32_16x16x32_bf16 v[156:159], a[224:227], v[44:47], 0
TR 224,18,4608
TR 226,18,6656
v_mul_f32 v162, v12, v162
v_mul_f32 v163, v12, v163
v_pk_mul_f32 v[168:169], v[168:169], v[12:13] op_sel_hi:[1,0]
v_pk_mul_f32 v[170:171], v[170:171], v[12:13] op_sel_hi:[1,0]
v_cvt_pk_bf16_f32 v160, v160, v161
v_cvt_pk_bf16_f32 v161, v162, v163
v_cvt_pk_bf16_f32 v162, v168, v169
v_cvt_pk_bf16_f32 v163, v170, v171
v_accvgpr_write_b32 a20, v160
v_accvgpr_write_b32 a21, v161
v_accvgpr_write_b32 a22, v162
v_accvgpr_write_b32 a23, v163
v_mfma_f32_16x16x32_bf16 v[160:163], a[228:231], v[40:43], 0
v_mul_f32 v164, v8, v164
v_mul_f32 v165, v8, v165
v_mul_f32 v166, v8, v166
v_mul_f32 v167, v8, v167
v_pk_mul_f32 v[172:173], v[172:173], v[8:9] op_sel_hi:[1,0]
v_pk_mul_f32 v[174:175], v[174:175], v[8:9] op_sel_hi:[1,0]
v_cvt_pk_bf16_f32 v164, v164, v165
v_cvt_pk_bf16_f32 v165, v166, v167
v_cvt_pk_bf16_f32 v166, v172, v173
v_cvt_pk_bf16_f32 v167, v174, v175
v_accvgpr_write_b32 a24, v164
v_accvgpr_write_b32 a25, v165
v_accvgpr_write_b32 a26, v166
v_accvgpr_write_b32 a27, v167
v_mfma_f32_16x16x32_bf16 v[164:167], a[228:231], v[44:47], 0
s_waitcnt lgkmcnt(6)
TR 228,17,8192
TR 230,17,10240
v_mfma_f32_16x16x32_bf16 v[168:171], a[232:235], v[40:43], 0
buffer_load_dwordx4 v4, s[8:11], s32 offen offset:128 nt lds
v_mfma_f32_16x16x32_bf16 v[172:175], a[232:235], v[44:47], 0
s_add_u32 m0, s38, 32512
TR 232,18,8192
TR 234,18,10240
Mvaa 224,236,200
v_exp_f32 v24, v64
Mvaa 228,236,204
s_waitcnt lgkmcnt(6)
TR 236,17,8704
TR 238,17,10752
Mvaa 232,240,200
v_exp_f32 v25, v65
Mvaa 236,240,204
s_waitcnt vmcnt(8)
TR 240,18,8704
TR 242,18,10752
Mvaa 240,244,200
s_barrier
Mvaa 244,244,204
s_waitcnt lgkmcnt(6)
ds_read_b128 a[244:247], v11 offset:40960
v_cvt_pk_bf16_f32 v28, v24, v25
Mvaa 248,224,200
buffer_load_dwordx4 v4, s[8:11], s32 offen offset:256 nt lds
Mvaa 252,224,204
s_add_u32 s32, s32, 6144
ds_read_b128 a[224:227], v11 offset:41472
s_sub_u32 s45, s32, 98304
Mvaa 224,228,208
s_min_u32 s32, s32, s45
v_exp_f32 v26, v66
Mvaa 228,228,212
s_waitcnt lgkmcnt(4)
ds_read_b128 a[228:231], v9 offset:36864
s_add_u32 s43, s59, 696320
Mvaa 232,232,208
s_add_u32 m0, s38, 106496
v_exp_f32 v27, v67
Mvaa 236,232,212
ds_read_b128 a[232:235], v9 offset:37376
v_cvt_pk_bf16_f32 v29, v26, v27
Mvaa 240,236,208
buffer_load_dwordx4 v7, s[20:23], s43 offen lds
Mvaa 244,236,212
s_waitcnt lgkmcnt(3)
ds_read_b128 a[236:239], v10 offset:0
Mvaa 248,240,208
v_exp_f32 v24, v72
Mvaa 252,240,212
ds_read_b128 a[240:243], v10 offset:512
v_mfma_f32_16x16x32_bf16 v[48:51], a[244:247], a[28:31], 0
v_exp_f32 v25, v73
v_mfma_f32_16x16x32_bf16 v[56:59], a[244:247], a[32:35], 0
s_waitcnt lgkmcnt(3)
ds_read_b128 a[244:247], v11 offset:43008
v_cvt_pk_bf16_f32 v0, v24, v25
Mvaa 48,224,36
v_exp_f32 v26, v74
Mvaa 56,224,40
ds_read_b128 a[224:227], v11 offset:43520
Mvaa 48,228,44
v_exp_f32 v27, v75
Mvaa 56,228,48
s_waitcnt lgkmcnt(3)
ds_read_b128 a[228:231], v9 offset:38912
v_cvt_pk_bf16_f32 v1, v26, v27
Mvaa 48,232,52
v_exp_f32 v24, v68
Mvaa 56,232,56
ds_read_b128 a[232:235], v9 offset:39424
Mvaa 48,236,60
v_exp_f32 v25, v69
Mvaa 56,236,64
s_waitcnt lgkmcnt(3)
ds_read_b128 a[236:239], v10 offset:2048
v_cvt_pk_bf16_f32 v30, v24, v25
Mvaa 48,240,68
v_exp_f32 v26, v70
Mvaa 56,240,72
ds_read_b128 a[240:243], v10 offset:2560
v_mfma_f32_16x16x32_bf16 v[52:55], a[244:247], a[28:31], 0
v_exp_f32 v27, v71
v_mfma_f32_16x16x32_bf16 v[60:63], a[244:247], a[32:35], 0
s_waitcnt lgkmcnt(3)
TR 244,15,8192
TR 246,15,10240
Mvaa 52,224,36
v_cvt_pk_bf16_f32 v31, v26, v27
Mvaa 60,224,40
v_exp_f32 v24, v76
Mvaa 52,228,44
v_exp_f32 v25, v77
Mvaa 60,228,48
s_waitcnt lgkmcnt(3)
TR 228,16,8192
TR 230,16,10240
Mvaa 52,232,52
v_exp_f32 v26, v78
Mvaa 60,232,56
TR 232,15,8704
TR 234,15,10752
Mvaa 52,236,60
v_cvt_pk_bf16_f32 v2, v24, v25
Mvaa 60,236,64
s_waitcnt vmcnt(8) lgkmcnt(4)
TR 236,16,8704
TR 238,16,10752
Mvaa 52,240,68
s_barrier
Mvaa 60,240,72
s_add_u32 m0, s38, 0
TR 240,17,12288
TR 242,17,14336
Mvaa 224,244,216
buffer_load_dwordx4 v7, s[20:23], s51 offen lds
Mvaa 228,244,220
s_waitcnt lgkmcnt(6)
TR 244,18,12288
TR 246,18,14336
Mvav 32,252,28
s_add_u32 s43, s51, 40960
v_exp_f32 v27, v79
s_nop 0
v_cvt_pk_bf16_f32 v3, v26, v27
s_nop 1
Mvav 36,252,0
s_add_u32 m0, s38, 36864
TR 224,17,12800
TR 226,17,14848
Mvaa 232,228,216
buffer_load_dwordx4 v7, s[20:23], s43 offen lds
Mvaa 236,228,220
s_waitcnt lgkmcnt(6)
TR 228,18,12800
TR 230,18,14848
Mvaa 240,232,216
s_add_u32 m0, s38, 40960
v_max_f32 v33, v32, v36
v_cmp_nge_f32 vcc, s39, v33
Mvaa 244,232,220
TR 232,19,32768
TR 234,19,34816
Mvaa 248,236,216
v_exp_f32 v24, v48
Mvaa 252,236,220
s_waitcnt lgkmcnt(6)
TR 236,20,32768
TR 238,20,34816
s_cbranch_vccnz Lr49
Lb49:
Mvav 80,240,28
buffer_load_dwordx4 v5, s[12:15], s33 offen nt lds
Mvav 84,240,0
s_add_u32 m0, s38, 44928
TR 240,19,33280
TR 242,19,35328
Mvav 88,244,28
v_exp_f32 v25, v49
Mvav 92,244,0
s_waitcnt lgkmcnt(6)
TR 244,20,33280
TR 246,20,35328
Mvav 96,224,28
v_exp_f32 v26, v50
Mvav 100,224,0
TR 224,19,20480
TR 226,19,22528
Mvav 104,228,28
buffer_load_dwordx4 v5, s[12:15], s33 offen offset:128 nt lds
Mvav 108,228,0
s_waitcnt lgkmcnt(6)
TR 228,20,20480
TR 230,20,22528
Mvav 112,232,28
s_add_u32 m0, s38, 48896
v_cvt_pk_bf16_f32 v40, v24, v25
Mvav 116,232,0
TR 232,19,20992
TR 234,19,23040
Mvav 120,236,28
v_exp_f32 v27, v51
Mvav 124,236,0
s_waitcnt lgkmcnt(6)
TR 236,20,20992
TR 238,20,23040
Mvav 128,240,28
buffer_load_dwordx4 v5, s[12:15], s33 offen offset:256 nt lds
Mvav 132,240,0
s_add_u32 s33, s33, 6144
TR 240,15,16384
TR 242,15,18432
Mvav 136,244,28
s_sub_u32 s45, s33, 98304
v_exp_f32 v24, v56
Mvav 140,244,0
s_waitcnt lgkmcnt(6)
TR 244,16,16384
TR 246,16,18432
Mvav 144,224,28
s_min_u32 s33, s33, s45
v_cvt_pk_bf16_f32 v41, v26, v27
s_add_u32 m0, s38, 53248
Mvav 148,224,0
TR 224,15,16896
TR 226,15,18944
Mvav 152,228,28
buffer_load_dwordx4 v4, s[8:11], s32 offen nt lds
Mvav 156,228,0
s_waitcnt lgkmcnt(6)
TR 228,16,16896
TR 230,16,18944
Mvav 160,232,28
s_add_u32 m0, s38, 57216
v_exp_f32 v25, v57
Mvav 164,232,0
TR 232,15,20480
TR 234,15,22528
Mvav 168,236,28
v_exp_f32 v26, v58
Mvav 172,236,0
s_waitcnt lgkmcnt(6)
TR 236,16,20480
TR 238,16,22528
Mvaa 224,240,248
buffer_load_dwordx4 v4, s[8:11], s32 offen offset:128 nt lds
Mvaa 228,240,0
s_add_u32 m0, s38, 65280
TR 240,15,20992
TR 242,15,23040
Mvaa 232,244,248
v_cvt_pk_bf16_f32 v44, v24, v25
Mvaa 236,244,0
s_waitcnt vmcnt(7) lgkmcnt(6)
TR 244,16,20992
TR 246,16,23040
Mvaa 240,224,248
s_barrier
Mvaa 244,224,0
ds_read_b128 a[224:227], v11 offset:24576
Mvaa 248,228,248
buffer_load_dwordx4 v4, s[8:11], s32 offen offset:256 nt lds
Mvaa 252,228,0
s_waitcnt lgkmcnt(5)
ds_read_b128 a[228:231], v11 offset:25088
s_add_u32 s32, s32, 6144
Mvaa 224,232,4
s_sub_u32 s45, s32, 98304
v_exp_f32 v27, v59
Mvaa 228,232,8
s_min_u32 s32, s32, s45
ds_read_b128 a[232:235], v11 offset:12288
v_cvt_pk_bf16_f32 v45, v26, v27
Mvaa 232,236,4
s_add_u32 s43, s51, 81920
v_exp_f32 v24, v52
Mvaa 236,236,8
s_waitcnt lgkmcnt(3)
ds_read_b128 a[236:239], v11 offset:12800
s_add_u32 m0, s38, 131072
Mvaa 240,240,4
buffer_load_dwordx4 v7, s[20:23], s43 offen lds
Mvaa 244,240,8
ds_read_b128 a[240:243], v9 offset:4096
Mvaa 248,244,4
v_exp_f32 v25, v53
Mvaa 252,244,8
s_waitcnt lgkmcnt(3)
ds_read_b128 a[244:247], v9 offset:4608
v_cvt_pk_bf16_f32 v42, v24, v25
v_mfma_f32_16x16x32_bf16 v[64:67], a[224:227], a[28:31], 0
v_exp_f32 v26, v54
v_mfma_f32_16x16x32_bf16 v[72:75], a[224:227], a[32:35], 0
ds_read_b128 a[224:227], v11 offset:26624
Mvaa 64,228,36
v_exp_f32 v27, v55
Mvaa 72,228,40
s_waitcnt lgkmcnt(3)
ds_read_b128 a[228:231], v11 offset:27136
v_cvt_pk_bf16_f32 v43, v26, v27
Mvaa 64,232,44
v_exp_f32 v24, v60
Mvaa 72,232,48
ds_read_b128 a[232:235], v11 offset:14336
Mvaa 64,236,52
v_exp_f32 v25, v61
Mvaa 72,236,56
s_waitcnt lgkmcnt(3)
ds_read_b128 a[236:239], v11 offset:14848
v_cvt_pk_bf16_f32 v46, v24, v25
Mvaa 64,240,60
v_exp_f32 v26, v62
Mvaa 72,240,64
ds_read_b128 a[240:243], v9 offset:6144
Mvaa 64,244,68
v_exp_f32 v27, v63
Mvaa 72,244,72
s_waitcnt lgkmcnt(3)
ds_read_b128 a[244:247], v9 offset:6656
v_cvt_pk_bf16_f32 v47, v26, v27
v_mfma_f32_16x16x32_bf16 v[68:71], a[224:227], a[28:31], 0
v_exp_f32 v24, v64
v_mfma_f32_16x16x32_bf16 v[76:79], a[224:227], a[32:35], 0
TR 224,19,28672
TR 226,19,30720
Mvaa 68,228,36
v_exp_f32 v25, v65
Mvaa 76,228,40
s_waitcnt lgkmcnt(4)
TR 228,20,28672
TR 230,20,30720
Mvaa 68,232,44
v_exp_f32 v26, v66
Mvaa 76,232,48
TR 232,19,8192
TR 234,19,10240
Mvaa 68,236,52
v_cvt_pk_bf16_f32 v28, v24, v25
Mvaa 76,236,56
s_waitcnt lgkmcnt(6)
TR 236,20,8192
TR 238,20,10240
Mvaa 68,240,60
v_exp_f32 v27, v67
Mvaa 76,240,64
TR 240,19,29184
TR 242,19,31232
Mvaa 68,244,68
v_exp_f32 v24, v72
Mvaa 76,244,72
s_waitcnt lgkmcnt(6)
v_cvt_pk_bf16_f32 v29, v26, v27
s_add_u32 s43, s51, 122880
Mvaa 224,224,12
s_add_u32 m0, s38, 118784
v_exp_f32 v25, v73
Mvaa 228,224,16
TR 224,20,29184
TR 226,20,31232
Mvaa 232,228,12
buffer_load_dwordx4 v7, s[20:23], s43 offen lds
Mvaa 236,228,16
s_waitcnt lgkmcnt(4)
TR 228,19,8704
TR 230,19,10752
Mvaa 224,232,20
s_add_u32 s43, s51, 163840
v_exp_f32 v26, v74
Mvaa 228,232,24
s_waitcnt vmcnt(8)
TR 232,20,8704
TR 234,20,10752
Mvaa 232,236,20
s_barrier
Mvaa 236,236,24
s_waitcnt lgkmcnt(6)
TR 236,19,16384
TR 238,19,18432
Mvaa 240,240,12
s_add_u32 m0, s38, 8192
v_cvt_pk_bf16_f32 v224, v224, v225
v_cvt_pk_bf16_f32 v225, v226, v227
Mvaa 244,240,16
TR 240,20,16384
TR 242,20,18432
Mvav 32,252,40
buffer_load_dwordx4 v7, s[20:23], s43 offen lds
Mvav 36,252,44
s_waitcnt lgkmcnt(6)
TR 244,19,16896
TR 246,19,18944
Mvaa 248,224,12
s_add_u32 s43, s51, 204800
v_cvt_pk_bf16_f32 v226, v232, v233
v_cvt_pk_bf16_f32 v227, v234, v235
Mvaa 252,224,16
s_add_u32 m0, s38, 122880
TR 224,20,16896
TR 226,20,18944
Mvaa 240,228,20
buffer_load_dwordx4 v7, s[20:23], s43 offen lds
Mvaa 244,228,24
s_waitcnt lgkmcnt(6)
TR 228,19,4096
TR 230,19,6144
Mvaa 248,232,20
s_add_u32 m0, s38, 110592
v_max_f32 v33, v32, v36
v_cmp_nge_f32 vcc, s39, v33
Mvaa 252,232,24
TR 232,20,4096
TR 234,20,6144
s_cbranch_vccnz Lr50
Lb50:
Mvav 80,236,40
ds_write_b128 v13, v[224:227] offset:49152
v_cvt_pk_bf16_f32 v228, v228, v229
Mvav 84,236,44
s_waitcnt lgkmcnt(7)
TR 236,19,4608
TR 238,19,6656
Mvav 88,240,40
buffer_load_dwordx4 v5, s[12:15], s33 offen nt lds
Mvav 92,240,44
s_add_u32 m0, s38, 3968
TR 240,20,4608
TR 242,20,6656
Mvav 96,244,40
v_cvt_pk_bf16_f32 v229, v230, v231
v_cvt_pk_bf16_f32 v230, v236, v237
Mvav 100,244,44
s_waitcnt lgkmcnt(7)
TR 244,15,12288
TR 246,15,14336
Mvav 104,224,40
Tc28:
s_cbranch_execz Tr28
s_cmpk_eq_u32 s88, 31
s_cselect_b64 exec, 0, -1
s_cbranch_execz Tc31
Tr31:
s_mov_b64 exec, -1
v_cvt_pk_bf16_f32 v231, v238, v239
ds_write_b128 v13, v[228:231] offset:45056
Mvav 108,224,44
TR 224,16,12288
TR 226,16,14336
Mvav 112,228,40
buffer_load_dwordx4 v5, s[12:15], s33 offen offset:128 nt lds
Mvav 116,228,44
s_waitcnt lgkmcnt(7)
TR 228,15,12800
TR 230,15,14848
Mvav 120,232,40
s_add_u32 m0, s38, 16128
v_cvt_pk_bf16_f32 v240, v240, v241
v_cvt_pk_bf16_f32 v241, v242, v243
Mvav 124,232,44
TR 232,16,12800
TR 234,16,14848
Mvav 128,236,40
v_cvt_pk_bf16_f32 v242, v248, v249
v_cvt_pk_bf16_f32 v243, v250, v251
Mvav 132,236,44
s_waitcnt lgkmcnt(7)
TR 236,15,0
TR 238,15,2048
Mvav 136,240,40
buffer_load_dwordx4 v5, s[12:15], s33 offen offset:256 nt lds
Mvav 140,240,44
s_add_u32 s33, s33, 6144
TR 240,16,0
TR 242,16,2048
Mvav 144,244,40
s_sub_u32 s45, s33, 98304
ds_write_b128 v13, v[240:243] offset:40960
v_cvt_pk_bf16_f32 v244, v244, v245
Mvav 148,244,44
s_waitcnt lgkmcnt(7)
TR 244,15,36864
TR 246,15,38912
Mvav 152,224,40
s_min_u32 s33, s33, s45
v_cvt_pk_bf16_f32 v245, v246, v247
v_cvt_pk_bf16_f32 v246, v252, v253
Mvav 156,224,44
s_add_u32 m0, s38, 20480
TR 224,16,36864
TR 226,16,38912
Mvav 160,228,40
buffer_load_dwordx4 v4, s[8:11], s32 offen nt lds
Mvav 164,228,44
s_waitcnt lgkmcnt(7)
TR 228,15,512
TR 230,15,2560
Mvav 168,232,40
s_add_u32 m0, s38, 61312
v_cvt_pk_bf16_f32 v247, v254, v255
ds_write_b128 v13, v[244:247] offset:36864
Mvav 172,232,44
TR 232,16,512
TR 234,16,2560
v_mfma_f32_16x16x32_bf16 v[224:227], a[236:239], v[176:179], 0
v_cvt_pk_bf16_f32 v0, v24, v25
v_mfma_f32_16x16x32_bf16 v[228:231], a[236:239], v[180:183], 0
s_waitcnt lgkmcnt(7)
TR 236,15,37376
TR 238,15,39424
v_mfma_f32_16x16x32_bf16 v[232:235], a[240:243], v[176:179], 0
buffer_load_dwordx4 v4, s[8:11], s32 offen offset:128 nt lds
v_mfma_f32_16x16x32_bf16 v[236:239], a[240:243], v[180:183], 0
s_waitcnt vmcnt(8)
TR 240,16,37376
TR 242,16,39424
Mvav 224,244,184
s_barrier
Mvav 228,244,188
s_waitcnt lgkmcnt(7)
ds_read_b128 a[244:247], v9 offset:24576
s_add_u32 m0, s38, 126720
Mvav 232,224,184
v_exp_f32 v27, v75
Mvav 236,224,188
ds_read_b128 a[224:227], v9 offset:25088
v_cvt_pk_bf16_f32 v1, v26, v27
v_mfma_f32_16x16x32_bf16 v[240:243], a[228:231], v[176:179], 0
buffer_load_dwordx4 v4, s[8:11], s32 offen offset:256 nt lds
v_mfma_f32_16x16x32_bf16 v[244:247], a[228:231], v[180:183], 0
s_waitcnt lgkmcnt(4)
ds_read_b128 a[228:231], v9 offset:28672
s_add_u32 s32, s32, 6144
v_mfma_f32_16x16x32_bf16 v[248:251], a[232:235], v[176:179], 0
s_sub_u32 s45, s32, 98304
v_exp_f32 v24, v68
v_mfma_f32_16x16x32_bf16 v[252:255], a[232:235], v[180:183], 0
s_min_u32 s32, s32, s45
ds_read_b128 a[232:235], v9 offset:29184
s_add_u32 s43, s51, 245760
Mvav 240,236,184
s_add_u32 m0, s38, 114688
v_exp_f32 v25, v69
Mvav 244,236,188
s_waitcnt lgkmcnt(3)
ds_read_b128 a[236:239], v9 offset:32768
v_cvt_pk_bf16_f32 v30, v24, v25
Mvav 248,240,184
buffer_load_dwordx4 v7, s[20:23], s43 offen lds
Mvav 252,240,188
ds_read_b128 a[240:243], v9 offset:33280
v_mfma_f32_16x16x32_bf16 v[48:51], a[244:247], a[28:31], 0
v_exp_f32 v26, v70
v_mfma_f32_16x16x32_bf16 v[56:59], a[244:247], a[32:35], 0
s_waitcnt lgkmcnt(3)
ds_read_b128 a[244:247], v9 offset:26624
Mvaa 48,224,36
v_exp_f32 v27, v71
Mvaa 56,224,40
ds_read_b128 a[224:227], v9 offset:27136
v_cvt_pk_bf16_f32 v31, v26, v27
Mvaa 48,228,44
v_exp_f32 v24, v76
Mvaa 56,228,48
s_waitcnt lgkmcnt(3)
ds_read_b128 a[228:231], v9 offset:30720
Mvaa 48,232,52
v_exp_f32 v25, v77
Mvaa 56,232,56
ds_read_b128 a[232:235], v9 offset:31232
v_cvt_pk_bf16_f32 v2, v24, v25
Mvaa 48,236,60
v_exp_f32 v26, v78
Mvaa 56,236,64
s_waitcnt lgkmcnt(3)
ds_read_b128 a[236:239], v9 offset:34816
Mvaa 48,240,68
v_exp_f32 v27, v79
Mvaa 56,240,72
ds_read_b128 a[240:243], v9 offset:35328
v_cvt_pk_bf16_f32 v3, v26, v27
v_mfma_f32_16x16x32_bf16 v[52:55], a[244:247], a[28:31], 0
v_exp_f32 v24, v48
v_mfma_f32_16x16x32_bf16 v[60:63], a[244:247], a[32:35], 0
s_waitcnt lgkmcnt(3)
TR 244,19,32768
TR 246,19,34816
Mvaa 52,224,36
v_exp_f32 v25, v49
Mvaa 60,224,40
v_exp_f32 v26, v50
Mvaa 52,228,44
v_cvt_pk_bf16_f32 v40, v24, v25
Mvaa 60,228,48
s_waitcnt lgkmcnt(3)
TR 228,20,32768
TR 230,20,34816
Mvaa 52,232,52
v_exp_f32 v27, v51
Mvaa 60,232,56
TR 232,19,33280
TR 234,19,35328
Mvaa 52,236,60
v_exp_f32 v24, v56
Mvaa 60,236,64
s_waitcnt vmcnt(8) lgkmcnt(4)
TR 236,20,33280
TR 238,20,35328
Mvaa 52,240,68
s_barrier
Mvaa 60,240,72
TR 240,15,40960
TR 242,15,43008
Mvav 224,244,192
v_cvt_pk_bf16_f32 v41, v26, v27
Mvav 228,244,196
s_waitcnt lgkmcnt(6)
TR 244,16,40960
TR 246,16,43008
Mvav 32,252,28
s_add_u32 s43, s51, 286720
v_exp_f32 v25, v57
Mvav 36,252,0
s_add_u32 m0, s38, 102400
TR 224,15,41472
TR 226,15,43520
Mvav 232,228,192
buffer_load_dwordx4 v7, s[20:23], s43 offen lds
Mvav 236,228,196
s_waitcnt lgkmcnt(6)
TR 228,16,41472
TR 230,16,43520
Mvav 240,232,192
s_add_u32 s43, s51, 327680
v_max_f32 v33, v32, v36
v_cmp_nge_f32 vcc, s39, v33
Mvav 244,232,196
s_add_u32 m0, s38, 106496
TR 232,15,45056
TR 234,15,47104
Mvav 248,236,192
buffer_load_dwordx4 v7, s[20:23], s43 offen lds
Mvav 252,236,196
s_waitcnt lgkmcnt(6)
TR 236,16,45056
TR 238,16,47104
s_cbranch_vccnz Lr51
Lb51:
Mvav 80,240,28
s_add_u32 m0, s38, 0
v_exp_f32 v26, v58
Mvav 84,240,0
TR 240,15,45568
TR 242,15,47616
Mvav 88,244,28
v_cvt_pk_bf16_f32 v44, v24, v25
Mvav 92,244,0
s_waitcnt lgkmcnt(6)
TR 244,16,45568
TR 246,16,47616
Mvav 96,224,28
buffer_load_dwordx4 v5, s[12:15], s33 offen nt lds
Mvav 100,224,0
s_add_u32 m0, s38, 12160
TR 224,17,0
TR 226,17,2048
Mvav 104,228,28
v_exp_f32 v27, v59
Mvav 108,228,0
s_waitcnt lgkmcnt(6)
TR 228,18,0
TR 230,18,2048
Mvav 112,232,28
v_exp_f32 v24, v52
Mvav 116,232,0
TR 232,17,512
TR 234,17,2560
Mvav 120,236,28
buffer_load_dwordx4 v5, s[12:15], s33 offen offset:128 nt lds
Mvav 124,236,0
s_waitcnt lgkmcnt(6)
TR 236,18,512
TR 238,18,2560
Mvav 128,240,28
s_add_u32 m0, s38, 24320
v_cvt_pk_bf16_f32 v45, v26, v27
Mvav 132,240,0
TR 240,19,20480
TR 242,19,22528
Mvav 136,244,28
v_exp_f32 v25, v53
Mvav 140,244,0
s_waitcnt lgkmcnt(6)
TR 244,20,20480
TR 246,20,22528
Mvav 144,224,28
buffer_load_dwordx4 v5, s[12:15], s33 offen offset:256 nt lds
Mvav 148,224,0
s_add_u32 s33, s33, 6144
TR 224,19,20992
TR 226,19,23040
Mvav 152,228,28
s_sub_u32 s45, s33, 98304
v_exp_f32 v26, v54
Mvav 156,228,0
s_waitcnt lgkmcnt(6)
TR 228,20,20992
TR 230,20,23040
Mvav 160,232,28
s_min_u32 s33, s33, s45
v_cvt_pk_bf16_f32 v42, v24, v25
s_add_u32 m0, s38, 28672
Mvav 164,232,0
TR 232,15,8192
TR 234,15,10240
Mvav 168,236,28
buffer_load_dwordx4 v4, s[8:11], s32 offen nt lds
Mvav 172,236,0
s_waitcnt lgkmcnt(6)
TR 236,16,8192
TR 238,16,10240
Mvav 224,240,200
s_add_u32 m0, s38, 32640
v_exp_f32 v27, v55
Mvav 228,240,204
TR 240,15,8704
TR 242,15,10752
Mvav 232,244,200
v_cvt_pk_bf16_f32 v43, v26, v27
Mvav 236,244,204
s_waitcnt vmcnt(6) lgkmcnt(6)
TR 244,16,8704
TR 246,16,10752
Mvav 240,224,200
s_barrier
Mvav 244,224,204
ds_read_b128 a[224:227], v10 offset:4096
Mvav 248,228,200
buffer_load_dwordx4 v4, s[8:11], s32 offen offset:128 nt lds
Mvav 252,228,204
s_waitcnt lgkmcnt(5)
ds_read_b128 a[228:231], v10 offset:4608
s_add_u32 m0, s38, 36608
Mvav 224,232,208
v_exp_f32 v24, v60
Mvav 228,232,212
ds_read_b128 a[232:235], v10 offset:8192
Mvav 232,236,208
v_exp_f32 v25, v61
Mvav 236,236,212
s_waitcnt lgkmcnt(3)
ds_read_b128 a[236:239], v10 offset:8704
v_cvt_pk_bf16_f32 v46, v24, v25
Mvav 240,240,208
buffer_load_dwordx4 v4, s[8:11], s32 offen offset:256 nt lds
Mvav 244,240,212
s_add_u32 s32, s32, 6144
ds_read_b128 a[240:243], v10 offset:16384
s_sub_u32 s45, s32, 98304
Mvav 248,244,208
s_min_u32 s32, s32, s45
v_exp_f32 v26, v62
Mvav 252,244,212
s_waitcnt lgkmcnt(3)
ds_read_b128 a[244:247], v10 offset:16896
s_add_u32 s43, s51, 368640
v_mfma_f32_16x16x32_bf16 v[64:67], a[224:227], a[28:31], 0
s_add_u32 m0, s38, 131072
v_exp_f32 v27, v63
v_mfma_f32_16x16x32_bf16 v[72:75], a[224:227], a[32:35], 0
ds_read_b128 a[224:227], v10 offset:6144
v_cvt_pk_bf16_f32 v47, v26, v27
Mvaa 64,228,36
buffer_load_dwordx4 v7, s[20:23], s43 offen lds
Mvaa 72,228,40
s_waitcnt lgkmcnt(3)
ds_read_b128 a[228:231], v10 offset:6656
Mvaa 64,232,44
Mvaa 72,232,48
ds_read_b128 a[232:235], v10 offset:10240
Mvaa 64,236,52
Mvaa 72,236,56
s_waitcnt lgkmcnt(3)
ds_read_b128 a[236:239], v10 offset:10752
Mvaa 64,240,60
Mvaa 72,240,64
ds_read_b128 a[240:243], v10 offset:18432
Mvaa 64,244,68
Mvaa 72,244,72
s_waitcnt lgkmcnt(3)
ds_read_b128 a[244:247], v10 offset:18944
v_mfma_f32_16x16x32_bf16 v[68:71], a[224:227], a[28:31], 0
v_exp_f32 v24, v64
v_mfma_f32_16x16x32_bf16 v[76:79], a[224:227], a[32:35], 0
TR 224,19,24576
TR 226,19,26624
Mvaa 68,228,36
v_exp_f32 v25, v65
Mvaa 76,228,40
s_waitcnt lgkmcnt(4)
TR 228,20,24576
TR 230,20,26624
Mvaa 68,232,44
v_exp_f32 v26, v66
Mvaa 76,232,48
TR 232,19,25088
TR 234,19,27136
Mvaa 68,236,52
v_cvt_pk_bf16_f32 v28, v24, v25
Mvaa 76,236,56
s_waitcnt lgkmcnt(6)
TR 236,20,25088
TR 238,20,27136
Mvaa 68,240,60
v_exp_f32 v27, v67
Mvaa 76,240,64
TR 240,19,16384
TR 242,19,18432
Mvaa 68,244,68
v_exp_f32 v24, v72
Mvaa 76,244,72
s_waitcnt lgkmcnt(6)
v_cvt_pk_bf16_f32 v29, v26, v27
Mvav 224,224,216
v_exp_f32 v25, v73
Mvav 228,224,220
TR 224,20,16384
TR 226,20,18432
Mvav 232,228,216
v_exp_f32 v26, v74
Mvav 236,228,220
s_waitcnt lgkmcnt(4)
TR 228,19,16896
TR 230,19,18944
Mvav 240,232,216
s_add_u32 s43, s51, 409600
v_cvt_pk_bf16_f32 v0, v24, v25
s_add_u32 m0, s38, 40960
Mvav 244,232,220
s_waitcnt vmcnt(7)
TR 232,20,16896
TR 234,20,18944
Mvav 248,236,216
s_barrier
Mvav 252,236,220
s_waitcnt lgkmcnt(6)
TR 236,19,12288
TR 238,19,14336
Mvaa 224,240,160
buffer_load_dwordx4 v7, s[20:23], s43 offen lds
Mvaa 228,240,164
s_add_u32 s43, s51, 450560
TR 240,20,12288
TR 242,20,14336
Mvav 32,252,40
s_add_u32 m0, s38, 8192
v_exp_f32 v27, v75
Mvav 36,252,44
s_waitcnt lgkmcnt(6)
TR 244,19,12800
TR 246,19,14848
Mvaa 232,224,160
buffer_load_dwordx4 v7, s[20:23], s43 offen lds
Mvaa 236,224,164
s_add_u32 m0, s38, 45056
TR 224,20,12800
TR 226,20,14848
Mvaa 240,228,160
v_max_f32 v33, v32, v36
v_cmp_nge_f32 vcc, s39, v33
Mvaa 244,228,164
s_waitcnt lgkmcnt(6)
TR 228,15,4096
TR 230,15,6144
Mvaa 248,232,160
buffer_load_dwordx4 v7, s[20:23], s52 offen lds
Mvaa 252,232,164
s_add_u32 m0, s38, 49152
TR 232,16,4096
TR 234,16,6144
s_cbranch_vccnz Lr52
Lb52:
Mvav 80,236,40
v_exp_f32 v24, v68
Mvav 84,236,44
s_waitcnt lgkmcnt(6)
TR 236,15,4608
TR 238,15,6656
Mvav 88,240,40
v_cvt_pk_bf16_f32 v1, v26, v27
Mvav 92,240,44
TR 240,16,4608
TR 242,16,6656
Mvav 96,244,40
buffer_load_dwordx4 v5, s[12:15], s33 offen nt lds
Mvav 100,244,44
s_waitcnt lgkmcnt(6)
TR 244,15,16384
TR 246,15,18432
Mvav 104,224,40
s_add_u32 m0, s38, 53120
v_exp_f32 v25, v69
Mvav 108,224,44
TR 224,16,16384
TR 226,16,18432
Mvav 112,228,40
v_exp_f32 v26, v70
Mvav 116,228,44
s_waitcnt lgkmcnt(6)
TR 228,15,16896
TR 230,15,18944
Mvav 120,232,40
buffer_load_dwordx4 v5, s[12:15], s33 offen offset:128 nt lds
Mvav 124,232,44
s_add_u32 m0, s38, 57088
TR 232,16,16896
TR 234,16,18944
Mvav 128,236,40
v_cvt_pk_bf16_f32 v30, v24, v25
Mvav 132,236,44
s_waitcnt lgkmcnt(6)
TR 236,19,4096
TR 238,19,6144
Mvav 136,240,40
v_exp_f32 v27, v71
Mvav 140,240,44
TR 240,20,4096
TR 242,20,6144
Mvav 144,244,40
buffer_load_dwordx4 v5, s[12:15], s33 offen offset:256 nt lds
Mvav 148,244,44
s_waitcnt lgkmcnt(6)
TR 244,19,4608
TR 246,19,6656
Mvav 152,224,40
s_add_u32 s33, s33, 6144
v_cvt_pk_bf16_f32 v31, v26, v27
s_sub_u32 s45, s33, 98304
Mvav 156,224,44
s_min_u32 s33, s33, s45
TR 224,20,4608
TR 226,20,6656
Mvav 160,228,40
s_add_u32 m0, s38, 65536
v_exp_f32 v24, v76
Mvav 164,228,44
s_waitcnt lgkmcnt(6)
TR 228,19,8192
TR 230,19,10240
Mvav 168,232,40
buffer_load_dwordx4 v4, s[8:11], s32 offen nt lds
Mvav 172,232,44
s_add_u32 m0, s38, 69504
TR 232,20,8192
TR 234,20,10240
Mvaa 224,236,168
v_exp_f32 v25, v77
Mvaa 228,236,172
s_waitcnt lgkmcnt(6)
TR 236,19,8704
TR 238,19,10752
Mvaa 232,240,168
v_exp_f32 v26, v78
Mvaa 236,240,172
s_waitcnt vmcnt(7)
TR 240,20,8704
TR 242,20,10752
Mvaa 240,244,168
s_barrier
Mvaa 244,244,172
s_waitcnt lgkmcnt(6)
ds_read_b128 a[244:247], v9 offset:20480
v_cvt_pk_bf16_f32 v2, v24, v25
Mvaa 248,224,168
buffer_load_dwordx4 v4, s[8:11], s32 offen offset:128 nt lds
Mvaa 252,224,172
s_add_u32 m0, s38, 110336
ds_read_b128 a[224:227], v9 offset:20992
Mvaa 224,228,176
v_exp_f32 v27, v79
Mvaa 228,228,180
s_waitcnt lgkmcnt(4)
ds_read_b128 a[228:231], v10 offset:12288
v_cvt_pk_bf16_f32 v3, v26, v27
Mvaa 232,232,176
Mvaa 236,232,180
ds_read_b128 a[232:235], v10 offset:12800
Mvaa 240,236,176
buffer_load_dwordx4 v4, s[8:11], s32 offen offset:256 nt lds
Mvaa 244,236,180
s_waitcnt lgkmcnt(3)
ds_read_b128 a[236:239], v11 offset:28672
s_add_u32 s32, s32, 6144
Mvaa 248,240,176
s_sub_u32 s45, s32, 98304
s_min_u32 s32, s32, s45
s_add_u32 s43, s52, 40960
Mvaa 252,240,180
s_add_u32 m0, s38, 114688
ds_read_b128 a[240:243], v11 offset:29184
v_mfma_f32_16x16x32_bf16 v[48:51], a[244:247], a[28:31], 0
buffer_load_dwordx4 v7, s[20:23], s43 offen lds
v_mfma_f32_16x16x32_bf16 v[56:59], a[244:247], a[32:35], 0
s_waitcnt lgkmcnt(3)
ds_read_b128 a[244:247], v9 offset:22528
Mvaa 48,224,36
Mvaa 56,224,40
ds_read_b128 a[224:227], v9 offset:23040
Mvaa 48,228,44
Mvaa 56,228,48
s_waitcnt lgkmcnt(3)
Tc29:
s_cbranch_execz Tr29
s_cmpk_eq_u32 s88, 0
s_cselect_b64 exec, 0, -1
s_cbranch_execz Tc32
Tr32:
s_mov_b64 exec, -1
ds_read_b128 a[228:231], v10 offset:14336
Mvaa 48,232,52
Mvaa 56,232,56
ds_read_b128 a[232:235], v10 offset:14848
Mvaa 48,236,60
Mvaa 56,236,64
s_waitcnt lgkmcnt(3)
ds_read_b128 a[236:239], v11 offset:30720
Mvaa 48,240,68
Mvaa 56,240,72
ds_read_b128 a[240:243], v11 offset:31232
v_mfma_f32_16x16x32_bf16 v[52:55], a[244:247], a[28:31], 0
v_exp_f32 v24, v48
v_mfma_f32_16x16x32_bf16 v[60:63], a[244:247], a[32:35], 0
s_waitcnt lgkmcnt(3)
TR 244,19,32768
TR 246,19,34816
Mvaa 52,224,36
v_exp_f32 v25, v49
Mvaa 60,224,40
v_exp_f32 v26, v50
Mvaa 52,228,44
v_cvt_pk_bf16_f32 v40, v24, v25
Mvaa 60,228,48
s_waitcnt lgkmcnt(3)
TR 228,20,32768
TR 230,20,34816
Mvaa 52,232,52
v_exp_f32 v27, v51
Mvaa 60,232,56
TR 232,19,33280
TR 234,19,35328
Mvaa 52,236,60
v_exp_f32 v24, v56
Mvaa 60,236,64
s_waitcnt vmcnt(8) lgkmcnt(4)
TR 236,20,33280
TR 238,20,35328
Mvaa 52,240,68
s_barrier
Mvaa 60,240,72
TR 240,15,0
TR 242,15,2048
Mvaa 224,244,184
v_cvt_pk_bf16_f32 v41, v26, v27
Mvaa 228,244,188
s_waitcnt lgkmcnt(6)
TR 244,16,0
TR 246,16,2048
Mvav 32,252,28
v_exp_f32 v25, v57
Mvav 36,252,0
s_add_u32 s43, s52, 81920
TR 224,15,512
TR 226,15,2560
Mvaa 232,228,184
s_add_u32 m0, s38, 102400
v_exp_f32 v26, v58
Mvaa 236,228,188
s_waitcnt lgkmcnt(6)
TR 228,16,512
TR 230,16,2560
Mvaa 240,232,184
buffer_load_dwordx4 v7, s[20:23], s43 offen lds
Mvaa 244,232,188
s_add_u32 s43, s52, 122880
TR 232,15,12288
TR 234,15,14336
Mvaa 248,236,184
s_add_u32 m0, s38, 106496
v_max_f32 v33, v32, v36
v_cmp_nge_f32 vcc, s39, v33
Mvaa 252,236,188
s_waitcnt lgkmcnt(6)
TR 236,16,12288
TR 238,16,14336
s_cbranch_vccnz Lr53
Lb53:
Mvav 80,240,28
buffer_load_dwordx4 v7, s[20:23], s43 offen lds
Mvav 84,240,0
s_add_u32 m0, s38, 4096
TR 240,15,12800
TR 242,15,14848
Mvav 88,244,28
v_cvt_pk_bf16_f32 v44, v24, v25
Mvav 92,244,0
s_waitcnt lgkmcnt(6)
TR 244,16,12800
TR 246,16,14848
Mvav 96,224,28
v_exp_f32 v27, v59
Mvav 100,224,0
TR 224,15,24576
TR 226,15,26624
Mvav 104,228,28
buffer_load_dwordx4 v5, s[12:15], s33 offen nt lds
Mvav 108,228,0
s_waitcnt lgkmcnt(6)
TR 228,16,24576
TR 230,16,26624
Mvav 112,232,28
s_add_u32 m0, s38, 16256
v_exp_f32 v24, v52
Mvav 116,232,0
TR 232,15,25088
TR 234,15,27136
Mvav 120,236,28
v_cvt_pk_bf16_f32 v45, v26, v27
Mvav 124,236,0
s_waitcnt lgkmcnt(6)
TR 236,16,25088
TR 238,16,27136
Mvav 128,240,28
buffer_load_dwordx4 v5, s[12:15], s33 offen offset:128 nt lds
Mvav 132,240,0
s_add_u32 m0, s38, 20224
TR 240,15,40960
TR 242,15,43008
Mvav 136,244,28
v_exp_f32 v25, v53
Mvav 140,244,0
s_waitcnt lgkmcnt(6)
TR 244,16,40960
TR 246,16,43008
Mvav 144,224,28
v_exp_f32 v26, v54
Mvav 148,224,0
TR 224,15,8192
TR 226,15,10240
Mvav 152,228,28
buffer_load_dwordx4 v5, s[12:15], s33 offen offset:256 nt lds
Mvav 156,228,0
s_waitcnt lgkmcnt(6)
TR 228,16,8192
TR 230,16,10240
Mvav 160,232,28
s_add_u32 s33, s33, 6144
v_cvt_pk_bf16_f32 v42, v24, v25
s_sub_u32 s45, s33, 98304
Mvav 164,232,0
s_min_u32 s33, s33, s45
TR 232,15,41472
TR 234,15,43520
Mvav 168,236,28
s_add_u32 m0, s38, 61440
v_exp_f32 v27, v55
Mvav 172,236,0
s_waitcnt lgkmcnt(6)
TR 236,16,41472
TR 238,16,43520
Mvaa 224,240,192
buffer_load_dwordx4 v4, s[8:11], s32 offen nt lds
Mvaa 228,240,196
s_add_u32 m0, s38, 73600
TR 240,15,8704
TR 242,15,10752
Mvaa 232,244,192
v_cvt_pk_bf16_f32 v43, v26, v27
Mvaa 236,244,196
s_waitcnt vmcnt(6) lgkmcnt(6)
TR 244,16,8704
TR 246,16,10752
Mvaa 224,224,200
s_barrier
Mvaa 228,224,204
ds_read_b128 a[224:227], v9 offset:28672
Mvaa 232,228,200
buffer_load_dwordx4 v4, s[8:11], s32 offen offset:128 nt lds
Mvaa 236,228,204
s_waitcnt lgkmcnt(5)
ds_read_b128 a[228:231], v9 offset:29184
v_cvt_pk_bf16_f32 v224, v224, v225
Mvaa 240,232,192
s_add_u32 s43, s32, 256
v_cvt_pk_bf16_f32 v225, v226, v227
v_cvt_pk_bf16_f32 v226, v232, v233
Mvaa 244,232,196
s_add_u32 m0, s38, 0
ds_read_b128 a[232:235], v9 offset:32768
v_cvt_pk_bf16_f32 v227, v234, v235
Mvaa 248,236,192
ds_write_b128 v13, v[224:227] offset:32768
v_cvt_pk_bf16_f32 v228, v228, v229
Mvaa 252,236,196
s_waitcnt lgkmcnt(4)
ds_read_b128 a[236:239], v9 offset:33280
v_cvt_pk_bf16_f32 v229, v230, v231
Mvaa 240,240,200
buffer_load_dwordx4 v4, s[8:11], s43 offen nt lds
Mvaa 244,240,204
s_add_u32 s32, s32, 6144
ds_read_b128 a[240:243], v9 offset:36864
v_cvt_pk_bf16_f32 v230, v236, v237
Mvaa 248,244,200
s_sub_u32 s45, s32, 98304
v_cvt_pk_bf16_f32 v231, v238, v239
ds_write_b128 v13, v[228:231] offset:28672
Mvaa 252,244,204
s_waitcnt lgkmcnt(5)
ds_read_b128 a[244:247], v9 offset:37376
v_cvt_pk_bf16_f32 v240, v240, v241
v_mfma_f32_16x16x32_bf16 v[64:67], a[224:227], a[28:31], 0
s_min_u32 s32, s32, s45
v_cvt_pk_bf16_f32 v241, v242, v243
v_cvt_pk_bf16_f32 v242, v248, v249
v_mfma_f32_16x16x32_bf16 v[72:75], a[224:227], a[32:35], 0
s_add_u32 s43, s52, 163840
ds_read_b128 a[224:227], v9 offset:30720
v_cvt_pk_bf16_f32 v243, v250, v251
Mvaa 64,228,36
s_add_u32 m0, s38, 12288
ds_write_b128 v13, v[240:243] offset:24576
v_cvt_pk_bf16_f32 v244, v244, v245
Mvaa 72,228,40
s_waitcnt lgkmcnt(5)
ds_read_b128 a[228:231], v9 offset:31232
v_cvt_pk_bf16_f32 v245, v246, v247
Mvaa 64,232,44
buffer_load_dwordx4 v7, s[20:23], s43 offen lds
Mvaa 72,232,48
ds_read_b128 a[232:235], v9 offset:34816
v_cvt_pk_bf16_f32 v246, v252, v253
Mvaa 64,236,52
v_cvt_pk_bf16_f32 v247, v254, v255
ds_write_b128 v13, v[244:247] offset:20480
Mvaa 72,236,56
s_waitcnt lgkmcnt(5)
ds_read_b128 a[236:239], v9 offset:35328
Mvaa 64,240,60
v_exp_f32 v24, v60
Mvaa 72,240,64
ds_read_b128 a[240:243], v9 offset:38912
Mvaa 64,244,68
v_exp_f32 v25, v61
Mvaa 72,244,72
s_waitcnt lgkmcnt(4)
ds_read_b128 a[244:247], v9 offset:39424
v_cvt_pk_bf16_f32 v46, v24, v25
v_mfma_f32_16x16x32_bf16 v[68:71], a[224:227], a[28:31], 0
v_exp_f32 v26, v62
v_mfma_f32_16x16x32_bf16 v[76:79], a[224:227], a[32:35], 0
TR 224,15,45056
TR 226,15,47104
Mvaa 68,228,36
v_exp_f32 v27, v63
Mvaa 76,228,40
s_waitcnt lgkmcnt(4)
TR 228,16,45056
TR 230,16,47104
Mvaa 68,232,44
v_cvt_pk_bf16_f32 v47, v26, v27
Mvaa 76,232,48
TR 232,19,16384
TR 234,19,18432
Mvaa 68,236,52
v_exp_f32 v24, v64
Mvaa 76,236,56
s_waitcnt lgkmcnt(6)
TR 236,20,16384
TR 238,20,18432
Mvaa 68,240,60
v_exp_f32 v25, v65
Mvaa 76,240,64
TR 240,15,45568
TR 242,15,47616
Mvaa 68,244,68
v_exp_f32 v26, v66
Mvaa 76,244,72
s_waitcnt lgkmcnt(6)
v_cvt_pk_bf16_f32 v28, v24, v25
v_mfma_f32_16x16x32_bf16 v[224:227], a[224:227], v[176:179], 0
v_exp_f32 v27, v67
v_mfma_f32_16x16x32_bf16 v[228:231], a[224:227], v[180:183], 0
TR 224,16,45568
TR 226,16,47616
v_mfma_f32_16x16x32_bf16 v[232:235], a[228:231], v[176:179], 0
v_exp_f32 v24, v72
v_mfma_f32_16x16x32_bf16 v[236:239], a[228:231], v[180:183], 0
s_waitcnt lgkmcnt(4)
TR 228,19,16896
TR 230,19,18944
Mvav 224,232,184
v_cvt_pk_bf16_f32 v29, v26, v27
s_add_u32 s43, s52, 204800
Mvav 228,232,188
s_waitcnt vmcnt(8)
TR 232,20,16896
TR 234,20,18944
Mvav 232,236,184
s_barrier
Mvav 236,236,188
s_waitcnt lgkmcnt(6)
TR 236,17,0
TR 238,17,2048
v_mfma_f32_16x16x32_bf16 v[240:243], a[240:243], v[176:179], 0
s_add_u32 m0, s38, 24576
v_exp_f32 v25, v73
v_mfma_f32_16x16x32_bf16 v[244:247], a[240:243], v[180:183], 0
TR 240,18,0
TR 242,18,2048
Mvav 32,252,40
buffer_load_dwordx4 v7, s[20:23], s43 offen lds
Mvav 36,252,44
s_waitcnt lgkmcnt(6)
TR 244,17,512
TR 246,17,2560
v_mfma_f32_16x16x32_bf16 v[248:251], a[224:227], v[176:179], 0
s_add_u32 s43, s52, 245760
v_exp_f32 v26, v74
v_mfma_f32_16x16x32_bf16 v[252:255], a[224:227], v[180:183], 0
s_add_u32 m0, s38, 8192
TR 224,18,512
TR 226,18,2560
Mvav 240,228,184
buffer_load_dwordx4 v7, s[20:23], s43 offen lds
Mvav 244,228,188
s_waitcnt lgkmcnt(6)
TR 228,17,4096
TR 230,17,6144
Mvav 248,232,184
s_add_u32 s43, s52, 286720
v_max_f32 v33, v32, v36
v_cmp_nge_f32 vcc, s39, v33
Mvav 252,232,188
s_add_u32 m0, s38, 28672
TR 232,18,4096
TR 234,18,6144
s_cbranch_vccnz Lr54
Lb54:
Mvav 80,236,40
buffer_load_dwordx4 v7, s[20:23], s43 offen lds
Mvav 84,236,44
s_waitcnt lgkmcnt(6)
TR 236,17,4608
TR 238,17,6656
Mvav 88,240,40
s_add_u32 m0, s38, 32768
v_cvt_pk_bf16_f32 v0, v24, v25
Mvav 92,240,44
TR 240,18,4608
TR 242,18,6656
Mvav 96,244,40
v_exp_f32 v27, v75
Mvav 100,244,44
s_waitcnt lgkmcnt(6)
TR 244,17,8192
TR 246,17,10240
Mvav 104,224,40
buffer_load_dwordx4 v5, s[12:15], s33 offen nt lds
Mvav 108,224,44
s_add_u32 m0, s38, 36736
TR 224,18,8192
TR 226,18,10240
Mvav 112,228,40
v_exp_f32 v24, v68
Mvav 116,228,44
s_waitcnt lgkmcnt(6)
TR 228,17,8704
TR 230,17,10752
Mvav 120,232,40
v_cvt_pk_bf16_f32 v1, v26, v27
Mvav 124,232,44
TR 232,18,8704
TR 234,18,10752
Mvav 128,236,40
buffer_load_dwordx4 v5, s[12:15], s33 offen offset:128 nt lds
Mvav 132,236,44
s_waitcnt lgkmcnt(6)
TR 236,19,4096
TR 238,19,6144
Mvav 136,240,40
s_add_u32 m0, s38, 40704
v_exp_f32 v25, v69
Mvav 140,240,44
TR 240,20,4096
TR 242,20,6144
Mvav 144,244,40
v_exp_f32 v26, v70
Mvav 148,244,44
s_waitcnt lgkmcnt(6)
TR 244,19,4608
TR 246,19,6656
Mvav 152,224,40
buffer_load_dwordx4 v5, s[12:15], s33 offen offset:256 nt lds
Mvav 156,224,44
s_waitcnt vmcnt(6)
TR 224,20,4608
TR 226,20,6656
Mvav 160,228,40
s_barrier
Mvav 164,228,44
s_waitcnt lgkmcnt(6)
ds_read_b128 a[228:231], v10 offset:16384
v_cvt_pk_bf16_f32 v30, v24, v25
Mvav 168,232,40
s_add_u32 s33, s33, 6144
v_exp_f32 v27, v71
Mvav 172,232,44
s_sub_u32 s45, s33, 98304
ds_read_b128 a[232:235], v10 offset:16896
v_cvt_pk_bf16_f32 v31, v26, v27
Mvav 224,236,192
s_min_u32 s33, s33, s45
v_exp_f32 v24, v76
Mvav 228,236,196
s_waitcnt lgkmcnt(4)
ds_read_b128 a[236:239], v10 offset:20480
s_add_u32 m0, s38, 45056
Mvav 232,240,192
buffer_load_dwordx4 v4, s[8:11], s32 offen nt lds
Mvav 236,240,196
s_add_u32 m0, s38, 49024
ds_read_b128 a[240:243], v10 offset:20992
Mvav 240,244,192
v_exp_f32 v25, v77
Mvav 244,244,196
s_waitcnt lgkmcnt(3)
ds_read_b128 a[244:247], v11 offset:12288
v_cvt_pk_bf16_f32 v2, v24, v25
Mvav 248,224,192
v_exp_f32 v26, v78
Mvav 252,224,196
ds_read_b128 a[224:227], v11 offset:12800
v_mfma_f32_16x16x32_bf16 v[48:51], a[228:231], a[28:31], 0
buffer_load_dwordx4 v4, s[8:11], s32 offen offset:128 nt lds
v_mfma_f32_16x16x32_bf16 v[56:59], a[228:231], a[32:35], 0
s_waitcnt lgkmcnt(3)
ds_read_b128 a[228:231], v10 offset:18432
s_add_u32 m0, s38, 52992
Mvaa 48,232,36
v_exp_f32 v27, v79
Mvaa 56,232,40
ds_read_b128 a[232:235], v10 offset:18944
v_cvt_pk_bf16_f32 v3, v26, v27
Mvaa 48,236,44
Mvaa 56,236,48
s_waitcnt lgkmcnt(3)
ds_read_b128 a[236:239], v10 offset:22528
Mvaa 48,240,52
buffer_load_dwordx4 v4, s[8:11], s32 offen offset:256 nt lds
Mvaa 56,240,56
s_add_u32 s32, s32, 6144
ds_read_b128 a[240:243], v10 offset:23040
s_sub_u32 s45, s32, 98304
Mvaa 48,244,60
s_min_u32 s32, s32, s45
s_add_u32 s43, s52, 327680
s_add_u32 m0, s38, 114688
Mvaa 56,244,64
s_waitcnt lgkmcnt(3)
ds_read_b128 a[244:247], v11 offset:14336
Mvaa 48,224,68
buffer_load_dwordx4 v7, s[20:23], s43 offen lds
Mvaa 56,224,72
ds_read_b128 a[224:227], v11 offset:14848
v_mfma_f32_16x16x32_bf16 v[52:55], a[228:231], a[28:31], 0
v_exp_f32 v24, v48
v_mfma_f32_16x16x32_bf16 v[60:63], a[228:231], a[32:35], 0
s_waitcnt lgkmcnt(3)
TR 228,19,8192
TR 230,19,10240
Mvaa 52,232,36
v_exp_f32 v25, v49
Mvaa 60,232,40
TR 232,20,8192
TR 234,20,10240
Mvaa 52,236,44
v_exp_f32 v26, v50
Mvaa 60,236,48
s_waitcnt lgkmcnt(5)
TR 236,19,8704
TR 238,19,10752
Mvaa 52,240,52
v_cvt_pk_bf16_f32 v40, v24, v25
Mvaa 60,240,56
TR 240,20,8704
TR 242,20,10752
Mvaa 52,244,60
v_exp_f32 v27, v51
Mvaa 60,244,64
s_waitcnt lgkmcnt(6)
TR 244,15,12288
TR 246,15,14336
Mvaa 52,224,68
v_exp_f32 v24, v56
Mvaa 60,224,72
v_cvt_pk_bf16_f32 v41, v26, v27
Mvav 224,228,200
v_exp_f32 v25, v57
Mvav 228,228,204
s_waitcnt lgkmcnt(4)
TR 228,16,12288
TR 230,16,14336
Mvav 232,232,200
v_exp_f32 v26, v58
Mvav 236,232,204
TR 232,15,12800
TR 234,15,14848
Mvav 240,236,200
v_cvt_pk_bf16_f32 v44, v24, v25
Mvav 244,236,204
s_waitcnt vmcnt(8) lgkmcnt(4)
TR 236,16,12800
TR 238,16,14848
Mvav 248,240,200
s_barrier
Mvav 252,240,204
TR 240,15,4096
TR 242,15,6144
Mvav 224,244,208
v_exp_f32 v27, v59
Mvav 228,244,212
s_waitcnt lgkmcnt(6)
TR 244,16,4096
TR 246,16,6144
Mvav 32,252,28
v_exp_f32 v24, v52
Mvav 36,252,0
TR 224,15,4608
TR 226,15,6656
Mvav 232,228,208
v_cvt_pk_bf16_f32 v45, v26, v27
Mvav 236,228,212
s_waitcnt lgkmcnt(6)
TR 228,16,4608
TR 230,16,6656
Mvav 240,232,208
s_add_u32 s43, s52, 368640
v_max_f32 v33, v32, v36
v_cmp_nge_f32 vcc, s39, v33
Mvav 244,232,212
s_add_u32 m0, s38, 102400
TR 232,15,16384
TR 234,15,18432
Mvav 248,236,208
buffer_load_dwordx4 v7, s[20:23], s43 offen lds
Mvav 252,236,212
s_waitcnt lgkmcnt(6)
TR 236,16,16384
TR 238,16,18432
s_cbranch_vccnz Lr55
Lb55:
Mvav 80,240,28
s_add_u32 s43, s52, 409600
v_exp_f32 v25, v53
Mvav 84,240,0
s_add_u32 m0, s38, 57344
TR 240,15,16896
TR 242,15,18944
Mvav 88,244,28
buffer_load_dwordx4 v7, s[20:23], s43 offen lds
Mvav 92,244,0
s_waitcnt lgkmcnt(6)
TR 244,16,16896
TR 246,16,18944
Mvav 96,224,28
s_add_u32 s43, s52, 450560
v_exp_f32 v26, v54
Mvav 100,224,0
s_add_u32 m0, s38, 65536
TR 224,15,20480
TR 226,15,22528
Mvav 104,228,28
buffer_load_dwordx4 v7, s[20:23], s43 offen lds
Mvav 108,228,0
s_waitcnt lgkmcnt(6)
TR 228,16,20480
TR 230,16,22528
Tc30:
s_cbranch_execz Tr30
s_cmpk_eq_u32 s88, 1
s_cselect_b64 exec, 0, -1
s_cbranch_execz Tc33
Tr33:
s_mov_b64 exec, -1
Mvav 112,232,28
v_cvt_pk_bf16_f32 v42, v24, v25
Mvav 116,232,0
TR 232,15,20992
TR 234,15,23040
Mvav 120,236,28
s_add_u32 m0, s38, 69632
v_exp_f32 v27, v55
Mvav 124,236,0
s_waitcnt lgkmcnt(6)
TR 236,16,20992
TR 238,16,23040
Mvav 128,240,28
buffer_load_dwordx4 v5, s[12:15], s33 offen nt lds
Mvav 132,240,0
s_add_u32 m0, s38, 77696
TR 240,15,24576
TR 242,15,26624
Mvav 136,244,28
v_cvt_pk_bf16_f32 v43, v26, v27
Mvav 140,244,0
s_waitcnt lgkmcnt(6)
TR 244,16,24576
TR 246,16,26624
Mvav 144,224,28
v_exp_f32 v24, v60
Mvav 148,224,0
TR 224,15,25088
TR 226,15,27136
Mvav 152,228,28
buffer_load_dwordx4 v5, s[12:15], s33 offen offset:128 nt lds
Mvav 156,228,0
s_waitcnt lgkmcnt(6)
TR 228,16,25088
TR 230,16,27136
Mvav 160,232,28
s_add_u32 m0, s38, 81664
v_exp_f32 v25, v61
Mvav 164,232,0
TR 232,15,8192
TR 234,15,10240
Mvav 168,236,28
v_exp_f32 v26, v62
Mvav 172,236,0
s_waitcnt lgkmcnt(6)
TR 236,16,8192
TR 238,16,10240
Mvav 224,240,216
buffer_load_dwordx4 v5, s[12:15], s33 offen offset:256 nt lds
Mvav 228,240,220
s_add_u32 s33, s33, 6144
TR 240,15,8704
TR 242,15,10752
Mvav 232,244,216
s_sub_u32 s45, s33, 98304
v_cvt_pk_bf16_f32 v46, v24, v25
s_min_u32 s33, s33, s45
Mvav 236,244,220
s_waitcnt vmcnt(6) lgkmcnt(6)
TR 244,16,8704
TR 246,16,10752
Mvav 240,224,216
s_barrier
Mvav 244,224,220
s_add_u32 m0, s38, 4096
ds_read_b128 a[224:227], v10 offset:12288
Mvav 248,228,216
buffer_load_dwordx4 v4, s[8:11], s32 offen nt lds
Mvav 252,228,220
s_waitcnt lgkmcnt(5)
ds_read_b128 a[228:231], v10 offset:12800
s_add_u32 m0, s38, 12160
Mvaa 224,232,160
v_exp_f32 v27, v63
Mvaa 228,232,164
ds_read_b128 a[232:235], v10 offset:24576
v_cvt_pk_bf16_f32 v47, v26, v27
Mvaa 232,236,160
Mvaa 236,236,164
s_waitcnt lgkmcnt(3)
ds_read_b128 a[236:239], v10 offset:25088
Mvaa 240,240,160
buffer_load_dwordx4 v4, s[8:11], s32 offen offset:128 nt lds
Mvaa 244,240,164
s_add_u32 m0, s38, 16128
ds_read_b128 a[240:243], v9 offset:0
Mvaa 248,244,160
Mvaa 252,244,164
s_waitcnt lgkmcnt(3)
ds_read_b128 a[244:247], v9 offset:512
v_mfma_f32_16x16x32_bf16 v[64:67], a[224:227], a[28:31], 0
v_mfma_f32_16x16x32_bf16 v[72:75], a[224:227], a[32:35], 0
ds_read_b128 a[224:227], v10 offset:14336
Mvaa 64,228,36
buffer_load_dwordx4 v4, s[8:11], s32 offen offset:256 nt lds
Mvaa 72,228,40
s_waitcnt lgkmcnt(3)
ds_read_b128 a[228:231], v10 offset:14848
s_add_u32 s32, s32, 6144
Mvaa 64,232,44
s_sub_u32 s45, s32, 98304
s_min_u32 s32, s32, s45
s_add_u32 m0, s38, 20480
Mvaa 72,232,48
ds_read_b128 a[232:235], v10 offset:26624
Mvaa 64,236,52
buffer_load_dwordx4 v7, s[20:23], s58 offen lds
Mvaa 72,236,56
s_waitcnt lgkmcnt(3)
ds_read_b128 a[236:239], v10 offset:27136
Mvaa 64,240,60
Mvaa 72,240,64
ds_read_b128 a[240:243], v9 offset:2048
Mvaa 64,244,68
Mvaa 72,244,72
s_waitcnt lgkmcnt(3)
ds_read_b128 a[244:247], v9 offset:2560
v_mfma_f32_16x16x32_bf16 v[68:71], a[224:227], a[28:31], 0
v_exp_f32 v24, v64
v_mfma_f32_16x16x32_bf16 v[76:79], a[224:227], a[32:35], 0
TR 224,15,28672
TR 226,15,30720
Mvaa 68,228,36
v_exp_f32 v25, v65
Mvaa 76,228,40
s_waitcnt lgkmcnt(4)
TR 228,16,28672
TR 230,16,30720
Mvaa 68,232,44
v_exp_f32 v26, v66
Mvaa 76,232,48
TR 232,15,29184
TR 234,15,31232
Mvaa 68,236,52
v_cvt_pk_bf16_f32 v28, v24, v25
Mvaa 76,236,56
s_waitcnt lgkmcnt(6)
TR 236,16,29184
TR 238,16,31232
Mvaa 68,240,60
v_exp_f32 v27, v67
Mvaa 76,240,64
TR 240,19,16384
TR 242,19,18432
Mvaa 68,244,68
v_exp_f32 v24, v72
Mvaa 76,244,72
s_waitcnt lgkmcnt(6)
v_cvt_pk_bf16_f32 v29, v26, v27
Mvaa 224,224,168
v_exp_f32 v25, v73
Mvaa 228,224,172
TR 224,20,16384
TR 226,20,18432
Mvaa 232,228,168
v_exp_f32 v26, v74
Mvaa 236,228,172
s_waitcnt lgkmcnt(4)
TR 228,19,16896
TR 230,19,18944
Mvaa 240,232,168
v_cvt_pk_bf16_f32 v0, v24, v25
Mvaa 244,232,172
s_waitcnt vmcnt(9)
TR 232,20,16896
TR 234,20,18944
Mvaa 248,236,168
s_barrier
Mvaa 252,236,172
s_waitcnt lgkmcnt(6)
TR 236,15,32768
TR 238,15,34816
Mvaa 224,240,176
v_exp_f32 v27, v75
Mvaa 228,240,180
TR 240,16,32768
TR 242,16,34816
Mvav 32,252,40
v_exp_f32 v24, v68
Mvav 36,252,44
s_waitcnt lgkmcnt(6)
TR 244,15,33280
TR 246,15,35328
Mvaa 232,224,176
v_cvt_pk_bf16_f32 v1, v26, v27
Mvaa 236,224,180
TR 224,16,33280
TR 226,16,35328
Mvaa 240,228,176
s_add_u32 s43, s58, 40960
v_max_f32 v33, v32, v36
v_cmp_nge_f32 vcc, s39, v33
Mvaa 244,228,180
s_waitcnt lgkmcnt(6)
TR 228,15,36864
TR 230,15,38912
Mvaa 248,232,176
s_add_u32 m0, s38, 0
v_exp_f32 v25, v69
Mvaa 252,232,180
TR 232,16,36864
TR 234,16,38912
s_cbranch_vccnz Lr56
Lb56:
Mvav 80,236,40
buffer_load_dwordx4 v7, s[20:23], s43 offen lds
Mvav 84,236,44
s_waitcnt lgkmcnt(6)
TR 236,15,37376
TR 238,15,39424
Mvav 88,240,40
s_add_u32 s43, s58, 81920
v_exp_f32 v26, v70
Mvav 92,240,44
s_add_u32 m0, s38, 8192
TR 240,16,37376
TR 242,16,39424
Mvav 96,244,40
buffer_load_dwordx4 v7, s[20:23], s43 offen lds
Mvav 100,244,44
s_waitcnt lgkmcnt(6)
TR 244,15,40960
TR 246,15,43008
Mvav 104,224,40
v_cvt_pk_bf16_f32 v30, v24, v25
Mvav 108,224,44
TR 224,16,40960
TR 226,16,43008
Mvav 112,228,40
v_exp_f32 v27, v71
Mvav 116,228,44
s_waitcnt lgkmcnt(6)
TR 228,15,41472
TR 230,15,43520
Mvav 120,232,40
v_cvt_pk_bf16_f32 v31, v26, v27
Mvav 124,232,44
TR 232,16,41472
TR 234,16,43520
Mvav 128,236,40
v_exp_f32 v24, v76
Mvav 132,236,44
s_waitcnt lgkmcnt(6)
TR 236,19,4096
TR 238,19,6144
Mvav 136,240,40
s_add_u32 s43, s58, 122880
v_exp_f32 v25, v77
Mvav 140,240,44
s_add_u32 m0, s38, 24576
TR 240,20,4096
TR 242,20,6144
Mvav 144,244,40
buffer_load_dwordx4 v7, s[20:23], s43 offen lds
Mvav 148,244,44
s_waitcnt lgkmcnt(6)
TR 244,19,4608
TR 246,19,6656
Mvav 152,224,40
s_add_u32 s43, s58, 163840
v_exp_f32 v26, v78
Mvav 156,224,44
s_waitcnt vmcnt(10)
TR 224,20,4608
TR 226,20,6656
Mvav 160,228,40
s_barrier
Mvav 164,228,44
s_waitcnt lgkmcnt(6)
ds_read_b128 a[228:231], v9 offset:45056
v_cvt_pk_bf16_f32 v2, v24, v25
Mvav 168,232,40
s_add_u32 m0, s38, 28672
v_exp_f32 v27, v79
Mvav 172,232,44
ds_read_b128 a[232:235], v9 offset:45568
v_cvt_pk_bf16_f32 v3, v26, v27
Mvaa 224,236,184
buffer_load_dwordx4 v7, s[20:23], s43 offen lds
Mvaa 228,236,188
s_waitcnt lgkmcnt(4)
ds_read_b128 a[236:239], v10 offset:0
Mvaa 232,240,184
Mvaa 236,240,188
ds_read_b128 a[240:243], v10 offset:512
Mvaa 240,244,184
Mvaa 244,244,188
s_waitcnt lgkmcnt(3)
ds_read_b128 a[244:247], v10 offset:4096
s_add_u32 m0, s38, 32768
Mvaa 248,224,184
Mvaa 252,224,188
ds_read_b128 a[224:227], v10 offset:4608
v_mfma_f32_16x16x32_bf16 v[48:51], a[228:231], a[28:31], 0
buffer_load_dwordx4 v5, s[12:15], s33 offen nt lds
v_mfma_f32_16x16x32_bf16 v[56:59], a[228:231], a[32:35], 0
s_waitcnt lgkmcnt(3)
ds_read_b128 a[228:231], v9 offset:47104
s_add_u32 m0, s38, 36736
Mvaa 48,232,36
Mvaa 56,232,40
ds_read_b128 a[232:235], v9 offset:47616
Mvaa 48,236,44
Mvaa 56,236,48
s_waitcnt lgkmcnt(3)
ds_read_b128 a[236:239], v10 offset:2048
Mvaa 48,240,52
buffer_load_dwordx4 v5, s[12:15], s33 offen offset:128 nt lds
Mvaa 56,240,56
s_add_u32 m0, s38, 61184
ds_read_b128 a[240:243], v10 offset:2560
Mvaa 48,244,60
Mvaa 56,244,64
s_waitcnt lgkmcnt(3)
ds_read_b128 a[244:247], v10 offset:6144
Mvaa 48,224,68
Mvaa 56,224,72
ds_read_b128 a[224:227], v10 offset:6656
v_mfma_f32_16x16x32_bf16 v[52:55], a[228:231], a[28:31], 0
buffer_load_dwordx4 v5, s[12:15], s33 offen offset:256 nt lds
v_mfma_f32_16x16x32_bf16 v[60:63], a[228:231], a[32:35], 0
s_waitcnt lgkmcnt(3)
TR 228,17,8192
TR 230,17,10240
Mvaa 52,232,36
s_add_u32 s33, s33, 6144
v_exp_f32 v24, v48
Mvaa 60,232,40
s_sub_u32 s45, s33, 98304
TR 232,18,8192
TR 234,18,10240
Mvaa 52,236,44
s_min_u32 s33, s33, s45
v_exp_f32 v25, v49
Mvaa 60,236,48
s_waitcnt lgkmcnt(5)
TR 236,17,16384
TR 238,17,18432
Mvaa 52,240,52
s_add_u32 m0, s38, 73728
v_exp_f32 v26, v50
Mvaa 60,240,56
TR 240,18,16384
TR 242,18,18432
Mvaa 52,244,60
buffer_load_dwordx4 v4, s[8:11], s32 offen nt lds
Mvaa 60,244,64
s_waitcnt lgkmcnt(6)
TR 244,17,8704
TR 246,17,10752
Mvaa 52,224,68
s_add_u32 m0, s38, 85888
v_cvt_pk_bf16_f32 v40, v24, v25
Mvaa 60,224,72
v_exp_f32 v27, v51
Mvaa 224,228,192
v_exp_f32 v24, v56
Mvaa 228,228,196
s_waitcnt lgkmcnt(4)
TR 228,18,8704
TR 230,18,10752
Mvaa 232,232,192
buffer_load_dwordx4 v4, s[8:11], s32 offen offset:128 nt lds
Mvaa 236,232,196
s_add_u32 m0, s38, 40704
TR 232,17,16896
TR 234,17,18944
Mvaa 224,236,200
v_cvt_pk_bf16_f32 v41, v26, v27
Mvaa 228,236,204
s_waitcnt vmcnt(8) lgkmcnt(4)
TR 236,18,16896
TR 238,18,18944
Mvaa 232,240,200
s_barrier
Mvaa 236,240,204
TR 240,17,20480
TR 242,17,22528
Mvaa 240,244,192
buffer_load_dwordx4 v4, s[8:11], s32 offen offset:256 nt lds
Mvaa 244,244,196
s_waitcnt lgkmcnt(6)
TR 244,18,20480
TR 246,18,22528
Mvav 32,252,28
s_add_u32 s32, s32, 6144
v_cvt_pk_bf16_f32 v224, v224, v225
v_cvt_pk_bf16_f32 v225, v226, v227
Mvav 36,252,0
s_sub_u32 s45, s32, 98304
TR 224,17,20992
TR 226,17,23040
Mvaa 248,228,192
s_min_u32 s32, s32, s45
v_cvt_pk_bf16_f32 v226, v232, v233
v_cvt_pk_bf16_f32 v227, v234, v235
Mvaa 252,228,196
s_waitcnt lgkmcnt(6)
TR 228,18,20992
TR 230,18,23040
Mvaa 240,232,200
s_add_u32 s43, s58, 204800
v_max_f32 v33, v32, v36
v_cmp_nge_f32 vcc, s39, v33
Mvaa 244,232,204
s_add_u32 m0, s38, 45056
TR 232,17,28672
TR 234,17,30720
Mvaa 248,236,200
buffer_load_dwordx4 v7, s[20:23], s43 offen lds
Mvaa 252,236,204
s_waitcnt lgkmcnt(6)
TR 236,18,28672
TR 238,18,30720
s_cbranch_vccnz Lr57
Lb57:
Mvav 80,240,28
ds_write_b128 v13, v[224:227] offset:16384
v_cvt_pk_bf16_f32 v228, v228, v229
Mvav 84,240,0
TR 240,17,29184
TR 242,17,31232
Mvav 88,244,28
v_cvt_pk_bf16_f32 v229, v230, v231
v_cvt_pk_bf16_f32 v230, v236, v237
Mvav 92,244,0
s_waitcnt lgkmcnt(7)
TR 244,18,29184
TR 246,18,31232
Mvav 96,224,28
v_cvt_pk_bf16_f32 v231, v238, v239
ds_write_b128 v13, v[228:231] offset:12288
Mvav 100,224,0
TR 224,17,32768
TR 226,17,34816
Mvav 104,228,28
v_cvt_pk_bf16_f32 v240, v240, v241
v_cvt_pk_bf16_f32 v241, v242, v243
Mvav 108,228,0
s_waitcnt lgkmcnt(8)
TR 228,18,32768
TR 230,18,34816
Mvav 112,232,28
v_cvt_pk_bf16_f32 v242, v248, v249
v_cvt_pk_bf16_f32 v243, v250, v251
Mvav 116,232,0
TR 232,17,33280
TR 234,17,35328
Mvav 120,236,28
ds_write_b128 v13, v[240:243] offset:8192
v_cvt_pk_bf16_f32 v244, v244, v245
Mvav 124,236,0
s_waitcnt lgkmcnt(8)
TR 236,18,33280
TR 238,18,35328
Mvav 128,240,28
v_cvt_pk_bf16_f32 v245, v246, v247
v_cvt_pk_bf16_f32 v246, v252, v253
Mvav 132,240,0
TR 240,15,20480
TR 242,15,22528
Mvav 136,244,28
v_cvt_pk_bf16_f32 v247, v254, v255
ds_write_b128 v13, v[244:247] offset:4096
Mvav 140,244,0
s_waitcnt lgkmcnt(8)
TR 244,16,20480
TR 246,16,22528
Mvav 144,224,28
v_exp_f32 v25, v57
Mvav 148,224,0
TR 224,15,0
TR 226,15,2048
Mvav 152,228,28
v_exp_f32 v26, v58
Mvav 156,228,0
s_waitcnt lgkmcnt(7)
TR 228,16,0
TR 230,16,2048
Mvav 160,232,28
v_cvt_pk_bf16_f32 v44, v24, v25
Mvav 164,232,0
TR 232,15,20992
TR 234,15,23040
Mvav 168,236,28
v_exp_f32 v27, v59
Mvav 172,236,0
s_waitcnt lgkmcnt(6)
TR 236,16,20992
TR 238,16,23040
v_mfma_f32_16x16x32_bf16 v[224:227], a[240:243], v[176:179], 0
s_add_u32 s43, s58, 245760
v_exp_f32 v24, v52
v_mfma_f32_16x16x32_bf16 v[228:231], a[240:243], v[180:183], 0
s_add_u32 m0, s38, 49152
TR 240,15,512
TR 242,15,2560
v_mfma_f32_16x16x32_bf16 v[232:235], a[244:247], v[176:179], 0
buffer_load_dwordx4 v7, s[20:23], s43 offen lds
v_mfma_f32_16x16x32_bf16 v[236:239], a[244:247], v[180:183], 0
s_waitcnt vmcnt(10) lgkmcnt(6)
TR 244,16,512
TR 246,16,2560
Mvav 224,224,184
s_barrier
Mvav 228,224,188
s_add_u32 m0, s38, 53248
ds_read_b128 a[224:227], v9 offset:4096
v_cvt_pk_bf16_f32 v45, v26, v27
Mvav 232,228,184
v_exp_f32 v25, v53
Mvav 236,228,188
s_waitcnt lgkmcnt(5)
ds_read_b128 a[228:231], v9 offset:4608
v_cvt_pk_bf16_f32 v42, v24, v25
v_mfma_f32_16x16x32_bf16 v[240:243], a[232:235], v[176:179], 0
buffer_load_dwordx4 v5, s[12:15], s33 offen nt lds
v_mfma_f32_16x16x32_bf16 v[244:247], a[232:235], v[180:183], 0
s_add_u32 m0, s38, 57216
ds_read_b128 a[232:235], v9 offset:12288
v_mfma_f32_16x16x32_bf16 v[248:251], a[236:239], v[176:179], 0
v_exp_f32 v26, v54
v_mfma_f32_16x16x32_bf16 v[252:255], a[236:239], v[180:183], 0
s_waitcnt lgkmcnt(3)
ds_read_b128 a[236:239], v9 offset:12800
ds_read_b128 v[176:179], v13 offset:61440
Mvav 240,240,184
v_exp_f32 v27, v55
Mvav 244,240,188
ds_read_b128 a[240:243], v9 offset:16384
v_cvt_pk_bf16_f32 v43, v26, v27
Mvav 248,244,184
buffer_load_dwordx4 v5, s[12:15], s33 offen offset:128 nt lds
Mvav 252,244,188
s_waitcnt lgkmcnt(4)
ds_read_b128 a[244:247], v9 offset:16896
ds_read_b128 v[180:183], v13 offset:57344
v_mfma_f32_16x16x32_bf16 v[64:67], a[224:227], a[28:31], 0
s_add_u32 m0, s38, 65280
v_exp_f32 v24, v60
v_mfma_f32_16x16x32_bf16 v[72:75], a[224:227], a[32:35], 0
ds_read_b128 a[224:227], v9 offset:6144
ds_read_b128 v[184:187], v13 offset:53248
Mvaa 64,228,36
v_exp_f32 v25, v61
Mvaa 72,228,40
s_waitcnt lgkmcnt(6)
ds_read_b128 a[228:231], v9 offset:6656
v_cvt_pk_bf16_f32 v46, v24, v25
Mvaa 64,232,44
buffer_load_dwordx4 v5, s[12:15], s33 offen offset:256 nt lds
Mvaa 72,232,48
s_add_u32 s33, s33, 6144
ds_read_b128 a[232:235], v9 offset:14336
ds_read_b128 v[188:191], v13 offset:49152
Mvaa 64,236,52
s_sub_u32 s45, s33, 98304
v_exp_f32 v26, v62
Mvaa 72,236,56
s_waitcnt lgkmcnt(6)
ds_read_b128 a[236:239], v9 offset:14848
s_min_u32 s33, s33, s45
Mvaa 64,240,60
Tc31:
s_cbranch_execz Tr31
s_cmpk_eq_u32 s88, 2
s_cselect_b64 exec, 0, -1
s_cbranch_execz Tc34
Tr34:
s_mov_b64 exec, -1
s_add_u32 m0, s38, 69632
v_exp_f32 v27, v63
Mvaa 72,240,64
ds_read_b128 a[240:243], v9 offset:18432
v_cvt_pk_bf16_f32 v47, v26, v27
Mvaa 64,244,68
buffer_load_dwordx4 v4, s[8:11], s32 offen nt lds
Mvaa 72,244,72
s_waitcnt lgkmcnt(4)
ds_read_b128 a[244:247], v9 offset:18944
s_add_u32 m0, s38, 77696
v_mfma_f32_16x16x32_bf16 v[68:71], a[224:227], a[28:31], 0
v_exp_f32 v24, v64
v_mfma_f32_16x16x32_bf16 v[76:79], a[224:227], a[32:35], 0
TR 224,15,8192
TR 226,15,10240
Mvaa 68,228,36
v_exp_f32 v25, v65
Mvaa 76,228,40
s_waitcnt lgkmcnt(4)
v_exp_f32 v26, v66
Mvaa 68,232,44
buffer_load_dwordx4 v4, s[8:11], s32 offen offset:128 nt lds
Mvaa 76,232,48
s_add_u32 m0, s38, 81664
TR 232,16,8192
TR 234,16,10240
Mvaa 68,236,52
v_cvt_pk_bf16_f32 v28, v24, v25
Mvaa 76,236,56
s_waitcnt lgkmcnt(4)
TR 236,15,8704
TR 238,15,10752
Mvaa 68,240,60
v_exp_f32 v27, v67
Mvaa 76,240,64
s_waitcnt vmcnt(10)
TR 240,16,8704
TR 242,16,10752
Mvaa 68,244,68
s_barrier
Mvaa 76,244,72
s_waitcnt lgkmcnt(6)
TR 244,15,32768
TR 246,15,34816
Mvav 224,224,192
buffer_load_dwordx4 v4, s[8:11], s32 offen offset:256 nt lds
Mvav 228,224,196
s_add_u32 s32, s32, 6144
TR 224,16,32768
TR 226,16,34816
Mvav 32,252,40
s_sub_u32 s45, s32, 98304
v_exp_f32 v24, v72
Mvav 36,252,44
s_waitcnt lgkmcnt(6)
TR 228,15,33280
TR 230,15,35328
Mvav 232,232,192
s_min_u32 s32, s32, s45
v_cvt_pk_bf16_f32 v29, v26, v27
s_add_u32 s43, s58, 286720
Mvav 236,232,196
s_add_u32 m0, s38, 0
TR 232,16,33280
TR 234,16,35328
Mvav 240,236,192
buffer_load_dwordx4 v7, s[20:23], s43 offen lds
Mvav 244,236,196
s_waitcnt lgkmcnt(6)
TR 236,15,36864
TR 238,15,38912
Mvav 248,240,192
v_max_f32 v33, v32, v36
v_cmp_nge_f32 vcc, s39, v33
Mvav 252,240,196
TR 240,16,36864
TR 242,16,38912
s_cbranch_vccnz Lr58
Lb58:
Mvav 80,244,40
ds_read_b128 v[192:195], v13 offset:45056
ds_read_b128 v[196:199], v13 offset:40960
Mvav 84,244,44
s_waitcnt lgkmcnt(8)
TR 244,15,37376
TR 246,15,39424
Mvav 88,224,40
v_exp_f32 v25, v73
Mvav 92,224,44
TR 224,16,37376
TR 226,16,39424
Mvav 96,228,40
v_exp_f32 v26, v74
Mvav 100,228,44
s_waitcnt lgkmcnt(8)
TR 228,17,12288
TR 230,17,14336
Mvav 104,232,40
v_cvt_pk_bf16_f32 v0, v24, v25
Mvav 108,232,44
TR 232,18,12288
TR 234,18,14336
Mvav 112,236,40
v_exp_f32 v27, v75
Mvav 116,236,44
s_waitcnt lgkmcnt(6)
TR 236,17,12800
TR 238,17,14848
Mvav 120,240,40
v_exp_f32 v24, v68
Mvav 124,240,44
TR 240,18,12800
TR 242,18,14848
Mvav 128,244,40
v_cvt_pk_bf16_f32 v1, v26, v27
Mvav 132,244,44
s_waitcnt lgkmcnt(6)
TR 244,15,24576
TR 246,15,26624
Mvav 136,224,40
v_exp_f32 v25, v69
Mvav 140,224,44
TR 224,16,24576
TR 226,16,26624
Mvav 144,228,40
v_exp_f32 v26, v70
Mvav 148,228,44
s_waitcnt lgkmcnt(6)
TR 228,15,25088
TR 230,15,27136
Mvav 152,232,40
v_cvt_pk_bf16_f32 v30, v24, v25
Mvav 156,232,44
TR 232,16,25088
TR 234,16,27136
Mvav 160,236,40
v_exp_f32 v27, v71
Mvav 164,236,44
s_waitcnt lgkmcnt(6)
TR 236,15,28672
TR 238,15,30720
Mvav 168,240,40
v_cvt_pk_bf16_f32 v31, v26, v27
s_add_u32 s43, s58, 327680
Mvav 172,240,44
s_add_u32 m0, s38, 4096
TR 240,16,28672
TR 242,16,30720
Mvav 224,244,200
buffer_load_dwordx4 v7, s[20:23], s43 offen lds
Mvav 228,244,204
s_waitcnt lgkmcnt(6)
TR 244,15,29184
TR 246,15,31232
Mvav 232,224,200
s_add_u32 s43, s58, 368640
v_exp_f32 v24, v76
Mvav 236,224,204
s_waitcnt vmcnt(8)
TR 224,16,29184
TR 226,16,31232
Mvav 240,228,200
s_barrier
Mvav 244,228,204
s_waitcnt lgkmcnt(6)
ds_read_b128 a[228:231], v10 offset:24576
s_add_u32 m0, s38, 12288
Mvav 248,232,200
buffer_load_dwordx4 v7, s[20:23], s43 offen lds
Mvav 252,232,204
s_add_u32 m0, s38, 8192
ds_read_b128 a[232:235], v10 offset:25088
ds_read_b128 v[200:203], v13 offset:36864
Mvav 224,236,208
ds_read_b128 v[204:207], v13 offset:32768
Mvav 228,236,212
s_waitcnt lgkmcnt(6)
ds_read_b128 a[236:239], v10 offset:36864
Mvav 232,240,208
v_exp_f32 v25, v77
Mvav 236,240,212
ds_read_b128 a[240:243], v10 offset:37376
v_cvt_pk_bf16_f32 v2, v24, v25
Mvav 240,244,208
buffer_load_dwordx4 v5, s[12:15], s33 offen nt lds
Mvav 244,244,212
s_waitcnt lgkmcnt(5)
ds_read_b128 a[244:247], v9 offset:40960
s_add_u32 m0, s38, 16256
Mvav 248,224,208
v_exp_f32 v26, v78
Mvav 252,224,212
ds_read_b128 a[224:227], v9 offset:41472
ds_read_b128 v[208:211], v13 offset:28672
v_mfma_f32_16x16x32_bf16 v[48:51], a[228:231], a[28:31], 0
v_exp_f32 v27, v79
v_mfma_f32_16x16x32_bf16 v[56:59], a[228:231], a[32:35], 0
s_waitcnt lgkmcnt(4)
ds_read_b128 a[228:231], v10 offset:26624
v_cvt_pk_bf16_f32 v3, v26, v27
Mvaa 48,232,36
buffer_load_dwordx4 v5, s[12:15], s33 offen offset:128 nt lds
Mvaa 56,232,40
s_add_u32 m0, s38, 20224
ds_read_b128 a[232:235], v10 offset:27136
ds_read_b128 v[212:215], v13 offset:24576
Mvaa 48,236,44
Mvaa 56,236,48
s_waitcnt lgkmcnt(5)
ds_read_b128 a[236:239], v10 offset:38912
Mvaa 48,240,52
Mvaa 56,240,56
ds_read_b128 a[240:243], v10 offset:39424
Mvaa 48,244,60
buffer_load_dwordx4 v5, s[12:15], s33 offen offset:256 nt lds
Mvaa 56,244,64
s_waitcnt lgkmcnt(4)
ds_read_b128 a[244:247], v9 offset:43008
s_add_u32 s33, s33, 6144
Mvaa 48,224,68
s_sub_u32 s45, s33, 98304
s_min_u32 s33, s33, s45
s_add_u32 m0, s38, 32768
Mvaa 56,224,72
ds_read_b128 a[224:227], v9 offset:43520
v_mfma_f32_16x16x32_bf16 v[52:55], a[228:231], a[28:31], 0
v_exp_f32 v24, v48
v_mfma_f32_16x16x32_bf16 v[60:63], a[228:231], a[32:35], 0
s_waitcnt lgkmcnt(3)
TR 228,15,45056
TR 230,15,47104
Mvaa 52,232,36
buffer_load_dwordx4 v4, s[8:11], s32 offen nt lds
Mvaa 60,232,40
s_add_u32 m0, s38, 36736
TR 232,16,45056
TR 234,16,47104
Mvaa 52,236,44
v_exp_f32 v25, v49
Mvaa 60,236,48
s_waitcnt lgkmcnt(5)
TR 236,15,45568
TR 238,15,47616
Mvaa 52,240,52
v_exp_f32 v26, v50
Mvaa 60,240,56
TR 240,16,45568
TR 242,16,47616
Mvaa 52,244,60
buffer_load_dwordx4 v4, s[8:11], s32 offen offset:128 nt lds
Mvaa 60,244,64
s_waitcnt lgkmcnt(6)
TR 244,17,0
TR 246,17,2048
Mvaa 52,224,68
s_add_u32 m0, s38, 61184
v_cvt_pk_bf16_f32 v40, v24, v25
Mvaa 60,224,72
v_exp_f32 v27, v51
Mvav 224,228,216
v_exp_f32 v24, v56
Mvav 228,228,220
s_waitcnt lgkmcnt(4)
TR 228,18,0
TR 230,18,2048
Mvav 232,232,216
buffer_load_dwordx4 v4, s[8:11], s32 offen offset:256 nt lds
Mvav 236,232,220
s_add_u32 s32, s32, 6144
TR 232,17,512
TR 234,17,2560
Mvav 240,236,216
s_sub_u32 s45, s32, 98304
v_cvt_pk_bf16_f32 v41, v26, v27
s_min_u32 s32, s32, s45
Mvav 244,236,220
s_waitcnt vmcnt(8) lgkmcnt(4)
TR 236,18,512
TR 238,18,2560
Mvav 248,240,216
s_barrier
Mvav 252,240,220
s_add_u32 s43, s58, 409600
TR 240,17,4096
TR 242,17,6144
Mvaa 224,244,160
s_add_u32 m0, s38, 24576
ds_read_b128 v[216:219], v13 offset:20480
ds_read_b128 v[220:223], v13 offset:16384
Mvaa 228,244,164
s_waitcnt lgkmcnt(8)
TR 244,18,4096
TR 246,18,6144
Mvav 32,252,28
buffer_load_dwordx4 v7, s[20:23], s43 offen lds
Mvav 36,252,0
TR 224,17,4608
TR 226,17,6656
Mvaa 232,228,160
v_exp_f32 v25, v57
Mvaa 236,228,164
s_waitcnt lgkmcnt(8)
TR 228,18,4608
TR 230,18,6656
Mvaa 240,232,160
v_max_f32 v33, v32, v36
v_cmp_nge_f32 vcc, s39, v33
Mvaa 244,232,164
TR 232,17,8192
TR 234,17,10240
Mvaa 248,236,160
v_exp_f32 v26, v58
Mvaa 252,236,164
s_waitcnt lgkmcnt(6)
TR 236,18,8192
TR 238,18,10240
s_cbranch_vccnz Lr59
Lb59:
Mvav 80,240,28
ds_read_b128 a[160:163], v13 offset:12288
ds_read_b128 a[164:167], v13 offset:8192
Mvav 84,240,0
TR 240,17,8704
TR 242,17,10752
Mvav 88,244,28
v_cvt_pk_bf16_f32 v44, v24, v25
Mvav 92,244,0
s_waitcnt lgkmcnt(8)
TR 244,18,8704
TR 246,18,10752
Mvav 96,224,28
v_exp_f32 v27, v59
Mvav 100,224,0
TR 224,17,16384
TR 226,17,18432
Mvav 104,228,28
v_exp_f32 v24, v52
Mvav 108,228,0
s_waitcnt lgkmcnt(8)
TR 228,18,16384
TR 230,18,18432
Mvav 112,232,28
v_cvt_pk_bf16_f32 v45, v26, v27
Mvav 116,232,0
TR 232,17,16896
TR 234,17,18944
Mvav 120,236,28
v_exp_f32 v25, v53
Mvav 124,236,0
s_waitcnt lgkmcnt(6)
TR 236,18,16896
TR 238,18,18944
Mvav 128,240,28
v_exp_f32 v26, v54
Mvav 132,240,0
TR 240,15,0
TR 242,15,2048
Mvav 136,244,28
v_cvt_pk_bf16_f32 v42, v24, v25
Mvav 140,244,0
s_waitcnt lgkmcnt(6)
TR 244,16,0
TR 246,16,2048
Mvav 144,224,28
v_exp_f32 v27, v55
Mvav 148,224,0
s_add_u32 s43, s58, 450560
TR 224,15,512
TR 226,15,2560
Mvav 152,228,28
s_add_u32 m0, s38, 28672
v_cvt_pk_bf16_f32 v43, v26, v27
Mvav 156,228,0
s_waitcnt vmcnt(7) lgkmcnt(6)
TR 228,16,512
TR 230,16,2560
Mvav 160,232,28
s_barrier
Mvav 164,232,0
ds_read_b128 a[232:235], v10 offset:20480
Mvav 168,236,28
buffer_load_dwordx4 v7, s[20:23], s43 offen lds
Mvav 172,236,0
s_waitcnt lgkmcnt(5)
ds_read_b128 a[236:239], v10 offset:20992
s_add_u32 s43, s58, 491520
Mvaa 224,240,168
s_add_u32 m0, s38, 40960
v_exp_f32 v24, v60
Mvaa 228,240,172
ds_read_b128 a[240:243], v10 offset:28672
Mvaa 232,244,168
buffer_load_dwordx4 v7, s[20:23], s43 offen lds
Mvaa 236,244,172
s_waitcnt lgkmcnt(3)
ds_read_b128 a[244:247], v10 offset:29184
s_add_u32 s43, s58, 532480
Mvaa 240,224,168
s_add_u32 m0, s38, 45056
v_exp_f32 v25, v61
Mvaa 244,224,172
ds_read_b128 a[224:227], v10 offset:32768
v_cvt_pk_bf16_f32 v46, v24, v25
Mvaa 248,228,168
buffer_load_dwordx4 v7, s[20:23], s43 offen lds
Mvaa 252,228,172
s_waitcnt lgkmcnt(3)
ds_read_b128 a[228:231], v10 offset:33280
ds_read_b128 a[168:171], v13 offset:4096
v_mfma_f32_16x16x32_bf16 v[64:67], a[232:235], a[28:31], 0
s_add_u32 m0, s38, 49152
v_exp_f32 v26, v62
v_mfma_f32_16x16x32_bf16 v[72:75], a[232:235], a[32:35], 0
ds_read_b128 a[232:235], v10 offset:22528
Mvaa 64,236,36
v_exp_f32 v27, v63
Mvaa 72,236,40
s_waitcnt lgkmcnt(4)
ds_read_b128 a[236:239], v10 offset:23040
v_cvt_pk_bf16_f32 v47, v26, v27
Mvaa 64,240,44
buffer_load_dwordx4 v5, s[12:15], s33 offen nt lds
Mvaa 72,240,48
s_add_u32 m0, s38, 53120
ds_read_b128 a[240:243], v10 offset:30720
Mvaa 64,244,52
Mvaa 72,244,56
s_waitcnt lgkmcnt(4)
ds_read_b128 a[244:247], v10 offset:31232
Mvaa 64,224,60
Mvaa 72,224,64
ds_read_b128 a[224:227], v10 offset:34816
Mvaa 64,228,68
buffer_load_dwordx4 v5, s[12:15], s33 offen offset:128 nt lds
Mvaa 72,228,72
s_waitcnt lgkmcnt(3)
ds_read_b128 a[228:231], v10 offset:35328
s_add_u32 m0, s38, 57088
v_mfma_f32_16x16x32_bf16 v[68:71], a[232:235], a[28:31], 0
v_exp_f32 v24, v64
v_mfma_f32_16x16x32_bf16 v[76:79], a[232:235], a[32:35], 0
TR 232,15,4096
TR 234,15,6144
Mvaa 68,236,36
v_exp_f32 v25, v65
Mvaa 76,236,40
s_waitcnt lgkmcnt(4)
TR 236,16,4096
TR 238,16,6144
Mvaa 68,240,44
buffer_load_dwordx4 v5, s[12:15], s33 offen offset:256 nt lds
Mvaa 76,240,48
s_add_u32 s33, s33, 6144
TR 240,15,4608
TR 242,15,6656
Mvaa 68,244,52
s_sub_u32 s45, s33, 98304
v_exp_f32 v26, v66
Mvaa 76,244,56
s_waitcnt lgkmcnt(6)
TR 244,16,4608
TR 246,16,6656
Mvaa 68,224,60
s_min_u32 s33, s33, s45
v_cvt_pk_bf16_f32 v28, v24, v25
s_add_u32 m0, s38, 73728
Mvaa 76,224,64
TR 224,15,12288
TR 226,15,14336
Mvaa 68,228,68
buffer_load_dwordx4 v4, s[8:11], s32 offen nt lds
Mvaa 76,228,72
s_waitcnt lgkmcnt(6)
v_exp_f32 v27, v67
Mvaa 224,232,176
s_add_u32 m0, s38, 85888
v_exp_f32 v24, v72
Mvaa 228,232,180
TR 232,16,12288
TR 234,16,14336
Mvaa 232,236,176
v_cvt_pk_bf16_f32 v29, v26, v27
Mvaa 236,236,180
s_waitcnt lgkmcnt(4)
TR 236,15,12800
TR 238,15,14848
Mvaa 240,240,176
buffer_load_dwordx4 v4, s[8:11], s32 offen offset:128 nt lds
Mvaa 244,240,180
s_waitcnt vmcnt(8)
TR 240,16,12800
TR 242,16,14848
Mvaa 248,244,176
s_barrier
Mvaa 252,244,180
s_waitcnt lgkmcnt(6)
TR 244,15,8192
TR 246,15,10240
Mvaa 224,224,184
s_add_u32 s43, s32, 256
v_exp_f32 v25, v73
Mvaa 228,224,188
s_add_u32 m0, s38, 0
TR 224,16,8192
TR 226,16,10240
Mvav 32,252,40
buffer_load_dwordx4 v4, s[8:11], s43 offen nt lds
Mvav 36,252,44
s_waitcnt lgkmcnt(6)
TR 228,15,8704
TR 230,15,10752
Mvaa 232,232,184
s_add_u32 s32, s32, 6144
v_exp_f32 v26, v74
Mvaa 236,232,188
s_sub_u32 s45, s32, 98304
TR 232,16,8704
TR 234,16,10752
Mvaa 240,236,184
s_min_u32 s32, s32, s45
v_max_f32 v33, v32, v36
v_cmp_nge_f32 vcc, s39, v33
Mvaa 244,236,188
s_waitcnt lgkmcnt(6)
TR 236,15,16384
TR 238,15,18432
Mvaa 248,240,184
s_add_u32 s43, s58, 573440
v_cvt_pk_bf16_f32 v0, v24, v25
s_add_u32 m0, s38, 4096
Mvaa 252,240,188
TR 240,16,16384
TR 242,16,18432
s_cbranch_vccnz Lr60
Lb60:
Mvav 80,244,40
buffer_load_dwordx4 v7, s[20:23], s43 offen lds
Mvav 84,244,44
s_waitcnt lgkmcnt(6)
TR 244,15,16896
TR 246,15,18944
Mvav 88,224,40
v_exp_f32 v27, v75
Mvav 92,224,44
TR 224,16,16896
TR 226,16,18944
Mvav 96,228,40
v_exp_f32 v24, v68
Mvav 100,228,44
s_waitcnt lgkmcnt(6)
TR 228,15,20480
TR 230,15,22528
Mvav 104,232,40
v_cvt_pk_bf16_f32 v1, v26, v27
Mvav 108,232,44
TR 232,16,20480
TR 234,16,22528
Mvav 112,236,40
v_exp_f32 v25, v69
Mvav 116,236,44
s_waitcnt lgkmcnt(6)
TR 236,15,20992
TR 238,15,23040
Mvav 120,240,40
v_exp_f32 v26, v70
Mvav 124,240,44
TR 240,16,20992
TR 242,16,23040
Mvav 128,244,40
v_cvt_pk_bf16_f32 v30, v24, v25
Tc32:
s_cbranch_execz Tr32
s_cmpk_eq_u32 s88, 3
s_cselect_b64 exec, 0, -1
s_cbranch_execz Tc35
Tr35:
s_mov_b64 exec, -1
Mvav 132,244,44
s_waitcnt lgkmcnt(6)
TR 244,15,24576
TR 246,15,26624
Mvav 136,224,40
v_exp_f32 v27, v71
Mvav 140,224,44
TR 224,16,24576
TR 226,16,26624
Mvav 144,228,40
v_cvt_pk_bf16_f32 v31, v26, v27
Mvav 148,228,44
s_waitcnt lgkmcnt(6)
TR 228,15,25088
TR 230,15,27136
Mvav 152,232,40
v_exp_f32 v24, v76
Mvav 156,232,44
s_waitcnt vmcnt(8)
TR 232,16,25088
TR 234,16,27136
Mvav 160,236,40
s_barrier
Mvav 164,236,44
s_waitcnt lgkmcnt(6)
ds_read_b128 a[236:239], v9 offset:32768
Mvav 168,240,40
v_exp_f32 v25, v77
Mvav 172,240,44
ds_read_b128 a[240:243], v9 offset:33280
v_cvt_pk_bf16_f32 v2, v24, v25
Mvaa 224,244,192
v_exp_f32 v26, v78
Mvaa 228,244,196
s_waitcnt lgkmcnt(4)
ds_read_b128 a[244:247], v9 offset:36864
s_add_u32 s43, s58, 614400
Mvaa 232,224,192
s_add_u32 m0, s38, 8192
v_exp_f32 v27, v79
Mvaa 236,224,196
ds_read_b128 a[224:227], v9 offset:37376
v_cvt_pk_bf16_f32 v3, v26, v27
Mvaa 240,228,192
buffer_load_dwordx4 v7, s[20:23], s43 offen lds
Mvaa 244,228,196
s_waitcnt lgkmcnt(3)
ds_read_b128 a[228:231], v10 offset:12288
s_add_u32 s43, s58, 655360
Mvaa 248,232,192
s_add_u32 m0, s38, 12288
Mvaa 252,232,196
ds_read_b128 a[232:235], v10 offset:12800
v_mfma_f32_16x16x32_bf16 v[48:51], a[236:239], a[28:31], 0
buffer_load_dwordx4 v7, s[20:23], s43 offen lds
v_mfma_f32_16x16x32_bf16 v[56:59], a[236:239], a[32:35], 0
s_waitcnt lgkmcnt(3)
ds_read_b128 a[236:239], v9 offset:34816
s_add_u32 m0, s38, 16384
Mvaa 48,240,36
Mvaa 56,240,40
ds_read_b128 a[240:243], v9 offset:35328
Mvaa 48,244,44
Mvaa 56,244,48
s_waitcnt lgkmcnt(3)
ds_read_b128 a[244:247], v9 offset:38912
Mvaa 48,224,52
buffer_load_dwordx4 v5, s[12:15], s33 offen nt lds
Mvaa 56,224,56
s_add_u32 m0, s38, 65408
ds_read_b128 a[224:227], v9 offset:39424
Mvaa 48,228,60
Mvaa 56,228,64
s_waitcnt lgkmcnt(3)
ds_read_b128 a[228:231], v10 offset:14336
Mvaa 48,232,68
Mvaa 56,232,72
ds_read_b128 a[232:235], v10 offset:14848
v_mfma_f32_16x16x32_bf16 v[52:55], a[236:239], a[28:31], 0
buffer_load_dwordx4 v5, s[12:15], s33 offen offset:128 nt lds
v_mfma_f32_16x16x32_bf16 v[60:63], a[236:239], a[32:35], 0
s_waitcnt lgkmcnt(3)
TR 236,15,28672
TR 238,15,30720
Mvaa 52,240,36
s_add_u32 m0, s38, 69376
v_exp_f32 v24, v48
Mvaa 60,240,40
TR 240,16,28672
TR 242,16,30720
Mvaa 52,244,44
v_exp_f32 v25, v49
Mvaa 60,244,48
s_waitcnt lgkmcnt(5)
TR 244,15,29184
TR 246,15,31232
Mvaa 52,224,52
buffer_load_dwordx4 v5, s[12:15], s33 offen offset:256 nt lds
Mvaa 60,224,56
s_add_u32 s33, s33, 6144
TR 224,16,29184
TR 226,16,31232
Mvaa 52,228,60
s_sub_u32 s45, s33, 98304
v_exp_f32 v26, v50
Mvaa 60,228,64
s_waitcnt lgkmcnt(6)
TR 228,15,40960
TR 230,15,43008
Mvaa 52,232,68
s_min_u32 s33, s33, s45
v_cvt_pk_bf16_f32 v40, v24, v25
s_add_u32 m0, s38, 77824
Mvaa 60,232,72
v_exp_f32 v27, v51
Mvaa 224,236,200
buffer_load_dwordx4 v5, s[12:15], s33 offen nt lds
Mvaa 228,236,204
s_waitcnt lgkmcnt(4)
TR 236,16,40960
TR 238,16,43008
Mvaa 232,240,200
s_add_u32 m0, s38, 81792
v_exp_f32 v24, v56
Mvaa 236,240,204
TR 240,15,41472
TR 242,15,43520
Mvaa 240,244,200
v_cvt_pk_bf16_f32 v41, v26, v27
Mvaa 244,244,204
s_waitcnt vmcnt(6) lgkmcnt(4)
TR 244,16,41472
TR 246,16,43520
Mvaa 248,224,200
s_barrier
Mvaa 252,224,204
TR 224,17,0
TR 226,17,2048
Mvaa 224,228,208
buffer_load_dwordx4 v5, s[12:15], s33 offen offset:128 nt lds
Mvaa 228,228,212
s_waitcnt lgkmcnt(6)
TR 228,18,0
TR 230,18,2048
Mvav 32,252,28
s_add_u32 m0, s38, 20224
v_exp_f32 v25, v57
Mvav 36,252,0
TR 232,17,512
TR 234,17,2560
Mvaa 232,236,208
v_exp_f32 v26, v58
Mvaa 236,236,212
s_waitcnt lgkmcnt(6)
TR 236,18,512
TR 238,18,2560
Mvaa 240,240,208
buffer_load_dwordx4 v5, s[12:15], s33 offen offset:256 nt lds
Mvaa 244,240,212
s_add_u32 s33, s33, 6144
TR 240,17,4096
TR 242,17,6144
Mvaa 248,244,208
s_sub_u32 s45, s33, 98304
v_max_f32 v33, v32, v36
v_cmp_nge_f32 vcc, s39, v33
Mvaa 252,244,212
s_waitcnt lgkmcnt(6)
TR 244,18,4096
TR 246,18,6144
s_cbranch_vccnz Lr61
Lb61:
Mvav 80,224,28
s_min_u32 s33, s33, s45
v_cvt_pk_bf16_f32 v44, v24, v25
s_add_u32 s43, s58, 696320
Mvav 84,224,0
s_add_u32 m0, s38, 24576
TR 224,17,4608
TR 226,17,6656
Mvav 88,228,28
buffer_load_dwordx4 v7, s[20:23], s43 offen lds
Mvav 92,228,0
s_waitcnt lgkmcnt(6)
TR 228,18,4608
TR 230,18,6656
Mvav 96,232,28
v_exp_f32 v27, v59
Mvav 100,232,0
TR 232,17,8192
TR 234,17,10240
Mvav 104,236,28
v_exp_f32 v24, v52
Mvav 108,236,0
s_waitcnt lgkmcnt(6)
TR 236,18,8192
TR 238,18,10240
Mvav 112,240,28
v_cvt_pk_bf16_f32 v45, v26, v27
Mvav 116,240,0
TR 240,17,8704
TR 242,17,10752
Mvav 120,244,28
v_exp_f32 v25, v53
Mvav 124,244,0
s_waitcnt lgkmcnt(6)
TR 244,18,8704
TR 246,18,10752
Mvav 128,224,28
v_exp_f32 v26, v54
Mvav 132,224,0
TR 224,15,45056
TR 226,15,47104
Mvav 136,228,28
v_cvt_pk_bf16_f32 v42, v24, v25
Mvav 140,228,0
s_waitcnt lgkmcnt(6)
TR 228,16,45056
TR 230,16,47104
Mvav 144,232,28
v_exp_f32 v27, v55
Mvav 148,232,0
TR 232,15,45568
TR 234,15,47616
Mvav 152,236,28
v_cvt_pk_bf16_f32 v43, v26, v27
Mvav 156,236,0
s_waitcnt lgkmcnt(6)
TR 236,16,45568
TR 238,16,47616
s_mov_b64 exec, 0
s_bitcmp1_b32 s88, 0
s_cbranch_scc1 Xt0_1
s_bitcmp1_b32 s88, 1
s_cbranch_scc1 Xt1_2
s_bitcmp1_b32 s88, 2
s_cbranch_scc1 Xt2_4
s_bitcmp1_b32 s88, 3
s_cbranch_scc1 Xt3_8
s_bitcmp1_b32 s88, 4
s_cbranch_scc1 X16
s_branch X0
Xt3_8:
s_bitcmp1_b32 s88, 4
s_cbranch_scc1 XR0
s_branch X8
Xt2_4:
s_bitcmp1_b32 s88, 3
s_cbranch_scc1 Xt3_12
s_bitcmp1_b32 s88, 4
s_cbranch_scc1 X20
s_branch X4
Xt3_12:
s_bitcmp1_b32 s88, 4
s_cbranch_scc1 Xe
s_branch X12
Xt1_2:
s_bitcmp1_b32 s88, 2
s_cbranch_scc1 Xt2_6
s_bitcmp1_b32 s88, 3
s_cbranch_scc1 Xt3_10
s_bitcmp1_b32 s88, 4
s_cbranch_scc1 X18
s_branch X2
Xt3_10:
s_bitcmp1_b32 s88, 4
s_cbranch_scc1 XR2
s_branch X10
Xt2_6:
s_bitcmp1_b32 s88, 3
s_cbranch_scc1 Xt3_14
s_bitcmp1_b32 s88, 4
s_cbranch_scc1 X22
s_branch X6
Xt3_14:
s_bitcmp1_b32 s88, 4
s_cbranch_scc1 Xe
s_branch X14
Xt0_1:
s_bitcmp1_b32 s88, 1
s_cbranch_scc1 Xt1_3
s_bitcmp1_b32 s88, 2
s_cbranch_scc1 Xt2_5
s_bitcmp1_b32 s88, 3
s_cbranch_scc1 Xt3_9
s_bitcmp1_b32 s88, 4
s_cbranch_scc1 X17
s_branch X1
Xt3_9:
s_bitcmp1_b32 s88, 4
s_cbranch_scc1 XR1
s_branch X9
Xt2_5:
s_bitcmp1_b32 s88, 3
s_cbranch_scc1 Xt3_13
s_bitcmp1_b32 s88, 4
s_cbranch_scc1 X21
s_branch X5
Xt3_13:
s_bitcmp1_b32 s88, 4
s_cbranch_scc1 Xe
s_branch X13
Xt1_3:
s_bitcmp1_b32 s88, 2
s_cbranch_scc1 Xt2_7
s_bitcmp1_b32 s88, 3
s_cbranch_scc1 Xt3_11
s_bitcmp1_b32 s88, 4
s_cbranch_scc1 X19
s_branch X3
Xt3_11:
s_bitcmp1_b32 s88, 4
s_cbranch_scc1 Xe
s_branch X11
Xt2_7:
s_bitcmp1_b32 s88, 3
s_cbranch_scc1 Xt3_15
s_bitcmp1_b32 s88, 4
s_cbranch_scc1 X23
s_branch X7
Xt3_15:
s_bitcmp1_b32 s88, 4
s_cbranch_scc1 Xe
s_branch X15
Xe:
s_mov_b64 exec, -1
Mvav 160,240,28
v_exp_f32 v24, v60
Mvav 164,240,0
TR 240,15,4096
TR 242,15,6144
Mvav 168,244,28
v_exp_f32 v25, v61
Mvav 172,244,0
s_waitcnt lgkmcnt(6)
TR 244,16,4096
TR 246,16,6144
Mvaa 224,224,216
v_exp_f32 v26, v62
Mvaa 228,224,220
s_add_u32 s43, s58, 737280
TR 224,15,4608
TR 226,15,6656
Mvaa 232,228,216
s_add_u32 m0, s38, 28672
v_cvt_pk_bf16_f32 v46, v24, v25
Mvaa 236,228,220
s_waitcnt vmcnt(8) lgkmcnt(6)
TR 228,16,4608
TR 230,16,6656
Mvaa 240,232,216
s_barrier
Mvaa 244,232,220
ds_read_b128 a[232:235], v10 offset:24576
Mvaa 248,236,216
buffer_load_dwordx4 v7, s[20:23], s43 offen lds
Mvaa 252,236,220
s_waitcnt lgkmcnt(5)
ds_read_b128 a[236:239], v10 offset:25088
s_add_u32 s43, s58, 778240
Mvaa 224,240,248
s_add_u32 m0, s38, 32768
v_exp_f32 v27, v63
Mvaa 228,240,0
ds_read_b128 a[240:243], v10 offset:36864
v_cvt_pk_bf16_f32 v47, v26, v27
Mvaa 232,244,248
buffer_load_dwordx4 v7, s[20:23], s43 offen lds
Mvaa 236,244,0
s_waitcnt lgkmcnt(3)
ds_read_b128 a[244:247], v10 offset:37376
s_add_u32 s43, s58, 819200
Mvaa 240,224,248
s_add_u32 m0, s38, 36864
Mvaa 244,224,0
ds_read_b128 a[224:227], v9 offset:0
Mvaa 248,228,248
buffer_load_dwordx4 v7, s[20:23], s43 offen lds
Mvaa 252,228,0
s_waitcnt lgkmcnt(3)
ds_read_b128 a[228:231], v9 offset:512
s_add_u32 s43, s58, 860160
v_mfma_f32_16x16x32_bf16 v[64:67], a[232:235], a[28:31], 0
s_add_u32 m0, s38, 40960
v_mfma_f32_16x16x32_bf16 v[72:75], a[232:235], a[32:35], 0
ds_read_b128 a[232:235], v10 offset:26624
Mvaa 64,236,36
buffer_load_dwordx4 v7, s[20:23], s43 offen lds
Mvaa 72,236,40
s_waitcnt lgkmcnt(3)
ds_read_b128 a[236:239], v10 offset:27136
s_add_u32 s43, s58, 901120
Mvaa 64,240,44
s_add_u32 m0, s38, 49152
Mvaa 72,240,48
ds_read_b128 a[240:243], v10 offset:38912
Mvaa 64,244,52
buffer_load_dwordx4 v7, s[20:23], s43 offen lds
Mvaa 72,244,56
s_waitcnt lgkmcnt(3)
ds_read_b128 a[244:247], v10 offset:39424
s_add_u32 s43, s58, 942080
Mvaa 64,224,60
s_add_u32 m0, s38, 53248
Mvaa 72,224,64
ds_read_b128 a[224:227], v9 offset:2048
Mvaa 64,228,68
buffer_load_dwordx4 v7, s[20:23], s43 offen lds
Mvaa 72,228,72
s_waitcnt lgkmcnt(3)
ds_read_b128 a[228:231], v9 offset:2560
s_add_u32 s43, s59, 737280
v_mfma_f32_16x16x32_bf16 v[68:71], a[232:235], a[28:31], 0
s_add_u32 m0, s38, 57344
v_exp_f32 v24, v64
v_mfma_f32_16x16x32_bf16 v[76:79], a[232:235], a[32:35], 0
TR 232,15,8192
TR 234,15,10240
Mvaa 68,236,36
buffer_load_dwordx4 v7, s[20:23], s43 offen lds
Mvaa 76,236,40
s_waitcnt lgkmcnt(4)
v_exp_f32 v25, v65
Mvaa 68,240,44
s_add_u32 s43, s59, 778240
v_exp_f32 v26, v66
Mvaa 76,240,48
s_add_u32 m0, s38, 61440
TR 240,16,8192
TR 242,16,10240
Mvaa 68,244,52
buffer_load_dwordx4 v7, s[20:23], s43 offen lds
Mvaa 76,244,56
s_waitcnt lgkmcnt(4)
TR 244,15,8704
TR 246,15,10752
Mvaa 68,224,60
s_add_u32 s43, s59, 819200
v_cvt_pk_bf16_f32 v28, v24, v25
s_add_u32 m0, s38, 90112
Mvaa 76,224,64
s_waitcnt vmcnt(8)
TR 224,16,8704
TR 226,16,10752
Mvaa 68,228,68
s_barrier
Mvaa 76,228,72
s_waitcnt lgkmcnt(6)
TR 228,15,16384
TR 230,15,18432
Mvaa 224,232,4
buffer_load_dwordx4 v7, s[20:23], s43 offen lds
Mvaa 228,232,8
s_add_u32 s43, s59, 860160
TR 232,16,16384
TR 234,16,18432
Mvav 32,252,40
s_add_u32 m0, s38, 0
v_exp_f32 v27, v67
Mvav 36,252,44
s_waitcnt lgkmcnt(6)
TR 236,15,16896
TR 238,15,18944
Mvaa 232,240,4
buffer_load_dwordx4 v7, s[20:23], s43 offen lds
Mvaa 236,240,8
s_add_u32 s43, s59, 901120
TR 240,16,16896
TR 242,16,18944
Mvaa 240,244,4
s_add_u32 m0, s38, 4096
v_max_f32 v33, v32, v36
v_cmp_nge_f32 vcc, s39, v33
Mvaa 244,244,8
s_waitcnt lgkmcnt(6)
TR 244,17,16384
TR 246,17,18432
Mvaa 248,224,4
buffer_load_dwordx4 v7, s[20:23], s43 offen lds
Mvaa 252,224,8
s_add_u32 s43, s59, 942080
TR 224,18,16384
TR 226,18,18432
s_cbranch_vccnz Lr62
Lb62:
Mvav 80,228,40
s_add_u32 m0, s38, 45056
v_exp_f32 v24, v72
Mvav 84,228,44
s_waitcnt lgkmcnt(6)
TR 228,17,16896
TR 230,17,18944
Mvav 88,232,40
buffer_load_dwordx4 v7, s[20:23], s43 offen lds
Mvav 92,232,44
s_add_u32 s43, s51, 491520
TR 232,18,16896
TR 234,18,18944
Mvav 96,236,40
s_add_u32 m0, s38, 73728
v_cvt_pk_bf16_f32 v29, v26, v27
Mvav 100,236,44
s_waitcnt lgkmcnt(6)
TR 236,17,20480
TR 238,17,22528
Mvav 104,240,40
buffer_load_dwordx4 v7, s[20:23], s43 offen lds
Mvav 108,240,44
s_add_u32 s43, s51, 532480
TR 240,18,20480
TR 242,18,22528
Mvav 112,244,40
s_add_u32 m0, s38, 86016
v_exp_f32 v25, v73
Mvav 116,244,44
s_waitcnt lgkmcnt(6)
TR 244,17,20992
TR 246,17,23040
Mvav 120,224,40
buffer_load_dwordx4 v7, s[20:23], s43 offen lds
Mvav 124,224,44
s_add_u32 s43, s51, 573440
TR 224,18,20992
TR 226,18,23040
Mvav 128,228,40
s_add_u32 m0, s38, 94208
v_exp_f32 v26, v74
Mvav 132,228,44
s_waitcnt lgkmcnt(6)
TR 228,15,12288
TR 230,15,14336
Mvav 136,232,40
buffer_load_dwordx4 v7, s[20:23], s43 offen lds
Mvav 140,232,44
s_add_u32 s43, s51, 614400
TR 232,16,12288
TR 234,16,14336
Mvav 144,236,40
s_add_u32 m0, s38, 98304
v_cvt_pk_bf16_f32 v0, v24, v25
Mvav 148,236,44
s_waitcnt lgkmcnt(6)
TR 236,15,12800
TR 238,15,14848
Mvav 152,240,40
buffer_load_dwordx4 v7, s[20:23], s43 offen lds
Mvav 156,240,44
s_add_u32 s43, s51, 655360
TR 240,16,12800
TR 242,16,14848
Mvav 160,244,40
s_add_u32 m0, s38, 102400
v_exp_f32 v27, v75
Mvav 164,244,44
s_waitcnt lgkmcnt(6)
TR 244,15,24576
TR 246,15,26624
Mvav 168,224,40
buffer_load_dwordx4 v7, s[20:23], s43 offen lds
Mvav 172,224,44
s_add_u32 s43, s51, 696320
v_exp_f32 v24, v68
Mvaa 224,228,12
s_add_u32 m0, s38, 106496
v_cvt_pk_bf16_f32 v1, v26, v27
v_mov_b32 v44, 0
Mvaa 228,228,16
s_waitcnt lgkmcnt(4)
TR 228,16,24576
TR 230,16,26624
Mvaa 232,232,12
buffer_load_dwordx4 v7, s[20:23], s43 offen lds
Mvaa 236,232,16
s_add_u32 s43, s51, 737280
TR 232,15,25088
TR 234,15,27136
Mvaa 240,236,12
s_add_u32 m0, s38, 110592
v_exp_f32 v25, v69
Mvaa 244,236,16
s_waitcnt lgkmcnt(4)
TR 236,16,25088
TR 238,16,27136
Mvaa 248,240,12
s_barrier
Mvaa 252,240,16
TR 240,17,28672
TR 242,17,30720
Mvaa 224,244,20
buffer_load_dwordx4 v7, s[20:23], s43 offen lds
Mvaa 228,244,24
s_waitcnt lgkmcnt(6)
TR 244,18,28672
TR 246,18,30720
v_exp_f32 v26, v70
v_cvt_pk_bf16_f32 v30, v24, v25
v_exp_f32 v27, v71
s_nop 0
v_cvt_pk_bf16_f32 v31, v26, v27
s_nop 1
Mvav 32,252,28
s_add_u32 s43, s51, 778240
v_exp_f32 v24, v76
v_exp_f32 v25, v77
v_exp_f32 v26, v78
v_cvt_pk_bf16_f32 v2, v24, v25
v_exp_f32 v27, v79
s_nop 0
v_cvt_pk_bf16_f32 v3, v26, v27
s_nop 1
Mvav 36,252,0
s_add_u32 m0, s38, 8192
TR 224,17,29184
TR 226,17,31232
Mvaa 232,228,20
buffer_load_dwordx4 v7, s[20:23], s43 offen lds
Mvaa 236,228,24
s_waitcnt lgkmcnt(6)
Tc33:
s_cbranch_execz Tr33
TR 228,18,29184
TR 230,18,31232
Mvaa 240,232,20
s_add_u32 s43, s51, 819200
v_max_f32 v33, v32, v36
v_cmp_nge_f32 vcc, s39, v33
Mvaa 244,232,24
s_add_u32 m0, s38, 12288
TR 232,17,32768
TR 234,17,34816
Mvaa 248,236,20
buffer_load_dwordx4 v7, s[20:23], s43 offen lds
Mvaa 252,236,24
s_waitcnt lgkmcnt(6)
TR 236,18,32768
TR 238,18,34816
s_cbranch_vccnz Lr63
Lb63:
Mvav 80,240,28
s_add_u32 s43, s51, 860160
v_rcp_f32 v12, v32
Mvav 84,240,0
s_add_u32 m0, s38, 16384
TR 240,17,33280
TR 242,17,35328
Mvav 88,244,28
buffer_load_dwordx4 v7, s[20:23], s43 offen lds
Mvav 92,244,0
s_waitcnt lgkmcnt(6)
TR 244,18,33280
TR 246,18,35328
Mvav 96,224,28
s_add_u32 s43, s51, 901120
v_mul_f32 v80, v12, v80
v_mul_f32 v81, v12, v81
Mvav 100,224,0
s_add_u32 m0, s38, 65536
TR 224,15,20480
TR 226,15,22528
Mvav 104,228,28
buffer_load_dwordx4 v7, s[20:23], s43 offen lds
Mvav 108,228,0
s_waitcnt lgkmcnt(6)
TR 228,16,20480
TR 230,16,22528
Mvav 112,232,28
s_add_u32 s43, s51, 942080
v_mul_f32 v82, v12, v82
v_mul_f32 v83, v12, v83
Mvav 116,232,0
s_add_u32 m0, s38, 69632
TR 232,15,20992
TR 234,15,23040
Mvav 120,236,28
buffer_load_dwordx4 v7, s[20:23], s43 offen lds
Mvav 124,236,0
s_waitcnt vmcnt(17) lgkmcnt(6)
TR 236,16,20992
TR 238,16,23040
Mvav 128,240,28
s_barrier
Mvav 132,240,0
s_add_u32 s43, s52, 491520
TR 240,15,28672
TR 242,15,30720
Mvav 136,244,28
s_add_u32 m0, s38, 24576
v_mul_f32 v88, v12, v88
v_mul_f32 v89, v12, v89
Mvav 140,244,0
s_waitcnt lgkmcnt(6)
TR 244,16,28672
TR 246,16,30720
Mvav 144,224,28
buffer_load_dwordx4 v7, s[20:23], s43 offen lds
Mvav 148,224,0
s_add_u32 s43, s52, 532480
TR 224,15,29184
TR 226,15,31232
Mvav 152,228,28
s_add_u32 m0, s38, 77824
v_mul_f32 v90, v12, v90
v_mul_f32 v91, v12, v91
Mvav 156,228,0
s_waitcnt lgkmcnt(6)
TR 228,16,29184
TR 230,16,31232
Mvav 160,232,28
buffer_load_dwordx4 v7, s[20:23], s43 offen lds
Mvav 164,232,0
s_add_u32 s43, s52, 573440
TR 232,15,32768
TR 234,15,34816
Mvav 168,236,28
s_add_u32 m0, s38, 114688
v_cvt_pk_bf16_f32 v80, v80, v81
v_cvt_pk_bf16_f32 v81, v82, v83
Mvav 172,236,0
s_waitcnt lgkmcnt(6)
TR 236,16,32768
TR 238,16,34816
v_cvt_pk_bf16_f32 v82, v88, v89
v_cvt_pk_bf16_f32 v83, v90, v91
s_nop 1
Mvav 224,240,80
buffer_load_dwordx4 v7, s[20:23], s43 offen lds
v_rcp_f32 v8, v36
s_nop 0
v_mul_f32 v84, v8, v84
v_mul_f32 v85, v8, v85
v_pk_mul_f32 v[86:87], v[86:87], v[8:9] op_sel_hi:[1,0]
v_pk_mul_f32 v[92:93], v[92:93], v[8:9] op_sel_hi:[1,0]
v_pk_mul_f32 v[94:95], v[94:95], v[8:9] op_sel_hi:[1,0]
v_cvt_pk_bf16_f32 v84, v84, v85
v_cvt_pk_bf16_f32 v85, v86, v87
v_cvt_pk_bf16_f32 v86, v92, v93
v_cvt_pk_bf16_f32 v87, v94, v95
s_nop 1
Mvav 228,240,84
s_add_u32 s43, s52, 614400
TR 240,15,33280
TR 242,15,35328
Mvav 232,244,80
s_add_u32 m0, s38, 118784
v_mul_f32 v96, v12, v96
v_mul_f32 v97, v12, v97
Mvav 236,244,84
s_waitcnt lgkmcnt(6)
TR 244,16,33280
TR 246,16,35328
Mvav 240,224,80
buffer_load_dwordx4 v7, s[20:23], s43 offen lds
Mvav 244,224,84
s_add_u32 s43, s52, 655360
TR 224,15,36864
TR 226,15,38912
Mvav 248,228,80
s_add_u32 m0, s38, 122880
v_mul_f32 v98, v12, v98
v_mul_f32 v99, v12, v99
Mvav 252,228,84
s_waitcnt lgkmcnt(6)
TR 228,16,36864
TR 230,16,38912
v_mul_f32 v104, v12, v104
v_mul_f32 v105, v12, v105
v_pk_mul_f32 v[106:107], v[106:107], v[12:13] op_sel_hi:[1,0]
v_cvt_pk_bf16_f32 v96, v96, v97
v_cvt_pk_bf16_f32 v97, v98, v99
v_cvt_pk_bf16_f32 v98, v104, v105
v_cvt_pk_bf16_f32 v99, v106, v107
s_nop 1
Mvav 224,232,96
buffer_load_dwordx4 v7, s[20:23], s43 offen lds
v_mul_f32 v100, v8, v100
v_mul_f32 v101, v8, v101
v_mul_f32 v102, v8, v102
v_mul_f32 v103, v8, v103
v_pk_mul_f32 v[108:109], v[108:109], v[8:9] op_sel_hi:[1,0]
v_pk_mul_f32 v[110:111], v[110:111], v[8:9] op_sel_hi:[1,0]
v_cvt_pk_bf16_f32 v100, v100, v101
v_cvt_pk_bf16_f32 v101, v102, v103
v_cvt_pk_bf16_f32 v102, v108, v109
v_cvt_pk_bf16_f32 v103, v110, v111
s_nop 1
Mvav 228,232,100
s_add_u32 s43, s52, 696320
TR 232,15,37376
TR 234,15,39424
Mvav 232,236,96
s_add_u32 m0, s38, 126976
v_mul_f32 v112, v12, v112
v_mul_f32 v113, v12, v113
Mvav 236,236,100
s_waitcnt lgkmcnt(6)
TR 236,16,37376
TR 238,16,39424
Mvav 240,240,96
buffer_load_dwordx4 v7, s[20:23], s43 offen lds
Mvav 244,240,100
s_add_u32 s43, s52, 737280
TR 240,15,40960
TR 242,15,43008
Mvav 248,244,96
s_add_u32 m0, s38, 131072
v_mul_f32 v114, v12, v114
v_mul_f32 v115, v12, v115
Mvav 252,244,100
s_waitcnt lgkmcnt(6)
TR 244,16,40960
TR 246,16,43008
v_mul_f32 v120, v12, v120
v_mul_f32 v121, v12, v121
v_pk_mul_f32 v[122:123], v[122:123], v[12:13] op_sel_hi:[1,0]
v_cvt_pk_bf16_f32 v112, v112, v113
v_cvt_pk_bf16_f32 v113, v114, v115
v_cvt_pk_bf16_f32 v114, v120, v121
v_cvt_pk_bf16_f32 v115, v122, v123
s_nop 1
Mvav 224,224,112
buffer_load_dwordx4 v7, s[20:23], s43 offen lds
v_mul_f32 v116, v8, v116
v_mul_f32 v117, v8, v117
v_mul_f32 v118, v8, v118
v_mul_f32 v119, v8, v119
v_pk_mul_f32 v[124:125], v[124:125], v[8:9] op_sel_hi:[1,0]
v_pk_mul_f32 v[126:127], v[126:127], v[8:9] op_sel_hi:[1,0]
v_cvt_pk_bf16_f32 v116, v116, v117
v_cvt_pk_bf16_f32 v117, v118, v119
v_cvt_pk_bf16_f32 v118, v124, v125
v_cvt_pk_bf16_f32 v119, v126, v127
s_nop 1
Mvav 228,224,116
s_add_u32 s43, s52, 778240
TR 224,15,41472
TR 226,15,43520
Mvav 232,228,112
s_add_u32 m0, s38, 135168
v_mul_f32 v128, v12, v128
v_mul_f32 v129, v12, v129
Mvav 236,228,116
s_waitcnt lgkmcnt(6)
TR 228,16,41472
TR 230,16,43520
Mvav 240,232,112
buffer_load_dwordx4 v7, s[20:23], s43 offen lds
Mvav 244,232,116
s_add_u32 s43, s52, 819200
TR 232,17,0
TR 234,17,2048
Mvav 248,236,112
s_add_u32 m0, s38, 139264
v_mul_f32 v130, v12, v130
v_mul_f32 v131, v12, v131
Mvav 252,236,116
s_waitcnt lgkmcnt(6)
TR 236,18,0
TR 238,18,2048
v_mul_f32 v136, v12, v136
v_mul_f32 v137, v12, v137
v_pk_mul_f32 v[138:139], v[138:139], v[12:13] op_sel_hi:[1,0]
v_cvt_pk_bf16_f32 v128, v128, v129
v_cvt_pk_bf16_f32 v129, v130, v131
v_cvt_pk_bf16_f32 v130, v136, v137
v_cvt_pk_bf16_f32 v131, v138, v139
s_nop 1
Mvav 224,240,128
buffer_load_dwordx4 v7, s[20:23], s43 offen lds
v_mul_f32 v132, v8, v132
v_mul_f32 v133, v8, v133
v_mul_f32 v134, v8, v134
v_mul_f32 v135, v8, v135
v_pk_mul_f32 v[140:141], v[140:141], v[8:9] op_sel_hi:[1,0]
v_pk_mul_f32 v[142:143], v[142:143], v[8:9] op_sel_hi:[1,0]
v_cvt_pk_bf16_f32 v132, v132, v133
v_cvt_pk_bf16_f32 v133, v134, v135
v_cvt_pk_bf16_f32 v134, v140, v141
v_cvt_pk_bf16_f32 v135, v142, v143
s_nop 1
Mvav 228,240,132
s_add_u32 s43, s52, 860160
TR 240,17,512
TR 242,17,2560
Mvav 232,244,128
s_add_u32 m0, s38, 143360
v_mul_f32 v144, v12, v144
v_mul_f32 v145, v12, v145
Mvav 236,244,132
s_waitcnt lgkmcnt(6)
TR 244,18,512
TR 246,18,2560
Mvav 240,224,128
buffer_load_dwordx4 v7, s[20:23], s43 offen lds
Mvav 244,224,132
s_add_u32 s43, s52, 901120
TR 224,17,4096
TR 226,17,6144
Mvav 248,228,128
s_add_u32 m0, s38, 147456
v_mul_f32 v146, v12, v146
v_mul_f32 v147, v12, v147
Mvav 252,228,132
s_waitcnt lgkmcnt(6)
TR 228,18,4096
TR 230,18,6144
v_mul_f32 v152, v12, v152
v_mul_f32 v153, v12, v153
v_pk_mul_f32 v[154:155], v[154:155], v[12:13] op_sel_hi:[1,0]
v_cvt_pk_bf16_f32 v144, v144, v145
v_cvt_pk_bf16_f32 v145, v146, v147
v_cvt_pk_bf16_f32 v146, v152, v153
v_cvt_pk_bf16_f32 v147, v154, v155
s_nop 1
Mvav 224,232,144
buffer_load_dwordx4 v7, s[20:23], s43 offen lds
v_mul_f32 v148, v8, v148
v_mul_f32 v149, v8, v149
v_mul_f32 v150, v8, v150
v_mul_f32 v151, v8, v151
v_pk_mul_f32 v[156:157], v[156:157], v[8:9] op_sel_hi:[1,0]
v_pk_mul_f32 v[158:159], v[158:159], v[8:9] op_sel_hi:[1,0]
v_cvt_pk_bf16_f32 v148, v148, v149
v_cvt_pk_bf16_f32 v149, v150, v151
v_cvt_pk_bf16_f32 v150, v156, v157
v_cvt_pk_bf16_f32 v151, v158, v159
s_nop 1
Mvav 228,232,148
s_add_u32 s43, s52, 942080
TR 232,17,4608
TR 234,17,6656
Mvav 232,236,144
s_add_u32 m0, s38, 151552
v_mul_f32 v160, v12, v160
v_mul_f32 v161, v12, v161
Mvav 236,236,148
s_waitcnt lgkmcnt(6)
TR 236,18,4608
TR 238,18,6656
Mvav 240,240,144
buffer_load_dwordx4 v7, s[20:23], s43 offen lds
Mvav 244,240,148
s_add_u32 s43, s53, 491520
v_mul_f32 v162, v12, v162
v_mul_f32 v163, v12, v163
Mvav 248,244,144
s_add_u32 m0, s38, 155648
v_mul_f32 v168, v12, v168
v_mul_f32 v169, v12, v169
Mvav 252,244,148
s_waitcnt lgkmcnt(4)
v_mul_f32 v170, v12, v170
v_mul_f32 v171, v12, v171
v_cvt_pk_bf16_f32 v160, v160, v161
v_cvt_pk_bf16_f32 v161, v162, v163
v_cvt_pk_bf16_f32 v162, v168, v169
v_cvt_pk_bf16_f32 v163, v170, v171
s_nop 1
Mvav 224,224,160
buffer_load_dwordx4 v7, s[20:23], s43 offen lds
v_mul_f32 v164, v8, v164
v_mul_f32 v165, v8, v165
v_mul_f32 v166, v8, v166
v_mul_f32 v167, v8, v167
v_pk_mul_f32 v[172:173], v[172:173], v[8:9] op_sel_hi:[1,0]
v_pk_mul_f32 v[174:175], v[174:175], v[8:9] op_sel_hi:[1,0]
v_cvt_pk_bf16_f32 v164, v164, v165
v_cvt_pk_bf16_f32 v165, v166, v167
v_cvt_pk_bf16_f32 v166, v172, v173
v_cvt_pk_bf16_f32 v167, v174, v175
s_nop 1
Mvav 228,224,164
s_add_u32 s43, s53, 532480
v_lshrrev_b32 v24, 4, v14
v_mul_u32_u24 v25, 0x3334, v24
Mvav 232,228,160
s_add_u32 m0, s38, 159744
v_lshrrev_b32 v25, 18, v25
v_mul_u32_u24 v25, 20, v25
Mvav 236,228,164
s_waitcnt lgkmcnt(0)
v_sub_u32 v24, v24, v25
v_lshlrev_b32 v24, 4, v24
Mvav 240,232,160
buffer_load_dwordx4 v7, s[20:23], s43 offen lds
Mvav 244,232,164
TR 232,17,8192
TR 234,17,10240
Mvav 248,236,160
v_min_u32 v24, 64, v24
v_mov_b32 v26, 0x3f80
Mvav 252,236,164
TR 236,18,8192
TR 238,18,10240
v_mov_b32 v27, 0
v_lshlrev_b64 v[26:27], v24, v[26:27]
v_cmp_gt_u32 s[86:87], 64, v24
s_nop 1
v_cndmask_b32 v26, 0, v26, s[86:87]
v_mov_b32 v42, v26
v_mov_b32 v43, v27
v_mov_b32 v45, 0
s_nop 1
v_mfma_f32_16x16x32_bf16 v[48:51], v[42:45], v[188:191], 0
v_mov_b32 v40, 0
v_mov_b32 v41, 0
v_mfma_f32_16x16x32_bf16 v[52:55], v[42:45], v[192:195], 0
TR 240,17,8704
TR 242,17,10752
v_mfma_f32_16x16x32_bf16 v[56:59], v[40:43], v[188:191], 0
s_add_u32 s43, s53, 573440
v_cvt_pk_bf16_f32 v224, v224, v225
v_cvt_pk_bf16_f32 v225, v226, v227
v_mfma_f32_16x16x32_bf16 v[60:63], v[40:43], v[192:195], 0
s_waitcnt vmcnt(24)
TR 244,18,8704
TR 246,18,10752
v_mfma_f32_16x16x32_bf16 v[64:67], v[42:45], v[196:199], 0
s_barrier
v_mfma_f32_16x16x32_bf16 v[68:71], v[42:45], v[200:203], 0
s_add_u32 m0, s38, 20480
TR 224,17,12288
TR 226,17,14336
v_mfma_f32_16x16x32_bf16 v[72:75], v[40:43], v[196:199], 0
buffer_load_dwordx4 v7, s[20:23], s43 offen lds
v_mfma_f32_16x16x32_bf16 v[76:79], v[40:43], v[200:203], 0
s_waitcnt lgkmcnt(6)
TR 228,18,12288
TR 230,18,14336
Mvav 48,232,80
s_add_u32 s43, s53, 614400
v_cvt_pk_bf16_f32 v226, v228, v229
v_cvt_pk_bf16_f32 v227, v230, v231
Mvav 52,232,84
s_add_u32 m0, s38, 28672
TR 232,17,12800
TR 234,17,14848
Mvav 56,236,80
buffer_load_dwordx4 v7, s[20:23], s43 offen lds
Mvav 60,236,84
s_waitcnt lgkmcnt(6)
TR 236,18,12800
TR 238,18,14848
Mvav 64,240,80
s_add_u32 s43, s53, 655360
s_add_u32 s44, s42, 262144
buffer_store_dwordx4 v[224:227], v14, s[28:31], s44 offen sc1
Mvav 68,240,84
s_add_u32 m0, s38, 32768
TR 240,17,40960
TR 242,17,43008
Mvav 72,244,80
buffer_load_dwordx4 v7, s[20:23], s43 offen lds
Mvav 76,244,84
s_waitcnt lgkmcnt(6)
TR 244,18,40960
TR 246,18,43008
Mvav 48,224,96
s_add_u32 s43, s53, 696320
v_cvt_pk_bf16_f32 v232, v232, v233
v_cvt_pk_bf16_f32 v233, v234, v235
Mvav 52,224,100
s_add_u32 m0, s38, 36864
TR 224,17,41472
TR 226,17,43520
Mvav 56,228,96
buffer_load_dwordx4 v7, s[20:23], s43 offen lds
Mvav 60,228,100
s_waitcnt lgkmcnt(6)
TR 228,18,41472
TR 230,18,43520
Mvav 64,232,96
s_add_u32 s43, s53, 737280
v_cvt_pk_bf16_f32 v234, v236, v237
v_cvt_pk_bf16_f32 v235, v238, v239
Mvav 68,232,100
s_add_u32 m0, s38, 40960
TR 232,15,0
TR 234,15,2048
Mvav 72,236,96
buffer_load_dwordx4 v7, s[20:23], s43 offen lds
Mvav 76,236,100
s_waitcnt lgkmcnt(6)
TR 236,16,0
TR 238,16,2048
Mvav 48,240,112
s_add_u32 s43, s53, 778240
buffer_store_dwordx4 v[232:235], v14, s[28:31], s44 offen offset:1024 sc1
Mvav 52,240,116
s_add_u32 m0, s38, 49152
TR 240,15,512
TR 242,15,2560
Mvav 56,244,112
buffer_load_dwordx4 v7, s[20:23], s43 offen lds
Mvav 60,244,116
s_waitcnt lgkmcnt(6)
TR 244,16,512
TR 246,16,2560
Mvav 64,224,112
s_add_u32 s43, s53, 819200
v_cvt_pk_bf16_f32 v240, v240, v241
v_cvt_pk_bf16_f32 v241, v242, v243
Mvav 68,224,116
s_add_u32 m0, s38, 53248
TR 224,15,4096
TR 226,15,6144
Mvav 72,228,112
buffer_load_dwordx4 v7, s[20:23], s43 offen lds
Mvav 76,228,116
s_waitcnt lgkmcnt(6)
TR 228,16,4096
TR 230,16,6144
Xb:
X0:
s_cbranch_execz Xe
Mvav 48,232,128
s_add_u32 s43, s53, 860160
v_cvt_pk_bf16_f32 v242, v244, v245
v_cvt_pk_bf16_f32 v243, v246, v247
Mvav 52,232,132
s_add_u32 m0, s38, 81920
TR 232,15,4608
TR 234,15,6656
Mvav 56,236,128
buffer_load_dwordx4 v7, s[20:23], s43 offen lds
Mvav 60,236,132
s_waitcnt lgkmcnt(6)
TR 236,16,4608
TR 238,16,6656
Mvav 64,240,128
buffer_store_dwordx4 v[240:243], v14, s[28:31], s44 offen offset:2048 sc1
Mvav 68,240,132
TR 240,15,45056
TR 242,15,47104
Mvav 72,244,128
v_cvt_pk_bf16_f32 v248, v248, v249
v_cvt_pk_bf16_f32 v249, v250, v251
Mvav 76,244,132
s_waitcnt lgkmcnt(6)
TR 244,16,45056
TR 246,16,47104
Mvav 48,224,144
v_cvt_pk_bf16_f32 v250, v252, v253
v_cvt_pk_bf16_f32 v251, v254, v255
Mvav 52,224,148
TR 224,15,45568
TR 226,15,47616
Mvav 56,228,144
buffer_store_dwordx4 v[248:251], v14, s[28:31], s44 offen offset:3072 sc1
Mvav 60,228,148
s_waitcnt lgkmcnt(6)
TR 228,16,45568
TR 230,16,47616
Mvav 64,232,144
v_lshrrev_b32 v24, 2, v14
v_and_b32 v24, 0x7c, v24
Mvav 68,232,148
v_bfe_u32 v25, v14, 4, 4
v_mul_u32_u24 v25, 2560, v25
Mvav 72,236,144
v_bfe_u32 v26, v14, 9, 1
v_lshl_add_u32 v25, v26, 4, v25
Mvav 76,236,148
s_waitcnt lgkmcnt(4)
v_bfe_u32 v26, v14, 8, 1
v_lshl_add_u32 v21, v26, 5, v25
Mvav 48,240,160
v_mul_u32_u24 v26, 40960, v26
v_add_u32 v22, v25, v26
Mvav 52,240,164
Mvav 56,244,160
v_cvt_pk_bf16_f32 v48, v48, v49
v_cvt_pk_bf16_f32 v49, v50, v51
Mvav 60,244,164
s_waitcnt lgkmcnt(0)
v_cvt_pk_bf16_f32 v50, v52, v53
v_cvt_pk_bf16_f32 v51, v54, v55
Mvav 64,224,160
s_add_u32 s44, s42, 294912
buffer_store_dwordx4 v[48:51], v14, s[28:31], s44 offen sc1
Mvav 68,224,164
TR 224,17,24576
TR 226,17,26624
Mvav 72,228,160
v_cvt_pk_bf16_f32 v56, v56, v57
v_cvt_pk_bf16_f32 v57, v58, v59
Mvav 76,228,164
TR 228,18,24576
TR 230,18,26624
v_mfma_f32_16x16x32_bf16 v[224:227], v[42:45], v[204:207], 0
v_cvt_pk_bf16_f32 v58, v60, v61
v_cvt_pk_bf16_f32 v59, v62, v63
v_mfma_f32_16x16x32_bf16 v[228:231], v[42:45], v[208:211], 0
TR 232,17,25088
TR 234,17,27136
v_mfma_f32_16x16x32_bf16 v[232:235], v[40:43], v[204:207], 0
buffer_store_dwordx4 v[56:59], v14, s[28:31], s44 offen offset:1024 sc1
v_mfma_f32_16x16x32_bf16 v[236:239], v[40:43], v[208:211], 0
TR 236,18,25088
TR 238,18,27136
v_mfma_f32_16x16x32_bf16 v[240:243], v[42:45], v[212:215], 0
Tc34:
s_cbranch_execz Tr34
v_cvt_pk_bf16_f32 v64, v64, v65
v_cvt_pk_bf16_f32 v65, v66, v67
v_mfma_f32_16x16x32_bf16 v[244:247], v[42:45], v[216:219], 0
TR 240,17,36864
TR 242,17,38912
v_mfma_f32_16x16x32_bf16 v[248:251], v[40:43], v[212:215], 0
v_cvt_pk_bf16_f32 v66, v68, v69
v_cvt_pk_bf16_f32 v67, v70, v71
v_mfma_f32_16x16x32_bf16 v[252:255], v[40:43], v[216:219], 0
s_waitcnt lgkmcnt(6)
TR 244,18,36864
TR 246,18,38912
Mvaa 224,224,208
buffer_store_dwordx4 v[64:67], v14, s[28:31], s44 offen offset:2048 sc1
Mvaa 228,224,212
TR 224,17,37376
TR 226,17,39424
Mvaa 232,228,208
X1:
s_cbranch_execz Xe
s_add_u32 s43, s53, 901120
v_cvt_pk_bf16_f32 v72, v72, v73
v_cvt_pk_bf16_f32 v73, v74, v75
Mvaa 236,228,212
s_waitcnt vmcnt(31) lgkmcnt(6)
TR 228,18,37376
TR 230,18,39424
Mvaa 240,232,208
s_barrier
Mvaa 244,232,212
s_add_u32 m0, s38, 0
TR 232,17,45056
TR 234,17,47104
Mvaa 248,236,208
buffer_load_dwordx4 v7, s[20:23], s43 offen lds
Mvaa 252,236,212
s_waitcnt lgkmcnt(6)
TR 236,18,45056
TR 238,18,47104
Mvaa 224,240,216
s_add_u32 s43, s53, 942080
v_cvt_pk_bf16_f32 v74, v76, v77
v_cvt_pk_bf16_f32 v75, v78, v79
Mvaa 228,240,220
s_add_u32 m0, s38, 4096
TR 240,17,45568
TR 242,17,47616
Mvaa 232,244,216
buffer_load_dwordx4 v7, s[20:23], s43 offen lds
Mvaa 236,244,220
s_waitcnt lgkmcnt(6)
TR 244,18,45568
TR 246,18,47616
Mvaa 240,224,216
s_add_u32 s43, s54, 491520
buffer_store_dwordx4 v[72:75], v14, s[28:31], s44 offen offset:3072 sc1
Mvaa 244,224,220
s_add_u32 m0, s38, 45056
TR 224,19,0
TR 226,19,2048
Mvaa 248,228,216
buffer_load_dwordx4 v7, s[20:23], s43 offen lds
Mvaa 252,228,220
s_waitcnt lgkmcnt(6)
TR 228,20,0
TR 230,20,2048
Mvaa 224,232,248
s_add_u32 s43, s54, 532480
s_add_u32 m0, s38, 57344
Mvaa 228,232,0
TR 232,19,512
TR 234,19,2560
Mvaa 232,236,248
buffer_load_dwordx4 v7, s[20:23], s43 offen lds
Mvaa 236,236,0
s_waitcnt lgkmcnt(6)
TR 236,20,512
TR 238,20,2560
Mvaa 240,240,248
s_add_u32 s43, s54, 573440
s_add_u32 m0, s38, 61440
Mvaa 244,240,0
TR 240,19,4096
TR 242,19,6144
Mvaa 248,244,248
buffer_load_dwordx4 v7, s[20:23], s43 offen lds
Mvaa 252,244,0
s_waitcnt lgkmcnt(6)
TR 244,20,4096
TR 246,20,6144
Mvaa 224,224,4
s_add_u32 s43, s54, 614400
s_add_u32 m0, s38, 90112
Mvaa 228,224,8
TR 224,19,4608
TR 226,19,6656
Mvaa 232,228,4
buffer_load_dwordx4 v7, s[20:23], s43 offen lds
Mvaa 236,228,8
s_waitcnt lgkmcnt(6)
TR 228,20,4608
TR 230,20,6656
Mvaa 240,232,4
Mvaa 244,232,8
TR 232,19,8192
TR 234,19,10240
Mvaa 248,236,4
Mvaa 252,236,8
s_waitcnt lgkmcnt(6)
TR 236,20,8192
TR 238,20,10240
Mvaa 224,240,12
Mvaa 228,240,16
TR 240,19,8704
TR 242,19,10752
Mvaa 232,244,12
Mvaa 236,244,16
s_waitcnt lgkmcnt(6)
TR 244,20,8704
TR 246,20,10752
Mvaa 240,224,12
Mvaa 244,224,16
TR 224,19,12288
TR 226,19,14336
Mvaa 248,228,12
X2:
s_cbranch_execz Xe
Mvaa 252,228,16
s_waitcnt lgkmcnt(6)
TR 228,20,12288
TR 230,20,14336
Mvaa 224,232,20
Mvaa 228,232,24
TR 232,19,12800
TR 234,19,14848
Mvaa 232,236,20
Mvaa 236,236,24
s_waitcnt lgkmcnt(6)
TR 236,20,12800
TR 238,20,14848
Mvaa 240,240,20
Mvaa 244,240,24
TR 240,15,8192
TR 242,15,10240
Mvaa 248,244,20
Mvaa 252,244,24
s_waitcnt lgkmcnt(6)
TR 244,16,8192
TR 246,16,10240
Mvav 224,224,80
Mvav 228,224,84
TR 224,15,8704
TR 226,15,10752
Mvav 232,228,80
Mvav 236,228,84
s_waitcnt lgkmcnt(6)
TR 228,16,8704
TR 230,16,10752
Mvav 240,232,80
Mvav 244,232,84
TR 232,15,12288
TR 234,15,14336
Mvav 248,236,80
Mvav 252,236,84
s_waitcnt lgkmcnt(6)
TR 236,16,12288
TR 238,16,14336
Mvav 224,240,96
Mvav 228,240,100
TR 240,15,12800
TR 242,15,14848
Mvav 232,244,96
Mvav 236,244,100
s_waitcnt lgkmcnt(6)
TR 244,16,12800
TR 246,16,14848
Mvav 240,224,96
Mvav 244,224,100
TR 224,15,16384
TR 226,15,18432
Mvav 248,228,96
Mvav 252,228,100
s_waitcnt lgkmcnt(6)
TR 228,16,16384
TR 230,16,18432
Mvav 224,232,112
s_waitcnt vmcnt(4)
buffer_load_dwordx4 v[188:191], v14, s[28:31], s37 offen sc1
Mvav 228,232,116
TR 232,15,16896
TR 234,15,18944
Mvav 232,236,112
s_add_u32 s43, s54, 655360
s_add_u32 m0, s38, 8192
Mvav 236,236,116
s_waitcnt lgkmcnt(6)
TR 236,16,16896
TR 238,16,18944
Mvav 240,240,112
s_barrier
Mvav 244,240,116
TR 240,17,16384
TR 242,17,18432
Mvav 248,244,112
buffer_load_dwordx4 v7, s[20:23], s43 offen lds
Mvav 252,244,116
s_waitcnt lgkmcnt(6)
TR 244,18,16384
TR 246,18,18432
Mvav 224,224,128
s_add_u32 s43, s54, 696320
s_add_u32 m0, s38, 73728
Mvav 228,224,132
TR 224,17,16896
TR 226,17,18944
Mvav 232,228,128
buffer_load_dwordx4 v7, s[20:23], s43 offen lds
Mvav 236,228,132
s_waitcnt lgkmcnt(6)
TR 228,18,16896
TR 230,18,18944
Mvav 240,232,128
s_add_u32 s43, s54, 737280
s_add_u32 m0, s38, 86016
Mvav 244,232,132
TR 232,17,20480
TR 234,17,22528
Mvav 248,236,128
buffer_load_dwordx4 v7, s[20:23], s43 offen lds
Mvav 252,236,132
s_waitcnt lgkmcnt(6)
TR 236,18,20480
TR 238,18,22528
X3:
s_cbranch_execz Xe
Mvav 224,240,144
s_add_u32 s43, s54, 778240
s_add_u32 m0, s38, 94208
Mvav 228,240,148
TR 240,17,20992
TR 242,17,23040
Mvav 232,244,144
buffer_load_dwordx4 v7, s[20:23], s43 offen lds
Mvav 236,244,148
s_waitcnt lgkmcnt(6)
TR 244,18,20992
TR 246,18,23040
Mvav 240,224,144
s_add_u32 s43, s54, 819200
s_add_u32 m0, s38, 98304
Mvav 244,224,148
Mvav 248,228,144
buffer_load_dwordx4 v7, s[20:23], s43 offen lds
Mvav 252,228,148
s_waitcnt lgkmcnt(4)
s_add_u32 s43, s54, 860160
s_add_u32 m0, s38, 102400
Mvav 224,232,160
Mvav 228,232,164
Mvav 232,236,160
buffer_load_dwordx4 v7, s[20:23], s43 offen lds
Mvav 236,236,164
s_waitcnt lgkmcnt(0)
v_cvt_pk_bf16_f32 v224, v224, v225
v_cvt_pk_bf16_f32 v225, v226, v227
Mvav 240,240,160
s_add_u32 s43, s54, 901120
v_cvt_pk_bf16_f32 v226, v228, v229
v_cvt_pk_bf16_f32 v227, v230, v231
Mvav 244,240,164
s_add_u32 m0, s38, 106496
TR 240,15,24576
TR 242,15,26624
Mvav 248,244,160
buffer_load_dwordx4 v7, s[20:23], s43 offen lds
Mvav 252,244,164
s_add_u32 s43, s54, 942080
TR 244,16,24576
TR 246,16,26624
v_mfma_f32_16x16x32_bf16 v[48:51], v[42:45], v[220:223], 0
s_add_u32 m0, s38, 110592
s_add_u32 s44, s42, 32768
buffer_store_dwordx4 v[224:227], v14, s[28:31], s44 offen sc1
v_mfma_f32_16x16x32_bf16 v[52:55], v[42:45], a[160:163], 0
TR 224,15,25088
TR 226,15,27136
v_mfma_f32_16x16x32_bf16 v[56:59], v[40:43], v[220:223], 0
buffer_load_dwordx4 v7, s[20:23], s43 offen lds
v_mfma_f32_16x16x32_bf16 v[60:63], v[40:43], a[160:163], 0
TR 228,16,25088
TR 230,16,27136
v_mfma_f32_16x16x32_bf16 v[64:67], v[42:45], a[164:167], 0
v_cvt_pk_bf16_f32 v232, v232, v233
v_cvt_pk_bf16_f32 v233, v234, v235
v_mfma_f32_16x16x32_bf16 v[68:71], v[42:45], a[168:171], 0
TR 232,17,28672
TR 234,17,30720
v_mfma_f32_16x16x32_bf16 v[72:75], v[40:43], a[164:167], 0
v_cvt_pk_bf16_f32 v234, v236, v237
v_cvt_pk_bf16_f32 v235, v238, v239
v_mfma_f32_16x16x32_bf16 v[76:79], v[40:43], a[168:171], 0
s_waitcnt lgkmcnt(6)
TR 236,18,28672
TR 238,18,30720
Mvaa 48,240,208
buffer_store_dwordx4 v[232:235], v14, s[28:31], s44 offen offset:1024 sc1
Mvaa 52,240,212
TR 240,17,29184
TR 242,17,31232
Mvaa 56,244,208
v_cvt_pk_bf16_f32 v240, v240, v241
v_cvt_pk_bf16_f32 v241, v242, v243
Mvaa 60,244,212
s_waitcnt lgkmcnt(6)
TR 244,18,29184
TR 246,18,31232
Mvaa 64,224,208
v_cvt_pk_bf16_f32 v242, v244, v245
v_cvt_pk_bf16_f32 v243, v246, v247
Mvaa 68,224,212
TR 224,19,16384
TR 226,19,18432
Mvaa 72,228,208
buffer_store_dwordx4 v[240:243], v14, s[28:31], s44 offen offset:2048 sc1
Mvaa 76,228,212
s_waitcnt lgkmcnt(6)
TR 228,20,16384
TR 230,20,18432
Mvaa 48,232,216
v_cvt_pk_bf16_f32 v248, v248, v249
v_cvt_pk_bf16_f32 v249, v250, v251
Mvaa 52,232,220
TR 232,19,16896
TR 234,19,18944
Mvaa 56,236,216
v_cvt_pk_bf16_f32 v250, v252, v253
v_cvt_pk_bf16_f32 v251, v254, v255
X4:
s_cbranch_execz Xe
Mvaa 60,236,220
s_waitcnt lgkmcnt(6)
TR 236,20,16896
TR 238,20,18944
Mvaa 64,240,216
buffer_store_dwordx4 v[248:251], v14, s[28:31], s44 offen offset:3072 sc1
Mvaa 68,240,220
TR 240,19,20480
TR 242,19,22528
Mvaa 72,244,216
Mvaa 76,244,220
s_waitcnt lgkmcnt(6)
TR 244,20,20480
TR 246,20,22528
Mvaa 48,224,248
Mvaa 52,224,0
TR 224,19,20992
TR 226,19,23040
Mvaa 56,228,248
Mvaa 60,228,0
s_waitcnt lgkmcnt(6)
TR 228,20,20992
TR 230,20,23040
Mvaa 64,232,248
Mvaa 68,232,0
TR 232,19,24576
TR 234,19,26624
Mvaa 72,236,248
Mvaa 76,236,0
s_waitcnt lgkmcnt(6)
TR 236,20,24576
TR 238,20,26624
Mvaa 48,240,4
Mvaa 52,240,8
TR 240,19,25088
TR 242,19,27136
Mvaa 56,244,4
s_add_u32 s43, s55, 491520
s_add_u32 m0, s38, 12288
Mvaa 60,244,8
s_waitcnt lgkmcnt(6)
TR 244,20,25088
TR 246,20,27136
Mvaa 64,224,4
s_barrier
Mvaa 68,224,8
TR 224,19,28672
TR 226,19,30720
Mvaa 72,228,4
buffer_load_dwordx4 v7, s[20:23], s43 offen lds
Mvaa 76,228,8
s_waitcnt lgkmcnt(6)
TR 228,20,28672
TR 230,20,30720
Mvaa 48,232,12
s_add_u32 s43, s55, 532480
s_add_u32 m0, s38, 16384
Mvaa 52,232,16
TR 232,19,29184
TR 234,19,31232
Mvaa 56,236,12
buffer_load_dwordx4 v7, s[20:23], s43 offen lds
Mvaa 60,236,16
s_waitcnt lgkmcnt(6)
TR 236,20,29184
TR 238,20,31232
Mvaa 64,240,12
s_add_u32 s43, s55, 573440
s_add_u32 m0, s38, 24576
Mvaa 68,240,16
TR 240,19,32768
TR 242,19,34816
Mvaa 72,244,12
buffer_load_dwordx4 v7, s[20:23], s43 offen lds
Mvaa 76,244,16
s_waitcnt lgkmcnt(6)
TR 244,20,32768
TR 246,20,34816
Mvaa 48,224,20
s_add_u32 s43, s55, 614400
s_add_u32 m0, s38, 65536
Mvaa 52,224,24
TR 224,19,33280
TR 226,19,35328
Mvaa 56,228,20
buffer_load_dwordx4 v7, s[20:23], s43 offen lds
Mvaa 60,228,24
s_waitcnt lgkmcnt(6)
TR 228,20,33280
TR 230,20,35328
Mvaa 64,232,20
s_add_u32 s43, s55, 655360
s_add_u32 m0, s38, 69632
Mvaa 68,232,24
TR 232,19,36864
TR 234,19,38912
Mvaa 72,236,20
buffer_load_dwordx4 v7, s[20:23], s43 offen lds
Mvaa 76,236,24
s_waitcnt lgkmcnt(6)
TR 236,20,36864
TR 238,20,38912
Mvav 48,240,80
s_add_u32 s43, s55, 696320
s_add_u32 m0, s38, 77824
Mvav 52,240,84
X5:
s_cbranch_execz Xe
TR 240,19,37376
TR 242,19,39424
Mvav 56,244,80
buffer_load_dwordx4 v7, s[20:23], s43 offen lds
Mvav 60,244,84
s_waitcnt lgkmcnt(6)
TR 244,20,37376
TR 246,20,39424
Mvav 64,224,80
s_add_u32 s43, s55, 737280
s_add_u32 m0, s38, 114688
Mvav 68,224,84
TR 224,19,40960
TR 226,19,43008
Mvav 72,228,80
buffer_load_dwordx4 v7, s[20:23], s43 offen lds
Mvav 76,228,84
s_waitcnt lgkmcnt(6)
TR 228,20,40960
TR 230,20,43008
Mvav 48,232,96
Mvav 52,232,100
TR 232,19,41472
TR 234,19,43520
Mvav 56,236,96
Mvav 60,236,100
s_waitcnt lgkmcnt(6)
TR 236,20,41472
TR 238,20,43520
Mvav 64,240,96
Mvav 68,240,100
TR 240,19,45056
TR 242,19,47104
Mvav 72,244,96
Mvav 76,244,100
s_waitcnt lgkmcnt(6)
TR 244,20,45056
TR 246,20,47104
Mvav 48,224,112
s_waitcnt vmcnt(7)
s_xor_b32 s63, s35, 4096
s_mov_b64 exec, 1
buffer_store_dword v13, off, s[28:31], s63 offset:128 sc1
s_mov_b64 exec, -1
Mvav 52,224,116
TR 224,19,45568
TR 226,19,47616
Mvav 56,228,112
Mvav 60,228,116
s_waitcnt lgkmcnt(6)
TR 228,20,45568
TR 230,20,47616
Mvav 64,232,112
Mvav 68,232,116
TR 232,19,49152
TR 234,19,51200
Mvav 72,236,112
Mvav 76,236,116
s_waitcnt lgkmcnt(6)
TR 236,20,49152
TR 238,20,51200
Mvav 48,240,128
Mvav 52,240,132
TR 240,19,49664
TR 242,19,51712
Mvav 56,244,128
Mvav 60,244,132
s_waitcnt lgkmcnt(6)
TR 244,20,49664
TR 246,20,51712
Mvav 64,224,128
Mvav 68,224,132
TR 224,19,53248
TR 226,19,55296
Mvav 72,228,128
Mvav 76,228,132
s_waitcnt lgkmcnt(6)
TR 228,20,53248
TR 230,20,55296
Mvav 48,232,144
Mvav 52,232,148
TR 232,19,53760
TR 234,19,55808
Mvav 56,236,144
Mvav 60,236,148
s_waitcnt lgkmcnt(6)
TR 236,20,53760
TR 238,20,55808
Mvav 64,240,144
Mvav 68,240,148
Mvav 72,244,144
Mvav 76,244,148
s_waitcnt lgkmcnt(4)
Mvav 48,224,160
Mvav 52,224,164
s_add_u32 s43, s55, 778240
s_add_u32 m0, s38, 118784
Mvav 56,228,160
v_cvt_pk_bf16_f32 v48, v48, v49
Tc35:
s_cbranch_execz Tr35
v_cvt_pk_bf16_f32 v49, v50, v51
Mvav 60,228,164
s_waitcnt lgkmcnt(0)
v_cvt_pk_bf16_f32 v50, v52, v53
v_cvt_pk_bf16_f32 v51, v54, v55
Mvav 64,232,160
s_barrier
X6:
s_cbranch_execz Xe
Mvav 68,232,164
TR 232,19,57344
TR 234,19,59392
Mvav 72,236,160
buffer_load_dwordx4 v7, s[20:23], s43 offen lds
Mvav 76,236,164
s_add_u32 s43, s55, 819200
TR 236,20,57344
TR 238,20,59392
v_mfma_f32_16x16x32_bf16 v[224:227], v[42:45], a[76:79], 0
s_add_u32 m0, s38, 122880
s_add_u32 s44, s42, 65536
buffer_store_dwordx4 v[48:51], v14, s[28:31], s44 offen sc1
v_mfma_f32_16x16x32_bf16 v[228:231], v[42:45], a[80:83], 0
TR 240,19,57856
TR 242,19,59904
v_mfma_f32_16x16x32_bf16 v[232:235], v[40:43], a[76:79], 0
buffer_load_dwordx4 v7, s[20:23], s43 offen lds
v_mfma_f32_16x16x32_bf16 v[236:239], v[40:43], a[80:83], 0
s_add_u32 s43, s55, 860160
TR 244,20,57856
TR 246,20,59904
v_mfma_f32_16x16x32_bf16 v[240:243], v[42:45], a[84:87], 0
s_add_u32 m0, s38, 126976
v_cvt_pk_bf16_f32 v56, v56, v57
v_cvt_pk_bf16_f32 v57, v58, v59
v_mfma_f32_16x16x32_bf16 v[244:247], v[42:45], a[88:91], 0
TR 224,19,61440
TR 226,19,63488
v_mfma_f32_16x16x32_bf16 v[248:251], v[40:43], a[84:87], 0
buffer_load_dwordx4 v7, s[20:23], s43 offen lds
v_mfma_f32_16x16x32_bf16 v[252:255], v[40:43], a[88:91], 0
s_waitcnt lgkmcnt(6)
TR 228,20,61440
TR 230,20,63488
Mvaa 224,232,208
s_add_u32 s43, s55, 901120
v_cvt_pk_bf16_f32 v58, v60, v61
v_cvt_pk_bf16_f32 v59, v62, v63
Mvaa 228,232,212
s_add_u32 m0, s38, 131072
TR 232,19,61952
TR 234,19,64000
Mvaa 232,236,208
buffer_load_dwordx4 v7, s[20:23], s43 offen lds
Mvaa 236,236,212
s_waitcnt lgkmcnt(6)
TR 236,20,61952
TR 238,20,64000
Mvaa 240,240,208
s_add_u32 s43, s55, 942080
buffer_store_dwordx4 v[56:59], v14, s[28:31], s44 offen offset:1024 sc1
Mvaa 244,240,212
s_add_u32 m0, s38, 135168
TR 240,15,20480
TR 242,15,22528
Mvaa 248,244,208
buffer_load_dwordx4 v7, s[20:23], s43 offen lds
Mvaa 252,244,212
s_waitcnt lgkmcnt(6)
TR 244,16,20480
TR 246,16,22528
Mvaa 224,224,216
s_add_u32 s43, s56, 491520
v_cvt_pk_bf16_f32 v64, v64, v65
v_cvt_pk_bf16_f32 v65, v66, v67
Mvaa 228,224,220
s_add_u32 m0, s38, 139264
TR 224,15,20992
TR 226,15,23040
Mvaa 232,228,216
buffer_load_dwordx4 v7, s[20:23], s43 offen lds
Mvaa 236,228,220
s_waitcnt lgkmcnt(6)
TR 228,16,20992
TR 230,16,23040
Mvaa 240,232,216
s_add_u32 s43, s56, 532480
v_cvt_pk_bf16_f32 v66, v68, v69
v_cvt_pk_bf16_f32 v67, v70, v71
Mvaa 244,232,220
s_add_u32 m0, s38, 143360
TR 232,15,28672
TR 234,15,30720
Mvaa 248,236,216
buffer_load_dwordx4 v7, s[20:23], s43 offen lds
Mvaa 252,236,220
s_waitcnt lgkmcnt(6)
TR 236,16,28672
TR 238,16,30720
Mvaa 224,240,248
s_add_u32 s43, s56, 573440
buffer_store_dwordx4 v[64:67], v14, s[28:31], s44 offen offset:2048 sc1
Mvaa 228,240,0
s_add_u32 m0, s38, 147456
TR 240,15,29184
TR 242,15,31232
Mvaa 232,244,248
buffer_load_dwordx4 v7, s[20:23], s43 offen lds
Mvaa 236,244,0
s_waitcnt lgkmcnt(6)
TR 244,16,29184
TR 246,16,31232
X7:
s_cbranch_execz Xe
Mvaa 240,224,248
v_cvt_pk_bf16_f32 v72, v72, v73
v_cvt_pk_bf16_f32 v73, v74, v75
Mvaa 244,224,0
TR 224,15,32768
TR 226,15,34816
Mvaa 248,228,248
v_cvt_pk_bf16_f32 v74, v76, v77
v_cvt_pk_bf16_f32 v75, v78, v79
Mvaa 252,228,0
s_waitcnt lgkmcnt(6)
TR 228,16,32768
TR 230,16,34816
Mvaa 224,232,4
buffer_store_dwordx4 v[72:75], v14, s[28:31], s44 offen offset:3072 sc1
Mvaa 228,232,8
TR 232,15,33280
TR 234,15,35328
Mvaa 232,236,4
Mvaa 236,236,8
s_waitcnt lgkmcnt(6)
TR 236,16,33280
TR 238,16,35328
Mvaa 240,240,4
Mvaa 244,240,8
TR 240,15,36864
TR 242,15,38912
Mvaa 248,244,4
Mvaa 252,244,8
s_waitcnt lgkmcnt(6)
TR 244,16,36864
TR 246,16,38912
Mvaa 224,224,12
Mvaa 228,224,16
TR 224,15,37376
TR 226,15,39424
Mvaa 232,228,12
Mvaa 236,228,16
s_waitcnt lgkmcnt(6)
TR 228,16,37376
TR 230,16,39424
Mvaa 240,232,12
Mvaa 244,232,16
TR 232,15,40960
TR 234,15,43008
Mvaa 248,236,12
buffer_load_dword v33, off, s[28:31], s35 offset:128 sc1
Mvaa 252,236,16
s_waitcnt lgkmcnt(6)
TR 236,16,40960
TR 238,16,43008
Mvaa 224,240,20
Mvaa 228,240,24
TR 240,15,41472
TR 242,15,43520
Mvaa 232,244,20
Mvaa 236,244,24
s_waitcnt lgkmcnt(6)
TR 244,16,41472
TR 246,16,43520
Mvaa 240,224,20
Mvaa 244,224,24
TR 224,17,0
TR 226,17,2048
Mvaa 248,228,20
Mvaa 252,228,24
s_waitcnt lgkmcnt(6)
TR 228,18,0
TR 230,18,2048
Mvav 224,232,80
Mvav 228,232,84
TR 232,17,512
TR 234,17,2560
Mvav 232,236,80
s_add_u32 s43, s56, 614400
s_add_u32 m0, s38, 20480
Mvav 236,236,84
s_waitcnt lgkmcnt(6)
TR 236,18,512
TR 238,18,2560
Mvav 240,240,80
s_barrier
Mvav 244,240,84
TR 240,17,4096
TR 242,17,6144
Mvav 248,244,80
buffer_load_dwordx4 v7, s[20:23], s43 offen lds
Mvav 252,244,84
s_waitcnt lgkmcnt(6)
TR 244,18,4096
TR 246,18,6144
Mvav 224,224,96
s_add_u32 s43, s56, 655360
s_add_u32 m0, s38, 28672
Mvav 228,224,100
TR 224,17,4608
TR 226,17,6656
Mvav 232,228,96
buffer_load_dwordx4 v7, s[20:23], s43 offen lds
Mvav 236,228,100
s_waitcnt lgkmcnt(6)
TR 228,18,4608
TR 230,18,6656
Mvav 240,232,96
s_add_u32 s43, s56, 696320
X8:
s_cbranch_execz Xe
s_add_u32 m0, s38, 32768
Mvav 244,232,100
TR 232,17,32768
TR 234,17,34816
Mvav 248,236,96
buffer_load_dwordx4 v7, s[20:23], s43 offen lds
Mvav 252,236,100
s_waitcnt lgkmcnt(6)
TR 236,18,32768
TR 238,18,34816
Mvav 224,240,112
s_add_u32 s43, s56, 737280
s_waitcnt vmcnt(4)
s_xor_b32 s63, s35, 8192
s_mov_b64 exec, 1
buffer_store_dword v13, off, s[28:31], s63 offset:256 sc1
s_mov_b64 exec, -1
Mvav 228,240,116
s_add_u32 m0, s38, 36864
TR 240,17,33280
TR 242,17,35328
Mvav 232,244,112
buffer_load_dwordx4 v7, s[20:23], s43 offen lds
Mvav 236,244,116
s_waitcnt lgkmcnt(6)
TR 244,18,33280
TR 246,18,35328
Mvav 240,224,112
s_add_u32 s43, s56, 778240
s_add_u32 m0, s38, 151552
Mvav 244,224,116
TR 224,15,0
TR 226,15,2048
Mvav 248,228,112
buffer_load_dwordx4 v7, s[20:23], s43 offen lds
Mvav 252,228,116
s_waitcnt lgkmcnt(6)
TR 228,16,0
TR 230,16,2048
Mvav 224,232,128
s_add_u32 s43, s56, 819200
s_add_u32 m0, s38, 155648
Mvav 228,232,132
TR 232,15,512
TR 234,15,2560
Mvav 232,236,128
buffer_load_dwordx4 v7, s[20:23], s43 offen lds
Mvav 236,236,132
s_waitcnt lgkmcnt(6)
TR 236,16,512
TR 238,16,2560
Mvav 240,240,128
s_add_u32 s43, s56, 860160
s_add_u32 m0, s38, 159744
Mvav 244,240,132
TR 240,15,4096
TR 242,15,6144
Mvav 248,244,128
buffer_load_dwordx4 v7, s[20:23], s43 offen lds
Mvav 252,244,132
s_waitcnt lgkmcnt(6)
TR 244,16,4096
TR 246,16,6144
Mvav 224,224,144
Mvav 228,224,148
TR 224,15,4608
TR 226,15,6656
Mvav 232,228,144
Mvav 236,228,148
s_waitcnt lgkmcnt(6)
TR 228,16,4608
TR 230,16,6656
Mvav 240,232,144
Mvav 244,232,148
Mvav 248,236,144
Mvav 252,236,148
s_waitcnt lgkmcnt(4)
Mvav 224,240,160
Mvav 228,240,164
Mvav 232,244,160
v_cvt_pk_bf16_f32 v224, v224, v225
v_cvt_pk_bf16_f32 v225, v226, v227
Mvav 236,244,164
s_waitcnt lgkmcnt(0)
v_cvt_pk_bf16_f32 v226, v228, v229
v_cvt_pk_bf16_f32 v227, v230, v231
Mvav 240,224,160
s_add_u32 s44, s42, 98304
buffer_store_dwordx4 v[224:227], v14, s[28:31], s44 offen sc1
Mvav 244,224,164
TR 224,15,45056
TR 226,15,47104
Mvav 248,228,160
v_cvt_pk_bf16_f32 v232, v232, v233
v_cvt_pk_bf16_f32 v233, v234, v235
Mvav 252,228,164
TR 228,16,45056
TR 230,16,47104
v_mfma_f32_16x16x32_bf16 v[48:51], v[42:45], a[92:95], 0
v_cvt_pk_bf16_f32 v234, v236, v237
v_cvt_pk_bf16_f32 v235, v238, v239
v_mfma_f32_16x16x32_bf16 v[52:55], v[42:45], a[96:99], 0
TR 232,15,45568
TR 234,15,47616
v_mfma_f32_16x16x32_bf16 v[56:59], v[40:43], a[92:95], 0
X9:
s_cbranch_execz Xe
s_waitcnt vmcnt(9)
v_cmp_eq_u32 vcc, 0, v33
s_cbranch_vccnz Lp1
Lq1:
v_mfma_f32_16x16x32_bf16 v[60:63], v[40:43], a[96:99], 0
TR 236,16,45568
TR 238,16,47616
v_mfma_f32_16x16x32_bf16 v[64:67], v[42:45], a[100:103], 0
s_xor_b32 s84, s42, 4096
s_add_u32 s84, s84, 32768
buffer_load_dwordx4 v[192:195], v14, s[28:31], s84 offen sc1
v_mfma_f32_16x16x32_bf16 v[68:71], v[42:45], a[104:107], 0
TR 240,17,8192
TR 242,17,10240
v_mfma_f32_16x16x32_bf16 v[72:75], v[40:43], a[100:103], 0
buffer_load_dwordx4 v[196:199], v14, s[28:31], s84 offen offset:1024 sc1
v_mfma_f32_16x16x32_bf16 v[76:79], v[40:43], a[104:107], 0
s_waitcnt lgkmcnt(6)
TR 244,18,8192
TR 246,18,10240
Mvaa 48,224,208
buffer_load_dwordx4 v[200:203], v14, s[28:31], s84 offen offset:2048 sc1
Mvaa 52,224,212
TR 224,17,8704
TR 226,17,10752
Mvaa 56,228,208
buffer_load_dwordx4 v[204:207], v14, s[28:31], s84 offen offset:3072 sc1
Mvaa 60,228,212
s_waitcnt lgkmcnt(6)
TR 228,18,8704
TR 230,18,10752
Mvaa 64,232,208
s_xor_b32 s84, s37, 4096
buffer_load_dwordx4 v[208:211], v14, s[28:31], s84 offen sc1
Mvaa 68,232,212
TR 232,17,12288
TR 234,17,14336
Mvaa 72,236,208
buffer_store_dwordx4 v[232:235], v14, s[28:31], s44 offen offset:1024 sc1
Mvaa 76,236,212
s_waitcnt lgkmcnt(6)
TR 236,18,12288
TR 238,18,14336
Mvaa 48,240,216
v_cvt_pk_bf16_f32 v240, v240, v241
v_cvt_pk_bf16_f32 v241, v242, v243
Mvaa 52,240,220
TR 240,17,12800
TR 242,17,14848
Mvaa 56,244,216
s_add_u32 s43, s56, 901120
v_cvt_pk_bf16_f32 v242, v244, v245
v_cvt_pk_bf16_f32 v243, v246, v247
Mvaa 60,244,220
s_waitcnt lgkmcnt(6)
TR 244,18,12800
TR 246,18,14848
Mvaa 64,224,216
s_barrier
Mvaa 68,224,220
s_add_u32 m0, s38, 0
TR 224,17,40960
TR 226,17,43008
Mvaa 72,228,216
buffer_load_dwordx4 v7, s[20:23], s43 offen lds
Mvaa 76,228,220
s_waitcnt lgkmcnt(6)
TR 228,18,40960
TR 230,18,43008
Mvaa 48,232,248
s_add_u32 s43, s56, 942080
buffer_store_dwordx4 v[240:243], v14, s[28:31], s44 offen offset:2048 sc1
Mvaa 52,232,0
s_add_u32 m0, s38, 4096
TR 232,17,41472
TR 234,17,43520
Mvaa 56,236,248
buffer_load_dwordx4 v7, s[20:23], s43 offen lds
Mvaa 60,236,0
s_waitcnt lgkmcnt(6)
TR 236,18,41472
TR 238,18,43520
Mvaa 64,240,248
s_add_u32 s43, s57, 491520
v_cvt_pk_bf16_f32 v248, v248, v249
v_cvt_pk_bf16_f32 v249, v250, v251
Mvaa 68,240,0
s_add_u32 m0, s38, 40960
TR 240,15,8192
TR 242,15,10240
Mvaa 72,244,248
buffer_load_dwordx4 v7, s[20:23], s43 offen lds
Mvaa 76,244,0
s_waitcnt lgkmcnt(6)
TR 244,16,8192
TR 246,16,10240
Mvaa 48,224,4
s_add_u32 s43, s57, 532480
v_cvt_pk_bf16_f32 v250, v252, v253
v_cvt_pk_bf16_f32 v251, v254, v255
Mvaa 52,224,8
s_add_u32 m0, s38, 45056
TR 224,15,8704
TR 226,15,10752
Mvaa 56,228,4
buffer_load_dwordx4 v7, s[20:23], s43 offen lds
X10:
s_cbranch_execz Xe
Mvaa 60,228,8
s_waitcnt lgkmcnt(6)
TR 228,16,8704
TR 230,16,10752
Mvaa 64,232,4
s_add_u32 s43, s57, 573440
buffer_store_dwordx4 v[248:251], v14, s[28:31], s44 offen offset:3072 sc1
Mvaa 68,232,8
s_add_u32 m0, s38, 49152
TR 232,17,24576
TR 234,17,26624
Mvaa 72,236,4
buffer_load_dwordx4 v7, s[20:23], s43 offen lds
Mvaa 76,236,8
s_waitcnt lgkmcnt(6)
TR 236,18,24576
TR 238,18,26624
Mvaa 48,240,12
s_add_u32 s43, s57, 614400
s_add_u32 m0, s38, 53248
Mvaa 52,240,16
TR 240,17,25088
TR 242,17,27136
Mvaa 56,244,12
buffer_load_dwordx4 v7, s[20:23], s43 offen lds
Mvaa 60,244,16
s_waitcnt lgkmcnt(6)
TR 244,18,25088
TR 246,18,27136
Mvaa 64,224,12
s_add_u32 s43, s57, 655360
s_add_u32 m0, s38, 81920
Mvaa 68,224,16
TR 224,17,36864
TR 226,17,38912
Mvaa 72,228,12
buffer_load_dwordx4 v7, s[20:23], s43 offen lds
Mvaa 76,228,16
s_waitcnt lgkmcnt(6)
TR 228,18,36864
TR 230,18,38912
Mvaa 48,232,20
buffer_load_dword v34, off, s[28:31], s35 offset:256 sc1
Mvaa 52,232,24
TR 232,17,37376
TR 234,17,39424
Mvaa 56,236,20
Mvaa 60,236,24
s_waitcnt lgkmcnt(6)
TR 236,18,37376
TR 238,18,39424
Mvaa 64,240,20
Mvaa 68,240,24
TR 240,17,45056
TR 242,17,47104
Mvaa 72,244,20
Mvaa 76,244,24
s_waitcnt lgkmcnt(6)
TR 244,18,45056
TR 246,18,47104
Mvav 48,224,80
Mvav 52,224,84
TR 224,17,45568
TR 226,17,47616
Mvav 56,228,80
Mvav 60,228,84
s_waitcnt lgkmcnt(6)
TR 228,18,45568
TR 230,18,47616
Mvav 64,232,80
Mvav 68,232,84
TR 232,19,0
TR 234,19,2048
Mvav 72,236,80
Mvav 76,236,84
s_waitcnt lgkmcnt(6)
TR 236,20,0
TR 238,20,2048
Mvav 48,240,96
Mvav 52,240,100
TR 240,19,512
TR 242,19,2560
Mvav 56,244,96
Mvav 60,244,100
s_waitcnt lgkmcnt(6)
TR 244,20,512
TR 246,20,2560
Mvav 64,224,96
Mvav 68,224,100
TR 224,19,4096
TR 226,19,6144
Mvav 72,228,96
Mvav 76,228,100
s_waitcnt lgkmcnt(6)
TR 228,20,4096
TR 230,20,6144
Mvav 48,232,112
s_waitcnt vmcnt(4)
s_xor_b32 s63, s35, 12288
s_mov_b64 exec, 1
buffer_store_dword v13, off, s[28:31], s63 offset:384 sc1
s_mov_b64 exec, -1
Mvav 52,232,116
TR 232,19,4608
TR 234,19,6656
Mvav 56,236,112
X11:
s_cbranch_execz Xe
Mvav 60,236,116
s_waitcnt lgkmcnt(6)
TR 236,20,4608
TR 238,20,6656
Mvav 64,240,112
Mvav 68,240,116
XR0:
s_cbranch_execz Xe
TR 240,19,8192
TR 242,19,10240
Mvav 72,244,112
Mvav 76,244,116
s_waitcnt lgkmcnt(6)
TR 244,20,8192
TR 246,20,10240
Mvav 48,224,128
Mvav 52,224,132
TR 224,19,8704
TR 226,19,10752
Mvav 56,228,128
s_add_u32 s43, s57, 696320
s_add_u32 m0, s38, 8192
Mvav 60,228,132
s_waitcnt lgkmcnt(6)
TR 228,20,8704
TR 230,20,10752
Mvav 64,232,128
s_barrier
Mvav 68,232,132
TR 232,19,12288
TR 234,19,14336
Mvav 72,236,128
buffer_load_dwordx4 v7, s[20:23], s43 offen lds
Mvav 76,236,132
s_waitcnt lgkmcnt(6)
TR 236,20,12288
TR 238,20,14336
Mvav 48,240,144
s_add_u32 s43, s57, 737280
s_add_u32 m0, s38, 57344
Mvav 52,240,148
TR 240,19,12800
TR 242,19,14848
Mvav 56,244,144
buffer_load_dwordx4 v7, s[20:23], s43 offen lds
Mvav 60,244,148
s_waitcnt lgkmcnt(6)
TR 244,20,12800
TR 246,20,14848
Mvav 64,224,144
s_add_u32 s43, s57, 778240
s_add_u32 m0, s38, 61440
Mvav 68,224,148
Mvav 72,228,144
buffer_load_dwordx4 v7, s[20:23], s43 offen lds
Mvav 76,228,148
s_waitcnt lgkmcnt(4)
s_add_u32 s43, s57, 819200
s_add_u32 m0, s38, 73728
Mvav 48,232,160
Mvav 52,232,164
Mvav 56,236,160
buffer_load_dwordx4 v7, s[20:23], s43 offen lds
Mvav 60,236,164
s_waitcnt lgkmcnt(0)
v_cvt_pk_bf16_f32 v48, v48, v49
v_cvt_pk_bf16_f32 v49, v50, v51
Mvav 64,240,160
s_add_u32 s43, s57, 860160
v_cvt_pk_bf16_f32 v50, v52, v53
v_cvt_pk_bf16_f32 v51, v54, v55
Mvav 68,240,164
s_add_u32 m0, s38, 86016
TR 240,15,12288
TR 242,15,14336
Mvav 72,244,160
buffer_load_dwordx4 v7, s[20:23], s43 offen lds
Mvav 76,244,164
s_add_u32 s43, s57, 901120
TR 244,16,12288
TR 246,16,14336
v_mfma_f32_16x16x32_bf16 v[224:227], v[42:45], a[108:111], 0
s_add_u32 m0, s38, 90112
s_add_u32 s44, s42, 131072
buffer_store_dwordx4 v[48:51], v14, s[28:31], s44 offen sc1
v_mfma_f32_16x16x32_bf16 v[228:231], v[42:45], a[112:115], 0
TR 224,15,12800
TR 226,15,14848
v_mfma_f32_16x16x32_bf16 v[232:235], v[40:43], a[108:111], 0
buffer_load_dwordx4 v7, s[20:23], s43 offen lds
v_mfma_f32_16x16x32_bf16 v[236:239], v[40:43], a[112:115], 0
s_add_u32 s43, s57, 942080
TR 228,16,12800
TR 230,16,14848
v_mfma_f32_16x16x32_bf16 v[240:243], v[42:45], a[116:119], 0
s_add_u32 m0, s38, 94208
s_waitcnt vmcnt(8)
v_cmp_eq_u32 vcc, 0, v34
s_cbranch_vccnz Lp2
Lq2:
v_mfma_f32_16x16x32_bf16 v[244:247], v[42:45], a[120:123], 0
TR 232,15,16384
TR 234,15,18432
v_mfma_f32_16x16x32_bf16 v[248:251], v[40:43], a[116:119], 0
buffer_load_dwordx4 v7, s[20:23], s43 offen lds
v_mfma_f32_16x16x32_bf16 v[252:255], v[40:43], a[120:123], 0
s_waitcnt lgkmcnt(6)
TR 236,16,16384
TR 238,16,18432
X12:
s_cbranch_execz Xe
Mvaa 224,240,208
s_add_u32 s43, s50, 491520
s_xor_b32 s84, s42, 8192
s_add_u32 s84, s84, 65536
buffer_load_dwordx4 v[212:215], v14, s[28:31], s84 offen sc1
Mvaa 228,240,212
s_add_u32 m0, s38, 98304
TR 240,15,16896
TR 242,15,18944
Mvaa 232,244,208
buffer_load_dwordx4 v7, s[20:23], s43 offen lds
Mvaa 236,244,212
s_waitcnt lgkmcnt(6)
TR 244,16,16896
TR 246,16,18944
buffer_load_dwordx4 v[216:219], v14, s[28:31], s84 offen offset:1024 sc1
Mvaa 240,224,208
buffer_load_dwordx4 v[220:223], v14, s[28:31], s84 offen offset:2048 sc1
Mvaa 244,224,212
TR 224,15,24576
TR 226,15,26624
Mvaa 248,228,208
buffer_load_dwordx4 a[160:163], v14, s[28:31], s84 offen offset:3072 sc1
Mvaa 252,228,212
s_waitcnt lgkmcnt(6)
TR 228,16,24576
TR 230,16,26624
Mvaa 224,232,216
s_xor_b32 s84, s37, 8192
buffer_load_dwordx4 a[164:167], v14, s[28:31], s84 offen sc1
Mvaa 228,232,220
TR 232,15,25088
TR 234,15,27136
Mvaa 232,236,216
v_cvt_pk_bf16_f32 v56, v56, v57
v_cvt_pk_bf16_f32 v57, v58, v59
Mvaa 236,236,220
s_waitcnt lgkmcnt(6)
TR 236,16,25088
TR 238,16,27136
Mvaa 240,240,216
v_cvt_pk_bf16_f32 v58, v60, v61
v_cvt_pk_bf16_f32 v59, v62, v63
Mvaa 244,240,220
TR 240,17,16384
TR 242,17,18432
Mvaa 248,244,216
buffer_store_dwordx4 v[56:59], v14, s[28:31], s44 offen offset:1024 sc1
Mvaa 252,244,220
s_waitcnt lgkmcnt(6)
TR 244,18,16384
TR 246,18,18432
Mvaa 224,224,248
v_cvt_pk_bf16_f32 v64, v64, v65
v_cvt_pk_bf16_f32 v65, v66, v67
Mvaa 228,224,0
TR 224,17,16896
TR 226,17,18944
Mvaa 232,228,248
v_cvt_pk_bf16_f32 v66, v68, v69
v_cvt_pk_bf16_f32 v67, v70, v71
Mvaa 236,228,0
s_waitcnt lgkmcnt(6)
TR 228,18,16896
TR 230,18,18944
Mvaa 240,232,248
buffer_store_dwordx4 v[64:67], v14, s[28:31], s44 offen offset:2048 sc1
Mvaa 244,232,0
TR 232,17,20480
TR 234,17,22528
Mvaa 248,236,248
v_cvt_pk_bf16_f32 v72, v72, v73
v_cvt_pk_bf16_f32 v73, v74, v75
Mvaa 252,236,0
s_waitcnt lgkmcnt(6)
TR 236,18,20480
TR 238,18,22528
Mvaa 224,240,4
v_cvt_pk_bf16_f32 v74, v76, v77
v_cvt_pk_bf16_f32 v75, v78, v79
Mvaa 228,240,8
TR 240,17,20992
TR 242,17,23040
Mvaa 232,244,4
buffer_store_dwordx4 v[72:75], v14, s[28:31], s44 offen offset:3072 sc1
Mvaa 236,244,8
s_waitcnt lgkmcnt(6)
TR 244,18,20992
TR 246,18,23040
Mvaa 240,224,4
Mvaa 244,224,8
TR 224,17,28672
TR 226,17,30720
Mvaa 248,228,4
Mvaa 252,228,8
s_waitcnt lgkmcnt(6)
TR 228,18,28672
TR 230,18,30720
Mvaa 224,232,12
Mvaa 228,232,16
TR 232,17,29184
TR 234,17,31232
Mvaa 232,236,12
X13:
s_cbranch_execz Xe
s_add_u32 s43, s50, 532480
s_add_u32 m0, s38, 12288
Mvaa 236,236,16
s_waitcnt lgkmcnt(6)
TR 236,18,29184
TR 238,18,31232
Mvaa 240,240,12
s_barrier
Mvaa 244,240,16
TR 240,19,16384
TR 242,19,18432
Mvaa 248,244,12
buffer_load_dwordx4 v7, s[20:23], s43 offen lds
Mvaa 252,244,16
s_waitcnt lgkmcnt(6)
TR 244,20,16384
TR 246,20,18432
Mvaa 224,224,20
s_add_u32 s43, s50, 573440
buffer_load_dword v35, off, s[28:31], s35 offset:384 sc1
Mvaa 228,224,24
s_add_u32 m0, s38, 16384
TR 224,19,16896
TR 226,19,18944
Mvaa 232,228,20
buffer_load_dwordx4 v7, s[20:23], s43 offen lds
Mvaa 236,228,24
s_waitcnt lgkmcnt(6)
TR 228,20,16896
TR 230,20,18944
Mvaa 240,232,20
s_add_u32 s43, s50, 614400
s_add_u32 m0, s38, 24576
Mvaa 244,232,24
TR 232,19,20480
TR 234,19,22528
Mvaa 248,236,20
buffer_load_dwordx4 v7, s[20:23], s43 offen lds
Mvaa 252,236,24
s_waitcnt lgkmcnt(6)
TR 236,20,20480
TR 238,20,22528
Mvav 224,240,80
s_add_u32 s43, s50, 655360
s_add_u32 m0, s38, 65536
Mvav 228,240,84
TR 240,19,20992
TR 242,19,23040
Mvav 232,244,80
buffer_load_dwordx4 v7, s[20:23], s43 offen lds
Mvav 236,244,84
s_waitcnt lgkmcnt(6)
TR 244,20,20992
TR 246,20,23040
Mvav 240,224,80
s_add_u32 s43, s50, 696320
s_add_u32 m0, s38, 102400
Mvav 244,224,84
TR 224,19,24576
TR 226,19,26624
Mvav 248,228,80
buffer_load_dwordx4 v7, s[20:23], s43 offen lds
Mvav 252,228,84
s_waitcnt lgkmcnt(6)
TR 228,20,24576
TR 230,20,26624
Mvav 224,232,96
s_add_u32 s43, s50, 737280
s_add_u32 m0, s38, 106496
Mvav 228,232,100
TR 232,19,25088
TR 234,19,27136
Mvav 232,236,96
buffer_load_dwordx4 v7, s[20:23], s43 offen lds
Mvav 236,236,100
s_waitcnt lgkmcnt(6)
TR 236,20,25088
TR 238,20,27136
Mvav 240,240,96
s_add_u32 s43, s50, 778240
s_add_u32 m0, s38, 110592
Mvav 244,240,100
TR 240,19,28672
TR 242,19,30720
Mvav 248,244,96
buffer_load_dwordx4 v7, s[20:23], s43 offen lds
Mvav 252,244,100
s_waitcnt lgkmcnt(6)
TR 244,20,28672
TR 246,20,30720
Mvav 224,224,112
s_waitcnt vmcnt(8)
s_xor_b32 s63, s35, 16384
s_mov_b64 exec, 1
buffer_store_dword v13, off, s[28:31], s63 offset:512 sc1
s_mov_b64 exec, -1
Mvav 228,224,116
TR 224,19,29184
TR 226,19,31232
Mvav 232,228,112
Mvav 236,228,116
s_waitcnt lgkmcnt(6)
TR 228,20,29184
TR 230,20,31232
Mvav 240,232,112
Mvav 244,232,116
X14:
s_cbranch_execz Xe
TR 232,19,32768
TR 234,19,34816
Mvav 248,236,112
Mvav 252,236,116
s_waitcnt lgkmcnt(6)
TR 236,20,32768
TR 238,20,34816
Mvav 224,240,128
Mvav 228,240,132
TR 240,19,33280
TR 242,19,35328
Mvav 232,244,128
Mvav 236,244,132
s_waitcnt lgkmcnt(6)
TR 244,20,33280
TR 246,20,35328
Mvav 240,224,128
Mvav 244,224,132
TR 224,19,36864
TR 226,19,38912
Mvav 248,228,128
Mvav 252,228,132
s_waitcnt lgkmcnt(6)
TR 228,20,36864
TR 230,20,38912
Mvav 224,232,144
Mvav 228,232,148
TR 232,19,37376
TR 234,19,39424
Mvav 232,236,144
Mvav 236,236,148
s_waitcnt lgkmcnt(6)
TR 236,20,37376
TR 238,20,39424
Mvav 240,240,144
Mvav 244,240,148
Mvav 248,244,144
Mvav 252,244,148
s_waitcnt lgkmcnt(4)
Mvav 224,224,160
Mvav 228,224,164
Mvav 232,228,160
v_cvt_pk_bf16_f32 v224, v224, v225
v_cvt_pk_bf16_f32 v225, v226, v227
Mvav 236,228,164
s_waitcnt lgkmcnt(0)
v_cvt_pk_bf16_f32 v226, v228, v229
v_cvt_pk_bf16_f32 v227, v230, v231
Mvav 240,232,160
s_add_u32 s44, s42, 163840
buffer_store_dwordx4 v[224:227], v14, s[28:31], s44 offen sc1
Mvav 244,232,164
TR 232,19,40960
TR 234,19,43008
Mvav 248,236,160
v_cvt_pk_bf16_f32 v232, v232, v233
v_cvt_pk_bf16_f32 v233, v234, v235
Mvav 252,236,164
TR 236,20,40960
TR 238,20,43008
v_mfma_f32_16x16x32_bf16 v[48:51], v[42:45], a[124:127], 0
v_cvt_pk_bf16_f32 v234, v236, v237
v_cvt_pk_bf16_f32 v235, v238, v239
v_mfma_f32_16x16x32_bf16 v[52:55], v[42:45], a[128:131], 0
TR 240,19,41472
TR 242,19,43520
v_mfma_f32_16x16x32_bf16 v[56:59], v[40:43], a[124:127], 0
s_add_u32 s43, s50, 819200
s_waitcnt vmcnt(8)
v_cmp_eq_u32 vcc, 0, v35
s_cbranch_vccnz Lp3
Lq3:
v_mfma_f32_16x16x32_bf16 v[60:63], v[40:43], a[128:131], 0
TR 244,20,41472
TR 246,20,43520
v_mfma_f32_16x16x32_bf16 v[64:67], v[42:45], a[132:135], 0
s_barrier
v_mfma_f32_16x16x32_bf16 v[68:71], v[42:45], a[136:139], 0
s_add_u32 m0, s38, 69632
TR 224,19,45056
TR 226,19,47104
v_mfma_f32_16x16x32_bf16 v[72:75], v[40:43], a[132:135], 0
buffer_load_dwordx4 v7, s[20:23], s43 offen lds
v_mfma_f32_16x16x32_bf16 v[76:79], v[40:43], a[136:139], 0
s_waitcnt lgkmcnt(6)
TR 228,20,45056
TR 230,20,47104
Mvaa 48,232,208
s_add_u32 s43, s50, 860160
s_xor_b32 s84, s42, 12288
s_add_u32 s84, s84, 98304
buffer_load_dwordx4 a[168:171], v14, s[28:31], s84 offen sc1
Mvaa 52,232,212
s_add_u32 m0, s38, 77824
TR 232,19,45568
TR 234,19,47616
Mvaa 56,236,208
buffer_load_dwordx4 v7, s[20:23], s43 offen lds
Mvaa 60,236,212
s_waitcnt lgkmcnt(6)
TR 236,20,45568
TR 238,20,47616
buffer_load_dwordx4 a[172:175], v14, s[28:31], s84 offen offset:1024 sc1
Mvaa 64,240,208
s_add_u32 s43, s50, 901120
buffer_load_dwordx4 a[176:179], v14, s[28:31], s84 offen offset:2048 sc1
Mvaa 68,240,212
X15:
s_cbranch_execz Xe
s_add_u32 m0, s38, 114688
TR 240,19,49152
TR 242,19,51200
Mvaa 72,244,208
buffer_load_dwordx4 v7, s[20:23], s43 offen lds
Mvaa 76,244,212
s_waitcnt lgkmcnt(6)
TR 244,20,49152
TR 246,20,51200
buffer_load_dwordx4 a[180:183], v14, s[28:31], s84 offen offset:3072 sc1
Mvaa 48,224,216
s_add_u32 s43, s50, 942080
s_xor_b32 s84, s37, 12288
buffer_load_dwordx4 a[184:187], v14, s[28:31], s84 offen sc1
Mvaa 52,224,220
s_add_u32 m0, s38, 118784
TR 224,19,49664
TR 226,19,51712
Mvaa 56,228,216
buffer_load_dwordx4 v7, s[20:23], s43 offen lds
Mvaa 60,228,220
s_waitcnt lgkmcnt(6)
TR 228,20,49664
TR 230,20,51712
Mvaa 64,232,216
buffer_store_dwordx4 v[232:235], v14, s[28:31], s44 offen offset:1024 sc1
Mvaa 68,232,220
TR 232,15,20480
TR 234,15,22528
Mvaa 72,236,216
v_cvt_pk_bf16_f32 v240, v240, v241
v_cvt_pk_bf16_f32 v241, v242, v243
Mvaa 76,236,220
s_waitcnt lgkmcnt(6)
TR 236,16,20480
TR 238,16,22528
Mvaa 48,240,248
v_cvt_pk_bf16_f32 v242, v244, v245
v_cvt_pk_bf16_f32 v243, v246, v247
Mvaa 52,240,0
TR 240,15,20992
TR 242,15,23040
Mvaa 56,244,248
buffer_store_dwordx4 v[240:243], v14, s[28:31], s44 offen offset:2048 sc1
Mvaa 60,244,0
s_waitcnt lgkmcnt(6)
TR 244,16,20992
TR 246,16,23040
Mvaa 64,224,248
v_cvt_pk_bf16_f32 v248, v248, v249
v_cvt_pk_bf16_f32 v249, v250, v251
Mvaa 68,224,0
TR 224,15,28672
TR 226,15,30720
Mvaa 72,228,248
v_cvt_pk_bf16_f32 v250, v252, v253
v_cvt_pk_bf16_f32 v251, v254, v255
Mvaa 76,228,0
s_waitcnt lgkmcnt(6)
TR 228,16,28672
TR 230,16,30720
Mvaa 48,232,4
buffer_store_dwordx4 v[248:251], v14, s[28:31], s44 offen offset:3072 sc1
Mvaa 52,232,8
TR 232,15,29184
TR 234,15,31232
Mvaa 56,236,4
Mvaa 60,236,8
s_waitcnt lgkmcnt(6)
TR 236,16,29184
TR 238,16,31232
Mvaa 64,240,4
Mvaa 68,240,8
TR 240,15,32768
TR 242,15,34816
Mvaa 72,244,4
Mvaa 76,244,8
s_waitcnt lgkmcnt(6)
TR 244,16,32768
TR 246,16,34816
Mvaa 48,224,12
Mvaa 52,224,16
TR 224,15,33280
TR 226,15,35328
Mvaa 56,228,12
Mvaa 60,228,16
s_waitcnt lgkmcnt(6)
TR 228,16,33280
TR 230,16,35328
Mvaa 64,232,12
Mvaa 68,232,16
TR 232,15,36864
TR 234,15,38912
Mvaa 72,236,12
buffer_load_dword v36, off, s[28:31], s35 offset:512 sc1
Mvaa 76,236,16
s_waitcnt lgkmcnt(6)
TR 236,16,36864
TR 238,16,38912
Mvaa 48,240,20
Mvaa 52,240,24
TR 240,15,37376
TR 242,15,39424
Mvaa 56,244,20
X16:
s_cbranch_execz Xe
Mvaa 60,244,24
s_waitcnt lgkmcnt(6)
TR 244,16,37376
TR 246,16,39424
Mvaa 64,224,20
Mvaa 68,224,24
TR 224,19,53248
TR 226,19,55296
Mvaa 72,228,20
Mvaa 76,228,24
s_waitcnt lgkmcnt(6)
TR 228,20,53248
TR 230,20,55296
Mvav 48,232,80
Mvav 52,232,84
TR 232,19,53760
TR 234,19,55808
XR1:
s_cbranch_execz Xe
Mvav 56,236,80
Mvav 60,236,84
s_waitcnt lgkmcnt(6)
TR 236,20,53760
TR 238,20,55808
Mvav 64,240,80
Mvav 68,240,84
TR 240,19,57344
TR 242,19,59392
Mvav 72,244,80
Mvav 76,244,84
s_waitcnt lgkmcnt(6)
TR 244,20,57344
TR 246,20,59392
Mvav 48,224,96
Mvav 52,224,100
TR 224,19,57856
TR 226,19,59904
Mvav 56,228,96
Mvav 60,228,100
s_waitcnt lgkmcnt(6)
TR 228,20,57856
TR 230,20,59904
Mvav 64,232,96
s_barrier
Mvav 68,232,100
TR 232,19,61440
TR 234,19,63488
Mvav 72,236,96
Mvav 76,236,100
s_waitcnt lgkmcnt(6)
TR 236,20,61440
TR 238,20,63488
Mvav 48,240,112
s_waitcnt vmcnt(1)
s_xor_b32 s63, s35, 20480
s_mov_b64 exec, 1
buffer_store_dword v13, off, s[28:31], s63 offset:640 sc1
s_mov_b64 exec, -1
Mvav 52,240,116
TR 240,19,61952
TR 242,19,64000
Mvav 56,244,112
Mvav 60,244,116
s_waitcnt lgkmcnt(6)
TR 244,20,61952
TR 246,20,64000
Mvav 64,224,112
Mvav 68,224,116
TR 224,15,0
TR 226,15,2048
Mvav 72,228,112
Mvav 76,228,116
s_waitcnt lgkmcnt(6)
TR 228,16,0
TR 230,16,2048
Mvav 48,232,128
Mvav 52,232,132
TR 232,15,512
TR 234,15,2560
Mvav 56,236,128
Mvav 60,236,132
s_waitcnt lgkmcnt(6)
TR 236,16,512
TR 238,16,2560
Mvav 64,240,128
Mvav 68,240,132
TR 240,15,4096
TR 242,15,6144
Mvav 72,244,128
Mvav 76,244,132
s_waitcnt lgkmcnt(6)
TR 244,16,4096
TR 246,16,6144
Mvav 48,224,144
Mvav 52,224,148
TR 224,15,4608
TR 226,15,6656
Mvav 56,228,144
Mvav 60,228,148
s_waitcnt lgkmcnt(6)
TR 228,16,4608
TR 230,16,6656
Mvav 64,232,144
Mvav 68,232,148
Mvav 72,236,144
Mvav 76,236,148
s_waitcnt lgkmcnt(4)
Mvav 48,240,160
Mvav 52,240,164
X17:
s_cbranch_execz Xe
Mvav 56,244,160
v_cvt_pk_bf16_f32 v48, v48, v49
v_cvt_pk_bf16_f32 v49, v50, v51
Mvav 60,244,164
s_waitcnt lgkmcnt(0)
v_cvt_pk_bf16_f32 v50, v52, v53
v_cvt_pk_bf16_f32 v51, v54, v55
Mvav 64,224,160
s_add_u32 s44, s42, 196608
buffer_store_dwordx4 v[48:51], v14, s[28:31], s44 offen sc1
Mvav 68,224,164
TR 224,15,40960
TR 226,15,43008
Mvav 72,228,160
v_cvt_pk_bf16_f32 v56, v56, v57
v_cvt_pk_bf16_f32 v57, v58, v59
Mvav 76,228,164
TR 228,16,40960
TR 230,16,43008
v_mfma_f32_16x16x32_bf16 v[224:227], v[42:45], a[140:143], 0
v_cvt_pk_bf16_f32 v58, v60, v61
v_cvt_pk_bf16_f32 v59, v62, v63
v_mfma_f32_16x16x32_bf16 v[228:231], v[42:45], a[144:147], 0
TR 232,15,41472
TR 234,15,43520
v_mfma_f32_16x16x32_bf16 v[232:235], v[40:43], a[140:143], 0
s_waitcnt vmcnt(2)
v_cmp_eq_u32 vcc, 0, v36
s_cbranch_vccnz Lp4
Lq4:
v_mfma_f32_16x16x32_bf16 v[236:239], v[40:43], a[144:147], 0
TR 236,16,41472
TR 238,16,43520
v_mfma_f32_16x16x32_bf16 v[240:243], v[42:45], a[148:151], 0
s_xor_b32 s84, s42, 16384
s_add_u32 s84, s84, 131072
buffer_load_dwordx4 a[188:191], v14, s[28:31], s84 offen sc1
v_mfma_f32_16x16x32_bf16 v[244:247], v[42:45], a[152:155], 0
TR 240,15,45056
TR 242,15,47104
v_mfma_f32_16x16x32_bf16 v[248:251], v[40:43], a[148:151], 0
buffer_load_dwordx4 a[192:195], v14, s[28:31], s84 offen offset:1024 sc1
v_mfma_f32_16x16x32_bf16 v[252:255], v[40:43], a[152:155], 0
s_waitcnt lgkmcnt(6)
TR 244,16,45056
TR 246,16,47104
Mvaa 224,224,208
buffer_load_dwordx4 a[196:199], v14, s[28:31], s84 offen offset:2048 sc1
Mvaa 228,224,212
TR 224,15,45568
TR 226,15,47616
Mvaa 232,228,208
buffer_load_dwordx4 a[200:203], v14, s[28:31], s84 offen offset:3072 sc1
Mvaa 236,228,212
s_waitcnt lgkmcnt(6)
TR 228,16,45568
TR 230,16,47616
Mvaa 240,232,208
s_xor_b32 s84, s37, 16384
buffer_load_dwordx4 a[204:207], v14, s[28:31], s84 offen sc1
Mvaa 244,232,212
TR 232,17,0
TR 234,17,2048
Mvaa 248,236,208
buffer_store_dwordx4 v[56:59], v14, s[28:31], s44 offen offset:1024 sc1
Mvaa 252,236,212
s_waitcnt lgkmcnt(6)
TR 236,18,0
TR 238,18,2048
Mvaa 224,240,216
v_cvt_pk_bf16_f32 v64, v64, v65
v_cvt_pk_bf16_f32 v65, v66, v67
Mvaa 228,240,220
TR 240,17,512
TR 242,17,2560
Mvaa 232,244,216
v_cvt_pk_bf16_f32 v66, v68, v69
v_cvt_pk_bf16_f32 v67, v70, v71
Mvaa 236,244,220
s_waitcnt lgkmcnt(6)
TR 244,18,512
TR 246,18,2560
Mvaa 240,224,216
buffer_store_dwordx4 v[64:67], v14, s[28:31], s44 offen offset:2048 sc1
Mvaa 244,224,220
TR 224,17,4096
TR 226,17,6144
Mvaa 248,228,216
v_cvt_pk_bf16_f32 v72, v72, v73
v_cvt_pk_bf16_f32 v73, v74, v75
Mvaa 252,228,220
s_waitcnt lgkmcnt(6)
TR 228,18,4096
TR 230,18,6144
Mvaa 224,232,248
v_cvt_pk_bf16_f32 v74, v76, v77
v_cvt_pk_bf16_f32 v75, v78, v79
Mvaa 228,232,0
TR 232,17,4608
TR 234,17,6656
Mvaa 232,236,248
buffer_store_dwordx4 v[72:75], v14, s[28:31], s44 offen offset:3072 sc1
Mvaa 236,236,0
s_waitcnt lgkmcnt(6)
TR 236,18,4608
TR 238,18,6656
X18:
s_cbranch_execz Xe
Mvaa 240,240,248
s_barrier
Mvaa 244,240,0
TR 240,17,32768
TR 242,17,34816
Mvaa 248,244,248
Mvaa 252,244,0
s_waitcnt lgkmcnt(6)
TR 244,18,32768
TR 246,18,34816
Mvaa 224,224,4
Mvaa 228,224,8
TR 224,17,33280
TR 226,17,35328
Mvaa 232,228,4
Mvaa 236,228,8
s_waitcnt lgkmcnt(6)
TR 228,18,33280
TR 230,18,35328
Mvaa 240,232,4
Mvaa 244,232,8
TR 232,15,8192
TR 234,15,10240
Mvaa 248,236,4
Mvaa 252,236,8
s_waitcnt lgkmcnt(6)
TR 236,16,8192
TR 238,16,10240
Mvaa 224,240,12
Mvaa 228,240,16
TR 240,15,8704
TR 242,15,10752
Mvaa 232,244,12
Mvaa 236,244,16
s_waitcnt lgkmcnt(6)
TR 244,16,8704
TR 246,16,10752
Mvaa 240,224,12
Mvaa 244,224,16
TR 224,17,8192
TR 226,17,10240
Mvaa 248,228,12
buffer_load_dword v37, off, s[28:31], s35 offset:640 sc1
Mvaa 252,228,16
s_waitcnt lgkmcnt(6)
TR 228,18,8192
TR 230,18,10240
Mvaa 224,232,20
Mvaa 228,232,24
TR 232,17,8704
TR 234,17,10752
Mvaa 232,236,20
Mvaa 236,236,24
s_waitcnt lgkmcnt(6)
TR 236,18,8704
TR 238,18,10752
Mvaa 240,240,20
Mvaa 244,240,24
TR 240,17,12288
TR 242,17,14336
Mvaa 248,244,20
Mvaa 252,244,24
s_waitcnt lgkmcnt(6)
TR 244,18,12288
TR 246,18,14336
Mvav 224,224,80
Mvav 228,224,84
TR 224,17,12800
TR 226,17,14848
Mvav 232,228,80
Mvav 236,228,84
s_waitcnt lgkmcnt(6)
TR 228,18,12800
TR 230,18,14848
Mvav 240,232,80
Mvav 244,232,84
TR 232,17,24576
TR 234,17,26624
Mvav 248,236,80
Mvav 252,236,84
s_waitcnt lgkmcnt(6)
TR 236,18,24576
TR 238,18,26624
Mvav 224,240,96
Mvav 228,240,100
TR 240,17,25088
TR 242,17,27136
Mvav 232,244,96
Mvav 236,244,100
s_waitcnt lgkmcnt(6)
TR 244,18,25088
TR 246,18,27136
Mvav 240,224,96
Mvav 244,224,100
TR 224,17,36864
TR 226,17,38912
Mvav 248,228,96
Mvav 252,228,100
s_waitcnt lgkmcnt(6)
TR 228,18,36864
TR 230,18,38912
Mvav 224,232,112
s_waitcnt vmcnt(1)
s_xor_b32 s63, s35, 24576
s_mov_b64 exec, 1
buffer_store_dword v13, off, s[28:31], s63 offset:768 sc1
s_mov_b64 exec, -1
X19:
s_cbranch_execz Xe
Mvav 228,232,116
TR 232,17,37376
TR 234,17,39424
Mvav 232,236,112
Mvav 236,236,116
s_waitcnt lgkmcnt(6)
TR 236,18,37376
TR 238,18,39424
Mvav 240,240,112
Mvav 244,240,116
TR 240,17,40960
TR 242,17,43008
Mvav 248,244,112
Mvav 252,244,116
s_waitcnt lgkmcnt(6)
TR 244,18,40960
TR 246,18,43008
Mvav 224,224,128
Mvav 228,224,132
TR 224,17,41472
TR 226,17,43520
Mvav 232,228,128
Mvav 236,228,132
s_waitcnt lgkmcnt(6)
TR 228,18,41472
TR 230,18,43520
Mvav 240,232,128
Mvav 244,232,132
TR 232,17,45056
TR 234,17,47104
Mvav 248,236,128
Mvav 252,236,132
s_waitcnt lgkmcnt(6)
TR 236,18,45056
TR 238,18,47104
Mvav 224,240,144
Mvav 228,240,148
TR 240,17,45568
TR 242,17,47616
Mvav 232,244,144
Mvav 236,244,148
s_waitcnt lgkmcnt(6)
TR 244,18,45568
TR 246,18,47616
Mvav 240,224,144
s_barrier
Mvav 244,224,148
Mvav 248,228,144
Mvav 252,228,148
s_waitcnt lgkmcnt(4)
Mvav 224,232,160
Mvav 228,232,164
Mvav 232,236,160
v_cvt_pk_bf16_f32 v224, v224, v225
v_cvt_pk_bf16_f32 v225, v226, v227
Mvav 236,236,164
s_waitcnt lgkmcnt(0)
v_cvt_pk_bf16_f32 v226, v228, v229
v_cvt_pk_bf16_f32 v227, v230, v231
Mvav 240,240,160
s_add_u32 s44, s42, 229376
buffer_store_dwordx4 v[224:227], v14, s[28:31], s44 offen sc1
Mvav 244,240,164
TR 240,19,0
TR 242,19,2048
Mvav 248,244,160
v_cvt_pk_bf16_f32 v232, v232, v233
v_cvt_pk_bf16_f32 v233, v234, v235
Mvav 252,244,164
TR 244,20,0
TR 246,20,2048
v_mfma_f32_16x16x32_bf16 v[88:91], v[42:45], a[156:159], 0
v_cvt_pk_bf16_f32 v234, v236, v237
v_cvt_pk_bf16_f32 v235, v238, v239
v_mfma_f32_16x16x32_bf16 v[92:95], v[42:45], v[176:179], 0
TR 224,19,512
TR 226,19,2560
v_mfma_f32_16x16x32_bf16 v[104:107], v[40:43], a[156:159], 0
s_waitcnt vmcnt(2)
v_cmp_eq_u32 vcc, 0, v37
s_cbranch_vccnz Lp5
Lq5:
v_mfma_f32_16x16x32_bf16 v[108:111], v[40:43], v[176:179], 0
TR 228,20,512
TR 230,20,2560
v_mfma_f32_16x16x32_bf16 v[120:123], v[42:45], v[180:183], 0
s_xor_b32 s84, s42, 20480
s_add_u32 s84, s84, 163840
buffer_load_dwordx4 a[252:255], v14, s[28:31], s84 offen sc1
v_mfma_f32_16x16x32_bf16 v[124:127], v[42:45], v[184:187], 0
TR 232,15,12288
TR 234,15,14336
v_mfma_f32_16x16x32_bf16 v[136:139], v[40:43], v[180:183], 0
buffer_load_dwordx4 a[28:31], v14, s[28:31], s84 offen offset:1024 sc1
v_mfma_f32_16x16x32_bf16 v[140:143], v[40:43], v[184:187], 0
s_waitcnt lgkmcnt(6)
TR 236,16,12288
TR 238,16,14336
Mvaa 88,240,208
buffer_load_dwordx4 a[32:35], v14, s[28:31], s84 offen offset:2048 sc1
Mvaa 92,240,212
TR 240,15,12800
TR 242,15,14848
Mvaa 104,244,208
buffer_load_dwordx4 a[36:39], v14, s[28:31], s84 offen offset:3072 sc1
Mvaa 108,244,212
X20:
s_cbranch_execz Xe
s_waitcnt lgkmcnt(6)
TR 244,16,12800
TR 246,16,14848
Mvaa 120,224,208
s_xor_b32 s84, s37, 20480
buffer_load_dwordx4 a[40:43], v14, s[28:31], s84 offen sc1
Mvaa 124,224,212
TR 224,15,16384
TR 226,15,18432
Mvaa 136,228,208
buffer_store_dwordx4 v[232:235], v14, s[28:31], s44 offen offset:1024 sc1
Mvaa 140,228,212
s_waitcnt lgkmcnt(6)
TR 228,16,16384
TR 230,16,18432
Mvaa 88,232,216
v_cvt_pk_bf16_f32 v240, v240, v241
v_cvt_pk_bf16_f32 v241, v242, v243
Mvaa 92,232,220
TR 232,15,16896
TR 234,15,18944
Mvaa 104,236,216
v_cvt_pk_bf16_f32 v242, v244, v245
v_cvt_pk_bf16_f32 v243, v246, v247
Mvaa 108,236,220
s_waitcnt lgkmcnt(6)
TR 236,16,16896
TR 238,16,18944
Mvaa 120,240,216
buffer_store_dwordx4 v[240:243], v14, s[28:31], s44 offen offset:2048 sc1
Mvaa 124,240,220
TR 240,15,24576
TR 242,15,26624
Mvaa 136,244,216
v_cvt_pk_bf16_f32 v248, v248, v249
v_cvt_pk_bf16_f32 v249, v250, v251
Mvaa 140,244,220
s_waitcnt lgkmcnt(6)
TR 244,16,24576
TR 246,16,26624
Mvaa 88,224,248
v_cvt_pk_bf16_f32 v250, v252, v253
v_cvt_pk_bf16_f32 v251, v254, v255
Mvaa 92,224,0
TR 224,15,25088
TR 226,15,27136
Mvaa 104,228,248
buffer_store_dwordx4 v[248:251], v14, s[28:31], s44 offen offset:3072 sc1
Mvaa 108,228,0
s_waitcnt lgkmcnt(6)
TR 228,16,25088
TR 230,16,27136
Mvaa 120,232,248
buffer_load_dword v38, off, s[28:31], s35 offset:768 sc1
Mvaa 124,232,0
TR 232,17,16384
TR 234,17,18432
Mvaa 136,236,248
Mvaa 140,236,0
s_waitcnt lgkmcnt(6)
TR 236,18,16384
TR 238,18,18432
Mvaa 88,240,4
Mvaa 92,240,8
TR 240,17,16896
TR 242,17,18944
Mvaa 104,244,4
Mvaa 108,244,8
s_waitcnt lgkmcnt(6)
TR 244,18,16896
TR 246,18,18944
Mvaa 120,224,4
Mvaa 124,224,8
TR 224,19,4096
TR 226,19,6144
Mvaa 136,228,4
Mvaa 140,228,8
s_waitcnt lgkmcnt(6)
TR 228,20,4096
TR 230,20,6144
Mvaa 88,232,12
Mvaa 92,232,16
TR 232,19,4608
TR 234,19,6656
Mvaa 104,236,12
Mvaa 108,236,16
s_waitcnt lgkmcnt(6)
TR 236,20,4608
TR 238,20,6656
Mvaa 120,240,12
Mvaa 124,240,16
TR 240,19,8192
TR 242,19,10240
Mvaa 136,244,12
Mvaa 140,244,16
s_waitcnt lgkmcnt(6)
TR 244,20,8192
TR 246,20,10240
Mvaa 88,224,20
Mvaa 92,224,24
TR 224,19,8704
TR 226,19,10752
Mvaa 104,228,20
Mvaa 108,228,24
s_waitcnt lgkmcnt(6)
X21:
s_cbranch_execz Xe
TR 228,20,8704
TR 230,20,10752
Mvaa 120,232,20
s_barrier
Mvaa 124,232,24
TR 232,19,12288
TR 234,19,14336
Mvaa 136,236,20
Mvaa 140,236,24
s_waitcnt lgkmcnt(6)
TR 236,20,12288
TR 238,20,14336
Mvav 88,240,80
Mvav 92,240,84
TR 240,19,12800
TR 242,19,14848
Mvav 104,244,80
Mvav 108,244,84
s_waitcnt lgkmcnt(6)
TR 244,20,12800
TR 246,20,14848
Mvav 120,224,80
Mvav 124,224,84
TR 224,17,20480
TR 226,17,22528
Mvav 136,228,80
Mvav 140,228,84
s_waitcnt lgkmcnt(6)
TR 228,18,20480
TR 230,18,22528
XR2:
s_cbranch_execz Xe
Mvav 88,232,96
Mvav 92,232,100
TR 232,17,20992
TR 234,17,23040
Mvav 104,236,96
s_waitcnt vmcnt(1)
s_xor_b32 s63, s35, 28672
s_mov_b64 exec, 1
buffer_store_dword v13, off, s[28:31], s63 offset:896 sc1
s_mov_b64 exec, -1
Mvav 108,236,100
s_waitcnt lgkmcnt(6)
TR 236,18,20992
TR 238,18,23040
Mvav 120,240,96
buffer_load_dword v39, off, s[28:31], s35 offset:896 sc1
Mvav 124,240,100
TR 240,17,28672
TR 242,17,30720
Mvav 136,244,96
Mvav 140,244,100
s_waitcnt lgkmcnt(6)
TR 244,18,28672
TR 246,18,30720
Mvav 88,224,112
Mvav 92,224,116
TR 224,17,29184
TR 226,17,31232
Mvav 104,228,112
Mvav 108,228,116
s_waitcnt lgkmcnt(6)
TR 228,18,29184
TR 230,18,31232
Mvav 120,232,112
Mvav 124,232,116
TR 232,19,16384
TR 234,19,18432
Mvav 136,236,112
Mvav 140,236,116
s_waitcnt lgkmcnt(6)
TR 236,20,16384
TR 238,20,18432
Mvav 88,240,128
Mvav 92,240,132
TR 240,19,16896
TR 242,19,18944
Mvav 104,244,128
Mvav 108,244,132
s_waitcnt lgkmcnt(6)
TR 244,20,16896
TR 246,20,18944
Mvav 120,224,128
Mvav 124,224,132
TR 224,19,20480
TR 226,19,22528
Mvav 136,228,128
Mvav 140,228,132
s_waitcnt lgkmcnt(6)
TR 228,20,20480
TR 230,20,22528
Mvav 88,232,144
s_waitcnt vmcnt(2)
v_cmp_eq_u32 vcc, 0, v38
s_cbranch_vccz Lq6
Lp6:
s_sub_u32 s41, s41, 1
s_cbranch_scc1 Lf6
buffer_load_dword v38, off, s[28:31], s35 offset:768 sc1
s_waitcnt vmcnt(0)
v_cmp_eq_u32 vcc, 0, v38
s_cbranch_vccnz Lp6
Lq6:
Mvav 92,232,148
TR 232,19,20992
TR 234,19,23040
Mvav 104,236,144
s_xor_b32 s84, s42, 24576
s_add_u32 s84, s84, 196608
buffer_load_dwordx4 v[176:179], v14, s[28:31], s84 offen sc1
Mvav 108,236,148
s_waitcnt lgkmcnt(6)
TR 236,20,20992
TR 238,20,23040
X22:
s_cbranch_execz Xe
Mvav 120,240,144
buffer_load_dwordx4 v[180:183], v14, s[28:31], s84 offen offset:1024 sc1
Mvav 124,240,148
buffer_load_dwordx4 v[184:187], v14, s[28:31], s84 offen offset:2048 sc1
Mvav 136,244,144
buffer_load_dwordx4 a[208:211], v14, s[28:31], s84 offen offset:3072 sc1
Mvav 140,244,148
s_waitcnt lgkmcnt(4)
s_xor_b32 s84, s37, 24576
buffer_load_dwordx4 a[212:215], v14, s[28:31], s84 offen sc1
Mvav 88,224,160
Mvav 92,224,164
Mvav 104,228,160
Mvav 108,228,164
s_waitcnt lgkmcnt(0)
Mvav 120,232,160
Mvav 124,232,164
Mvav 136,236,160
Mvav 140,236,164
v_mfma_f32_16x16x32_bf16 v[152:155], v[42:45], v[188:191], 0
v_mfma_f32_16x16x32_bf16 v[156:159], v[40:43], v[188:191], 0
Mvvv 88,42,192
Mvvv 92,40,192
Mvvv 104,42,196
Mvvv 108,40,196
Mvvv 120,42,200
Mvvv 124,40,200
Mvvv 136,42,204
Mvvv 140,40,204
Mvvv 152,42,208
Mvvv 156,40,208
Mvvv 88,42,212
s_barrier
Mvvv 92,40,212
Mvvv 104,42,216
Mvvv 108,40,216
Mvvv 120,42,220
Mvvv 124,40,220
Mvva 136,42,160
Mvva 140,40,160
Mvva 152,42,164
s_waitcnt vmcnt(5)
v_cmp_eq_u32 vcc, 0, v39
s_cbranch_vccz Lq7
Lp7:
s_sub_u32 s41, s41, 1
s_cbranch_scc1 Lf7
buffer_load_dword v39, off, s[28:31], s35 offset:896 sc1
s_waitcnt vmcnt(0)
v_cmp_eq_u32 vcc, 0, v39
s_cbranch_vccnz Lp7
Lq7:
s_xor_b32 s84, s42, 28672
s_add_u32 s84, s84, 229376
buffer_load_dwordx4 v[188:191], v14, s[28:31], s84 offen sc1
buffer_load_dwordx4 v[192:195], v14, s[28:31], s84 offen offset:1024 sc1
buffer_load_dwordx4 v[196:199], v14, s[28:31], s84 offen offset:2048 sc1
buffer_load_dwordx4 v[200:203], v14, s[28:31], s84 offen offset:3072 sc1
s_xor_b32 s84, s37, 28672
buffer_load_dwordx4 v[204:207], v14, s[28:31], s84 offen sc1
Mvva 156,40,164
Mvva 88,42,168
Mvva 92,40,168
Mvva 104,42,172
Mvva 108,40,172
Mvva 120,42,176
Mvva 124,40,176
Mvva 136,42,180
Mvva 140,40,180
Mvva 152,42,184
Mvva 156,40,184
Mvva 88,42,188
Mvva 92,40,188
Mvva 104,42,192
Mvva 108,40,192
Mvva 120,42,196
Mvva 124,40,196
Mvva 136,42,200
Mvva 140,40,200
Mvva 152,42,204
Mvva 156,40,204
Mvva 88,42,252
Mvva 92,40,252
Mvva 104,42,28
Mvva 108,40,28
Mvva 120,42,32
Mvva 124,40,32
Mvva 136,42,36
Mvva 140,40,36
Mvva 152,42,40
Mvva 156,40,40
s_waitcnt vmcnt(9)
Mvvv 88,42,176
Mvvv 92,40,176
s_waitcnt vmcnt(8)
Mvvv 104,42,180
Mvvv 108,40,180
s_waitcnt vmcnt(7)
Mvvv 120,42,184
Mvvv 124,40,184
s_waitcnt vmcnt(6)
Mvva 136,42,208
Mvva 140,40,208
s_waitcnt vmcnt(5)
Mvva 152,42,212
Mvva 156,40,212
s_waitcnt vmcnt(4)
Mvvv 88,42,188
Mvvv 92,40,188
s_waitcnt vmcnt(3)
X23:
s_cbranch_execz Xe
Mvvv 104,42,192
v_cvt_pk_bf16_f32 v88, v88, v89
v_cvt_pk_bf16_f32 v89, v90, v91
Mvvv 108,40,192
s_waitcnt vmcnt(2)
v_cvt_pk_bf16_f32 v92, v92, v93
v_cvt_pk_bf16_f32 v93, v94, v95
Mvvv 120,42,196
v_cvt_pk_bf16_f32 v90, v104, v105
v_cvt_pk_bf16_f32 v91, v106, v107
Mvvv 124,40,196
s_waitcnt vmcnt(1)
v_permlane16_swap_b32 v88, v90
v_permlane16_swap_b32 v89, v91
Mvvv 136,42,200
buffer_store_dwordx4 v[88:91], v21, s[4:7], s60 offen nt
Mvvv 140,40,200
s_waitcnt vmcnt(1)
v_cvt_pk_bf16_f32 v94, v108, v109
v_cvt_pk_bf16_f32 v95, v110, v111
Mvvv 152,42,204
v_permlane16_swap_b32 v92, v94
v_permlane16_swap_b32 v93, v95
Mvvv 156,40,204
buffer_store_dwordx4 v[92:95], v21, s[4:7], s61 offen nt
v_cvt_pk_bf16_f32 v120, v120, v121
v_cvt_pk_bf16_f32 v121, v122, v123
v_cvt_pk_bf16_f32 v122, v136, v137
v_cvt_pk_bf16_f32 v123, v138, v139
s_nop 0
v_permlane16_swap_b32 v120, v122
v_permlane16_swap_b32 v121, v123
buffer_store_dwordx4 v[120:123], v21, s[4:7], s60 offen offset:64 nt
v_cvt_pk_bf16_f32 v124, v124, v125
v_cvt_pk_bf16_f32 v125, v126, v127
v_cvt_pk_bf16_f32 v126, v140, v141
v_cvt_pk_bf16_f32 v127, v142, v143
s_nop 0
v_permlane16_swap_b32 v124, v126
v_permlane16_swap_b32 v125, v127
buffer_store_dwordx4 v[124:127], v21, s[4:7], s61 offen offset:64 nt
v_cvt_pk_bf16_f32 v152, v152, v153
v_cvt_pk_bf16_f32 v153, v154, v155
v_cvt_pk_bf16_f32 v154, v156, v157
s_nop 1
v_permlane16_swap_b32 v152, v154
v_cvt_pk_bf16_f32 v155, v158, v159
s_nop 1
v_permlane16_swap_b32 v153, v155
buffer_store_dwordx4 v[152:155], v22, s[4:7], s62 offen nt
v_mov_b32 v25, s47
ds_write_b32 v13, v25 offset:61440
v_lshlrev_b32 v26, 6, v14
v_and_b32 v26, 0xc00, v26
v_add_u32 v26, 159744, v26
s_waitcnt lgkmcnt(0)
s_barrier
ds_read_b32 v25, v26
s_waitcnt lgkmcnt(0)
v_cmp_ne_u32 vcc, 0, v25
s_cbranch_vccnz L_again
L_fin:
s_endpgm
Lf1:
s_mov_b32 s41, 0
s_mov_b32 s47, 1
s_branch Lq1
Lp1:
s_sub_u32 s41, s41, 1
s_cbranch_scc1 Lf1
buffer_load_dword v33, off, s[28:31], s35 offset:128 sc1
s_waitcnt vmcnt(0)
v_cmp_eq_u32 vcc, 0, v33
s_cbranch_vccnz Lp1
s_branch Lq1
Lf2:
s_mov_b32 s41, 0
s_mov_b32 s47, 1
s_branch Lq2
Lp2:
s_sub_u32 s41, s41, 1
s_cbranch_scc1 Lf2
buffer_load_dword v34, off, s[28:31], s35 offset:256 sc1
s_waitcnt vmcnt(0)
v_cmp_eq_u32 vcc, 0, v34
s_cbranch_vccnz Lp2
s_branch Lq2
Lf3:
s_mov_b32 s41, 0
s_mov_b32 s47, 1
s_branch Lq3
Lp3:
s_sub_u32 s41, s41, 1
s_cbranch_scc1 Lf3
buffer_load_dword v35, off, s[28:31], s35 offset:384 sc1
s_waitcnt vmcnt(0)
v_cmp_eq_u32 vcc, 0, v35
s_cbranch_vccnz Lp3
s_branch Lq3
Lf4:
s_mov_b32 s41, 0
s_mov_b32 s47, 1
s_branch Lq4
Lp4:
s_sub_u32 s41, s41, 1
s_cbranch_scc1 Lf4
buffer_load_dword v36, off, s[28:31], s35 offset:512 sc1
s_waitcnt vmcnt(0)
v_cmp_eq_u32 vcc, 0, v36
s_cbranch_vccnz Lp4
s_branch Lq4
Lf5:
s_mov_b32 s41, 0
s_mov_b32 s47, 1
s_branch Lq5
Lp5:
s_sub_u32 s41, s41, 1
s_cbranch_scc1 Lf5
buffer_load_dword v37, off, s[28:31], s35 offset:640 sc1
s_waitcnt vmcnt(0)
v_cmp_eq_u32 vcc, 0, v37
s_cbranch_vccnz Lp5
s_branch Lq5
Lf6:
s_mov_b32 s41, 0
s_mov_b32 s47, 1
s_branch Lq6
Lf7:
s_mov_b32 s41, 0
s_mov_b32 s47, 1
s_branch Lq7
L_again:
s_cmp_eq_u32 s3, 8
s_cbranch_scc1 L_fin
s_add_u32 s3, s3, 1
v_lshrrev_b32 v0, 4, v13
v_and_b32 v0, 0xff, v0
s_waitcnt vmcnt(0)
s_barrier
s_branch L_go
L_hop:
s_branch L_B
Tv19:
s_branch Tc19
Tw19:
s_branch Tr19
Tv20:
s_branch Tc20
Tw20:
s_branch Tr20
Tv21:
s_branch Tc21
Tw21:
s_branch Tr21
Lr0:
s_movk_i32 s48, 0
s_branch LR1
Lr1:
s_movk_i32 s48, 1
s_branch LR2
Lr2:
s_movk_i32 s48, 2
s_branch LR0
Lr3:
s_movk_i32 s48, 3
s_branch LR2
Lr4:
s_movk_i32 s48, 4
s_branch LR0
Lr5:
s_movk_i32 s48, 5
s_branch LR2
Lr6:
s_movk_i32 s48, 6
s_branch LR0
Lr7:
s_movk_i32 s48, 7
s_branch LR2
Lr8:
s_movk_i32 s48, 8
s_branch LR0
Lr9:
s_movk_i32 s48, 9
s_branch LR2
Lr10:
s_movk_i32 s48, 10
s_branch LR0
Lr11:
s_movk_i32 s48, 11
s_branch LR2
Lr12:
s_movk_i32 s48, 12
s_branch LR0
Lr13:
s_movk_i32 s48, 13
s_branch LR2
Lr14:
s_movk_i32 s48, 14
s_branch LR0
Lr15:
s_movk_i32 s48, 15
s_branch LR2
Lr16:
s_movk_i32 s48, 16
s_branch LR1
Lr17:
s_movk_i32 s48, 17
s_branch LR2
Lr18:
s_movk_i32 s48, 18
s_branch LR0
Lr19:
s_movk_i32 s48, 19
s_branch LR2
Lr20:
s_movk_i32 s48, 20
s_branch LR0
Lr21:
s_movk_i32 s48, 21
s_branch LR2
Lr22:
s_movk_i32 s48, 22
s_branch LR0
Lr23:
s_movk_i32 s48, 23
s_branch LR2
Lr24:
s_movk_i32 s48, 24
s_branch LR0
Lr25:
s_movk_i32 s48, 25
s_branch LR2
Lr26:
s_movk_i32 s48, 26
s_branch LR0
Lr27:
s_movk_i32 s48, 27
s_branch LR2
Lr28:
s_movk_i32 s48, 28
s_branch LR0
Lr29:
s_movk_i32 s48, 29
s_branch LR2
Lr30:
s_movk_i32 s48, 30
s_branch LR0
Lr31:
s_movk_i32 s48, 31
s_branch LR2
Lr32:
s_movk_i32 s48, 32
s_branch LR1
Lr33:
s_movk_i32 s48, 33
s_branch LR2
Lr34:
s_movk_i32 s48, 34
s_branch LR0
Lr35:
s_movk_i32 s48, 35
s_branch LR2
Lr36:
s_movk_i32 s48, 36
s_branch LR0
Lr37:
s_movk_i32 s48, 37
s_branch LR2
Lr38:
s_movk_i32 s48, 38
s_branch LR0
Lr39:
s_movk_i32 s48, 39
s_branch LR2
Lr40:
s_movk_i32 s48, 40
s_branch LR0
Lr41:
s_movk_i32 s48, 41
s_branch LR2
Lr42:
s_movk_i32 s48, 42
s_branch LR0
Lr43:
s_movk_i32 s48, 43
s_branch LR2
Lr44:
s_movk_i32 s48, 44
s_branch LR0
Lr45:
s_movk_i32 s48, 45
s_branch LR2
Lr46:
s_movk_i32 s48, 46
s_branch LR0
Lr47:
s_movk_i32 s48, 47
s_branch LR2
Lr48:
s_movk_i32 s48, 48
s_branch LR1
Lr49:
s_movk_i32 s48, 49
s_branch LR2
Lr50:
s_movk_i32 s48, 50
s_branch LR0
Lr51:
s_movk_i32 s48, 51
s_branch LR2
Lr52:
s_movk_i32 s48, 52
s_branch LR0
Lr53:
s_movk_i32 s48, 53
s_branch LR2
Lr54:
s_movk_i32 s48, 54
s_branch LR0
Lr55:
s_movk_i32 s48, 55
s_branch LR2
Lr56:
s_movk_i32 s48, 56
s_branch LR0
Lr57:
s_movk_i32 s48, 57
s_branch LR2
Lr58:
s_movk_i32 s48, 58
s_branch LR0
Lr59:
s_movk_i32 s48, 59
s_branch LR2
Lr60:
s_movk_i32 s48, 60
s_branch LR0
Lr61:
s_movk_i32 s48, 61
s_branch LR2
Lr62:
s_movk_i32 s48, 62
s_branch LR0
Lr63:
s_movk_i32 s48, 63
s_branch LR2
LR0:
s_nop 15
v_max3_f32 v33, v48, v49, v50
v_max3_f32 v33, v33, v51, v52
v_max3_f32 v33, v33, v53, v54
v_max_f32 v33, v33, v55
v_max3_f32 v34, v56, v57, v58
v_max3_f32 v34, v34, v59, v60
v_max3_f32 v34, v34, v61, v62
v_max_f32 v34, v34, v63
s_nop 1
v_permlane32_swap_b32 v33, v34
v_max_f32 v33, v33, v34
v_mov_b32 v34, v33
s_nop 1
v_permlane16_swap_b32 v33, v34
v_max_f32 v33, v33, v34
s_nop 1
s_cmp_eq_u32 s39, -1.0
s_cbranch_scc1 LM00
v_mov_b32 v21, 0
v_permlane32_swap_b32 v32, v36
v_mov_b32 v22, v32
s_nop 1
LM00:
v_max_f32 v33, v33, v21
v_sub_f32 v35, v21, v33
v_exp_f32 v35, v35
s_nop 0
v_mul_f32 v22, v22, v35
v_mov_b32 v37, v35
s_nop 1
v_permlane32_swap_b32 v35, v37
v_mov_b32 v21, v33
v_mov_b32 v34, v33
s_nop 1
v_permlane32_swap_b32 v33, v34
v_sub_f32 v48, v48, v33
v_sub_f32 v49, v49, v33
v_sub_f32 v50, v50, v33
v_sub_f32 v51, v51, v33
v_sub_f32 v52, v52, v33
v_sub_f32 v53, v53, v33
v_sub_f32 v54, v54, v33
v_sub_f32 v55, v55, v33
v_mul_f32 v80, v80, v35
v_mul_f32 v81, v81, v35
v_mul_f32 v82, v82, v35
v_mul_f32 v83, v83, v35
v_mul_f32 v88, v88, v35
v_mul_f32 v89, v89, v35
v_mul_f32 v90, v90, v35
v_mul_f32 v91, v91, v35
v_mul_f32 v96, v96, v35
v_mul_f32 v97, v97, v35
v_mul_f32 v98, v98, v35
v_mul_f32 v99, v99, v35
v_mul_f32 v104, v104, v35
v_mul_f32 v105, v105, v35
v_mul_f32 v106, v106, v35
v_mul_f32 v107, v107, v35
v_mul_f32 v112, v112, v35
v_mul_f32 v113, v113, v35
v_mul_f32 v114, v114, v35
v_mul_f32 v115, v115, v35
v_mul_f32 v120, v120, v35
v_mul_f32 v121, v121, v35
v_mul_f32 v122, v122, v35
v_mul_f32 v123, v123, v35
v_mul_f32 v128, v128, v35
v_mul_f32 v129, v129, v35
v_mul_f32 v130, v130, v35
v_mul_f32 v131, v131, v35
v_mul_f32 v136, v136, v35
v_mul_f32 v137, v137, v35
v_mul_f32 v138, v138, v35
v_mul_f32 v139, v139, v35
v_mul_f32 v144, v144, v35
v_mul_f32 v145, v145, v35
v_mul_f32 v146, v146, v35
v_mul_f32 v147, v147, v35
v_mul_f32 v152, v152, v35
v_mul_f32 v153, v153, v35
v_mul_f32 v154, v154, v35
v_mul_f32 v155, v155, v35
v_mul_f32 v160, v160, v35
v_mul_f32 v161, v161, v35
v_mul_f32 v162, v162, v35
v_mul_f32 v163, v163, v35
v_mul_f32 v168, v168, v35
v_mul_f32 v169, v169, v35
v_mul_f32 v170, v170, v35
v_mul_f32 v171, v171, v35
v_sub_f32 v56, v56, v34
v_sub_f32 v57, v57, v34
v_sub_f32 v58, v58, v34
v_sub_f32 v59, v59, v34
v_sub_f32 v60, v60, v34
v_sub_f32 v61, v61, v34
v_sub_f32 v62, v62, v34
v_sub_f32 v63, v63, v34
v_mul_f32 v84, v84, v37
v_mul_f32 v85, v85, v37
v_mul_f32 v86, v86, v37
v_mul_f32 v87, v87, v37
v_mul_f32 v92, v92, v37
v_mul_f32 v93, v93, v37
v_mul_f32 v94, v94, v37
v_mul_f32 v95, v95, v37
v_mul_f32 v100, v100, v37
v_mul_f32 v101, v101, v37
v_mul_f32 v102, v102, v37
v_mul_f32 v103, v103, v37
v_mul_f32 v108, v108, v37
v_mul_f32 v109, v109, v37
v_mul_f32 v110, v110, v37
v_mul_f32 v111, v111, v37
v_mul_f32 v116, v116, v37
v_mul_f32 v117, v117, v37
v_mul_f32 v118, v118, v37
v_mul_f32 v119, v119, v37
v_mul_f32 v124, v124, v37
v_mul_f32 v125, v125, v37
v_mul_f32 v126, v126, v37
v_mul_f32 v127, v127, v37
v_mul_f32 v132, v132, v37
v_mul_f32 v133, v133, v37
v_mul_f32 v134, v134, v37
v_mul_f32 v135, v135, v37
v_mul_f32 v140, v140, v37
v_mul_f32 v141, v141, v37
v_mul_f32 v142, v142, v37
v_mul_f32 v143, v143, v37
v_mul_f32 v148, v148, v37
v_mul_f32 v149, v149, v37
v_mul_f32 v150, v150, v37
v_mul_f32 v151, v151, v37
v_mul_f32 v156, v156, v37
v_mul_f32 v157, v157, v37
v_mul_f32 v158, v158, v37
v_mul_f32 v159, v159, v37
v_mul_f32 v164, v164, v37
v_mul_f32 v165, v165, v37
v_mul_f32 v166, v166, v37
v_mul_f32 v167, v167, v37
v_mul_f32 v172, v172, v37
v_mul_f32 v173, v173, v37
v_mul_f32 v174, v174, v37
v_mul_f32 v175, v175, v37
v_exp_f32 v48, v48
v_exp_f32 v49, v49
s_nop 0
v_cvt_pk_bf16_f32 v40, v48, v49
v_exp_f32 v50, v50
v_exp_f32 v51, v51
s_nop 0
v_cvt_pk_bf16_f32 v41, v50, v51
v_exp_f32 v52, v52
v_exp_f32 v53, v53
s_nop 0
v_cvt_pk_bf16_f32 v42, v52, v53
v_exp_f32 v54, v54
v_exp_f32 v55, v55
s_nop 0
v_cvt_pk_bf16_f32 v43, v54, v55
v_add_f32 v48, v48, v49
v_add_f32 v48, v48, v50
v_add_f32 v48, v48, v51
v_add_f32 v48, v48, v52
v_add_f32 v48, v48, v53
v_add_f32 v48, v48, v54
v_add_f32 v48, v48, v55
v_exp_f32 v56, v56
v_exp_f32 v57, v57
s_nop 0
v_cvt_pk_bf16_f32 v44, v56, v57
v_exp_f32 v58, v58
v_exp_f32 v59, v59
s_nop 0
v_cvt_pk_bf16_f32 v45, v58, v59
v_exp_f32 v60, v60
v_exp_f32 v61, v61
s_nop 0
v_cvt_pk_bf16_f32 v46, v60, v61
v_exp_f32 v62, v62
v_exp_f32 v63, v63
s_nop 0
v_cvt_pk_bf16_f32 v47, v62, v63
v_add_f32 v56, v56, v57
v_add_f32 v56, v56, v58
v_add_f32 v56, v56, v59
v_add_f32 v56, v56, v60
v_add_f32 v56, v56, v61
v_add_f32 v56, v56, v62
v_add_f32 v56, v56, v63
s_nop 1
v_permlane32_swap_b32 v48, v56
v_add_f32 v48, v48, v56
v_mov_b32 v56, v48
s_nop 1
v_permlane16_swap_b32 v48, v56
v_add_f32 v48, v48, v56
v_cmp_lt_f32 vcc, 0x42700000, v21
s_nop 1
v_cndmask_b32 v33, v22, v48, vcc
v_add_f32 v22, v22, v48
s_nop 1
s_cmp_eq_u32 s39, -1.0
s_cbranch_scc1 LN00
v_mov_b32 v22, v33
s_nop 1
LN00:
v_mov_b32 v32, v22
v_mov_b32 v36, v22
s_nop 1
v_permlane32_swap_b32 v32, v36
s_mov_b32 s39, -1.0
s_nop 3
s_cmp_eq_u32 s48, 2
s_cbranch_scc1 Lb2
s_cmp_eq_u32 s48, 4
s_cbranch_scc1 Lb4
s_cmp_eq_u32 s48, 6
s_cbranch_scc1 Lb6
s_cmp_eq_u32 s48, 8
s_cbranch_scc1 Lb8
s_cmp_eq_u32 s48, 10
s_cbranch_scc1 Lb10
s_cmp_eq_u32 s48, 12
s_cbranch_scc1 Lb12
s_cmp_eq_u32 s48, 14
s_cbranch_scc1 Lb14
s_cmp_eq_u32 s48, 18
s_cbranch_scc1 Lb18
s_cmp_eq_u32 s48, 20
s_cbranch_scc1 Lb20
s_cmp_eq_u32 s48, 22
s_cbranch_scc1 Lb22
s_cmp_eq_u32 s48, 24
s_cbranch_scc1 Lb24
s_cmp_eq_u32 s48, 26
s_cbranch_scc1 Lb26
s_cmp_eq_u32 s48, 28
s_cbranch_scc1 Lb28
s_cmp_eq_u32 s48, 30
s_cbranch_scc1 Lb30
s_cmp_eq_u32 s48, 34
s_cbranch_scc1 Lb34
s_cmp_eq_u32 s48, 36
s_cbranch_scc1 Lb36
s_cmp_eq_u32 s48, 38
s_cbranch_scc1 Lb38
s_cmp_eq_u32 s48, 40
s_cbranch_scc1 Lb40
s_cmp_eq_u32 s48, 42
s_cbranch_scc1 Lb42
s_cmp_eq_u32 s48, 44
s_cbranch_scc1 Lb44
s_cmp_eq_u32 s48, 46
s_cbranch_scc1 Lb46
s_cmp_eq_u32 s48, 50
s_cbranch_scc1 Lb50
s_cmp_eq_u32 s48, 52
s_cbranch_scc1 Lb52
s_cmp_eq_u32 s48, 54
s_cbranch_scc1 Lb54
s_cmp_eq_u32 s48, 56
s_cbranch_scc1 Lb56
s_cmp_eq_u32 s48, 58
s_cbranch_scc1 Lb58
s_cmp_eq_u32 s48, 60
s_cbranch_scc1 Lb60
s_branch Lb62
LR1:
s_nop 15
v_max3_f32 v33, v48, v49, v50
v_max3_f32 v33, v33, v51, v52
v_max3_f32 v33, v33, v53, v54
v_max_f32 v33, v33, v55
v_max3_f32 v34, v56, v57, v58
v_max3_f32 v34, v34, v59, v60
v_max3_f32 v34, v34, v61, v62
v_max_f32 v34, v34, v63
s_nop 1
v_permlane32_swap_b32 v33, v34
v_max_f32 v33, v33, v34
v_mov_b32 v34, v33
s_nop 1
v_permlane16_swap_b32 v33, v34
v_max_f32 v33, v33, v34
v_mov_b32 v21, v33
v_mov_b32 v34, v33
s_nop 1
v_permlane32_swap_b32 v33, v34
v_sub_f32 v48, v48, v33
v_sub_f32 v49, v49, v33
v_sub_f32 v50, v50, v33
v_sub_f32 v51, v51, v33
v_sub_f32 v52, v52, v33
v_sub_f32 v53, v53, v33
v_sub_f32 v54, v54, v33
v_sub_f32 v55, v55, v33
v_sub_f32 v56, v56, v34
v_sub_f32 v57, v57, v34
v_sub_f32 v58, v58, v34
v_sub_f32 v59, v59, v34
v_sub_f32 v60, v60, v34
v_sub_f32 v61, v61, v34
v_sub_f32 v62, v62, v34
v_sub_f32 v63, v63, v34
v_exp_f32 v48, v48
v_exp_f32 v49, v49
s_nop 0
v_cvt_pk_bf16_f32 v40, v48, v49
v_exp_f32 v50, v50
v_exp_f32 v51, v51
s_nop 0
v_cvt_pk_bf16_f32 v41, v50, v51
v_exp_f32 v52, v52
v_exp_f32 v53, v53
s_nop 0
v_cvt_pk_bf16_f32 v42, v52, v53
v_exp_f32 v54, v54
v_exp_f32 v55, v55
s_nop 0
v_cvt_pk_bf16_f32 v43, v54, v55
v_add_f32 v48, v48, v49
v_add_f32 v48, v48, v50
v_add_f32 v48, v48, v51
v_add_f32 v48, v48, v52
v_add_f32 v48, v48, v53
v_add_f32 v48, v48, v54
v_add_f32 v48, v48, v55
v_exp_f32 v56, v56
v_exp_f32 v57, v57
s_nop 0
v_cvt_pk_bf16_f32 v44, v56, v57
v_exp_f32 v58, v58
v_exp_f32 v59, v59
s_nop 0
v_cvt_pk_bf16_f32 v45, v58, v59
v_exp_f32 v60, v60
v_exp_f32 v61, v61
s_nop 0
v_cvt_pk_bf16_f32 v46, v60, v61
v_exp_f32 v62, v62
v_exp_f32 v63, v63
s_nop 0
v_cvt_pk_bf16_f32 v47, v62, v63
v_add_f32 v56, v56, v57
v_add_f32 v56, v56, v58
v_add_f32 v56, v56, v59
v_add_f32 v56, v56, v60
v_add_f32 v56, v56, v61
v_add_f32 v56, v56, v62
v_add_f32 v56, v56, v63
s_nop 1
v_permlane32_swap_b32 v48, v56
v_add_f32 v48, v48, v56
v_mov_b32 v56, v48
s_nop 1
v_permlane16_swap_b32 v48, v56
v_add_f32 v48, v48, v56
v_mov_b32 v22, v48
v_mov_b32 v32, v22
v_mov_b32 v36, v22
s_nop 1
v_permlane32_swap_b32 v32, v36
s_mov_b32 s39, -1.0
s_nop 3
s_cmp_eq_u32 s48, 0
s_cbranch_scc1 Lb0
s_cmp_eq_u32 s48, 16
s_cbranch_scc1 Lb16
s_cmp_eq_u32 s48, 32
s_cbranch_scc1 Lb32
s_branch Lb48
LR2:
s_nop 15
v_max3_f32 v33, v64, v65, v66
v_max3_f32 v33, v33, v67, v68
v_max3_f32 v33, v33, v69, v70
v_max_f32 v33, v33, v71
v_max3_f32 v34, v72, v73, v74
v_max3_f32 v34, v34, v75, v76
v_max3_f32 v34, v34, v77, v78
v_max_f32 v34, v34, v79
s_nop 1
v_permlane32_swap_b32 v33, v34
v_max_f32 v33, v33, v34
v_mov_b32 v34, v33
s_nop 1
v_permlane16_swap_b32 v33, v34
v_max_f32 v33, v33, v34
s_nop 1
s_cmp_eq_u32 s39, -1.0
s_cbranch_scc1 LM10
v_mov_b32 v21, 0
v_permlane32_swap_b32 v32, v36
v_mov_b32 v22, v32
s_nop 1
LM10:
v_max_f32 v33, v33, v21
v_sub_f32 v35, v21, v33
v_exp_f32 v35, v35
s_nop 0
v_mul_f32 v22, v22, v35
v_mov_b32 v37, v35
s_nop 1
v_permlane32_swap_b32 v35, v37
v_mov_b32 v21, v33
v_mov_b32 v34, v33
s_nop 1
v_permlane32_swap_b32 v33, v34
v_sub_f32 v64, v64, v33
v_sub_f32 v65, v65, v33
v_sub_f32 v66, v66, v33
v_sub_f32 v67, v67, v33
v_sub_f32 v68, v68, v33
v_sub_f32 v69, v69, v33
v_sub_f32 v70, v70, v33
v_sub_f32 v71, v71, v33
v_mul_f32 v80, v80, v35
v_mul_f32 v81, v81, v35
v_mul_f32 v82, v82, v35
v_mul_f32 v83, v83, v35
v_mul_f32 v88, v88, v35
v_mul_f32 v89, v89, v35
v_mul_f32 v90, v90, v35
v_mul_f32 v91, v91, v35
v_mul_f32 v96, v96, v35
v_mul_f32 v97, v97, v35
v_mul_f32 v98, v98, v35
v_mul_f32 v99, v99, v35
v_mul_f32 v104, v104, v35
v_mul_f32 v105, v105, v35
v_mul_f32 v106, v106, v35
v_mul_f32 v107, v107, v35
v_mul_f32 v112, v112, v35
v_mul_f32 v113, v113, v35
v_mul_f32 v114, v114, v35
v_mul_f32 v115, v115, v35
v_mul_f32 v120, v120, v35
v_mul_f32 v121, v121, v35
v_mul_f32 v122, v122, v35
v_mul_f32 v123, v123, v35
v_mul_f32 v128, v128, v35
v_mul_f32 v129, v129, v35
v_mul_f32 v130, v130, v35
v_mul_f32 v131, v131, v35
v_mul_f32 v136, v136, v35
v_mul_f32 v137, v137, v35
v_mul_f32 v138, v138, v35
v_mul_f32 v139, v139, v35
v_mul_f32 v144, v144, v35
v_mul_f32 v145, v145, v35
v_mul_f32 v146, v146, v35
v_mul_f32 v147, v147, v35
v_mul_f32 v152, v152, v35
v_mul_f32 v153, v153, v35
v_mul_f32 v154, v154, v35
v_mul_f32 v155, v155, v35
v_mul_f32 v160, v160, v35
v_mul_f32 v161, v161, v35
v_mul_f32 v162, v162, v35
v_mul_f32 v163, v163, v35
v_mul_f32 v168, v168, v35
v_mul_f32 v169, v169, v35
v_mul_f32 v170, v170, v35
v_mul_f32 v171, v171, v35
v_sub_f32 v72, v72, v34
v_sub_f32 v73, v73, v34
v_sub_f32 v74, v74, v34
v_sub_f32 v75, v75, v34
v_sub_f32 v76, v76, v34
v_sub_f32 v77, v77, v34
v_sub_f32 v78, v78, v34
v_sub_f32 v79, v79, v34
v_mul_f32 v84, v84, v37
v_mul_f32 v85, v85, v37
v_mul_f32 v86, v86, v37
v_mul_f32 v87, v87, v37
v_mul_f32 v92, v92, v37
v_mul_f32 v93, v93, v37
v_mul_f32 v94, v94, v37
v_mul_f32 v95, v95, v37
v_mul_f32 v100, v100, v37
v_mul_f32 v101, v101, v37
v_mul_f32 v102, v102, v37
v_mul_f32 v103, v103, v37
v_mul_f32 v108, v108, v37
v_mul_f32 v109, v109, v37
v_mul_f32 v110, v110, v37
v_mul_f32 v111, v111, v37
v_mul_f32 v116, v116, v37
v_mul_f32 v117, v117, v37
v_mul_f32 v118, v118, v37
v_mul_f32 v119, v119, v37
v_mul_f32 v124, v124, v37
v_mul_f32 v125, v125, v37
v_mul_f32 v126, v126, v37
v_mul_f32 v127, v127, v37
v_mul_f32 v132, v132, v37
v_mul_f32 v133, v133, v37
v_mul_f32 v134, v134, v37
v_mul_f32 v135, v135, v37
v_mul_f32 v140, v140, v37
v_mul_f32 v141, v141, v37
v_mul_f32 v142, v142, v37
v_mul_f32 v143, v143, v37
v_mul_f32 v148, v148, v37
v_mul_f32 v149, v149, v37
v_mul_f32 v150, v150, v37
v_mul_f32 v151, v151, v37
v_mul_f32 v156, v156, v37
v_mul_f32 v157, v157, v37
v_mul_f32 v158, v158, v37
v_mul_f32 v159, v159, v37
v_mul_f32 v164, v164, v37
v_mul_f32 v165, v165, v37
v_mul_f32 v166, v166, v37
v_mul_f32 v167, v167, v37
v_mul_f32 v172, v172, v37
v_mul_f32 v173, v173, v37
v_mul_f32 v174, v174, v37
v_mul_f32 v175, v175, v37
v_exp_f32 v64, v64
v_exp_f32 v65, v65
s_nop 0
v_cvt_pk_bf16_f32 v28, v64, v65
v_exp_f32 v66, v66
v_exp_f32 v67, v67
s_nop 0
v_cvt_pk_bf16_f32 v29, v66, v67
v_exp_f32 v68, v68
v_exp_f32 v69, v69
s_nop 0
v_cvt_pk_bf16_f32 v30, v68, v69
v_exp_f32 v70, v70
v_exp_f32 v71, v71
s_nop 0
v_cvt_pk_bf16_f32 v31, v70, v71
v_add_f32 v64, v64, v65
v_add_f32 v64, v64, v66
v_add_f32 v64, v64, v67
v_add_f32 v64, v64, v68
v_add_f32 v64, v64, v69
v_add_f32 v64, v64, v70
v_add_f32 v64, v64, v71
v_exp_f32 v72, v72
v_exp_f32 v73, v73
s_nop 0
v_cvt_pk_bf16_f32 v0, v72, v73
v_exp_f32 v74, v74
v_exp_f32 v75, v75
s_nop 0
v_cvt_pk_bf16_f32 v1, v74, v75
v_exp_f32 v76, v76
v_exp_f32 v77, v77
s_nop 0
v_cvt_pk_bf16_f32 v2, v76, v77
v_exp_f32 v78, v78
v_exp_f32 v79, v79
s_nop 0
v_cvt_pk_bf16_f32 v3, v78, v79
v_add_f32 v72, v72, v73
v_add_f32 v72, v72, v74
v_add_f32 v72, v72, v75
v_add_f32 v72, v72, v76
v_add_f32 v72, v72, v77
v_add_f32 v72, v72, v78
v_add_f32 v72, v72, v79
s_nop 1
v_permlane32_swap_b32 v64, v72
v_add_f32 v64, v64, v72
v_mov_b32 v72, v64
s_nop 1
v_permlane16_swap_b32 v64, v72
v_add_f32 v64, v64, v72
v_cmp_lt_f32 vcc, 0x42700000, v21
s_nop 1
v_cndmask_b32 v33, v22, v64, vcc
v_add_f32 v22, v22, v64
s_nop 1
s_cmp_eq_u32 s39, -1.0
s_cbranch_scc1 LN10
v_mov_b32 v22, v33
s_nop 1
LN10:
v_mov_b32 v32, v22
v_mov_b32 v36, v22
s_nop 1
v_permlane32_swap_b32 v32, v36
s_mov_b32 s39, -1.0
s_nop 3
s_cmp_eq_u32 s48, 1
s_cbranch_scc1 Lb1
s_cmp_eq_u32 s48, 3
s_cbranch_scc1 Lb3
s_cmp_eq_u32 s48, 5
s_cbranch_scc1 Lb5
s_cmp_eq_u32 s48, 7
s_cbranch_scc1 Lb7
s_cmp_eq_u32 s48, 9
s_cbranch_scc1 Lb9
s_cmp_eq_u32 s48, 11
s_cbranch_scc1 Lb11
s_cmp_eq_u32 s48, 13
s_cbranch_scc1 Lb13
s_cmp_eq_u32 s48, 15
s_cbranch_scc1 Lb15
s_cmp_eq_u32 s48, 17
s_cbranch_scc1 Lb17
s_cmp_eq_u32 s48, 19
s_cbranch_scc1 Lb19
s_cmp_eq_u32 s48, 21
s_cbranch_scc1 Lb21
s_cmp_eq_u32 s48, 23
s_cbranch_scc1 Lb23
s_cmp_eq_u32 s48, 25
s_cbranch_scc1 Lb25
s_cmp_eq_u32 s48, 27
s_cbranch_scc1 Lb27
s_cmp_eq_u32 s48, 29
s_cbranch_scc1 Lb29
s_cmp_eq_u32 s48, 31
s_cbranch_scc1 Lb31
s_cmp_eq_u32 s48, 33
s_cbranch_scc1 Lb33
s_cmp_eq_u32 s48, 35
s_cbranch_scc1 Lb35
s_cmp_eq_u32 s48, 37
s_cbranch_scc1 Lb37
s_cmp_eq_u32 s48, 39
s_cbranch_scc1 Lb39
s_cmp_eq_u32 s48, 41
s_cbranch_scc1 Lb41
s_cmp_eq_u32 s48, 43
s_cbranch_scc1 Lb43
s_cmp_eq_u32 s48, 45
s_cbranch_scc1 Lb45
s_cmp_eq_u32 s48, 47
s_cbranch_scc1 Lb47
s_cmp_eq_u32 s48, 49
s_cbranch_scc1 Lb49
s_cmp_eq_u32 s48, 51
s_cbranch_scc1 Lb51
s_cmp_eq_u32 s48, 53
s_cbranch_scc1 Lb53
s_cmp_eq_u32 s48, 55
s_cbranch_scc1 Lb55
s_cmp_eq_u32 s48, 57
s_cbranch_scc1 Lb57
s_cmp_eq_u32 s48, 59
s_cbranch_scc1 Lb59
s_cmp_eq_u32 s48, 61
s_cbranch_scc1 Lb61
s_branch Lb63
.globl attn_kernel
.p2align 12
.type attn_kernel,@function
attn_kernel:
s_cmp_ge_u32 s2, 256
s_mov_b32 s3, 0
s_cbranch_scc0 L_go
s_endpgm
L_go:
s_load_dwordx16 s[64:79], s[0:1], 0
s_load_dwordx4 s[80:83], s[0:1], 64
s_load_dwordx2 s[84:85], s[0:1], 96
s_load_dwordx2 s[4:5], s[0:1], 80
s_and_b32 s58, s2, 7
s_lshr_b32 s59, s2, 3
s_lshr_b32 s50, s58, 2
s_and_b32 s51, s58, 3
s_lshl_b32 s51, s51, 1
s_and_b32 s52, s59, 1
s_add_u32 s51, s51, s52
s_add_u32 s51, s51, s3
s_and_b32 s51, s51, 7
s_lshr_b32 s52, s59, 1
v_lshrrev_b32 v1, 6, v0
v_and_b32 v2, 63, v0
s_nop 0
v_readfirstlane_b32 s46, v1
s_lshl_b32 s53, s52, 5
s_lshl_b32 s54, s51, 2
s_add_u32 s53, s53, s54
s_mul_i32 s32, s53, 196608
s_mov_b32 s33, s32
s_mul_i32 s60, s54, 384
s_mul_i32 s61, s54, 245760
s_mul_i32 s62, s52, 163840
s_mul_i32 s55, s52, 10
s_lshr_b32 s55, s55, 4
s_lshl_b32 s36, s55, 7
s_and_b32 s56, s59, 1
s_mul_i32 s56, s56, 5
s_add_u32 s55, s55, s56
s_sub_u32 s56, s55, 10
s_min_u32 s55, s55, s56
s_lshl_b32 s34, s55, 7
s_lshl_b32 s38, s46, 10
s_lshl_b32 s88, s59, 2
s_add_u32 s88, s88, s46
s_and_b32 s88, s88, 31
s_mov_b32 s39, 0x4b800000
s_mov_b32 s40, 0x3dd53b95
s_movk_i32 s56, 0x78
s_movk_i32 s57, 0xd8
v_and_b32 v96, 3, v2
v_bfe_u32 v97, v2, 2, 3
v_lshrrev_b32 v98, 5, v2
v_lshrrev_b32 v99, 2, v97
v_lshlrev_b32 v102, 1, v99
v_xor_b32 v102, v102, v96
v_lshlrev_b32 v102, 4, v102
v_lshl_add_u32 v102, v98, 6, v102
v_and_b32 v103, 1, v1
v_lshlrev_b32 v104, 4, v103
v_lshl_add_u32 v104, v99, 3, v104
v_lshrrev_b32 v105, 1, v1
v_lshl_add_u32 v104, v105, 2, v104
v_and_b32 v105, 3, v97
v_add_u32 v104, v104, v105
v_mul_u32_u24 v104, 12288, v104
v_add3_u32 v6, v104, v102, s60
v_lshl_add_u32 v106, v1, 3, v97
v_mul_u32_u24 v107, 1280, v106
v_add3_u32 v7, v107, v102, s61
v_lshrrev_b32 v107, 4, v106
v_mul_u32_u24 v107, 240, v107
v_add_u32 v107, v107, v106
v_mul_u32_u24 v107, 384, v107
v_add_u32 v5, v107, v102
v_lshl_add_u32 v108, v103, 1, v99
v_lshlrev_b32 v108, 1, v108
v_bfe_u32 v108, s56, v108, 2
v_xor_b32 v108, v108, v96
v_mul_u32_u24 v100, 1280, v106
v_lshl_add_u32 v100, v108, 4, v100
v_lshl_add_u32 v100, v98, 6, v100
v_add_u32 v8, s62, v100
v_lshlrev_b32 v108, 1, v108
v_bfe_u32 v108, s57, v108, 2
v_lshl_add_u32 v107, v108, 4, v107
v_lshl_add_u32 v4, v98, 6, v107
v_add_u32 v4, s32, v4
v_add_u32 v5, s32, v5
s_mul_i32 s55, s51, 5
s_add_u32 s55, s55, s52
s_mul_i32 s55, s55, 1
s_and_b32 s55, s55, 15
s_mul_i32 s32, s55, 6144
s_mov_b32 s33, s32
s_waitcnt lgkmcnt(0)
s_cmp_eq_u32 s50, 0
s_cselect_b32 s24, s64, s74
s_cselect_b32 s25, s65, s75
s_mov_b32 s26, 2621440
s_mov_b32 s27, 0x00020000
s_cselect_b32 s16, s70, s80
s_cselect_b32 s17, s71, s81
s_mov_b32 s18, 7864320
s_mov_b32 s19, 0x00020000
s_cselect_b32 s8, s66, s76
s_cselect_b32 s9, s67, s77
s_mov_b32 s10, 100663296
s_mov_b32 s11, 0x00020000
s_cselect_b32 s12, s68, s78
s_cselect_b32 s13, s69, s79
s_mov_b32 s14, 100663296
s_mov_b32 s15, 0x00020000
s_cselect_b32 s20, s72, s82
s_cselect_b32 s21, s73, s83
s_mov_b32 s22, 7864320
s_mov_b32 s23, 0x00020000
s_mov_b32 s28, s84
s_mov_b32 s29, s85
s_mov_b32 s30, 439353344
s_mov_b32 s31, 0x00020000
s_add_u32 m0, s38, 147456
s_nop 0
buffer_load_dwordx4 v8, s[24:27], s34 offen lds
s_add_u32 s43, s34, 40960
s_add_u32 m0, s38, 151552
s_nop 0
buffer_load_dwordx4 v8, s[24:27], s43 offen lds
s_add_u32 s43, s34, 81920
s_add_u32 m0, s38, 155648
s_nop 0
buffer_load_dwordx4 v8, s[24:27], s43 offen lds
s_add_u32 s43, s34, 122880
s_add_u32 m0, s38, 159744
s_nop 0
buffer_load_dwordx4 v8, s[24:27], s43 offen lds
s_mul_i32 s64, s34, 6144
s_add_u32 s65, s64, 393216
s_add_u32 s34, s34, 128
s_sub_u32 s45, s34, 1280
s_min_u32 s34, s34, s45
s_add_u32 m0, s38, 110592
s_nop 0
buffer_load_dwordx4 v6, s[16:19], s64 offen lds
s_add_u32 m0, s38, 102272
s_nop 0
buffer_load_dwordx4 v6, s[16:19], s64 offen offset:128 lds
s_add_u32 m0, s38, 106240
s_nop 0
buffer_load_dwordx4 v6, s[16:19], s64 offen offset:256 lds
v_and_b32 v96, 15, v2
v_lshrrev_b32 v97, 4, v2
v_lshrrev_b32 v98, 2, v96
v_lshlrev_b32 v99, 1, v98
v_bfe_u32 v99, s56, v99, 2
v_xor_b32 v99, v99, v97
v_lshlrev_b32 v99, 4, v99
v_lshl_add_u32 v100, v96, 6, v99
v_lshrrev_b32 v101, 3, v96
v_lshl_add_u32 v9, v101, 9, v100
v_lshl_add_u32 v14, v1, 12, v9
v_add_u32 v14, 98304, v14
v_lshlrev_b32 v13, 4, v0
v_add_u32 v13, 98304, v13
v_lshrrev_b32 v102, 1, v97
v_lshlrev_b32 v102, 10, v102
v_and_b32 v103, 1, v97
v_mul_u32_u24 v103, 288, v103
v_add_u32 v102, v102, v103
v_lshl_add_u32 v102, v98, 6, v102
v_and_b32 v103, 3, v2
v_lshl_add_u32 v15, v103, 3, v102
v_xor_b32 v16, 32, v15
v_add_u32 v10, 49152, v9
v_add_u32 v17, 49152, v15
v_add_u32 v18, 49152, v16
v_add_u32 v11, 98304, v9
v_add_u32 v19, 98304, v15
v_add_u32 v20, 98304, v16
s_lshl_b32 s55, s50, 4
s_add_u32 s55, s55, s52
s_add_u32 s56, s2, 32
s_cmp_eq_u32 s3, 0
s_cselect_b32 s55, s55, s56
s_cselect_b32 s41, 4096, 0
s_cselect_b32 s63, 0, 1024
s_lshl_b32 s55, s55, 2
s_add_u32 s55, s55, s46
s_mul_i32 s42, s55, 360448
s_lshl_b32 s56, s51, 12
s_add_u32 s42, s42, s56
s_add_u32 s35, s42, 327680
s_add_u32 s63, s63, s35
s_lshr_b32 s55, s51, 2
s_and_b32 s56, s51, 3
s_lshl_b32 s57, s55, 5
s_add_u32 s57, s57, s56
s_lshl_b32 s57, s57, 10
s_add_u32 s37, s42, s57
s_add_u32 s37, s37, 262144
s_and_b32 s47, s3, 7
s_cselect_b32 s6, 0, 5242880
s_mov_b32 s7, 0x00020000
s_lshl_b32 s57, s52, 2
s_add_u32 s57, s57, s46
s_mul_i32 s57, s57, 81920
s_mul_i32 s58, s50, 1280
s_add_u32 s61, s57, s58
s_lshl_b32 s55, s55, 7
s_add_u32 s55, s55, s36
s_add_u32 s57, s55, 1024
s_sub_u32 s55, s55, 256
s_min_u32 s55, s55, s57
s_lshl_b32 s56, s56, 5
s_add_u32 s55, s55, s56
s_add_u32 s62, s61, s55
s_lshl_b32 s85, s51, 7
s_xor_b32 s50, s85, 0
s_add_u32 s50, s50, s36
s_sub_u32 s49, s50, 1280
s_min_u32 s50, s50, s49
s_xor_b32 s51, s85, 128
s_add_u32 s51, s51, s36
s_sub_u32 s49, s51, 1280
s_min_u32 s51, s51, s49
s_xor_b32 s52, s85, 256
s_add_u32 s52, s52, s36
s_sub_u32 s49, s52, 1280
s_min_u32 s52, s52, s49
s_xor_b32 s53, s85, 384
s_add_u32 s53, s53, s36
s_sub_u32 s49, s53, 1280
s_min_u32 s53, s53, s49
s_xor_b32 s54, s85, 512
s_add_u32 s54, s54, s36
s_sub_u32 s49, s54, 1280
s_min_u32 s54, s54, s49
s_xor_b32 s55, s85, 640
s_add_u32 s55, s55, s36
s_sub_u32 s49, s55, 1280
s_min_u32 s55, s55, s49
s_xor_b32 s56, s85, 768
s_add_u32 s56, s56, s36
s_sub_u32 s49, s56, 1280
s_min_u32 s56, s56, s49
s_xor_b32 s57, s85, 896
s_add_u32 s57, s57, s36
s_sub_u32 s49, s57, 1280
s_min_u32 s57, s57, s49
s_add_u32 s58, s36, 1024
s_sub_u32 s49, s58, 1280
s_min_u32 s58, s58, s49
s_add_u32 s59, s36, 1152
s_sub_u32 s49, s59, 1280
s_min_u32 s59, s59, s49
s_add_u32 s60, s61, s50
s_add_u32 s61, s60, 40960
s_mov_b64 exec, 0
s_cmp_eq_u32 s46, 0
s_cbranch_scc1 Tc0
s_cmp_eq_u32 s46, 1
s_cbranch_scc1 Tc1
s_cmp_eq_u32 s46, 2
s_cbranch_scc1 Tc2
s_cmp_eq_u32 s46, 3
s_cbranch_scc1 Tc3
Tdone0:
s_mov_b64 exec, -1
s_add_u32 m0, s38, 0
s_nop 0
buffer_load_dwordx4 v6, s[16:19], s65 offen lds
s_add_u32 m0, s38, 3968
s_nop 0
buffer_load_dwordx4 v6, s[16:19], s65 offen offset:128 lds
s_add_u32 m0, s38, 7936
s_nop 0
buffer_load_dwordx4 v6, s[16:19], s65 offen offset:256 lds
s_add_u32 m0, s38, 131072
s_nop 0
buffer_load_dwordx4 v8, s[24:27], s34 offen lds
s_add_u32 s43, s34, 40960
s_add_u32 m0, s38, 135168
s_nop 0
buffer_load_dwordx4 v8, s[24:27], s43 offen lds
s_add_u32 s43, s34, 81920
s_add_u32 m0, s38, 139264
s_nop 0
buffer_load_dwordx4 v8, s[24:27], s43 offen lds
s_add_u32 s43, s34, 122880
s_add_u32 m0, s38, 143360
s_nop 0
buffer_load_dwordx4 v8, s[24:27], s43 offen lds
s_mul_i32 s66, s34, 6144
s_add_u32 s67, s66, 393216
s_add_u32 s34, s34, 128
s_sub_u32 s45, s34, 1280
s_min_u32 s34, s34, s45
s_mov_b64 exec, 0
s_cmp_eq_u32 s46, 0
s_cbranch_scc1 Tc4
s_cmp_eq_u32 s46, 1
s_cbranch_scc1 Tc5
s_cmp_eq_u32 s46, 2
s_cbranch_scc1 Tc6
s_cmp_eq_u32 s46, 3
s_cbranch_scc1 Tc7
Tdone1:
s_mov_b64 exec, -1
s_add_u32 m0, s38, 12288
s_nop 0
buffer_load_dwordx4 v4, s[8:11], s32 offen nt lds
s_add_u32 m0, s38, 16256
s_nop 0
buffer_load_dwordx4 v4, s[8:11], s32 offen offset:128 nt lds
s_add_u32 m0, s38, 20224
s_nop 0
buffer_load_dwordx4 v4, s[8:11], s32 offen offset:256 nt lds
s_add_u32 s32, s32, 6144
s_sub_u32 s45, s32, 98304
s_min_u32 s32, s32, s45
s_add_u32 m0, s38, 24576
s_nop 0
buffer_load_dwordx4 v6, s[16:19], s66 offen lds
s_add_u32 m0, s38, 28544
s_nop 0
buffer_load_dwordx4 v6, s[16:19], s66 offen offset:128 lds
s_add_u32 m0, s38, 32512
s_nop 0
buffer_load_dwordx4 v6, s[16:19], s66 offen offset:256 lds
s_add_u32 m0, s38, 36864
s_nop 0
buffer_load_dwordx4 v6, s[16:19], s67 offen lds
s_mov_b64 exec, 0
s_cmp_eq_u32 s46, 0
s_cbranch_scc1 Tc8
s_cmp_eq_u32 s46, 1
s_cbranch_scc1 Tc9
s_cmp_eq_u32 s46, 2
s_cbranch_scc1 Tc10
s_cmp_eq_u32 s46, 3
s_cbranch_scc1 Tc11
Tdone2:
s_mov_b64 exec, -1
s_waitcnt vmcnt(14)
s_barrier
TR 224,19,12288
TR 226,19,14336
ds_read_b128 a[0:3], v14 offset:49152
TR 228,20,12288
TR 230,20,14336
ds_read_b128 a[4:7], v14 offset:51200
TR 232,19,12800
TR 234,19,14848
TR 236,20,12800
TR 238,20,14848
TR 240,19,4096
TR 242,19,6144
TR 244,20,4096
TR 246,20,6144
s_waitcnt lgkmcnt(8)
v_mfma_f32_16x16x32_bf16 v[80:83], a[224:227], a[0:3], 0
s_add_u32 m0, s38, 40832
s_nop 0
buffer_load_dwordx4 v6, s[16:19], s67 offen offset:128 lds
v_mfma_f32_16x16x32_bf16 v[84:87], a[224:227], a[4:7], 0
s_add_u32 m0, s38, 44800
TR 224,19,4608
TR 226,19,6656
v_mfma_f32_16x16x32_bf16 v[88:91], a[228:231], a[0:3], 0
buffer_load_dwordx4 v6, s[16:19], s67 offen offset:256 lds
v_mfma_f32_16x16x32_bf16 v[92:95], a[228:231], a[4:7], 0
s_waitcnt lgkmcnt(6)
TR 228,20,4608
TR 230,20,6656
v_mfma_f32_16x16x32_bf16 v[96:99], a[232:235], a[0:3], 0
s_add_u32 m0, s38, 114688
s_nop 0
buffer_load_dwordx4 v8, s[24:27], s34 offen lds
v_mfma_f32_16x16x32_bf16 v[100:103], a[232:235], a[4:7], 0
s_add_u32 s43, s34, 40960
TR 232,19,8192
TR 234,19,10240
v_mfma_f32_16x16x32_bf16 v[104:107], a[236:239], a[0:3], 0
s_add_u32 m0, s38, 118784
s_nop 0
buffer_load_dwordx4 v8, s[24:27], s43 offen lds
v_mfma_f32_16x16x32_bf16 v[108:111], a[236:239], a[4:7], 0
s_waitcnt lgkmcnt(6)
TR 236,20,8192
TR 238,20,10240
v_and_b32 v21, 0x3ff, v13
v_mov_b32 v24, 0
buffer_store_dword v24, v21, s[28:31], s63 offen sc1
v_mfma_f32_16x16x32_bf16 v[112:115], a[240:243], a[0:3], 0
s_add_u32 s43, s34, 81920
v_mov_b32 v24, 0x3f803f80
v_accvgpr_write_b32 a252, v24
v_mfma_f32_16x16x32_bf16 v[116:119], a[240:243], a[4:7], 0
s_add_u32 m0, s38, 122880
TR 240,19,8704
TR 242,19,10752
v_mfma_f32_16x16x32_bf16 v[120:123], a[244:247], a[0:3], 0
buffer_load_dwordx4 v8, s[24:27], s43 offen lds
v_mfma_f32_16x16x32_bf16 v[124:127], a[244:247], a[4:7], 0
s_waitcnt vmcnt(17) lgkmcnt(6)
TR 244,20,8704
TR 246,20,10752
v_mfma_f32_16x16x32_bf16 v[128:131], a[224:227], a[0:3], 0
s_barrier
v_mfma_f32_16x16x32_bf16 v[132:135], a[224:227], a[4:7], 0
s_add_u32 s43, s34, 122880
TR 224,15,0
TR 226,15,2048
v_mfma_f32_16x16x32_bf16 v[136:139], a[228:231], a[0:3], 0
s_add_u32 m0, s38, 126976
ds_read_b128 a[8:11], v14 offset:49664
v_accvgpr_write_b32 a253, v24
v_mfma_f32_16x16x32_bf16 v[140:143], a[228:231], a[4:7], 0
s_waitcnt lgkmcnt(7)
TR 228,16,0
TR 230,16,2048
v_mfma_f32_16x16x32_bf16 v[144:147], a[232:235], a[0:3], 0
ds_read_b128 a[12:15], v14 offset:51712
v_accvgpr_write_b32 a254, v24
v_mfma_f32_16x16x32_bf16 v[148:151], a[232:235], a[4:7], 0
TR 232,15,512
TR 234,15,2560
v_mfma_f32_16x16x32_bf16 v[152:155], a[236:239], a[0:3], 0
buffer_load_dwordx4 v8, s[24:27], s43 offen lds
v_mfma_f32_16x16x32_bf16 v[156:159], a[236:239], a[4:7], 0
s_waitcnt lgkmcnt(8)
TR 236,16,512
TR 238,16,2560
v_mfma_f32_16x16x32_bf16 v[160:163], a[240:243], a[0:3], 0
s_mul_i32 s68, s34, 6144
v_accvgpr_write_b32 a255, v24
s_add_u32 s69, s68, 393216
v_mfma_f32_16x16x32_bf16 v[164:167], a[240:243], a[4:7], 0
s_add_u32 s34, s34, 128
TR 240,15,4096
TR 242,15,6144
v_mfma_f32_16x16x32_bf16 v[168:171], a[244:247], a[0:3], 0
s_sub_u32 s45, s34, 1280
s_min_u32 s34, s34, s45
s_add_u32 m0, s38, 110592
v_mfma_f32_16x16x32_bf16 v[172:175], a[244:247], a[4:7], 0
s_waitcnt lgkmcnt(6)
TR 244,16,4096
TR 246,16,6144
Mvaa 80,224,8
buffer_load_dwordx4 v4, s[8:11], s32 offen nt lds
Mvaa 84,224,12
s_add_u32 m0, s38, 49024
TR 224,15,4608
TR 226,15,6656
Mvaa 88,228,8
buffer_load_dwordx4 v4, s[8:11], s32 offen offset:128 nt lds
Mvaa 92,228,12
s_waitcnt lgkmcnt(6)
TR 228,16,4608
TR 230,16,6656
Mvaa 96,232,8
s_add_u32 m0, s38, 53248
s_nop 0
buffer_load_dwordx4 v6, s[16:19], s68 offen lds
Mvaa 100,232,12
s_add_u32 m0, s38, 57216
TR 232,15,8192
TR 234,15,10240
Mvaa 104,236,8
buffer_load_dwordx4 v6, s[16:19], s68 offen offset:128 lds
Mvaa 108,236,12
s_waitcnt lgkmcnt(6)
TR 236,16,8192
TR 238,16,10240
Mvaa 112,240,8
s_add_u32 m0, s38, 61184
s_nop 0
buffer_load_dwordx4 v6, s[16:19], s68 offen offset:256 lds
Mvaa 116,240,12
TR 240,15,8704
TR 242,15,10752
Mvaa 120,244,8
Mvaa 124,244,12
s_waitcnt vmcnt(13) lgkmcnt(6)
TR 244,16,8704
TR 246,16,10752
Mvaa 128,224,8
s_barrier
Mvaa 132,224,12
TR 224,15,24576
TR 226,15,26624
Mvaa 136,228,8
ds_read_b128 a[16:19], v14 offset:32768
Mvaa 140,228,12
s_waitcnt lgkmcnt(7)
TR 228,16,24576
TR 230,16,26624
Mvaa 144,232,8
ds_read_b128 a[20:23], v14 offset:34816
Mvaa 148,232,12
TR 232,15,25088
TR 234,15,27136
Mvaa 152,236,8
Mvaa 156,236,12
s_waitcnt lgkmcnt(8)
TR 236,16,25088
TR 238,16,27136
Mvaa 160,240,8
Mvaa 164,240,12
TR 240,15,28672
TR 242,15,30720
Mvaa 168,244,8
s_add_u32 m0, s38, 102400
Mvaa 172,244,12
s_waitcnt lgkmcnt(6)
TR 244,16,28672
TR 246,16,30720
Mvaa 80,224,16
buffer_load_dwordx4 v6, s[16:19], s69 offen lds
Mvaa 84,224,20
s_add_u32 m0, s38, 106368
TR 224,15,29184
TR 226,15,31232
Mvaa 88,228,16
buffer_load_dwordx4 v6, s[16:19], s69 offen offset:128 lds
Mvaa 92,228,20
s_waitcnt lgkmcnt(6)
TR 228,16,29184
TR 230,16,31232
Mvaa 96,232,16
s_add_u32 s43, s69, 256
s_add_u32 m0, s38, 0
Mvaa 100,232,20
TR 232,15,32768
TR 234,15,34816
Mvaa 104,236,16
buffer_load_dwordx4 v6, s[16:19], s43 offen lds
Mvaa 108,236,20
s_waitcnt lgkmcnt(6)
TR 236,16,32768
TR 238,16,34816
Mvaa 112,240,16
s_add_u32 m0, s38, 147456
s_nop 0
buffer_load_dwordx4 v8, s[24:27], s34 offen lds
Mvaa 116,240,20
s_add_u32 s43, s34, 40960
TR 240,15,33280
TR 242,15,35328
Mvaa 120,244,16
s_add_u32 m0, s38, 151552
s_nop 0
buffer_load_dwordx4 v8, s[24:27], s43 offen lds
Mvaa 124,244,20
s_waitcnt vmcnt(15) lgkmcnt(6)
TR 244,16,33280
TR 246,16,35328
Mvaa 128,224,16
s_barrier
Mvaa 132,224,20
s_add_u32 s43, s34, 81920
TR 224,15,36864
TR 226,15,38912
Mvaa 136,228,16
s_add_u32 m0, s38, 155648
ds_read_b128 a[24:27], v14 offset:33280
Mvaa 140,228,20
s_waitcnt lgkmcnt(7)
TR 228,16,36864
TR 230,16,38912
Mvaa 144,232,16
ds_read_b128 a[28:31], v14 offset:35328
Mvaa 148,232,20
TR 232,15,37376
TR 234,15,39424
Mvaa 152,236,16
buffer_load_dwordx4 v8, s[24:27], s43 offen lds
Mvaa 156,236,20
s_waitcnt lgkmcnt(8)
TR 236,16,37376
TR 238,16,39424
Mvaa 160,240,16
s_add_u32 s43, s34, 122880
s_add_u32 m0, s38, 159744
Mvaa 164,240,20
TR 240,15,40960
TR 242,15,43008
Mvaa 168,244,16
buffer_load_dwordx4 v8, s[24:27], s43 offen lds
Mvaa 172,244,20
s_waitcnt lgkmcnt(6)
TR 244,16,40960
TR 246,16,43008
Mvaa 80,224,24
s_mul_i32 s70, s34, 6144
s_add_u32 s71, s70, 393216
s_add_u32 s34, s34, 128
Mvaa 84,224,28
s_sub_u32 s45, s34, 1280
TR 224,15,41472
TR 226,15,43520
Mvaa 88,228,24
s_min_u32 s34, s34, s45
s_add_u32 m0, s38, 4096
Mvaa 92,228,28
s_waitcnt lgkmcnt(6)
TR 228,16,41472
TR 230,16,43520
Mvaa 96,232,24
buffer_load_dwordx4 v6, s[16:19], s70 offen lds
Mvaa 100,232,28
s_add_u32 m0, s38, 8064
TR 232,15,45056
TR 234,15,47104
Mvaa 104,236,24
buffer_load_dwordx4 v6, s[16:19], s70 offen offset:128 lds
Mvaa 108,236,28
s_waitcnt lgkmcnt(6)
TR 236,16,45056
TR 238,16,47104
Mvaa 112,240,24
s_add_u32 m0, s38, 24320
s_nop 0
buffer_load_dwordx4 v6, s[16:19], s70 offen offset:256 lds
Mvaa 116,240,28
TR 240,15,45568
TR 242,15,47616
Mvaa 120,244,24
Mvaa 124,244,28
s_waitcnt vmcnt(10) lgkmcnt(6)
TR 244,16,45568
TR 246,16,47616
Tc0:
s_cbranch_execz Tdone0
Mvaa 128,224,24
s_barrier
Mvaa 132,224,28
TR 224,17,4096
TR 226,17,6144
Mvaa 136,228,24
ds_read_b128 a[32:35], v14 offset:16384
Mvaa 140,228,28
s_waitcnt lgkmcnt(7)
TR 228,18,4096
TR 230,18,6144
Mvaa 144,232,24
ds_read_b128 a[36:39], v14 offset:18432
Mvaa 148,232,28
TR 232,17,4608
TR 234,17,6656
Mvaa 152,236,24
Mvaa 156,236,28
s_waitcnt lgkmcnt(8)
TR 236,18,4608
TR 238,18,6656
Mvaa 160,240,24
Mvaa 164,240,28
TR 240,17,8192
TR 242,17,10240
Mvaa 168,244,24
s_add_u32 m0, s38, 28672
Mvaa 172,244,28
s_waitcnt lgkmcnt(6)
TR 244,18,8192
TR 246,18,10240
Mvaa 80,224,32
buffer_load_dwordx4 v6, s[16:19], s71 offen lds
Mvaa 84,224,36
s_add_u32 m0, s38, 32640
TR 224,17,8704
TR 226,17,10752
Mvaa 88,228,32
buffer_load_dwordx4 v6, s[16:19], s71 offen offset:128 lds
Mvaa 92,228,36
s_waitcnt lgkmcnt(6)
TR 228,18,8704
TR 230,18,10752
Mvaa 96,232,32
s_add_u32 m0, s38, 36608
s_nop 0
buffer_load_dwordx4 v6, s[16:19], s71 offen offset:256 lds
Mvaa 100,232,36
s_add_u32 m0, s38, 131072
TR 232,17,12288
TR 234,17,14336
Mvaa 104,236,32
buffer_load_dwordx4 v8, s[24:27], s34 offen lds
Mvaa 108,236,36
s_waitcnt lgkmcnt(6)
TR 236,18,12288
TR 238,18,14336
Mvaa 112,240,32
s_add_u32 s43, s34, 40960
s_add_u32 m0, s38, 135168
Mvaa 116,240,36
TR 240,17,12800
TR 242,17,14848
Mvaa 120,244,32
buffer_load_dwordx4 v8, s[24:27], s43 offen lds
Mvaa 124,244,36
s_waitcnt vmcnt(12) lgkmcnt(6)
TR 244,18,12800
TR 246,18,14848
Mvaa 128,224,32
s_barrier
Mvaa 132,224,36
s_add_u32 s43, s34, 81920
TR 224,19,4096
TR 226,19,6144
Mvaa 136,228,32
s_add_u32 m0, s38, 139264
ds_read_b128 a[40:43], v14 offset:16896
Mvaa 140,228,36
s_waitcnt lgkmcnt(7)
TR 228,20,4096
TR 230,20,6144
Mvaa 144,232,32
ds_read_b128 a[44:47], v14 offset:18944
Mvaa 148,232,36
TR 232,19,4608
TR 234,19,6656
Mvaa 152,236,32
buffer_load_dwordx4 v8, s[24:27], s43 offen lds
Mvaa 156,236,36
s_waitcnt lgkmcnt(8)
TR 236,20,4608
TR 238,20,6656
Mvaa 160,240,32
s_add_u32 s43, s34, 122880
s_add_u32 m0, s38, 143360
Mvaa 164,240,36
TR 240,19,8192
TR 242,19,10240
Mvaa 168,244,32
buffer_load_dwordx4 v8, s[24:27], s43 offen lds
Mvaa 172,244,36
s_waitcnt lgkmcnt(6)
TR 244,20,8192
TR 246,20,10240
Mvaa 80,224,40
s_mul_i32 s72, s34, 6144
s_add_u32 s73, s72, 393216
s_add_u32 s34, s34, 128
Mvaa 84,224,44
s_sub_u32 s45, s34, 1280
TR 224,19,8704
TR 226,19,10752
Mvaa 88,228,40
s_min_u32 s34, s34, s45
s_add_u32 m0, s38, 40960
Mvaa 92,228,44
s_waitcnt lgkmcnt(6)
TR 228,20,8704
TR 230,20,10752
Mvaa 96,232,40
buffer_load_dwordx4 v6, s[16:19], s72 offen lds
Mvaa 100,232,44
s_add_u32 m0, s38, 44928
TR 232,15,0
TR 234,15,2048
Mvaa 104,236,40
buffer_load_dwordx4 v6, s[16:19], s72 offen offset:128 lds
Mvaa 108,236,44
s_waitcnt lgkmcnt(6)
TR 236,16,0
TR 238,16,2048
Mvaa 112,240,40
s_add_u32 m0, s38, 52992
s_nop 0
buffer_load_dwordx4 v6, s[16:19], s72 offen offset:256 lds
Mvaa 116,240,44
TR 240,15,512
TR 242,15,2560
Mvaa 120,244,40
Mvaa 124,244,44
s_waitcnt vmcnt(10) lgkmcnt(6)
TR 244,16,512
TR 246,16,2560
Mvaa 128,224,40
s_barrier
Mvaa 132,224,44
TR 224,15,4096
TR 226,15,6144
Mvaa 136,228,40
ds_read_b128 a[48:51], v14 offset:49152
Mvaa 140,228,44
s_waitcnt lgkmcnt(7)
TR 228,16,4096
TR 230,16,6144
Mvaa 144,232,40
ds_read_b128 a[52:55], v14 offset:51200
Mvaa 148,232,44
TR 232,15,4608
TR 234,15,6656
Mvaa 152,236,40
Mvaa 156,236,44
s_waitcnt lgkmcnt(8)
TR 236,16,4608
TR 238,16,6656
Mvaa 160,240,40
Mvaa 164,240,44
TR 240,15,8192
TR 242,15,10240
Mvaa 168,244,40
s_add_u32 m0, s38, 102400
Mvaa 172,244,44
s_waitcnt lgkmcnt(6)
TR 244,16,8192
TR 246,16,10240
Mvaa 80,224,48
buffer_load_dwordx4 v6, s[16:19], s73 offen lds
Mvaa 84,224,52
s_add_u32 m0, s38, 57216
TR 224,15,8704
TR 226,15,10752
Mvaa 88,228,48
buffer_load_dwordx4 v6, s[16:19], s73 offen offset:128 lds
Mvaa 92,228,52
s_waitcnt lgkmcnt(6)
TR 228,16,8704
TR 230,16,10752
Mvaa 96,232,48
s_add_u32 m0, s38, 61184
s_nop 0
buffer_load_dwordx4 v6, s[16:19], s73 offen offset:256 lds
Mvaa 100,232,52
s_add_u32 m0, s38, 114688
TR 232,15,24576
TR 234,15,26624
Mvaa 104,236,48
buffer_load_dwordx4 v8, s[24:27], s34 offen lds
Mvaa 108,236,52
s_waitcnt lgkmcnt(6)
TR 236,16,24576
TR 238,16,26624
Mvaa 112,240,48
s_add_u32 s43, s34, 40960
s_add_u32 m0, s38, 118784
Mvaa 116,240,52
TR 240,15,25088
TR 242,15,27136
Mvaa 120,244,48
buffer_load_dwordx4 v8, s[24:27], s43 offen lds
Mvaa 124,244,52
s_waitcnt vmcnt(12) lgkmcnt(6)
TR 244,16,25088
TR 246,16,27136
Mvaa 128,224,48
s_barrier
Mvaa 132,224,52
s_add_u32 s43, s34, 81920
TR 224,15,28672
TR 226,15,30720
Mvaa 136,228,48
s_add_u32 m0, s38, 122880
ds_read_b128 a[56:59], v14 offset:49664
Mvaa 140,228,52
s_waitcnt lgkmcnt(7)
TR 228,16,28672
TR 230,16,30720
Mvaa 144,232,48
ds_read_b128 a[60:63], v14 offset:51712
Mvaa 148,232,52
TR 232,15,29184
TR 234,15,31232
Mvaa 152,236,48
buffer_load_dwordx4 v8, s[24:27], s43 offen lds
Mvaa 156,236,52
s_waitcnt lgkmcnt(8)
TR 236,16,29184
TR 238,16,31232
Mvaa 160,240,48
s_add_u32 s43, s34, 122880
s_add_u32 m0, s38, 126976
Mvaa 164,240,52
TR 240,15,32768
TR 242,15,34816
Mvaa 168,244,48
buffer_load_dwordx4 v8, s[24:27], s43 offen lds
Mvaa 172,244,52
s_waitcnt lgkmcnt(6)
TR 244,16,32768
TR 246,16,34816
Mvaa 80,224,56
s_mul_i32 s74, s34, 6144
s_add_u32 s75, s74, 393216
s_add_u32 s34, s34, 128
Mvaa 84,224,60
s_sub_u32 s45, s34, 1280
TR 224,15,33280
TR 226,15,35328
Mvaa 88,228,56
s_min_u32 s34, s34, s45
s_add_u32 m0, s38, 106496
Mvaa 92,228,60
s_waitcnt lgkmcnt(6)
TR 228,16,33280
TR 230,16,35328
Mvaa 96,232,56
buffer_load_dwordx4 v6, s[16:19], s74 offen lds
Mvaa 100,232,60
s_add_u32 s43, s74, 128
TR 232,15,36864
TR 234,15,38912
Mvaa 104,236,56
s_add_u32 m0, s38, 0
s_nop 0
buffer_load_dwordx4 v6, s[16:19], s43 offen lds
Mvaa 108,236,60
s_waitcnt lgkmcnt(6)
TR 236,16,36864
TR 238,16,38912
Mvaa 112,240,56
s_add_u32 m0, s38, 3840
s_nop 0
buffer_load_dwordx4 v6, s[16:19], s74 offen offset:256 lds
Mvaa 116,240,60
TR 240,15,37376
TR 242,15,39424
Mvaa 120,244,56
Mvaa 124,244,60
s_waitcnt vmcnt(10) lgkmcnt(6)
TR 244,16,37376
TR 246,16,39424
Mvaa 128,224,56
s_barrier
Mvaa 132,224,60
TR 224,15,40960
TR 226,15,43008
Mvaa 136,228,56
ds_read_b128 a[64:67], v14 offset:32768
Mvaa 140,228,60
s_waitcnt lgkmcnt(7)
TR 228,16,40960
TR 230,16,43008
Mvaa 144,232,56
ds_read_b128 a[68:71], v14 offset:34816
Mvaa 148,232,60
TR 232,15,41472
TR 234,15,43520
Mvaa 152,236,56
Mvaa 156,236,60
s_waitcnt lgkmcnt(8)
TR 236,16,41472
TR 238,16,43520
Mvaa 160,240,56
Mvaa 164,240,60
TR 240,15,45056
TR 242,15,47104
Mvaa 168,244,56
s_add_u32 m0, s38, 8192
Mvaa 172,244,60
s_waitcnt lgkmcnt(6)
TR 244,16,45056
TR 246,16,47104
Mvaa 80,224,64
buffer_load_dwordx4 v6, s[16:19], s75 offen lds
Mvaa 84,224,68
s_add_u32 m0, s38, 24448
TR 224,15,45568
TR 226,15,47616
Mvaa 88,228,64
buffer_load_dwordx4 v6, s[16:19], s75 offen offset:128 lds
Mvaa 92,228,68
s_waitcnt lgkmcnt(6)
TR 228,16,45568
TR 230,16,47616
Mvaa 96,232,64
s_add_u32 m0, s38, 28416
s_nop 0
buffer_load_dwordx4 v6, s[16:19], s75 offen offset:256 lds
Mvaa 100,232,68
s_add_u32 m0, s38, 147456
TR 232,17,4096
TR 234,17,6144
Mvaa 104,236,64
buffer_load_dwordx4 v8, s[24:27], s34 offen lds
Mvaa 108,236,68
s_waitcnt lgkmcnt(6)
TR 236,18,4096
TR 238,18,6144
Mvaa 112,240,64
s_add_u32 m0, s38, 65152
s_nop 0
buffer_load_dwordx4 v6, s[16:19], s64 offen offset:384 lds
Mvaa 116,240,68
s_add_u32 m0, s38, 69248
TR 240,17,4608
TR 242,17,6656
Mvaa 120,244,64
buffer_load_dwordx4 v6, s[16:19], s65 offen offset:384 lds
Mvaa 124,244,68
s_waitcnt vmcnt(13) lgkmcnt(6)
TR 244,18,4608
TR 246,18,6656
Mvaa 128,224,64
s_barrier
Mvaa 132,224,68
s_add_u32 s43, s34, 40960
TR 224,19,4096
TR 226,19,6144
Mvaa 136,228,64
s_add_u32 m0, s38, 151552
ds_read_b128 a[72:75], v14 offset:33280
Mvaa 140,228,68
s_waitcnt lgkmcnt(7)
TR 228,20,4096
TR 230,20,6144
Mvaa 144,232,64
ds_read_b128 a[76:79], v14 offset:35328
Mvaa 148,232,68
TR 232,19,4608
TR 234,19,6656
Mvaa 152,236,64
buffer_load_dwordx4 v8, s[24:27], s43 offen lds
Mvaa 156,236,68
s_waitcnt lgkmcnt(8)
TR 236,20,4608
TR 238,20,6656
Mvaa 160,240,64
s_add_u32 s43, s34, 81920
s_add_u32 m0, s38, 155648
Mvaa 164,240,68
TR 240,17,8192
TR 242,17,10240
Mvaa 168,244,64
buffer_load_dwordx4 v8, s[24:27], s43 offen lds
Mvaa 172,244,68
s_waitcnt lgkmcnt(6)
TR 244,18,8192
TR 246,18,10240
Mvaa 80,224,72
s_add_u32 s43, s34, 122880
s_add_u32 m0, s38, 159744
Mvaa 84,224,76
TR 224,17,8704
TR 226,17,10752
Mvaa 88,228,72
buffer_load_dwordx4 v8, s[24:27], s43 offen lds
Mvaa 92,228,76
s_waitcnt lgkmcnt(6)
TR 228,18,8704
TR 230,18,10752
Mvaa 96,232,72
s_mul_i32 s76, s34, 6144
s_add_u32 s77, s76, 393216
s_add_u32 s34, s34, 128
Mvaa 100,232,76
s_sub_u32 s45, s34, 1280
TR 232,17,12288
TR 234,17,14336
Mvaa 104,236,72
s_min_u32 s34, s34, s45
s_add_u32 m0, s38, 32768
Mvaa 108,236,76
s_waitcnt lgkmcnt(6)
TR 236,18,12288
TR 238,18,14336
Mvaa 112,240,72
buffer_load_dwordx4 v6, s[16:19], s76 offen lds
Mvaa 116,240,76
s_add_u32 m0, s38, 36736
TR 240,17,12800
TR 242,17,14848
Mvaa 120,244,72
buffer_load_dwordx4 v6, s[16:19], s76 offen offset:128 lds
Mvaa 124,244,76
s_waitcnt vmcnt(11) lgkmcnt(6)
TR 244,18,12800
TR 246,18,14848
Mvaa 128,224,72
s_barrier
Mvaa 132,224,76
s_add_u32 m0, s38, 102144
TR 224,19,8192
TR 226,19,10240
Mvaa 136,228,72
ds_read_b128 a[80:83], v14 offset:16384
Mvaa 140,228,76
s_waitcnt lgkmcnt(7)
TR 228,20,8192
TR 230,20,10240
Mvaa 144,232,72
ds_read_b128 a[84:87], v14 offset:18432
Mvaa 148,232,76
TR 232,19,8704
TR 234,19,10752
Mvaa 152,236,72
buffer_load_dwordx4 v6, s[16:19], s76 offen offset:256 lds
Mvaa 156,236,76
s_waitcnt lgkmcnt(8)
TR 236,20,8704
TR 238,20,10752
Mvaa 160,240,72
Mvaa 164,240,76
TR 240,15,0
TR 242,15,2048
Mvaa 168,244,72
s_add_u32 m0, s38, 40960
Mvaa 172,244,76
s_waitcnt lgkmcnt(6)
TR 244,16,0
TR 246,16,2048
Mvaa 80,224,80
buffer_load_dwordx4 v6, s[16:19], s77 offen lds
Mvaa 84,224,84
s_add_u32 m0, s38, 44928
TR 224,15,512
TR 226,15,2560
Mvaa 88,228,80
buffer_load_dwordx4 v6, s[16:19], s77 offen offset:128 lds
Mvaa 92,228,84
s_waitcnt lgkmcnt(6)
TR 228,16,512
TR 230,16,2560
Mvaa 96,232,80
s_add_u32 m0, s38, 52992
s_nop 0
buffer_load_dwordx4 v6, s[16:19], s77 offen offset:256 lds
Mvaa 100,232,84
s_add_u32 m0, s38, 131072
TR 232,15,4096
TR 234,15,6144
Mvaa 104,236,80
buffer_load_dwordx4 v8, s[24:27], s34 offen lds
Mvaa 108,236,84
s_waitcnt lgkmcnt(6)
TR 236,16,4096
TR 238,16,6144
Mvaa 112,240,80
s_add_u32 s43, s34, 40960
s_add_u32 m0, s38, 135168
Mvaa 116,240,84
TR 240,15,4608
TR 242,15,6656
Mvaa 120,244,80
buffer_load_dwordx4 v8, s[24:27], s43 offen lds
Mvaa 124,244,84
s_waitcnt vmcnt(14) lgkmcnt(6)
TR 244,16,4608
TR 246,16,6656
Mvaa 128,224,80
s_barrier
Mvaa 132,224,84
s_add_u32 s43, s34, 81920
TR 224,15,8192
TR 226,15,10240
Mvaa 136,228,80
s_add_u32 m0, s38, 139264
ds_read_b128 a[88:91], v14 offset:16896
Mvaa 140,228,84
s_waitcnt lgkmcnt(7)
TR 228,16,8192
TR 230,16,10240
Mvaa 144,232,80
ds_read_b128 a[92:95], v14 offset:18944
Mvaa 148,232,84
TR 232,15,8704
TR 234,15,10752
Mvaa 152,236,80
buffer_load_dwordx4 v8, s[24:27], s43 offen lds
Mvaa 156,236,84
s_waitcnt lgkmcnt(8)
TR 236,16,8704
TR 238,16,10752
Mvaa 160,240,80
s_add_u32 s43, s34, 122880
s_add_u32 m0, s38, 143360
Mvaa 164,240,84
TR 240,15,24576
TR 242,15,26624
Mvaa 168,244,80
buffer_load_dwordx4 v8, s[24:27], s43 offen lds
Mvaa 172,244,84
s_waitcnt lgkmcnt(6)
TR 244,16,24576
TR 246,16,26624
Mvaa 80,224,88
Tc1:
s_cbranch_execz Tdone0
s_mul_i32 s78, s34, 6144
s_add_u32 s79, s78, 393216
s_add_u32 s34, s34, 128
Mvaa 84,224,92
s_sub_u32 s45, s34, 1280
TR 224,15,25088
TR 226,15,27136
Mvaa 88,228,88
s_min_u32 s34, s34, s45
s_add_u32 m0, s38, 106496
Mvaa 92,228,92
s_waitcnt lgkmcnt(6)
TR 228,16,25088
TR 230,16,27136
Mvaa 96,232,88
buffer_load_dwordx4 v6, s[16:19], s78 offen lds
Mvaa 100,232,92
s_add_u32 m0, s38, 57216
TR 232,15,28672
TR 234,15,30720
Mvaa 104,236,88
buffer_load_dwordx4 v6, s[16:19], s78 offen offset:128 lds
Mvaa 108,236,92
s_waitcnt lgkmcnt(6)
TR 236,16,28672
TR 238,16,30720
Mvaa 112,240,88
s_add_u32 m0, s38, 61184
s_nop 0
buffer_load_dwordx4 v6, s[16:19], s78 offen offset:256 lds
Mvaa 116,240,92
TR 240,15,29184
TR 242,15,31232
Mvaa 120,244,88
Mvaa 124,244,92
s_waitcnt vmcnt(10) lgkmcnt(6)
TR 244,16,29184
TR 246,16,31232
Mvaa 128,224,88
s_barrier
Mvaa 132,224,92
TR 224,15,32768
TR 226,15,34816
Mvaa 136,228,88
ds_read_b128 a[96:99], v14 offset:49152
Mvaa 140,228,92
s_waitcnt lgkmcnt(7)
TR 228,16,32768
TR 230,16,34816
Mvaa 144,232,88
ds_read_b128 a[100:103], v14 offset:51200
Mvaa 148,232,92
TR 232,15,33280
TR 234,15,35328
Mvaa 152,236,88
Mvaa 156,236,92
s_waitcnt lgkmcnt(8)
TR 236,16,33280
TR 238,16,35328
Mvaa 160,240,88
Mvaa 164,240,92
TR 240,15,36864
TR 242,15,38912
Mvaa 168,244,88
s_add_u32 m0, s38, 0
Mvaa 172,244,92
s_waitcnt lgkmcnt(6)
TR 244,16,36864
TR 246,16,38912
Mvaa 80,224,96
buffer_load_dwordx4 v6, s[16:19], s79 offen lds
Mvaa 84,224,100
s_add_u32 m0, s38, 3968
TR 224,15,37376
TR 226,15,39424
Mvaa 88,228,96
buffer_load_dwordx4 v6, s[16:19], s79 offen offset:128 lds
Mvaa 92,228,100
s_waitcnt lgkmcnt(6)
TR 228,16,37376
TR 230,16,39424
Mvaa 96,232,96
s_add_u32 m0, s38, 7936
s_nop 0
buffer_load_dwordx4 v6, s[16:19], s79 offen offset:256 lds
Mvaa 100,232,100
s_add_u32 m0, s38, 114688
TR 232,19,4096
TR 234,19,6144
Mvaa 104,236,96
buffer_load_dwordx4 v8, s[24:27], s34 offen lds
Mvaa 108,236,100
s_waitcnt lgkmcnt(6)
TR 236,20,4096
TR 238,20,6144
Mvaa 112,240,96
s_add_u32 s43, s34, 40960
s_add_u32 m0, s38, 118784
Mvaa 116,240,100
TR 240,19,4608
TR 242,19,6656
Mvaa 120,244,96
buffer_load_dwordx4 v8, s[24:27], s43 offen lds
Mvaa 124,244,100
s_waitcnt vmcnt(12) lgkmcnt(6)
TR 244,20,4608
TR 246,20,6656
Mvaa 128,224,96
s_barrier
Mvaa 132,224,100
s_add_u32 s43, s34, 81920
TR 224,15,40960
TR 226,15,43008
Mvaa 136,228,96
s_add_u32 m0, s38, 122880
ds_read_b128 a[104:107], v14 offset:49664
Mvaa 140,228,100
s_waitcnt lgkmcnt(7)
TR 228,16,40960
TR 230,16,43008
Mvaa 144,232,96
ds_read_b128 a[108:111], v14 offset:51712
Mvaa 148,232,100
TR 232,15,41472
TR 234,15,43520
Mvaa 152,236,96
buffer_load_dwordx4 v8, s[24:27], s43 offen lds
Mvaa 156,236,100
s_waitcnt lgkmcnt(8)
TR 236,16,41472
TR 238,16,43520
Mvaa 160,240,96
s_add_u32 s43, s34, 122880
s_add_u32 m0, s38, 126976
Mvaa 164,240,100
TR 240,15,45056
TR 242,15,47104
Mvaa 168,244,96
buffer_load_dwordx4 v8, s[24:27], s43 offen lds
Mvaa 172,244,100
s_waitcnt lgkmcnt(6)
TR 244,16,45056
TR 246,16,47104
Mvaa 80,224,104
s_mul_i32 s80, s34, 6144
s_add_u32 s81, s80, 393216
s_add_u32 s34, s34, 128
Mvaa 84,224,108
s_sub_u32 s45, s34, 1280
TR 224,15,45568
TR 226,15,47616
Mvaa 88,228,104
s_min_u32 s34, s34, s45
s_add_u32 m0, s38, 24576
Mvaa 92,228,108
s_waitcnt lgkmcnt(6)
TR 228,16,45568
TR 230,16,47616
Mvaa 96,232,104
buffer_load_dwordx4 v6, s[16:19], s80 offen lds
Mvaa 100,232,108
s_add_u32 m0, s38, 28544
TR 232,17,4096
TR 234,17,6144
Mvaa 104,236,104
buffer_load_dwordx4 v6, s[16:19], s80 offen offset:128 lds
Mvaa 108,236,108
s_waitcnt lgkmcnt(6)
TR 236,18,4096
TR 238,18,6144
Mvaa 112,240,104
s_add_u32 m0, s38, 32512
s_nop 0
buffer_load_dwordx4 v6, s[16:19], s80 offen offset:256 lds
Mvaa 116,240,108
TR 240,17,4608
TR 242,17,6656
Mvaa 120,244,104
Mvaa 124,244,108
s_waitcnt vmcnt(10) lgkmcnt(6)
TR 244,18,4608
TR 246,18,6656
Mvaa 128,224,104
s_barrier
Mvaa 132,224,108
TR 224,19,8192
TR 226,19,10240
Mvaa 136,228,104
ds_read_b128 a[112:115], v14 offset:32768
Mvaa 140,228,108
s_waitcnt lgkmcnt(7)
TR 228,20,8192
TR 230,20,10240
Mvaa 144,232,104
ds_read_b128 a[116:119], v14 offset:34816
Mvaa 148,232,108
TR 232,19,8704
TR 234,19,10752
Mvaa 152,236,104
Mvaa 156,236,108
s_waitcnt lgkmcnt(8)
TR 236,20,8704
TR 238,20,10752
Mvaa 160,240,104
Mvaa 164,240,108
TR 240,17,8192
TR 242,17,10240
Mvaa 168,244,104
s_add_u32 m0, s38, 102400
Mvaa 172,244,108
s_waitcnt lgkmcnt(6)
TR 244,18,8192
TR 246,18,10240
Mvaa 80,224,112
buffer_load_dwordx4 v6, s[16:19], s81 offen lds
Mvaa 84,224,116
s_add_u32 m0, s38, 36736
TR 224,17,8704
TR 226,17,10752
Mvaa 88,228,112
buffer_load_dwordx4 v6, s[16:19], s81 offen offset:128 lds
Mvaa 92,228,116
s_waitcnt lgkmcnt(6)
TR 228,18,8704
TR 230,18,10752
Mvaa 96,232,112
s_add_u32 m0, s38, 40704
s_nop 0
buffer_load_dwordx4 v6, s[16:19], s81 offen offset:256 lds
Mvaa 100,232,116
s_add_u32 m0, s38, 147456
TR 232,17,12288
TR 234,17,14336
Mvaa 104,236,112
buffer_load_dwordx4 v8, s[24:27], s34 offen lds
Mvaa 108,236,116
s_waitcnt lgkmcnt(6)
TR 236,18,12288
TR 238,18,14336
Mvaa 112,240,112
s_add_u32 s43, s34, 40960
s_add_u32 m0, s38, 151552
Mvaa 116,240,116
TR 240,17,12800
TR 242,17,14848
Mvaa 120,244,112
buffer_load_dwordx4 v8, s[24:27], s43 offen lds
Mvaa 124,244,116
s_waitcnt vmcnt(12) lgkmcnt(6)
TR 244,18,12800
TR 246,18,14848
Mvaa 128,224,112
s_barrier
Mvaa 132,224,116
s_add_u32 s43, s34, 81920
TR 224,15,0
TR 226,15,2048
Mvaa 136,228,112
s_add_u32 m0, s38, 155648
ds_read_b128 a[120:123], v14 offset:33280
Mvaa 140,228,116
s_waitcnt lgkmcnt(7)
TR 228,16,0
TR 230,16,2048
Mvaa 144,232,112
ds_read_b128 a[124:127], v14 offset:35328
Mvaa 148,232,116
TR 232,15,512
TR 234,15,2560
Mvaa 152,236,112
buffer_load_dwordx4 v8, s[24:27], s43 offen lds
Mvaa 156,236,116
s_waitcnt lgkmcnt(8)
TR 236,16,512
TR 238,16,2560
Mvaa 160,240,112
s_add_u32 s43, s34, 122880
s_add_u32 m0, s38, 159744
Mvaa 164,240,116
TR 240,15,4096
TR 242,15,6144
Mvaa 168,244,112
buffer_load_dwordx4 v8, s[24:27], s43 offen lds
Mvaa 172,244,116
s_waitcnt lgkmcnt(6)
TR 244,16,4096
TR 246,16,6144
Mvaa 80,224,120
s_mul_i32 s82, s34, 6144
s_add_u32 s83, s82, 393216
s_add_u32 s34, s34, 128
Mvaa 84,224,124
s_sub_u32 s45, s34, 1280
TR 224,15,4608
TR 226,15,6656
Mvaa 88,228,120
s_min_u32 s34, s34, s45
s_add_u32 m0, s38, 106496
Mvaa 92,228,124
s_waitcnt lgkmcnt(6)
TR 228,16,4608
TR 230,16,6656
Mvaa 96,232,120
buffer_load_dwordx4 v6, s[16:19], s82 offen lds
Mvaa 100,232,124
s_add_u32 m0, s38, 44928
TR 232,15,8192
TR 234,15,10240
Mvaa 104,236,120
buffer_load_dwordx4 v6, s[16:19], s82 offen offset:128 lds
Mvaa 108,236,124
s_waitcnt lgkmcnt(6)
TR 236,16,8192
TR 238,16,10240
Mvaa 112,240,120
s_add_u32 m0, s38, 52992
s_nop 0
buffer_load_dwordx4 v6, s[16:19], s82 offen offset:256 lds
Mvaa 116,240,124
TR 240,15,8704
TR 242,15,10752
Mvaa 120,244,120
Mvaa 124,244,124
s_waitcnt vmcnt(10) lgkmcnt(6)
TR 244,16,8704
TR 246,16,10752
Mvaa 128,224,120
s_barrier
Mvaa 132,224,124
TR 224,15,24576
TR 226,15,26624
Mvaa 136,228,120
ds_read_b128 a[128:131], v14 offset:16384
Mvaa 140,228,124
s_waitcnt lgkmcnt(7)
TR 228,16,24576
TR 230,16,26624
Mvaa 144,232,120
ds_read_b128 a[132:135], v14 offset:18432
Mvaa 148,232,124
TR 232,15,25088
TR 234,15,27136
Mvaa 152,236,120
Mvaa 156,236,124
s_waitcnt lgkmcnt(8)
TR 236,16,25088
TR 238,16,27136
Mvaa 160,240,120
Mvaa 164,240,124
TR 240,15,28672
TR 242,15,30720
Mvaa 168,244,120
s_add_u32 m0, s38, 143360
Mvaa 172,244,124
s_waitcnt lgkmcnt(6)
TR 244,16,28672
TR 246,16,30720
Mvaa 80,224,128
buffer_load_dwordx4 v6, s[16:19], s83 offen lds
Mvaa 84,224,132
s_add_u32 m0, s38, 135040
TR 224,15,29184
TR 226,15,31232
Mvaa 88,228,128
buffer_load_dwordx4 v6, s[16:19], s83 offen offset:128 lds
Mvaa 92,228,132
s_waitcnt lgkmcnt(6)
TR 228,16,29184
TR 230,16,31232
Mvaa 96,232,128
s_add_u32 m0, s38, 139008
s_nop 0
buffer_load_dwordx4 v6, s[16:19], s83 offen offset:256 lds
Mvaa 100,232,132
s_add_u32 m0, s38, 130688
TR 232,15,32768
TR 234,15,34816
Mvaa 104,236,128
buffer_load_dwordx4 v6, s[16:19], s66 offen offset:384 lds
Mvaa 108,236,132
s_waitcnt lgkmcnt(6)
TR 236,16,32768
TR 238,16,34816
Mvaa 112,240,128
s_add_u32 s43, s67, 384
s_add_u32 m0, s38, 0
Mvaa 116,240,132
TR 240,15,33280
TR 242,15,35328
Mvaa 120,244,128
buffer_load_dwordx4 v6, s[16:19], s43 offen lds
Mvaa 124,244,132
s_waitcnt vmcnt(12) lgkmcnt(6)
TR 244,16,33280
TR 246,16,35328
Mvaa 128,224,128
s_barrier
Mvaa 132,224,132
s_add_u32 m0, s38, 3712
TR 224,19,4096
TR 226,19,6144
Mvaa 136,228,128
ds_read_b128 a[136:139], v14 offset:16896
Mvaa 140,228,132
s_waitcnt lgkmcnt(7)
TR 228,20,4096
TR 230,20,6144
Mvaa 144,232,128
ds_read_b128 a[140:143], v14 offset:18944
Mvaa 148,232,132
TR 232,19,4608
TR 234,19,6656
Mvaa 152,236,128
buffer_load_dwordx4 v6, s[16:19], s68 offen offset:384 lds
Mvaa 156,236,132
s_waitcnt lgkmcnt(8)
TR 236,20,4608
TR 238,20,6656
Mvaa 160,240,128
s_add_u32 m0, s38, 7808
s_nop 0
buffer_load_dwordx4 v6, s[16:19], s69 offen offset:384 lds
Mvaa 164,240,132
s_add_u32 m0, s38, 24192
TR 240,15,36864
TR 242,15,38912
Mvaa 168,244,128
buffer_load_dwordx4 v6, s[16:19], s70 offen offset:384 lds
Mvaa 172,244,132
s_waitcnt lgkmcnt(6)
TR 244,16,36864
TR 246,16,38912
Mvaa 80,224,136
s_add_u32 m0, s38, 56960
s_nop 0
buffer_load_dwordx4 v6, s[16:19], s71 offen offset:384 lds
Mvaa 84,224,140
s_add_u32 m0, s38, 61056
TR 224,15,37376
TR 226,15,39424
Mvaa 88,228,136
buffer_load_dwordx4 v6, s[16:19], s72 offen offset:384 lds
Mvaa 92,228,140
s_waitcnt lgkmcnt(6)
TR 228,16,37376
TR 230,16,39424
Mvaa 96,232,136
s_add_u32 m0, s38, 73472
s_nop 0
buffer_load_dwordx4 v4, s[8:11], s32 offen offset:256 nt lds
Mvaa 100,232,140
s_add_u32 s32, s32, 6144
TR 232,15,40960
TR 234,15,43008
Mvaa 104,236,136
s_sub_u32 s45, s32, 98304
s_min_u32 s32, s32, s45
s_add_u32 m0, s38, 77824
Mvaa 108,236,140
s_waitcnt lgkmcnt(6)
TR 236,16,40960
TR 238,16,43008
Mvaa 112,240,136
buffer_load_dwordx4 v5, s[12:15], s33 offen nt lds
Mvaa 116,240,140
s_add_u32 m0, s38, 81792
TR 240,15,41472
TR 242,15,43520
Mvaa 120,244,136
buffer_load_dwordx4 v5, s[12:15], s33 offen offset:128 nt lds
Mvaa 124,244,140
s_waitcnt vmcnt(13) lgkmcnt(6)
TR 244,16,41472
TR 246,16,43520
Mvaa 128,224,136
s_barrier
Mvaa 132,224,140
s_add_u32 m0, s38, 126720
TR 224,19,8192
TR 226,19,10240
Mvaa 136,228,136
ds_read_b128 a[144:147], v14 offset:49152
Mvaa 140,228,140
s_waitcnt lgkmcnt(7)
TR 228,20,8192
TR 230,20,10240
Mvaa 144,232,136
ds_read_b128 a[148:151], v14 offset:51200
Mvaa 148,232,140
TR 232,19,8704
TR 234,19,10752
Mvaa 152,236,136
buffer_load_dwordx4 v5, s[12:15], s33 offen offset:256 nt lds
Mvaa 156,236,140
s_waitcnt lgkmcnt(8)
TR 236,20,8704
TR 238,20,10752
Mvaa 160,240,136
s_add_u32 s33, s33, 6144
s_sub_u32 s45, s33, 98304
s_min_u32 s33, s33, s45
Mvaa 164,240,140
TR 240,15,45056
TR 242,15,47104
Mvaa 168,244,136
Mvaa 172,244,140
s_waitcnt lgkmcnt(6)
TR 244,16,45056
TR 246,16,47104
Mvaa 80,224,144
Mvaa 84,224,148
TR 224,15,45568
TR 226,15,47616
Mvaa 88,228,144
Mvaa 92,228,148
s_waitcnt lgkmcnt(6)
TR 228,16,45568
TR 230,16,47616
Mvaa 96,232,144
Mvaa 100,232,148
TR 232,17,4096
TR 234,17,6144
Mvaa 104,236,144
Mvaa 108,236,148
s_waitcnt lgkmcnt(6)
TR 236,18,4096
TR 238,18,6144
Mvaa 112,240,144
Mvaa 116,240,148
TR 240,17,4608
TR 242,17,6656
Mvaa 120,244,144
s_add_u32 m0, s38, 118400
Mvaa 124,244,148
s_waitcnt vmcnt(11) lgkmcnt(6)
TR 244,18,4608
TR 246,18,6656
Mvaa 128,224,144
s_barrier
Mvaa 132,224,148
TR 224,19,45056
TR 226,19,47104
Mvaa 136,228,144
ds_read_b128 a[152:155], v14 offset:49664
Mvaa 140,228,148
s_waitcnt lgkmcnt(7)
TR 228,20,45056
Tc2:
s_cbranch_execz Tdone0
TR 230,20,47104
Mvaa 144,232,144
ds_read_b128 a[156:159], v14 offset:51712
v_and_b32 v14, 0x3ff, v13
Mvaa 148,232,148
TR 232,19,45568
TR 234,19,47616
Mvaa 152,236,144
buffer_load_dwordx4 v6, s[16:19], s73 offen offset:384 lds
Mvaa 156,236,148
s_waitcnt lgkmcnt(8)
TR 236,20,45568
TR 238,20,47616
Mvaa 160,240,144
s_add_u32 m0, s38, 122496
s_nop 0
buffer_load_dwordx4 v6, s[16:19], s74 offen offset:384 lds
Mvaa 164,240,148
s_add_u32 m0, s38, 114304
TR 240,19,36864
TR 242,19,38912
Mvaa 168,244,144
buffer_load_dwordx4 v6, s[16:19], s75 offen offset:384 lds
Mvaa 172,244,148
s_waitcnt lgkmcnt(6)
TR 244,20,36864
TR 246,20,38912
Mvaa 80,224,152
s_add_u32 m0, s38, 102016
s_nop 0
buffer_load_dwordx4 v6, s[16:19], s76 offen offset:384 lds
Mvaa 84,224,156
s_add_u32 m0, s38, 106112
TR 224,19,37376
TR 226,19,39424
Mvaa 88,228,152
buffer_load_dwordx4 v6, s[16:19], s77 offen offset:384 lds
Mvaa 92,228,156
s_waitcnt lgkmcnt(6)
TR 228,20,37376
TR 230,20,39424
Mvaa 96,232,152
s_add_u32 m0, s38, 28288
s_nop 0
buffer_load_dwordx4 v6, s[16:19], s78 offen offset:384 lds
Mvaa 100,232,156
s_add_u32 m0, s38, 32384
TR 232,19,40960
TR 234,19,43008
Mvaa 104,236,152
buffer_load_dwordx4 v6, s[16:19], s79 offen offset:384 lds
Mvaa 108,236,156
s_waitcnt lgkmcnt(6)
TR 236,20,40960
TR 238,20,43008
Mvaa 112,240,152
s_add_u32 m0, s38, 36480
s_nop 0
buffer_load_dwordx4 v6, s[16:19], s80 offen offset:384 lds
Mvaa 116,240,156
s_add_u32 m0, s38, 40576
TR 240,19,41472
TR 242,19,43520
Mvaa 120,244,152
buffer_load_dwordx4 v6, s[16:19], s81 offen offset:384 lds
Mvaa 124,244,156
s_waitcnt vmcnt(13) lgkmcnt(6)
TR 244,20,41472
TR 246,20,43520
Mvaa 128,224,152
s_barrier
Mvaa 132,224,156
s_add_u32 m0, s38, 159360
ds_read_b128 a[224:227], v9 offset:12288
v_mul_f32 v80, s40, v80
Mvaa 136,228,152
buffer_load_dwordx4 v6, s[16:19], s82 offen offset:384 lds
Mvaa 140,228,156
s_waitcnt lgkmcnt(5)
ds_read_b128 a[228:231], v9 offset:12800
v_mul_f32 v81, s40, v81
Mvaa 144,232,152
s_add_u32 m0, s38, 151168
s_nop 0
buffer_load_dwordx4 v6, s[16:19], s83 offen offset:384 lds
Mvaa 148,232,156
s_add_u32 m0, s38, 155648
ds_read_b128 a[232:235], v9 offset:16384
v_mul_f32 v82, s40, v82
Mvaa 152,236,152
buffer_load_dwordx4 v4, s[8:11], s32 offen nt lds
Mvaa 156,236,156
s_waitcnt lgkmcnt(3)
ds_read_b128 a[236:239], v9 offset:16896
v_mul_f32 v83, s40, v83
Mvaa 160,240,152
s_add_u32 m0, s38, 143232
s_nop 0
buffer_load_dwordx4 v4, s[8:11], s32 offen offset:128 nt lds
Mvaa 164,240,156
s_add_u32 m0, s38, 147200
ds_read_b128 a[240:243], v9 offset:20480
v_mul_f32 v88, s40, v88
Mvaa 168,244,152
buffer_load_dwordx4 v4, s[8:11], s32 offen offset:256 nt lds
Mvaa 172,244,156
s_waitcnt lgkmcnt(3)
ds_read_b128 a[244:247], v9 offset:20992
v_mul_f32 v89, s40, v89
v_mul_f32 v90, s40, v90
v_mul_f32 v91, s40, v91
v_cvt_pk_bf16_f32 v176, v80, v81
v_cvt_pk_bf16_f32 v177, v82, v83
v_cvt_pk_bf16_f32 v178, v88, v89
v_cvt_pk_bf16_f32 v179, v90, v91
s_nop 0
v_permlane16_swap_b32 v176, v178
v_permlane16_swap_b32 v177, v179
s_nop 1
v_mfma_f32_16x16x32_bf16 v[48:51], a[224:227], v[176:179], 0
s_add_u32 s32, s32, 6144
v_mul_f32 v84, s40, v84
v_mul_f32 v85, s40, v85
v_mul_f32 v86, s40, v86
v_mul_f32 v87, s40, v87
v_pk_mul_f32 v[92:93], v[92:93], s[40:41] op_sel_hi:[1,0]
v_pk_mul_f32 v[94:95], v[94:95], s[40:41] op_sel_hi:[1,0]
v_cvt_pk_bf16_f32 v180, v84, v85
v_cvt_pk_bf16_f32 v181, v86, v87
v_cvt_pk_bf16_f32 v182, v92, v93
v_cvt_pk_bf16_f32 v183, v94, v95
s_nop 0
v_permlane16_swap_b32 v180, v182
v_permlane16_swap_b32 v181, v183
s_nop 1
v_mfma_f32_16x16x32_bf16 v[56:59], a[224:227], v[180:183], 0
s_sub_u32 s45, s32, 98304
ds_read_b128 a[224:227], v9 offset:14336
v_mul_f32 v96, s40, v96
v_mul_f32 v97, s40, v97
v_pk_mul_f32 v[98:99], v[98:99], s[40:41] op_sel_hi:[1,0]
v_pk_mul_f32 v[104:105], v[104:105], s[40:41] op_sel_hi:[1,0]
v_pk_mul_f32 v[106:107], v[106:107], s[40:41] op_sel_hi:[1,0]
v_cvt_pk_bf16_f32 v184, v96, v97
v_cvt_pk_bf16_f32 v185, v98, v99
v_cvt_pk_bf16_f32 v186, v104, v105
v_cvt_pk_bf16_f32 v187, v106, v107
s_nop 0
v_permlane16_swap_b32 v184, v186
v_permlane16_swap_b32 v185, v187
s_nop 1
Mvav 48,228,184
s_min_u32 s32, s32, s45
v_mul_f32 v100, s40, v100
v_mul_f32 v101, s40, v101
v_mul_f32 v102, s40, v102
v_mul_f32 v103, s40, v103
v_pk_mul_f32 v[108:109], v[108:109], s[40:41] op_sel_hi:[1,0]
v_pk_mul_f32 v[110:111], v[110:111], s[40:41] op_sel_hi:[1,0]
v_cvt_pk_bf16_f32 v188, v100, v101
v_cvt_pk_bf16_f32 v189, v102, v103
v_cvt_pk_bf16_f32 v190, v108, v109
v_cvt_pk_bf16_f32 v191, v110, v111
s_nop 0
v_permlane16_swap_b32 v188, v190
v_permlane16_swap_b32 v189, v191
s_nop 1
Mvav 56,228,188
s_waitcnt lgkmcnt(3)
ds_read_b128 a[228:231], v9 offset:14848
v_mul_f32 v112, s40, v112
v_mul_f32 v113, s40, v113
v_pk_mul_f32 v[114:115], v[114:115], s[40:41] op_sel_hi:[1,0]
v_pk_mul_f32 v[120:121], v[120:121], s[40:41] op_sel_hi:[1,0]
v_pk_mul_f32 v[122:123], v[122:123], s[40:41] op_sel_hi:[1,0]
v_cvt_pk_bf16_f32 v192, v112, v113
v_cvt_pk_bf16_f32 v193, v114, v115
v_cvt_pk_bf16_f32 v194, v120, v121
v_cvt_pk_bf16_f32 v195, v122, v123
s_nop 0
v_permlane16_swap_b32 v192, v194
v_permlane16_swap_b32 v193, v195
s_nop 1
Mvav 48,232,192
s_add_u32 m0, s38, 44544
v_mul_f32 v116, s40, v116
v_mul_f32 v117, s40, v117
v_mul_f32 v118, s40, v118
v_mul_f32 v119, s40, v119
v_pk_mul_f32 v[124:125], v[124:125], s[40:41] op_sel_hi:[1,0]
v_pk_mul_f32 v[126:127], v[126:127], s[40:41] op_sel_hi:[1,0]
v_cvt_pk_bf16_f32 v196, v116, v117
v_cvt_pk_bf16_f32 v197, v118, v119
v_cvt_pk_bf16_f32 v198, v124, v125
v_cvt_pk_bf16_f32 v199, v126, v127
s_nop 0
v_permlane16_swap_b32 v196, v198
v_permlane16_swap_b32 v197, v199
s_nop 1
Mvav 56,232,196
ds_read_b128 a[232:235], v9 offset:18432
v_mul_f32 v128, s40, v128
v_mul_f32 v129, s40, v129
v_pk_mul_f32 v[130:131], v[130:131], s[40:41] op_sel_hi:[1,0]
v_pk_mul_f32 v[136:137], v[136:137], s[40:41] op_sel_hi:[1,0]
v_pk_mul_f32 v[138:139], v[138:139], s[40:41] op_sel_hi:[1,0]
v_cvt_pk_bf16_f32 v200, v128, v129
v_cvt_pk_bf16_f32 v201, v130, v131
v_cvt_pk_bf16_f32 v202, v136, v137
v_cvt_pk_bf16_f32 v203, v138, v139
s_nop 0
v_permlane16_swap_b32 v200, v202
v_permlane16_swap_b32 v201, v203
s_nop 1
Mvav 48,236,200
buffer_load_dwordx4 v6, s[16:19], s64 offen offset:512 lds
v_mul_f32 v132, s40, v132
v_mul_f32 v133, s40, v133
v_mul_f32 v134, s40, v134
v_mul_f32 v135, s40, v135
v_pk_mul_f32 v[140:141], v[140:141], s[40:41] op_sel_hi:[1,0]
v_pk_mul_f32 v[142:143], v[142:143], s[40:41] op_sel_hi:[1,0]
v_cvt_pk_bf16_f32 v204, v132, v133
v_cvt_pk_bf16_f32 v205, v134, v135
v_cvt_pk_bf16_f32 v206, v140, v141
v_cvt_pk_bf16_f32 v207, v142, v143
s_nop 0
v_permlane16_swap_b32 v204, v206
v_permlane16_swap_b32 v205, v207
s_nop 1
Mvav 56,236,204
s_waitcnt lgkmcnt(3)
ds_read_b128 a[236:239], v9 offset:18944
v_mul_f32 v144, s40, v144
v_mul_f32 v145, s40, v145
v_pk_mul_f32 v[146:147], v[146:147], s[40:41] op_sel_hi:[1,0]
v_pk_mul_f32 v[152:153], v[152:153], s[40:41] op_sel_hi:[1,0]
v_pk_mul_f32 v[154:155], v[154:155], s[40:41] op_sel_hi:[1,0]
v_cvt_pk_bf16_f32 v208, v144, v145
v_cvt_pk_bf16_f32 v209, v146, v147
v_cvt_pk_bf16_f32 v210, v152, v153
v_cvt_pk_bf16_f32 v211, v154, v155
s_nop 0
v_permlane16_swap_b32 v208, v210
v_permlane16_swap_b32 v209, v211
s_nop 1
Mvav 48,240,208
v_mul_f32 v148, s40, v148
v_mul_f32 v149, s40, v149
v_mul_f32 v150, s40, v150
v_mul_f32 v151, s40, v151
v_pk_mul_f32 v[156:157], v[156:157], s[40:41] op_sel_hi:[1,0]
v_pk_mul_f32 v[158:159], v[158:159], s[40:41] op_sel_hi:[1,0]
v_cvt_pk_bf16_f32 v212, v148, v149
v_cvt_pk_bf16_f32 v213, v150, v151
v_cvt_pk_bf16_f32 v214, v156, v157
v_cvt_pk_bf16_f32 v215, v158, v159
s_nop 0
v_permlane16_swap_b32 v212, v214
v_permlane16_swap_b32 v213, v215
s_nop 1
Mvav 56,240,212
ds_read_b128 a[240:243], v9 offset:22528
v_mul_f32 v160, s40, v160
v_mul_f32 v161, s40, v161
v_pk_mul_f32 v[162:163], v[162:163], s[40:41] op_sel_hi:[1,0]
v_pk_mul_f32 v[168:169], v[168:169], s[40:41] op_sel_hi:[1,0]
v_pk_mul_f32 v[170:171], v[170:171], s[40:41] op_sel_hi:[1,0]
v_cvt_pk_bf16_f32 v216, v160, v161
v_cvt_pk_bf16_f32 v217, v162, v163
v_cvt_pk_bf16_f32 v218, v168, v169
v_cvt_pk_bf16_f32 v219, v170, v171
s_nop 0
v_permlane16_swap_b32 v216, v218
v_permlane16_swap_b32 v217, v219
s_nop 1
Mvav 48,244,216
v_mul_f32 v164, s40, v164
v_mul_f32 v165, s40, v165
v_mul_f32 v166, s40, v166
v_mul_f32 v167, s40, v167
v_pk_mul_f32 v[172:173], v[172:173], s[40:41] op_sel_hi:[1,0]
v_pk_mul_f32 v[174:175], v[174:175], s[40:41] op_sel_hi:[1,0]
v_cvt_pk_bf16_f32 v220, v164, v165
v_cvt_pk_bf16_f32 v221, v166, v167
v_cvt_pk_bf16_f32 v222, v172, v173
v_cvt_pk_bf16_f32 v223, v174, v175
s_nop 0
v_permlane16_swap_b32 v220, v222
v_permlane16_swap_b32 v221, v223
s_nop 1
Mvav 56,244,220
s_waitcnt lgkmcnt(3)
ds_read_b128 a[244:247], v9 offset:23040
v_mfma_f32_16x16x32_bf16 v[52:55], a[224:227], v[176:179], 0
v_exp_f32 v24, v48
v_mfma_f32_16x16x32_bf16 v[60:63], a[224:227], v[180:183], 0
TR 224,17,16384
TR 226,17,18432
Mvav 52,228,184
v_exp_f32 v25, v49
Mvav 60,228,188
s_waitcnt lgkmcnt(4)
TR 228,18,16384
TR 230,18,18432
Mvav 52,232,192
v_exp_f32 v26, v50
Mvav 60,232,196
TR 232,17,20480
TR 234,17,22528
Mvav 52,236,200
v_cvt_pk_bf16_f32 v40, v24, v25
Mvav 60,236,204
s_waitcnt lgkmcnt(6)
TR 236,18,20480
TR 238,18,22528
Mvav 52,240,208
v_exp_f32 v27, v51
Mvav 60,240,212
TR 240,19,32768
TR 242,19,34816
Mvav 52,244,216
v_exp_f32 v24, v56
Mvav 60,244,220
s_waitcnt lgkmcnt(6)
TR 244,20,32768
TR 246,20,34816
v_mfma_f32_16x16x32_bf16 v[224:227], a[224:227], a[0:3], 0
v_cvt_pk_bf16_f32 v41, v26, v27
v_mfma_f32_16x16x32_bf16 v[228:231], a[224:227], a[4:7], 0
TR 224,15,0
TR 226,15,2048
v_mfma_f32_16x16x32_bf16 v[232:235], a[228:231], a[0:3], 0
v_exp_f32 v25, v57
v_mfma_f32_16x16x32_bf16 v[236:239], a[228:231], a[4:7], 0
s_waitcnt lgkmcnt(6)
TR 228,16,0
TR 230,16,2048
Mvaa 224,232,8
v_exp_f32 v26, v58
Mvaa 228,232,12
TR 232,15,4096
TR 234,15,6144
Mvaa 232,236,8
v_cvt_pk_bf16_f32 v44, v24, v25
Mvaa 236,236,12
s_waitcnt lgkmcnt(6)
TR 236,16,4096
TR 238,16,6144
Mvaa 224,240,16
v_exp_f32 v27, v59
Mvaa 228,240,20
TR 240,15,8192
TR 242,15,10240
Mvaa 232,244,16
v_exp_f32 v24, v52
Mvaa 236,244,20
s_waitcnt lgkmcnt(6)
TR 244,16,8192
TR 246,16,10240
Mvaa 224,224,24
v_cvt_pk_bf16_f32 v45, v26, v27
Mvaa 228,224,28
TR 224,17,16896
TR 226,17,18944
Mvaa 232,228,24
v_exp_f32 v25, v53
Mvaa 236,228,28
s_waitcnt lgkmcnt(6)
TR 228,18,16896
TR 230,18,18944
Mvaa 224,232,32
v_exp_f32 v26, v54
Mvaa 228,232,36
TR 232,17,20992
TR 234,17,23040
Mvaa 232,236,32
v_cvt_pk_bf16_f32 v42, v24, v25
Mvaa 236,236,36
s_waitcnt lgkmcnt(6)
TR 236,18,20992
TR 238,18,23040
Mvaa 224,240,40
v_exp_f32 v27, v55
Mvaa 228,240,44
TR 240,19,33280
TR 242,19,35328
Mvaa 232,244,40
v_cvt_pk_bf16_f32 v43, v26, v27
Mvaa 236,244,44
s_waitcnt lgkmcnt(6)
TR 244,20,33280
TR 246,20,35328
v_mfma_f32_16x16x32_bf16 v[240:243], a[224:227], a[0:3], 0
v_exp_f32 v24, v60
v_mfma_f32_16x16x32_bf16 v[244:247], a[224:227], a[4:7], 0
TR 224,15,512
TR 226,15,2560
v_mfma_f32_16x16x32_bf16 v[248:251], a[228:231], a[0:3], 0
v_exp_f32 v25, v61
v_mfma_f32_16x16x32_bf16 v[252:255], a[228:231], a[4:7], 0
s_waitcnt lgkmcnt(6)
TR 228,16,512
TR 230,16,2560
Mvaa 240,232,8
v_exp_f32 v26, v62
Mvaa 244,232,12
TR 232,15,4608
TR 234,15,6656
Mvaa 248,236,8
v_cvt_pk_bf16_f32 v46, v24, v25
Mvaa 252,236,12
s_waitcnt lgkmcnt(6)
TR 236,16,4608
TR 238,16,6656
Mvaa 240,240,16
v_exp_f32 v27, v63
Mvaa 244,240,20
TR 240,15,8704
TR 242,15,10752
Mvaa 248,244,16
s_add_u32 m0, s38, 53248
v_cvt_pk_bf16_f32 v47, v26, v27
Mvaa 252,244,20
s_waitcnt lgkmcnt(6)
TR 244,16,8704
TR 246,16,10752
Mvaa 240,224,24
buffer_load_dwordx4 v5, s[12:15], s33 offen nt lds
Mvaa 244,224,28
s_add_u32 m0, s38, 85888
TR 224,15,24576
TR 226,15,26624
Mvaa 248,228,24
Mvaa 252,228,28
s_waitcnt lgkmcnt(6)
TR 228,16,24576
TR 230,16,26624
Mvaa 240,232,32
Mvaa 244,232,36
TR 232,15,25088
TR 234,15,27136
Mvaa 248,236,32
buffer_load_dwordx4 v5, s[12:15], s33 offen offset:128 nt lds
Mvaa 252,236,36
s_waitcnt lgkmcnt(6)
TR 236,16,25088
TR 238,16,27136
Mvaa 240,240,40
s_add_u32 m0, s38, 89856
Mvaa 244,240,44
TR 240,17,8192
TR 242,17,10240
Mvaa 248,244,40
Mvaa 252,244,44
s_waitcnt lgkmcnt(6)
TR 244,18,8192
TR 246,18,10240
Mvaa 224,224,48
buffer_load_dwordx4 v5, s[12:15], s33 offen offset:256 nt lds
Mvaa 228,224,52
s_add_u32 s33, s33, 6144
TR 224,17,8704
TR 226,17,10752
Mvaa 232,228,48
s_sub_u32 s45, s33, 98304
s_min_u32 s33, s33, s45
s_add_u32 m0, s38, 94208
Mvaa 236,228,52
s_waitcnt lgkmcnt(6)
TR 228,18,8704
TR 230,18,10752
Mvaa 240,232,48
Mvaa 244,232,52
TR 232,17,12288
TR 234,17,14336
Mvaa 248,236,48
buffer_load_dwordx4 v4, s[8:11], s32 offen nt lds
Mvaa 252,236,52
s_waitcnt lgkmcnt(6)
TR 236,18,12288
TR 238,18,14336
Mvaa 224,240,56
s_add_u32 m0, s38, 135040
Mvaa 228,240,60
TR 240,17,12800
TR 242,17,14848
Mvaa 232,244,56
Mvaa 236,244,60
s_waitcnt vmcnt(8) lgkmcnt(6)
TR 244,18,12800
TR 246,18,14848
Mvaa 240,224,56
s_barrier
Mvaa 244,224,60
ds_read_b128 a[224:227], v11 offset:12288
Mvaa 248,228,56
buffer_load_dwordx4 v4, s[8:11], s32 offen offset:128 nt lds
Mvaa 252,228,60
s_waitcnt lgkmcnt(5)
ds_read_b128 a[228:231], v11 offset:12800
s_add_u32 m0, s38, 139008
Mvaa 224,232,64
Mvaa 228,232,68
ds_read_b128 a[232:235], v10 offset:0
Mvaa 232,236,64
Mvaa 236,236,68
s_waitcnt lgkmcnt(3)
ds_read_b128 a[236:239], v10 offset:512
Mvaa 240,240,64
buffer_load_dwordx4 v4, s[8:11], s32 offen offset:256 nt lds
Mvaa 244,240,68
s_add_u32 s32, s32, 6144
ds_read_b128 a[240:243], v10 offset:24576
s_sub_u32 s45, s32, 98304
Mvaa 248,244,64
s_min_u32 s32, s32, s45
s_add_u32 m0, s38, 130560
Mvaa 252,244,68
s_waitcnt lgkmcnt(3)
ds_read_b128 a[244:247], v10 offset:25088
v_mfma_f32_16x16x32_bf16 v[64:67], a[224:227], v[176:179], 0
buffer_load_dwordx4 v6, s[16:19], s65 offen offset:512 lds
v_mfma_f32_16x16x32_bf16 v[72:75], a[224:227], v[180:183], 0
ds_read_b128 a[224:227], v11 offset:14336
Mvav 64,228,184
Mvav 72,228,188
s_waitcnt lgkmcnt(3)
ds_read_b128 a[228:231], v11 offset:14848
s_add_u32 s43, s66, 512
Mvav 64,232,192
s_add_u32 m0, s38, 0
Mvav 72,232,196
ds_read_b128 a[232:235], v10 offset:2048
Mvav 64,236,200
buffer_load_dwordx4 v6, s[16:19], s43 offen lds
Mvav 72,236,204
s_waitcnt lgkmcnt(3)
ds_read_b128 a[236:239], v10 offset:2560
Mvav 64,240,208
Mvav 72,240,212
ds_read_b128 a[240:243], v10 offset:26624
Mvav 64,244,216
Mvav 72,244,220
s_waitcnt lgkmcnt(3)
ds_read_b128 a[244:247], v10 offset:27136
v_mfma_f32_16x16x32_bf16 v[68:71], a[224:227], v[176:179], 0
v_exp_f32 v24, v64
v_mfma_f32_16x16x32_bf16 v[76:79], a[224:227], v[180:183], 0
TR 224,19,20480
TR 226,19,22528
Mvav 68,228,184
v_exp_f32 v25, v65
Mvav 76,228,188
s_waitcnt lgkmcnt(4)
TR 228,20,20480
TR 230,20,22528
Mvav 68,232,192
v_exp_f32 v26, v66
Mvav 76,232,196
TR 232,19,20992
TR 234,19,23040
Mvav 68,236,200
v_cvt_pk_bf16_f32 v28, v24, v25
Mvav 76,236,204
s_waitcnt lgkmcnt(6)
TR 236,20,20992
TR 238,20,23040
Mvav 68,240,208
v_exp_f32 v27, v67
Mvav 76,240,212
TR 240,19,24576
TR 242,19,26624
Mvav 68,244,216
v_exp_f32 v24, v72
Mvav 76,244,220
s_waitcnt lgkmcnt(6)
TR 244,20,24576
TR 246,20,26624
Mvaa 224,224,72
v_cvt_pk_bf16_f32 v29, v26, v27
Mvaa 228,224,76
TR 224,19,25088
TR 226,19,27136
Mvaa 232,228,72
v_exp_f32 v25, v73
Mvaa 236,228,76
s_waitcnt lgkmcnt(6)
TR 228,20,25088
TR 230,20,27136
Mvaa 240,232,72
v_exp_f32 v26, v74
Mvaa 244,232,76
Tc3:
s_cbranch_execz Tdone0
TR 232,19,16384
TR 234,19,18432
Mvaa 248,236,72
s_add_u32 m0, s38, 3584
v_cvt_pk_bf16_f32 v0, v24, v25
Mvaa 252,236,76
s_waitcnt lgkmcnt(6)
TR 236,20,16384
TR 238,20,18432
Mvaa 224,240,80
buffer_load_dwordx4 v6, s[16:19], s67 offen offset:512 lds
Mvaa 228,240,84
s_add_u32 m0, s38, 7680
TR 240,19,16896
TR 242,19,18944
Mvaa 232,244,80
v_exp_f32 v27, v75
Mvaa 236,244,84
s_waitcnt lgkmcnt(6)
TR 244,20,16896
TR 246,20,18944
Mvaa 240,224,80
buffer_load_dwordx4 v6, s[16:19], s68 offen offset:512 lds
Mvaa 244,224,84
s_add_u32 m0, s38, 11776
TR 224,19,4096
TR 226,19,6144
Mvaa 248,228,80
v_exp_f32 v24, v68
Mvaa 252,228,84
s_waitcnt lgkmcnt(6)
TR 228,20,4096
TR 230,20,6144
Mvaa 224,232,88
buffer_load_dwordx4 v6, s[16:19], s69 offen offset:512 lds
Mvaa 228,232,92
TR 232,19,4608
TR 234,19,6656
Mvaa 232,236,88
v_cvt_pk_bf16_f32 v1, v26, v27
Mvaa 236,236,92
s_waitcnt lgkmcnt(6)
TR 236,20,4608
TR 238,20,6656
Mvaa 240,240,88
v_exp_f32 v25, v69
Mvaa 244,240,92
TR 240,19,8192
TR 242,19,10240
Mvaa 248,244,88
v_exp_f32 v26, v70
Mvaa 252,244,92
s_waitcnt lgkmcnt(6)
TR 244,20,8192
TR 246,20,10240
Mvaa 224,224,96
v_cvt_pk_bf16_f32 v30, v24, v25
Mvaa 228,224,100
TR 224,19,8704
TR 226,19,10752
Mvaa 232,228,96
v_exp_f32 v27, v71
Mvaa 236,228,100
s_waitcnt lgkmcnt(6)
TR 228,20,8704
TR 230,20,10752
Mvaa 240,232,96
v_cvt_pk_bf16_f32 v31, v26, v27
Mvaa 244,232,100
TR 232,15,28672
TR 234,15,30720
Mvaa 248,236,96
v_exp_f32 v24, v76
Mvaa 252,236,100
s_waitcnt lgkmcnt(6)
TR 236,16,28672
TR 238,16,30720
Mvaa 224,240,104
v_exp_f32 v25, v77
Mvaa 228,240,108
TR 240,15,32768
TR 242,15,34816
Mvaa 232,244,104
v_exp_f32 v26, v78
Mvaa 236,244,108
s_waitcnt lgkmcnt(6)
TR 244,16,32768
TR 246,16,34816
Mvaa 240,224,104
v_cvt_pk_bf16_f32 v2, v24, v25
Mvaa 244,224,108
TR 224,15,36864
TR 226,15,38912
Mvaa 248,228,104
s_add_u32 m0, s38, 16384
v_exp_f32 v27, v79
Mvaa 252,228,108
s_waitcnt lgkmcnt(6)
TR 228,16,36864
TR 230,16,38912
Mvaa 224,232,112
buffer_load_dwordx4 v5, s[12:15], s33 offen nt lds
Mvaa 228,232,116
s_add_u32 m0, s38, 20352
TR 232,15,40960
TR 234,15,43008
Mvaa 232,236,112
v_cvt_pk_bf16_f32 v3, v26, v27
Mvaa 236,236,116
s_waitcnt lgkmcnt(6)
TR 236,16,40960
TR 238,16,43008
Mvaa 224,240,120
Mvaa 228,240,124
TR 240,19,61440
TR 242,19,63488
Mvaa 232,244,120
buffer_load_dwordx4 v5, s[12:15], s33 offen offset:128 nt lds
Mvaa 236,244,124
s_waitcnt lgkmcnt(6)
s_add_u32 m0, s38, 24320
Mvaa 224,224,128
Mvaa 228,224,132
TR 224,20,61440
TR 226,20,63488
Mvaa 232,228,128
Mvaa 236,228,132
s_waitcnt lgkmcnt(4)
TR 228,19,53248
TR 230,19,55296
Mvaa 224,232,136
buffer_load_dwordx4 v5, s[12:15], s33 offen offset:256 nt lds
Mvaa 228,232,140
TR 232,20,53248
TR 234,20,55296
Mvaa 232,236,136
s_barrier
Mvaa 236,236,140
s_waitcnt lgkmcnt(6)
TR 236,17,28672
TR 238,17,30720
Mvaa 224,240,144
s_add_u32 s33, s33, 6144
s_sub_u32 s45, s33, 98304
s_min_u32 s33, s33, s45
Mvaa 228,240,148
s_add_u32 m0, s38, 118784
TR 240,18,28672
TR 242,18,30720
v_mfma_f32_16x16x32_bf16 v[32:35], a[252:255], v[40:43], 0
buffer_load_dwordx4 v4, s[8:11], s32 offen nt lds
v_mfma_f32_16x16x32_bf16 v[36:39], a[252:255], v[44:47], 0
s_waitcnt lgkmcnt(6)
TR 244,17,29184
TR 246,17,31232
Mvaa 232,224,144
s_add_u32 m0, s38, 122752
Mvaa 236,224,148
TR 224,18,29184
TR 226,18,31232
Mvaa 224,228,152
s_mov_b32 s39, 0x4b800000
v_min_f32 v33, v32, v36
Mvaa 228,228,156
s_waitcnt lgkmcnt(6)
TR 228,17,32768
TR 230,17,34816
Mvaa 232,232,152
buffer_load_dwordx4 v4, s[8:11], s32 offen offset:128 nt lds
Mvaa 236,232,156
s_add_u32 m0, s38, 110336
TR 232,18,32768
TR 234,18,34816
v_rcp_f32 v33, v33
s_nop 0
v_max3_f32 v33, v33, v32, v36
v_cmp_nge_f32 vcc, s39, v33
s_cbranch_vccnz Lr0
Lb0:
v_mfma_f32_16x16x32_bf16 v[80:83], a[236:239], v[40:43], 0
v_mul_f32 v224, s40, v224
v_mul_f32 v225, s40, v225
v_mfma_f32_16x16x32_bf16 v[84:87], a[236:239], v[44:47], 0
s_waitcnt lgkmcnt(6)
TR 236,17,33280
TR 238,17,35328
v_mfma_f32_16x16x32_bf16 v[88:91], a[240:243], v[40:43], 0
v_mul_f32 v226, s40, v226
v_mul_f32 v227, s40, v227
v_mfma_f32_16x16x32_bf16 v[92:95], a[240:243], v[44:47], 0
TR 240,18,33280
TR 242,18,35328
v_mfma_f32_16x16x32_bf16 v[96:99], a[244:247], v[40:43], 0
buffer_load_dwordx4 v4, s[8:11], s32 offen offset:256 nt lds
v_mfma_f32_16x16x32_bf16 v[100:103], a[244:247], v[44:47], 0
s_waitcnt lgkmcnt(6)
TR 244,19,28672
TR 246,19,30720
v_mfma_f32_16x16x32_bf16 v[104:107], a[224:227], v[40:43], 0
s_add_u32 s32, s32, 6144
v_mul_f32 v232, s40, v232
v_mul_f32 v233, s40, v233
v_mfma_f32_16x16x32_bf16 v[108:111], a[224:227], v[44:47], 0
s_sub_u32 s45, s32, 98304
TR 224,20,28672
TR 226,20,30720
v_mfma_f32_16x16x32_bf16 v[112:115], a[228:231], v[40:43], 0
s_min_u32 s32, s32, s45
v_mul_f32 v234, s40, v234
v_mul_f32 v235, s40, v235
v_mfma_f32_16x16x32_bf16 v[116:119], a[228:231], v[44:47], 0
s_waitcnt lgkmcnt(6)
TR 228,19,29184
TR 230,19,31232
v_mfma_f32_16x16x32_bf16 v[120:123], a[232:235], v[40:43], 0
v_cvt_pk_bf16_f32 v224, v224, v225
v_cvt_pk_bf16_f32 v225, v226, v227
v_mfma_f32_16x16x32_bf16 v[124:127], a[232:235], v[44:47], 0
TR 232,20,29184
TR 234,20,31232
v_mfma_f32_16x16x32_bf16 v[128:131], a[236:239], v[40:43], 0
s_add_u32 m0, s38, 114176
v_cvt_pk_bf16_f32 v226, v232, v233
v_cvt_pk_bf16_f32 v227, v234, v235
v_mfma_f32_16x16x32_bf16 v[132:135], a[236:239], v[44:47], 0
s_waitcnt lgkmcnt(6)
TR 236,15,29184
TR 238,15,31232
v_mfma_f32_16x16x32_bf16 v[136:139], a[240:243], v[40:43], 0
buffer_load_dwordx4 v6, s[16:19], s70 offen offset:512 lds
v_mfma_f32_16x16x32_bf16 v[140:143], a[240:243], v[44:47], 0
TR 240,16,29184
TR 242,16,31232
v_mfma_f32_16x16x32_bf16 v[144:147], a[244:247], v[40:43], 0
v_permlane16_swap_b32 v224, v226
v_permlane16_swap_b32 v225, v227
v_mfma_f32_16x16x32_bf16 v[148:151], a[244:247], v[44:47], 0
s_waitcnt lgkmcnt(6)
TR 244,15,33280
TR 246,15,35328
v_mfma_f32_16x16x32_bf16 v[152:155], a[224:227], v[40:43], 0
v_accvgpr_write_b32 a160, v224
v_accvgpr_write_b32 a161, v225
v_mfma_f32_16x16x32_bf16 v[156:159], a[224:227], v[44:47], 0
TR 224,16,33280
TR 226,16,35328
v_mfma_f32_16x16x32_bf16 v[160:163], a[228:231], v[40:43], 0
v_accvgpr_write_b32 a162, v226
v_accvgpr_write_b32 a163, v227
v_mfma_f32_16x16x32_bf16 v[164:167], a[228:231], v[44:47], 0
s_waitcnt lgkmcnt(6)
TR 228,15,37376
TR 230,15,39424
v_mfma_f32_16x16x32_bf16 v[168:171], a[232:235], v[40:43], 0
v_mul_f32 v228, s40, v228
v_mul_f32 v229, s40, v229
v_mfma_f32_16x16x32_bf16 v[172:175], a[232:235], v[44:47], 0
TR 232,16,37376
TR 234,16,39424
Mvaa 240,236,112
v_mul_f32 v230, s40, v230
v_mul_f32 v231, s40, v231
Mvaa 244,236,116
s_waitcnt lgkmcnt(6)
TR 236,15,41472
TR 238,15,43520
Mvaa 248,240,112
v_mul_f32 v236, s40, v236
v_mul_f32 v237, s40, v237
Mvaa 252,240,116
TR 240,16,41472
TR 242,16,43520
Mvaa 240,244,120
v_mul_f32 v238, s40, v238
v_mul_f32 v239, s40, v239
Mvaa 244,244,124
s_waitcnt lgkmcnt(6)
TR 244,19,61952
TR 246,19,64000
Mvaa 248,224,120
v_cvt_pk_bf16_f32 v228, v228, v229
v_cvt_pk_bf16_f32 v229, v230, v231
Mvaa 252,224,124
TR 224,20,61952
TR 226,20,64000
Mvaa 240,228,128
v_cvt_pk_bf16_f32 v230, v236, v237
v_cvt_pk_bf16_f32 v231, v238, v239
Mvaa 244,228,132
s_waitcnt lgkmcnt(6)
TR 228,19,53760
TR 230,19,55808
Mvaa 248,232,128
v_permlane16_swap_b32 v228, v230
v_permlane16_swap_b32 v229, v231
Mvaa 252,232,132
s_waitcnt vmcnt(7)
TR 232,20,53760
TR 234,20,55808
Mvaa 240,236,136
s_barrier
Mvaa 244,236,140
s_waitcnt lgkmcnt(6)
ds_read_b128 a[236:239], v11 offset:57344
v_accvgpr_write_b32 a164, v228
Mvaa 248,240,136
v_accvgpr_write_b32 a165, v229
v_accvgpr_write_b32 a166, v230
Mvaa 252,240,140
ds_read_b128 a[240:243], v11 offset:57856
v_accvgpr_write_b32 a167, v231
Mvaa 240,244,144
s_add_u32 m0, s38, 126464
Mvaa 244,244,148
s_waitcnt lgkmcnt(4)
ds_read_b128 a[244:247], v11 offset:45056
Mvaa 248,224,144
buffer_load_dwordx4 v6, s[16:19], s71 offen offset:512 lds
Mvaa 252,224,148
s_add_u32 m0, s38, 101888
ds_read_b128 a[224:227], v11 offset:45568
Mvaa 240,228,152
Mvaa 244,228,156
s_waitcnt lgkmcnt(3)
ds_read_b128 a[228:231], v11 offset:49152
Mvaa 248,232,152
buffer_load_dwordx4 v6, s[16:19], s72 offen offset:512 lds
Mvaa 252,232,156
ds_read_b128 a[232:235], v11 offset:49664
v_mul_f32 v240, s40, v240
v_mfma_f32_16x16x32_bf16 v[48:51], a[236:239], v[176:179], 0
v_mul_f32 v241, s40, v241
v_mul_f32 v242, s40, v242
v_mfma_f32_16x16x32_bf16 v[56:59], a[236:239], v[180:183], 0
s_waitcnt lgkmcnt(3)
ds_read_b128 a[236:239], v11 offset:59392
v_mul_f32 v243, s40, v243
Mvav 48,240,184
v_mul_f32 v248, s40, v248
v_mul_f32 v249, s40, v249
Mvav 56,240,188
ds_read_b128 a[240:243], v11 offset:59904
v_mul_f32 v250, s40, v250
Mvav 48,244,192
v_mul_f32 v251, s40, v251
v_cvt_pk_bf16_f32 v240, v240, v241
Mvav 56,244,196
s_waitcnt lgkmcnt(3)
ds_read_b128 a[244:247], v11 offset:47104
v_cvt_pk_bf16_f32 v241, v242, v243
Mvav 48,224,200
v_cvt_pk_bf16_f32 v242, v248, v249
v_cvt_pk_bf16_f32 v243, v250, v251
Mvav 56,224,204
ds_read_b128 a[224:227], v11 offset:47616
v_permlane16_swap_b32 v240, v242
Mvav 48,228,208
v_permlane16_swap_b32 v241, v243
v_accvgpr_write_b32 a168, v240
Mvav 56,228,212
s_waitcnt lgkmcnt(3)
ds_read_b128 a[228:231], v11 offset:51200
v_accvgpr_write_b32 a169, v241
Mvav 48,232,216
v_accvgpr_write_b32 a170, v242
v_accvgpr_write_b32 a171, v243
Mvav 56,232,220
ds_read_b128 a[232:235], v11 offset:51712
v_mul_f32 v244, s40, v244
v_mfma_f32_16x16x32_bf16 v[52:55], a[236:239], v[176:179], 0
v_mul_f32 v245, s40, v245
v_mul_f32 v246, s40, v246
v_mfma_f32_16x16x32_bf16 v[60:63], a[236:239], v[180:183], 0
s_waitcnt lgkmcnt(3)
TR 236,15,45056
TR 238,15,47104
Mvav 52,240,184
s_add_u32 m0, s38, 105984
v_mul_f32 v247, s40, v247
v_mul_f32 v252, s40, v252
Mvav 60,240,188
TR 240,16,45056
TR 242,16,47104
Mvav 52,244,192
buffer_load_dwordx4 v6, s[16:19], s73 offen offset:512 lds
Mvav 60,244,196
s_waitcnt lgkmcnt(5)
TR 244,19,32768
TR 246,19,34816
Mvav 52,224,200
s_add_u32 m0, s38, 28160
v_mul_f32 v253, s40, v253
v_mul_f32 v254, s40, v254
Mvav 60,224,204
TR 224,20,32768
TR 226,20,34816
Mvav 52,228,208
buffer_load_dwordx4 v6, s[16:19], s74 offen offset:512 lds
Mvav 60,228,212
s_waitcnt lgkmcnt(6)
TR 228,15,0
TR 230,15,2048
Mvav 52,232,216
v_mul_f32 v255, s40, v255
v_cvt_pk_bf16_f32 v244, v244, v245
Mvav 60,232,220
TR 232,16,0
TR 234,16,2048
v_mfma_f32_16x16x32_bf16 v[224:227], a[236:239], a[0:3], 0
s_add_u32 m0, s38, 32768
v_cvt_pk_bf16_f32 v245, v246, v247
v_cvt_pk_bf16_f32 v246, v252, v253
v_mfma_f32_16x16x32_bf16 v[228:231], a[236:239], a[4:7], 0
s_waitcnt lgkmcnt(6)
TR 236,15,4096
TR 238,15,6144
v_mfma_f32_16x16x32_bf16 v[232:235], a[240:243], a[0:3], 0
buffer_load_dwordx4 v5, s[12:15], s33 offen nt lds
v_mfma_f32_16x16x32_bf16 v[236:239], a[240:243], a[4:7], 0
s_add_u32 m0, s38, 36736
TR 240,16,4096
TR 242,16,6144
Mvaa 224,244,8
v_cvt_pk_bf16_f32 v247, v254, v255
v_permlane16_swap_b32 v244, v246
Mvaa 228,244,12
s_waitcnt lgkmcnt(6)
TR 244,15,8192
TR 246,15,10240
Mvaa 232,224,8
v_permlane16_swap_b32 v245, v247
v_accvgpr_write_b32 a172, v244
Mvaa 236,224,12
v_accvgpr_write_b32 a173, v245
v_accvgpr_write_b32 a174, v246
Mvaa 224,228,16
buffer_load_dwordx4 v5, s[12:15], s33 offen offset:128 nt lds
Mvaa 228,228,20
s_waitcnt lgkmcnt(4)
TR 228,16,8192
TR 230,16,10240
Mvaa 232,232,16
s_add_u32 m0, s38, 159488
v_accvgpr_write_b32 a175, v247
Mvaa 236,232,20
TR 232,15,12288
TR 234,15,14336
Mvaa 224,236,24
v_exp_f32 v24, v48
Mvaa 228,236,28
s_waitcnt lgkmcnt(4)
TR 236,16,12288
TR 238,16,14336
Mvaa 232,240,24
s_barrier
Mvaa 236,240,28
TR 240,17,4096
TR 242,17,6144
Mvaa 224,244,32
buffer_load_dwordx4 v5, s[12:15], s33 offen offset:256 nt lds
Mvaa 228,244,36
s_waitcnt lgkmcnt(6)
TR 244,18,4096
TR 246,18,6144
Mvav 32,252,28
s_add_u32 s33, s33, 6144
v_exp_f32 v25, v49
Mvav 36,252,0
s_sub_u32 s45, s33, 98304
TR 224,17,4608
TR 226,17,6656
Mvaa 232,228,32
s_min_u32 s33, s33, s45
v_exp_f32 v26, v50
Mvaa 236,228,36
s_waitcnt lgkmcnt(6)
TR 228,18,4608
TR 230,18,6656
Mvaa 224,232,40
s_add_u32 m0, s38, 151552
v_max_f32 v33, v32, v36
v_cmp_nge_f32 vcc, s39, v33
Mvaa 228,232,44
TR 232,17,36864
TR 234,17,38912
Mvaa 232,236,40
buffer_load_dwordx4 v4, s[8:11], s32 offen nt lds
Mvaa 236,236,44
s_waitcnt lgkmcnt(6)
TR 236,18,36864
TR 238,18,38912
s_cbranch_vccnz Lr1
Lb1:
Mvav 80,240,28
s_add_u32 m0, s38, 155520
v_cvt_pk_bf16_f32 v40, v24, v25
Mvav 84,240,0
TR 240,17,37376
TR 242,17,39424
Mvav 88,244,28
v_exp_f32 v27, v51
Mvav 92,244,0
s_waitcnt lgkmcnt(6)
TR 244,18,37376
TR 246,18,39424
Mvav 96,224,28
buffer_load_dwordx4 v4, s[8:11], s32 offen offset:128 nt lds
Mvav 100,224,0
s_add_u32 m0, s38, 143104
TR 224,17,40960
TR 226,17,43008
Mvav 104,228,28
v_exp_f32 v24, v56
Mvav 108,228,0
s_waitcnt lgkmcnt(6)
TR 228,18,40960
TR 230,18,43008
Mvav 112,232,28
v_cvt_pk_bf16_f32 v41, v26, v27
Mvav 116,232,0
TR 232,17,41472
TR 234,17,43520
Mvav 120,236,28
buffer_load_dwordx4 v4, s[8:11], s32 offen offset:256 nt lds
Mvav 124,236,0
s_waitcnt lgkmcnt(6)
TR 236,18,41472
TR 238,18,43520
Mvav 128,240,28
s_add_u32 s32, s32, 6144
v_exp_f32 v25, v57
Mvav 132,240,0
s_sub_u32 s45, s32, 98304
TR 240,15,45568
TR 242,15,47616
Mvav 136,244,28
s_min_u32 s32, s32, s45
v_exp_f32 v26, v58
Mvav 140,244,0
s_waitcnt lgkmcnt(6)
TR 244,16,45568
TR 246,16,47616
Mvav 144,224,28
s_add_u32 m0, s38, 146944
v_cvt_pk_bf16_f32 v44, v24, v25
Mvav 148,224,0
TR 224,19,33280
TR 226,19,35328
Mvav 152,228,28
buffer_load_dwordx4 v6, s[16:19], s75 offen offset:512 lds
Mvav 156,228,0
s_waitcnt lgkmcnt(6)
TR 228,20,33280
TR 230,20,35328
Mvav 160,232,28
v_exp_f32 v27, v59
Mvav 164,232,0
TR 232,15,512
TR 234,15,2560
Mvav 168,236,28
v_exp_f32 v24, v52
Mvav 172,236,0
s_waitcnt lgkmcnt(6)
TR 236,16,512
TR 238,16,2560
v_mfma_f32_16x16x32_bf16 v[240:243], a[240:243], a[0:3], 0
v_cvt_pk_bf16_f32 v45, v26, v27
v_mfma_f32_16x16x32_bf16 v[244:247], a[240:243], a[4:7], 0
TR 240,15,4608
TR 242,15,6656
v_mfma_f32_16x16x32_bf16 v[248:251], a[244:247], a[0:3], 0
v_exp_f32 v25, v53
v_mfma_f32_16x16x32_bf16 v[252:255], a[244:247], a[4:7], 0
s_waitcnt lgkmcnt(6)
TR 244,16,4608
Tc4:
s_cbranch_execz Tdone1
TR 246,16,6656
Mvaa 240,224,8
v_exp_f32 v26, v54
Mvaa 244,224,12
TR 224,15,8704
TR 226,15,10752
Mvaa 248,228,8
v_cvt_pk_bf16_f32 v42, v24, v25
Mvaa 252,228,12
s_waitcnt lgkmcnt(6)
TR 228,16,8704
TR 230,16,10752
Mvaa 240,232,16
v_exp_f32 v27, v55
Mvaa 244,232,20
TR 232,15,12800
TR 234,15,14848
Mvaa 248,236,16
v_cvt_pk_bf16_f32 v43, v26, v27
Mvaa 252,236,20
s_waitcnt vmcnt(9) lgkmcnt(6)
TR 236,16,12800
TR 238,16,14848
Mvaa 240,240,24
s_barrier
Mvaa 244,240,28
ds_read_b128 a[240:243], v10 offset:45056
Mvaa 248,244,24
v_exp_f32 v24, v60
Mvaa 252,244,28
s_waitcnt lgkmcnt(5)
ds_read_b128 a[244:247], v10 offset:45568
Mvaa 240,224,32
v_exp_f32 v25, v61
Mvaa 244,224,36
ds_read_b128 a[224:227], v11 offset:36864
v_cvt_pk_bf16_f32 v46, v24, v25
Mvaa 248,228,32
s_add_u32 m0, s38, 130560
v_exp_f32 v26, v62
Mvaa 252,228,36
s_waitcnt lgkmcnt(3)
ds_read_b128 a[228:231], v11 offset:37376
Mvaa 240,232,40
buffer_load_dwordx4 v6, s[16:19], s76 offen offset:512 lds
Mvaa 244,232,44
s_add_u32 s43, s77, 512
ds_read_b128 a[232:235], v11 offset:40960
s_add_u32 m0, s38, 0
Mvaa 248,236,40
v_exp_f32 v27, v63
Mvaa 252,236,44
s_waitcnt lgkmcnt(3)
ds_read_b128 a[236:239], v11 offset:41472
v_cvt_pk_bf16_f32 v47, v26, v27
v_mfma_f32_16x16x32_bf16 v[64:67], a[240:243], v[176:179], 0
buffer_load_dwordx4 v6, s[16:19], s43 offen lds
v_mfma_f32_16x16x32_bf16 v[72:75], a[240:243], v[180:183], 0
ds_read_b128 a[240:243], v10 offset:47104
Mvav 64,244,184
Mvav 72,244,188
s_waitcnt lgkmcnt(3)
ds_read_b128 a[244:247], v10 offset:47616
Mvav 64,224,192
Mvav 72,224,196
ds_read_b128 a[224:227], v11 offset:38912
s_add_u32 m0, s38, 40448
Mvav 64,228,200
Mvav 72,228,204
s_waitcnt lgkmcnt(3)
ds_read_b128 a[228:231], v11 offset:39424
Mvav 64,232,208
buffer_load_dwordx4 v6, s[16:19], s78 offen offset:512 lds
Mvav 72,232,212
s_add_u32 m0, s38, 44544
ds_read_b128 a[232:235], v11 offset:43008
Mvav 64,236,216
Mvav 72,236,220
s_waitcnt lgkmcnt(3)
ds_read_b128 a[236:239], v11 offset:43520
v_mfma_f32_16x16x32_bf16 v[68:71], a[240:243], v[176:179], 0
buffer_load_dwordx4 v6, s[16:19], s79 offen offset:512 lds
v_mfma_f32_16x16x32_bf16 v[76:79], a[240:243], v[180:183], 0
s_add_u32 m0, s38, 48640
TR 240,19,16384
TR 242,19,18432
Mvav 68,244,184
v_exp_f32 v24, v64
Mvav 76,244,188
s_waitcnt lgkmcnt(4)
TR 244,20,16384
TR 246,20,18432
Mvav 68,224,192
buffer_load_dwordx4 v6, s[16:19], s80 offen offset:512 lds
Mvav 76,224,196
s_add_u32 m0, s38, 52736
TR 224,19,16896
TR 226,19,18944
Mvav 68,228,200
v_exp_f32 v25, v65
Mvav 76,228,204
s_waitcnt lgkmcnt(6)
TR 228,20,16896
TR 230,20,18944
Mvav 68,232,208
buffer_load_dwordx4 v6, s[16:19], s81 offen offset:512 lds
Mvav 76,232,212
s_add_u32 m0, s38, 56832
TR 232,19,28672
TR 234,19,30720
Mvav 68,236,216
v_exp_f32 v26, v66
Mvav 76,236,220
s_waitcnt lgkmcnt(6)
TR 236,20,28672
TR 238,20,30720
Mvaa 224,240,48
buffer_load_dwordx4 v6, s[16:19], s82 offen offset:512 lds
Mvaa 228,240,52
s_add_u32 m0, s38, 60928
TR 240,19,29184
TR 242,19,31232
Mvaa 232,244,48
v_cvt_pk_bf16_f32 v28, v24, v25
Mvaa 236,244,52
s_waitcnt lgkmcnt(6)
TR 244,20,29184
TR 246,20,31232
Mvaa 240,224,48
buffer_load_dwordx4 v6, s[16:19], s83 offen offset:512 lds
Mvaa 244,224,52
s_add_u32 m0, s38, 65536
TR 224,19,4096
TR 226,19,6144
Mvaa 248,228,48
v_exp_f32 v27, v67
Mvaa 252,228,52
s_waitcnt lgkmcnt(6)
v_exp_f32 v24, v72
Mvaa 224,232,56
v_cvt_pk_bf16_f32 v29, v26, v27
Mvaa 228,232,60
TR 232,20,4096
TR 234,20,6144
Mvaa 232,236,56
buffer_load_dwordx4 v5, s[12:15], s33 offen nt lds
Mvaa 236,236,60
s_waitcnt lgkmcnt(4)
TR 236,19,4608
TR 238,19,6656
Mvaa 240,240,56
s_add_u32 m0, s38, 69504
v_exp_f32 v25, v73
Mvaa 244,240,60
s_waitcnt vmcnt(16)
TR 240,20,4608
TR 242,20,6656
Mvaa 248,244,56
s_barrier
Mvaa 252,244,60
s_waitcnt lgkmcnt(6)
TR 244,15,16384
TR 246,15,18432
Mvaa 224,224,64
buffer_load_dwordx4 v5, s[12:15], s33 offen offset:128 nt lds
Mvaa 228,224,68
s_add_u32 m0, s38, 134912
TR 224,16,16384
TR 226,16,18432
Mvav 32,252,40
v_exp_f32 v26, v74
Mvav 36,252,44
s_waitcnt lgkmcnt(6)
TR 228,15,16896
TR 230,15,18944
Mvaa 232,232,64
v_cvt_pk_bf16_f32 v0, v24, v25
Mvaa 236,232,68
TR 232,16,16896
TR 234,16,18944
Mvaa 240,236,64
buffer_load_dwordx4 v5, s[12:15], s33 offen offset:256 nt lds
Mvaa 244,236,68
s_waitcnt lgkmcnt(6)
TR 236,15,20480
TR 238,15,22528
Mvaa 248,240,64
s_add_u32 s33, s33, 6144
v_max_f32 v33, v32, v36
v_cmp_nge_f32 vcc, s39, v33
Mvaa 252,240,68
s_sub_u32 s45, s33, 98304
TR 240,16,20480
TR 242,16,22528
s_cbranch_vccnz Lr2
Lb2:
Mvav 80,244,40
s_min_u32 s33, s33, s45
v_exp_f32 v27, v75
Mvav 84,244,44
s_waitcnt lgkmcnt(6)
TR 244,15,20992
TR 246,15,23040
Mvav 88,224,40
s_add_u32 m0, s38, 139264
v_exp_f32 v24, v68
Mvav 92,224,44
TR 224,16,20992
TR 226,16,23040
Mvav 96,228,40
buffer_load_dwordx4 v4, s[8:11], s32 offen nt lds
Mvav 100,228,44
s_waitcnt lgkmcnt(6)
TR 228,15,24576
TR 230,15,26624
Mvav 104,232,40
s_add_u32 m0, s38, 126848
v_cvt_pk_bf16_f32 v1, v26, v27
Mvav 108,232,44
TR 232,16,24576
TR 234,16,26624
Mvav 112,236,40
v_exp_f32 v25, v69
Mvav 116,236,44
s_waitcnt lgkmcnt(6)
TR 236,15,25088
TR 238,15,27136
Mvav 120,240,40
buffer_load_dwordx4 v4, s[8:11], s32 offen offset:128 nt lds
Mvav 124,240,44
s_add_u32 m0, s38, 114432
TR 240,16,25088
TR 242,16,27136
Mvav 128,244,40
v_exp_f32 v26, v70
Mvav 132,244,44
s_waitcnt lgkmcnt(6)
TR 244,19,8192
TR 246,19,10240
Mvav 136,224,40
v_cvt_pk_bf16_f32 v30, v24, v25
Mvav 140,224,44
TR 224,20,8192
TR 226,20,10240
Mvav 144,228,40
buffer_load_dwordx4 v4, s[8:11], s32 offen offset:256 nt lds
Mvav 148,228,44
s_waitcnt lgkmcnt(6)
TR 228,19,8704
TR 230,19,10752
Mvav 152,232,40
s_add_u32 s32, s32, 6144
v_exp_f32 v27, v71
Mvav 156,232,44
s_sub_u32 s45, s32, 98304
TR 232,20,8704
TR 234,20,10752
Mvav 160,236,40
s_min_u32 s32, s32, s45
v_cvt_pk_bf16_f32 v31, v26, v27
Mvav 164,236,44
s_waitcnt lgkmcnt(6)
TR 236,15,28672
TR 238,15,30720
Mvav 168,240,40
v_exp_f32 v24, v76
Mvav 172,240,44
TR 240,16,28672
TR 242,16,30720
Mvaa 224,244,72
v_exp_f32 v25, v77
Mvaa 228,244,76
s_waitcnt lgkmcnt(6)
TR 244,15,29184
TR 246,15,31232
Mvaa 232,224,72
v_exp_f32 v26, v78
Mvaa 236,224,76
s_waitcnt vmcnt(12)
TR 224,16,29184
TR 226,16,31232
Mvaa 240,228,72
s_barrier
Mvaa 244,228,76
s_waitcnt lgkmcnt(6)
ds_read_b128 a[228:231], v11 offset:20480
v_cvt_pk_bf16_f32 v2, v24, v25
Mvaa 248,232,72
v_exp_f32 v27, v79
Mvaa 252,232,76
ds_read_b128 a[232:235], v11 offset:20992
v_cvt_pk_bf16_f32 v3, v26, v27
Mvaa 224,236,80
Mvaa 228,236,84
s_waitcnt lgkmcnt(4)
ds_read_b128 a[236:239], v11 offset:24576
Mvaa 232,240,80
Mvaa 236,240,84
ds_read_b128 a[240:243], v11 offset:25088
Mvaa 240,244,80
Mvaa 244,244,84
s_waitcnt lgkmcnt(3)
ds_read_b128 a[244:247], v11 offset:12288
Mvaa 248,224,80
Mvaa 252,224,84
ds_read_b128 a[224:227], v11 offset:12800
v_mfma_f32_16x16x32_bf16 v[48:51], a[228:231], v[176:179], 0
v_mfma_f32_16x16x32_bf16 v[56:59], a[228:231], v[180:183], 0
s_waitcnt lgkmcnt(3)
ds_read_b128 a[228:231], v11 offset:22528
Mvav 48,232,184
Mvav 56,232,188
ds_read_b128 a[232:235], v11 offset:23040
Mvav 48,236,192
Mvav 56,236,196
s_waitcnt lgkmcnt(3)
ds_read_b128 a[236:239], v11 offset:26624
Mvav 48,240,200
Mvav 56,240,204
ds_read_b128 a[240:243], v11 offset:27136
Mvav 48,244,208
Mvav 56,244,212
s_waitcnt lgkmcnt(3)
ds_read_b128 a[244:247], v11 offset:14336
Mvav 48,224,216
Mvav 56,224,220
ds_read_b128 a[224:227], v11 offset:14848
v_mfma_f32_16x16x32_bf16 v[52:55], a[228:231], v[176:179], 0
v_exp_f32 v24, v48
v_mfma_f32_16x16x32_bf16 v[60:63], a[228:231], v[180:183], 0
s_waitcnt lgkmcnt(3)
TR 228,19,49152
TR 230,19,51200
Mvav 52,232,184
s_add_u32 m0, s38, 101760
v_exp_f32 v25, v49
Mvav 60,232,188
TR 232,20,49152
TR 234,20,51200
Mvav 52,236,192
buffer_load_dwordx4 v6, s[16:19], s66 offen offset:640 lds
Mvav 60,236,196
s_waitcnt lgkmcnt(5)
TR 236,19,49664
TR 238,19,51712
Mvav 52,240,200
s_add_u32 m0, s38, 3456
v_exp_f32 v26, v50
Mvav 60,240,204
TR 240,20,49664
TR 242,20,51712
Mvav 52,244,208
buffer_load_dwordx4 v6, s[16:19], s67 offen offset:640 lds
Mvav 60,244,212
s_waitcnt lgkmcnt(6)
TR 244,19,32768
TR 246,19,34816
Mvav 52,224,216
s_add_u32 m0, s38, 7552
v_cvt_pk_bf16_f32 v40, v24, v25
Mvav 60,224,220
TR 224,20,32768
TR 226,20,34816
Mvaa 224,228,88
buffer_load_dwordx4 v6, s[16:19], s68 offen offset:640 lds
Mvaa 228,228,92
s_waitcnt lgkmcnt(6)
TR 228,19,33280
TR 230,19,35328
Mvaa 232,232,88
s_add_u32 m0, s38, 11648
v_exp_f32 v27, v51
Mvaa 236,232,92
TR 232,20,33280
TR 234,20,35328
Mvaa 240,236,88
buffer_load_dwordx4 v6, s[16:19], s69 offen offset:640 lds
Mvaa 244,236,92
s_waitcnt lgkmcnt(6)
TR 236,15,0
TR 238,15,2048
Mvaa 248,240,88
v_exp_f32 v24, v56
Mvaa 252,240,92
v_cvt_pk_bf16_f32 v41, v26, v27
Mvaa 224,244,96
v_exp_f32 v25, v57
Mvaa 228,244,100
s_waitcnt lgkmcnt(4)
TR 244,16,0
TR 246,16,2048
Mvaa 232,224,96
v_exp_f32 v26, v58
Mvaa 236,224,100
s_add_u32 m0, s38, 16384
TR 224,15,512
TR 226,15,2560
Mvaa 240,228,96
v_cvt_pk_bf16_f32 v44, v24, v25
Mvaa 244,228,100
s_waitcnt vmcnt(10) lgkmcnt(4)
TR 228,16,512
TR 230,16,2560
Mvaa 248,232,96
s_barrier
Mvaa 252,232,100
TR 232,15,32768
TR 234,15,34816
Mvaa 224,236,104
buffer_load_dwordx4 v5, s[12:15], s33 offen nt lds
Mvaa 228,236,108
s_waitcnt lgkmcnt(6)
TR 236,16,32768
TR 238,16,34816
Mvav 32,252,28
s_add_u32 m0, s38, 147328
v_exp_f32 v27, v59
Mvav 36,252,0
TR 240,15,33280
TR 242,15,35328
Mvaa 232,244,104
v_exp_f32 v24, v52
Mvaa 236,244,108
s_waitcnt lgkmcnt(6)
TR 244,16,33280
TR 246,16,35328
Mvaa 240,224,104
buffer_load_dwordx4 v5, s[12:15], s33 offen offset:128 nt lds
Mvaa 244,224,108
s_add_u32 m0, s38, 130816
TR 224,15,36864
TR 226,15,38912
Mvaa 248,228,104
v_max_f32 v33, v32, v36
v_cmp_nge_f32 vcc, s39, v33
Mvaa 252,228,108
s_waitcnt lgkmcnt(6)
TR 228,16,36864
TR 230,16,38912
s_cbranch_vccnz Lr3
Lb3:
Mvav 80,232,28
v_cvt_pk_bf16_f32 v45, v26, v27
Mvav 84,232,0
TR 232,15,37376
TR 234,15,39424
Mvav 88,236,28
buffer_load_dwordx4 v5, s[12:15], s33 offen offset:256 nt lds
Mvav 92,236,0
s_waitcnt lgkmcnt(6)
TR 236,16,37376
TR 238,16,39424
Mvav 96,240,28
s_add_u32 s33, s33, 6144
v_exp_f32 v25, v53
Mvav 100,240,0
s_sub_u32 s45, s33, 98304
TR 240,19,61440
TR 242,19,63488
Mvav 104,244,28
s_min_u32 s33, s33, s45
v_exp_f32 v26, v54
Mvav 108,244,0
s_waitcnt lgkmcnt(6)
TR 244,20,61440
TR 246,20,63488
Mvav 112,224,28
s_add_u32 m0, s38, 118784
v_cvt_pk_bf16_f32 v42, v24, v25
Mvav 116,224,0
TR 224,19,61952
TR 226,19,64000
Mvav 120,228,28
buffer_load_dwordx4 v4, s[8:11], s32 offen nt lds
Mvav 124,228,0
s_waitcnt lgkmcnt(6)
TR 228,20,61952
TR 230,20,64000
Mvav 128,232,28
s_add_u32 m0, s38, 122752
v_exp_f32 v27, v55
Mvav 132,232,0
TR 232,15,40960
TR 234,15,43008
Mvav 136,236,28
v_cvt_pk_bf16_f32 v43, v26, v27
Mvav 140,236,0
s_waitcnt lgkmcnt(6)
TR 236,16,40960
TR 238,16,43008
Mvav 144,240,28
buffer_load_dwordx4 v4, s[8:11], s32 offen offset:128 nt lds
Mvav 148,240,0
s_add_u32 m0, s38, 110336
TR 240,15,45056
TR 242,15,47104
Mvav 152,244,28
v_exp_f32 v24, v60
Mvav 156,244,0
s_waitcnt lgkmcnt(6)
TR 244,16,45056
TR 246,16,47104
Mvav 160,224,28
v_exp_f32 v25, v61
Mvav 164,224,0
TR 224,17,0
TR 226,17,2048
Mvav 168,228,28
buffer_load_dwordx4 v4, s[8:11], s32 offen offset:256 nt lds
Mvav 172,228,0
s_waitcnt lgkmcnt(6)
TR 228,18,0
TR 230,18,2048
Mvaa 224,232,112
s_add_u32 s32, s32, 6144
v_exp_f32 v26, v62
Mvaa 228,232,116
s_sub_u32 s45, s32, 98304
TR 232,17,4096
TR 234,17,6144
Mvaa 232,236,112
s_min_u32 s32, s32, s45
v_cvt_pk_bf16_f32 v46, v24, v25
s_add_u32 m0, s38, 105856
Mvaa 236,236,116
s_waitcnt lgkmcnt(6)
TR 236,18,4096
TR 238,18,6144
Mvaa 224,240,120
buffer_load_dwordx4 v6, s[16:19], s64 offen offset:640 lds
Mvaa 228,240,124
s_add_u32 m0, s38, 19840
TR 240,17,8192
TR 242,17,10240
Mvaa 232,244,120
v_exp_f32 v27, v63
Mvaa 236,244,124
s_waitcnt lgkmcnt(6)
TR 244,18,8192
TR 246,18,10240
Mvaa 224,224,128
buffer_load_dwordx4 v6, s[16:19], s65 offen offset:640 lds
Mvaa 228,224,132
TR 224,17,12288
TR 226,17,14336
Mvaa 232,228,128
v_cvt_pk_bf16_f32 v47, v26, v27
Mvaa 236,228,132
s_waitcnt lgkmcnt(6)
TR 228,18,12288
TR 230,18,14336
Mvaa 224,232,136
s_barrier
Mvaa 228,232,140
ds_read_b128 a[232:235], v11 offset:53248
Mvaa 232,236,136
Mvaa 236,236,140
s_waitcnt lgkmcnt(5)
ds_read_b128 a[236:239], v11 offset:53760
Mvaa 224,240,144
Mvaa 228,240,148
ds_read_b128 a[240:243], v11 offset:57344
Mvaa 232,244,144
Mvaa 236,244,148
s_waitcnt lgkmcnt(3)
ds_read_b128 a[244:247], v11 offset:57856
Mvaa 224,224,152
Tc5:
s_cbranch_execz Tdone1
Mvaa 228,224,156
ds_read_b128 a[224:227], v11 offset:45056
Mvaa 232,228,152
v_mul_f32 v224, s40, v224
v_mul_f32 v225, s40, v225
Mvaa 236,228,156
s_waitcnt lgkmcnt(3)
ds_read_b128 a[228:231], v11 offset:45568
v_mul_f32 v226, s40, v226
v_mfma_f32_16x16x32_bf16 v[64:67], a[232:235], v[176:179], 0
v_mul_f32 v227, s40, v227
v_mul_f32 v232, s40, v232
v_mfma_f32_16x16x32_bf16 v[72:75], a[232:235], v[180:183], 0
ds_read_b128 a[232:235], v11 offset:55296
v_mul_f32 v233, s40, v233
Mvav 64,236,184
v_mul_f32 v234, s40, v234
v_mul_f32 v235, s40, v235
Mvav 72,236,188
s_waitcnt lgkmcnt(3)
ds_read_b128 a[236:239], v11 offset:55808
v_cvt_pk_bf16_f32 v224, v224, v225
Mvav 64,240,192
v_cvt_pk_bf16_f32 v225, v226, v227
v_cvt_pk_bf16_f32 v226, v232, v233
Mvav 72,240,196
ds_read_b128 a[240:243], v11 offset:59392
v_cvt_pk_bf16_f32 v227, v234, v235
Mvav 64,244,200
v_permlane16_swap_b32 v224, v226
v_permlane16_swap_b32 v225, v227
Mvav 72,244,204
s_waitcnt lgkmcnt(3)
ds_read_b128 a[244:247], v11 offset:59904
v_accvgpr_write_b32 a176, v224
Mvav 64,224,208
v_accvgpr_write_b32 a177, v225
v_accvgpr_write_b32 a178, v226
Mvav 72,224,212
ds_read_b128 a[224:227], v11 offset:47104
v_accvgpr_write_b32 a179, v227
Mvav 64,228,216
v_mul_f32 v228, s40, v228
v_mul_f32 v229, s40, v229
Mvav 72,228,220
s_waitcnt lgkmcnt(3)
ds_read_b128 a[228:231], v11 offset:47616
v_mul_f32 v230, s40, v230
v_mfma_f32_16x16x32_bf16 v[68:71], a[232:235], v[176:179], 0
v_mul_f32 v231, s40, v231
v_mul_f32 v236, s40, v236
v_mfma_f32_16x16x32_bf16 v[76:79], a[232:235], v[180:183], 0
TR 232,15,41472
TR 234,15,43520
Mvav 68,236,184
s_add_u32 m0, s38, 159104
v_mul_f32 v237, s40, v237
v_mul_f32 v238, s40, v238
Mvav 76,236,188
s_waitcnt lgkmcnt(4)
TR 236,16,41472
TR 238,16,43520
Mvav 68,240,192
buffer_load_dwordx4 v6, s[16:19], s70 offen offset:640 lds
Mvav 76,240,196
s_add_u32 s43, s71, 640
TR 240,15,45568
TR 242,15,47616
Mvav 68,244,200
s_add_u32 m0, s38, 0
v_mul_f32 v239, s40, v239
v_cvt_pk_bf16_f32 v228, v228, v229
Mvav 76,244,204
s_waitcnt lgkmcnt(6)
TR 244,16,45568
TR 246,16,47616
Mvav 68,224,208
buffer_load_dwordx4 v6, s[16:19], s43 offen lds
Mvav 76,224,212
s_add_u32 m0, s38, 23936
TR 224,17,512
TR 226,17,2560
Mvav 68,228,216
v_cvt_pk_bf16_f32 v229, v230, v231
v_cvt_pk_bf16_f32 v230, v236, v237
Mvav 76,228,220
s_waitcnt lgkmcnt(6)
TR 228,18,512
TR 230,18,2560
Mvaa 240,232,112
buffer_load_dwordx4 v6, s[16:19], s72 offen offset:640 lds
Mvaa 244,232,116
TR 232,17,4608
TR 234,17,6656
Mvaa 248,236,112
v_cvt_pk_bf16_f32 v231, v238, v239
v_permlane16_swap_b32 v228, v230
Mvaa 252,236,116
s_waitcnt lgkmcnt(6)
TR 236,18,4608
TR 238,18,6656
Mvaa 240,240,120
v_permlane16_swap_b32 v229, v231
v_accvgpr_write_b32 a180, v228
Mvaa 244,240,124
TR 240,17,8704
TR 242,17,10752
Mvaa 248,244,120
v_accvgpr_write_b32 a181, v229
v_accvgpr_write_b32 a182, v230
Mvaa 252,244,124
s_waitcnt lgkmcnt(6)
v_accvgpr_write_b32 a183, v231
Mvaa 240,224,128
v_exp_f32 v24, v64
Mvaa 244,224,132
TR 224,18,8704
TR 226,18,10752
Mvaa 248,228,128
v_exp_f32 v25, v65
Mvaa 252,228,132
s_waitcnt lgkmcnt(4)
TR 228,17,12800
TR 230,17,14848
Mvaa 240,232,136
v_exp_f32 v26, v66
Mvaa 244,232,140
s_waitcnt vmcnt(3)
TR 232,18,12800
TR 234,18,14848
Mvaa 248,236,136
s_barrier
Mvaa 252,236,140
s_waitcnt lgkmcnt(6)
TR 236,17,16384
TR 238,17,18432
Mvaa 240,240,144
s_add_u32 m0, s38, 151552
v_cvt_pk_bf16_f32 v28, v24, v25
Mvaa 244,240,148
TR 240,18,16384
TR 242,18,18432
Mvav 32,252,40
buffer_load_dwordx4 v5, s[12:15], s33 offen nt lds
Mvav 36,252,44
s_waitcnt lgkmcnt(6)
TR 244,17,16896
TR 246,17,18944
Mvaa 248,224,144
s_add_u32 m0, s38, 155520
v_exp_f32 v27, v67
Mvaa 252,224,148
TR 224,18,16896
TR 226,18,18944
Mvaa 240,228,152
v_max_f32 v33, v32, v36
v_cmp_nge_f32 vcc, s39, v33
Mvaa 244,228,156
s_waitcnt lgkmcnt(6)
TR 228,17,20480
TR 230,17,22528
Mvaa 248,232,152
buffer_load_dwordx4 v5, s[12:15], s33 offen offset:128 nt lds
Mvaa 252,232,156
s_add_u32 m0, s38, 143104
TR 232,18,20480
TR 234,18,22528
s_cbranch_vccnz Lr4
Lb4:
Mvav 80,236,40
v_mul_f32 v240, s40, v240
v_mul_f32 v241, s40, v241
Mvav 84,236,44
s_waitcnt lgkmcnt(6)
TR 236,17,20992
TR 238,17,23040
Mvav 88,240,40
v_mul_f32 v242, s40, v242
v_mul_f32 v243, s40, v243
Mvav 92,240,44
TR 240,18,20992
TR 242,18,23040
Mvav 96,244,40
buffer_load_dwordx4 v5, s[12:15], s33 offen offset:256 nt lds
Mvav 100,244,44
s_waitcnt lgkmcnt(6)
TR 244,19,36864
TR 246,19,38912
Mvav 104,224,40
s_add_u32 s33, s33, 6144
v_mul_f32 v248, s40, v248
v_mul_f32 v249, s40, v249
Mvav 108,224,44
s_sub_u32 s45, s33, 98304
TR 224,20,36864
TR 226,20,38912
Mvav 112,228,40
s_min_u32 s33, s33, s45
v_mul_f32 v250, s40, v250
v_mul_f32 v251, s40, v251
Mvav 116,228,44
s_waitcnt lgkmcnt(6)
TR 228,19,37376
TR 230,19,39424
Mvav 120,232,40
s_add_u32 m0, s38, 28672
v_cvt_pk_bf16_f32 v240, v240, v241
v_cvt_pk_bf16_f32 v241, v242, v243
Mvav 124,232,44
TR 232,20,37376
TR 234,20,39424
Mvav 128,236,40
buffer_load_dwordx4 v4, s[8:11], s32 offen nt lds
Mvav 132,236,44
s_waitcnt lgkmcnt(6)
TR 236,19,8192
TR 238,19,10240
Mvav 136,240,40
s_add_u32 m0, s38, 32640
v_cvt_pk_bf16_f32 v242, v248, v249
v_cvt_pk_bf16_f32 v243, v250, v251
Mvav 140,240,44
TR 240,20,8192
TR 242,20,10240
Mvav 144,244,40
v_permlane16_swap_b32 v240, v242
v_permlane16_swap_b32 v241, v243
Mvav 148,244,44
s_waitcnt lgkmcnt(6)
TR 244,15,20480
TR 246,15,22528
Mvav 152,224,40
buffer_load_dwordx4 v4, s[8:11], s32 offen offset:128 nt lds
Mvav 156,224,44
s_add_u32 m0, s38, 36608
TR 224,16,20480
TR 226,16,22528
Mvav 160,228,40
v_accvgpr_write_b32 a184, v240
v_accvgpr_write_b32 a185, v241
Mvav 164,228,44
s_waitcnt lgkmcnt(6)
TR 228,19,4096
TR 230,19,6144
Mvav 168,232,40
v_accvgpr_write_b32 a186, v242
v_accvgpr_write_b32 a187, v243
Mvav 172,232,44
TR 232,20,4096
TR 234,20,6144
v_mfma_f32_16x16x32_bf16 v[224:227], a[236:239], a[0:3], 0
buffer_load_dwordx4 v4, s[8:11], s32 offen offset:256 nt lds
v_mfma_f32_16x16x32_bf16 v[228:231], a[236:239], a[4:7], 0
s_waitcnt lgkmcnt(6)
TR 236,15,4096
TR 238,15,6144
v_mfma_f32_16x16x32_bf16 v[232:235], a[240:243], a[0:3], 0
s_add_u32 s32, s32, 6144
v_mul_f32 v244, s40, v244
v_mul_f32 v245, s40, v245
v_mfma_f32_16x16x32_bf16 v[236:239], a[240:243], a[4:7], 0
s_sub_u32 s45, s32, 98304
TR 240,16,4096
TR 242,16,6144
Mvaa 224,244,8
s_min_u32 s32, s32, s45
v_mul_f32 v246, s40, v246
v_mul_f32 v247, s40, v247
Mvaa 228,244,12
s_waitcnt lgkmcnt(6)
TR 244,15,8192
TR 246,15,10240
Mvaa 232,224,8
s_add_u32 m0, s38, 40320
v_mul_f32 v252, s40, v252
v_mul_f32 v253, s40, v253
Mvaa 236,224,12
TR 224,16,8192
TR 226,16,10240
Mvaa 224,228,16
buffer_load_dwordx4 v6, s[16:19], s73 offen offset:640 lds
Mvaa 228,228,20
s_waitcnt lgkmcnt(6)
TR 228,15,12288
TR 230,15,14336
Mvaa 232,232,16
v_mul_f32 v254, s40, v254
v_mul_f32 v255, s40, v255
Mvaa 236,232,20
TR 232,16,12288
TR 234,16,14336
Mvaa 224,236,24
s_barrier
Mvaa 228,236,28
s_waitcnt lgkmcnt(6)
ds_read_b128 a[236:239], v11 offset:40960
v_cvt_pk_bf16_f32 v244, v244, v245
Mvaa 232,240,24
v_cvt_pk_bf16_f32 v245, v246, v247
v_cvt_pk_bf16_f32 v246, v252, v253
Mvaa 236,240,28
ds_read_b128 a[240:243], v11 offset:41472
v_cvt_pk_bf16_f32 v247, v254, v255
Mvaa 224,244,32
v_permlane16_swap_b32 v244, v246
v_permlane16_swap_b32 v245, v247
Mvaa 228,244,36
s_waitcnt lgkmcnt(4)
ds_read_b128 a[244:247], v11 offset:28672
v_accvgpr_write_b32 a188, v244
Mvaa 232,224,32
v_accvgpr_write_b32 a189, v245
v_accvgpr_write_b32 a190, v246
Mvaa 236,224,36
ds_read_b128 a[224:227], v11 offset:29184
v_accvgpr_write_b32 a191, v247
Mvaa 224,228,40
v_exp_f32 v24, v72
Mvaa 228,228,44
s_waitcnt lgkmcnt(3)
ds_read_b128 a[228:231], v11 offset:16384
v_cvt_pk_bf16_f32 v29, v26, v27
Mvaa 232,232,40
v_exp_f32 v25, v73
Mvaa 236,232,44
ds_read_b128 a[232:235], v11 offset:16896
v_cvt_pk_bf16_f32 v0, v24, v25
v_mfma_f32_16x16x32_bf16 v[48:51], a[236:239], v[176:179], 0
v_exp_f32 v26, v74
v_mfma_f32_16x16x32_bf16 v[56:59], a[236:239], v[180:183], 0
s_waitcnt lgkmcnt(3)
ds_read_b128 a[236:239], v11 offset:43008
Mvav 48,240,184
v_exp_f32 v27, v75
Mvav 56,240,188
ds_read_b128 a[240:243], v11 offset:43520
v_cvt_pk_bf16_f32 v1, v26, v27
Mvav 48,244,192
v_exp_f32 v24, v68
Mvav 56,244,196
s_waitcnt lgkmcnt(3)
ds_read_b128 a[244:247], v11 offset:30720
Mvav 48,224,200
v_exp_f32 v25, v69
Mvav 56,224,204
ds_read_b128 a[224:227], v11 offset:31232
v_cvt_pk_bf16_f32 v30, v24, v25
Mvav 48,228,208
v_exp_f32 v26, v70
Mvav 56,228,212
s_waitcnt lgkmcnt(3)
ds_read_b128 a[228:231], v11 offset:18432
s_add_u32 m0, s38, 134528
Mvav 48,232,216
buffer_load_dwordx4 v6, s[16:19], s74 offen offset:640 lds
Mvav 56,232,220
s_add_u32 m0, s38, 44416
ds_read_b128 a[232:235], v11 offset:18944
v_mfma_f32_16x16x32_bf16 v[52:55], a[236:239], v[176:179], 0
v_exp_f32 v27, v71
v_mfma_f32_16x16x32_bf16 v[60:63], a[236:239], v[180:183], 0
s_waitcnt lgkmcnt(3)
TR 236,19,8704
TR 238,19,10752
Mvav 52,240,184
buffer_load_dwordx4 v6, s[16:19], s75 offen offset:640 lds
Mvav 60,240,188
s_add_u32 m0, s38, 48512
TR 240,20,8704
TR 242,20,10752
Mvav 52,244,192
v_cvt_pk_bf16_f32 v31, v26, v27
Mvav 60,244,196
s_waitcnt lgkmcnt(5)
TR 244,15,20992
TR 246,15,23040
Mvav 52,224,200
buffer_load_dwordx4 v6, s[16:19], s76 offen offset:640 lds
Mvav 60,224,204
s_add_u32 m0, s38, 52608
TR 224,16,20992
TR 226,16,23040
Mvav 52,228,208
v_exp_f32 v24, v76
Mvav 60,228,212
s_waitcnt lgkmcnt(6)
TR 228,19,4608
TR 230,19,6656
Mvav 52,232,216
buffer_load_dwordx4 v6, s[16:19], s77 offen offset:640 lds
Mvav 60,232,220
TR 232,20,4608
TR 234,20,6656
v_mfma_f32_16x16x32_bf16 v[240:243], a[236:239], a[0:3], 0
v_exp_f32 v25, v77
v_mfma_f32_16x16x32_bf16 v[244:247], a[236:239], a[4:7], 0
s_waitcnt lgkmcnt(6)
TR 236,15,4608
TR 238,15,6656
v_mfma_f32_16x16x32_bf16 v[248:251], a[240:243], a[0:3], 0
v_exp_f32 v26, v78
v_mfma_f32_16x16x32_bf16 v[252:255], a[240:243], a[4:7], 0
TR 240,16,4608
TR 242,16,6656
Mvaa 240,244,8
v_cvt_pk_bf16_f32 v2, v24, v25
Mvaa 244,244,12
s_waitcnt lgkmcnt(6)
TR 244,15,8704
TR 246,15,10752
Mvaa 248,224,8
v_exp_f32 v27, v79
Mvaa 252,224,12
v_cvt_pk_bf16_f32 v3, v26, v27
Mvaa 240,228,16
v_exp_f32 v24, v48
Mvaa 244,228,20
s_waitcnt lgkmcnt(4)
TR 228,16,8704
TR 230,16,10752
Mvaa 248,232,16
v_exp_f32 v25, v49
Mvaa 252,232,20
TR 232,15,12800
TR 234,15,14848
Mvaa 240,236,24
v_exp_f32 v26, v50
Mvaa 244,236,28
s_waitcnt vmcnt(11) lgkmcnt(4)
TR 236,16,12800
TR 238,16,14848
Mvaa 248,240,24
s_barrier
Mvaa 252,240,28
TR 240,15,16384
TR 242,15,18432
Mvaa 240,244,32
v_cvt_pk_bf16_f32 v40, v24, v25
Mvaa 244,244,36
s_waitcnt lgkmcnt(6)
TR 244,16,16384
TR 246,16,18432
Mvav 32,252,28
v_exp_f32 v27, v51
Mvav 36,252,0
TR 224,15,16896
TR 226,15,18944
Mvaa 248,228,32
v_exp_f32 v24, v56
Mvaa 252,228,36
s_waitcnt lgkmcnt(6)
TR 228,16,16896
TR 230,16,18944
Mvaa 240,232,40
v_max_f32 v33, v32, v36
v_cmp_nge_f32 vcc, s39, v33
Mvaa 244,232,44
TR 232,19,49152
TR 234,19,51200
Mvaa 248,236,40
v_cvt_pk_bf16_f32 v41, v26, v27
Mvaa 252,236,44
s_waitcnt lgkmcnt(6)
TR 236,20,49152
TR 238,20,51200
s_cbranch_vccnz Lr5
Lb5:
Mvav 80,240,28
v_exp_f32 v25, v57
Mvav 84,240,0
TR 240,19,49664
TR 242,19,51712
Mvav 88,244,28
v_exp_f32 v26, v58
Mvav 92,244,0
s_waitcnt lgkmcnt(6)
TR 244,20,49664
TR 246,20,51712
Mvav 96,224,28
s_add_u32 m0, s38, 138624
v_cvt_pk_bf16_f32 v44, v24, v25
Mvav 100,224,0
TR 224,19,32768
TR 226,19,34816
Mvav 104,228,28
buffer_load_dwordx4 v6, s[16:19], s78 offen offset:640 lds
Mvav 108,228,0
s_waitcnt lgkmcnt(6)
TR 228,20,32768
TR 230,20,34816
Mvav 112,232,28
s_add_u32 m0, s38, 126336
v_exp_f32 v27, v59
Mvav 116,232,0
TR 232,19,33280
TR 234,19,35328
Mvav 120,236,28
buffer_load_dwordx4 v6, s[16:19], s79 offen offset:640 lds
Mvav 124,236,0
s_waitcnt lgkmcnt(6)
TR 236,20,33280
TR 238,20,35328
Mvav 128,240,28
s_add_u32 m0, s38, 114048
v_exp_f32 v24, v52
Mvav 132,240,0
TR 240,19,61440
TR 242,19,63488
Mvav 136,244,28
buffer_load_dwordx4 v6, s[16:19], s80 offen offset:640 lds
Mvav 140,244,0
s_waitcnt lgkmcnt(6)
TR 244,20,61440
TR 246,20,63488
Mvav 144,224,28
s_add_u32 m0, s38, 101760
v_cvt_pk_bf16_f32 v45, v26, v27
Mvav 148,224,0
TR 224,19,61952
TR 226,19,64000
Mvav 152,228,28
buffer_load_dwordx4 v6, s[16:19], s81 offen offset:640 lds
Mvav 156,228,0
s_waitcnt lgkmcnt(6)
TR 228,20,61952
TR 230,20,64000
Mvav 160,232,28
s_add_u32 m0, s38, 105856
v_exp_f32 v25, v53
Mvav 164,232,0
TR 232,15,0
TR 234,15,2048
Mvav 168,236,28
buffer_load_dwordx4 v6, s[16:19], s82 offen offset:640 lds
Mvav 172,236,0
s_waitcnt lgkmcnt(6)
TR 236,16,0
TR 238,16,2048
Mvaa 224,240,48
s_add_u32 m0, s38, 4096
v_exp_f32 v26, v54
Mvaa 228,240,52
TR 240,15,512
TR 242,15,2560
Mvaa 232,244,48
v_cvt_pk_bf16_f32 v42, v24, v25
Mvaa 236,244,52
s_waitcnt lgkmcnt(6)
TR 244,16,512
TR 246,16,2560
Mvaa 240,224,48
buffer_load_dwordx4 v5, s[12:15], s33 offen nt lds
Mvaa 244,224,52
s_add_u32 m0, s38, 20352
TR 224,15,24576
TR 226,15,26624
Mvaa 248,228,48
v_exp_f32 v27, v55
Mvaa 252,228,52
s_waitcnt lgkmcnt(6)
TR 228,16,24576
TR 230,16,26624
Mvaa 224,232,56
v_cvt_pk_bf16_f32 v43, v26, v27
Mvaa 228,232,60
TR 232,15,25088
TR 234,15,27136
Mvaa 232,236,56
buffer_load_dwordx4 v5, s[12:15], s33 offen offset:128 nt lds
Mvaa 236,236,60
s_waitcnt vmcnt(10) lgkmcnt(6)
TR 236,16,25088
TR 238,16,27136
Mvaa 240,240,56
s_barrier
Mvaa 244,240,60
s_add_u32 m0, s38, 159488
ds_read_b128 a[240:243], v11 offset:20480
Tc6:
s_cbranch_execz Tdone1
Mvaa 248,244,56
v_exp_f32 v24, v60
Mvaa 252,244,60
s_waitcnt lgkmcnt(5)
ds_read_b128 a[244:247], v11 offset:20992
Mvaa 224,224,64
buffer_load_dwordx4 v5, s[12:15], s33 offen offset:256 nt lds
Mvaa 228,224,68
s_add_u32 s33, s33, 6144
ds_read_b128 a[224:227], v11 offset:24576
s_sub_u32 s45, s33, 98304
Mvaa 232,228,64
s_min_u32 s33, s33, s45
v_exp_f32 v25, v61
Mvaa 236,228,68
s_waitcnt lgkmcnt(3)
ds_read_b128 a[228:231], v11 offset:25088
v_cvt_pk_bf16_f32 v46, v24, v25
Mvaa 240,232,64
s_add_u32 m0, s38, 147456
v_exp_f32 v26, v62
Mvaa 244,232,68
ds_read_b128 a[232:235], v11 offset:12288
Mvaa 248,236,64
buffer_load_dwordx4 v4, s[8:11], s32 offen nt lds
Mvaa 252,236,68
s_waitcnt lgkmcnt(3)
ds_read_b128 a[236:239], v11 offset:12800
s_add_u32 m0, s38, 130944
v_mfma_f32_16x16x32_bf16 v[64:67], a[240:243], v[176:179], 0
v_exp_f32 v27, v63
v_mfma_f32_16x16x32_bf16 v[72:75], a[240:243], v[180:183], 0
ds_read_b128 a[240:243], v11 offset:22528
v_cvt_pk_bf16_f32 v47, v26, v27
Mvav 64,244,184
Mvav 72,244,188
s_waitcnt lgkmcnt(3)
ds_read_b128 a[244:247], v11 offset:23040
Mvav 64,224,192
buffer_load_dwordx4 v4, s[8:11], s32 offen offset:128 nt lds
Mvav 72,224,196
s_add_u32 m0, s38, 7936
ds_read_b128 a[224:227], v11 offset:26624
Mvav 64,228,200
Mvav 72,228,204
s_waitcnt lgkmcnt(3)
ds_read_b128 a[228:231], v11 offset:27136
Mvav 64,232,208
Mvav 72,232,212
ds_read_b128 a[232:235], v11 offset:14336
Mvav 64,236,216
buffer_load_dwordx4 v4, s[8:11], s32 offen offset:256 nt lds
Mvav 72,236,220
s_waitcnt lgkmcnt(3)
ds_read_b128 a[236:239], v11 offset:14848
s_add_u32 s32, s32, 6144
v_mfma_f32_16x16x32_bf16 v[68:71], a[240:243], v[176:179], 0
s_sub_u32 s45, s32, 98304
v_exp_f32 v24, v64
v_mfma_f32_16x16x32_bf16 v[76:79], a[240:243], v[180:183], 0
s_min_u32 s32, s32, s45
TR 240,15,40960
TR 242,15,43008
Mvav 68,244,184
s_add_u32 m0, s38, 11648
v_exp_f32 v25, v65
Mvav 76,244,188
s_waitcnt lgkmcnt(4)
TR 244,16,40960
TR 246,16,43008
Mvav 68,224,192
buffer_load_dwordx4 v6, s[16:19], s83 offen offset:640 lds
Mvav 76,224,196
TR 224,15,41472
TR 226,15,43520
Mvav 68,228,200
v_exp_f32 v26, v66
Mvav 76,228,204
s_waitcnt lgkmcnt(6)
TR 228,16,41472
TR 230,16,43520
Mvav 68,232,208
v_cvt_pk_bf16_f32 v28, v24, v25
Mvav 76,232,212
TR 232,19,36864
TR 234,19,38912
Mvav 68,236,216
v_exp_f32 v27, v67
Mvav 76,236,220
s_waitcnt lgkmcnt(6)
v_exp_f32 v24, v72
Mvaa 224,240,72
v_cvt_pk_bf16_f32 v29, v26, v27
Mvaa 228,240,76
TR 240,20,36864
TR 242,20,38912
Mvaa 232,244,72
v_exp_f32 v25, v73
Mvaa 236,244,76
s_waitcnt lgkmcnt(4)
TR 244,19,37376
TR 246,19,39424
Mvaa 240,224,72
v_exp_f32 v26, v74
Mvaa 244,224,76
s_waitcnt vmcnt(12)
TR 224,20,37376
TR 226,20,39424
Mvaa 248,228,72
s_barrier
Mvaa 252,228,76
s_waitcnt lgkmcnt(6)
TR 228,19,53248
TR 230,19,55296
Mvaa 224,232,80
v_cvt_pk_bf16_f32 v0, v24, v25
Mvaa 228,232,84
TR 232,20,53248
TR 234,20,55296
Mvav 32,252,40
v_exp_f32 v27, v75
Mvav 36,252,44
s_waitcnt lgkmcnt(6)
TR 236,19,53760
TR 238,19,55808
Mvaa 232,240,80
v_exp_f32 v24, v68
Mvaa 236,240,84
TR 240,20,53760
TR 242,20,55808
Mvaa 240,244,80
v_max_f32 v33, v32, v36
v_cmp_nge_f32 vcc, s39, v33
Mvaa 244,244,84
s_waitcnt lgkmcnt(6)
TR 244,19,57344
TR 246,19,59392
Mvaa 248,224,80
v_cvt_pk_bf16_f32 v1, v26, v27
Mvaa 252,224,84
TR 224,20,57344
TR 226,20,59392
s_cbranch_vccnz Lr6
Lb6:
Mvav 80,228,40
v_exp_f32 v25, v69
Mvav 84,228,44
s_waitcnt lgkmcnt(6)
TR 228,19,57856
TR 230,19,59904
Mvav 88,232,40
v_exp_f32 v26, v70
Mvav 92,232,44
TR 232,20,57856
TR 234,20,59904
Mvav 96,236,40
v_cvt_pk_bf16_f32 v30, v24, v25
Mvav 100,236,44
s_waitcnt lgkmcnt(6)
TR 236,19,45056
TR 238,19,47104
Mvav 104,240,40
v_exp_f32 v27, v71
Mvav 108,240,44
TR 240,20,45056
TR 242,20,47104
Mvav 112,244,40
v_cvt_pk_bf16_f32 v31, v26, v27
Mvav 116,244,44
s_waitcnt lgkmcnt(6)
TR 244,19,45568
TR 246,19,47616
Mvav 120,224,40
v_exp_f32 v24, v76
Mvav 124,224,44
TR 224,20,45568
TR 226,20,47616
Mvav 128,228,40
s_add_u32 m0, s38, 118016
v_exp_f32 v25, v77
Mvav 132,228,44
s_waitcnt lgkmcnt(6)
TR 228,15,45056
TR 230,15,47104
Mvav 136,232,40
buffer_load_dwordx4 v6, s[16:19], s66 offen offset:768 lds
Mvav 140,232,44
s_add_u32 m0, s38, 122112
TR 232,16,45056
TR 234,16,47104
Mvav 144,236,40
v_exp_f32 v26, v78
Mvav 148,236,44
s_waitcnt lgkmcnt(6)
TR 236,15,45568
TR 238,15,47616
Mvav 152,240,40
buffer_load_dwordx4 v6, s[16:19], s67 offen offset:768 lds
Mvav 156,240,44
s_add_u32 m0, s38, 109824
TR 240,16,45568
TR 242,16,47616
Mvav 160,244,40
v_cvt_pk_bf16_f32 v2, v24, v25
Mvav 164,244,44
s_waitcnt lgkmcnt(6)
TR 244,17,0
TR 246,17,2048
Mvav 168,224,40
buffer_load_dwordx4 v6, s[16:19], s68 offen offset:768 lds
Mvav 172,224,44
s_add_u32 m0, s38, 0
TR 224,18,0
TR 226,18,2048
Mvaa 224,228,88
v_exp_f32 v27, v79
Mvaa 228,228,92
s_waitcnt lgkmcnt(6)
TR 228,17,512
TR 230,17,2560
Mvaa 232,232,88
v_cvt_pk_bf16_f32 v3, v26, v27
Mvaa 236,232,92
TR 232,18,512
TR 234,18,2560
Mvaa 240,236,88
buffer_load_dwordx4 v5, s[12:15], s33 offen nt lds
Mvaa 244,236,92
s_waitcnt lgkmcnt(6)
TR 236,17,4096
TR 238,17,6144
Mvaa 248,240,88
s_add_u32 m0, s38, 16256
Mvaa 252,240,92
TR 240,18,4096
TR 242,18,6144
Mvaa 224,244,96
Mvaa 228,244,100
s_waitcnt lgkmcnt(6)
TR 244,17,4608
TR 246,17,6656
Mvaa 232,224,96
buffer_load_dwordx4 v5, s[12:15], s33 offen offset:128 nt lds
Mvaa 236,224,100
s_waitcnt vmcnt(5)
TR 224,18,4608
TR 226,18,6656
Mvaa 240,228,96
s_barrier
Mvaa 244,228,100
s_waitcnt lgkmcnt(6)
ds_read_b128 a[228:231], v9 offset:28672
s_add_u32 m0, s38, 151296
Mvaa 248,232,96
Mvaa 252,232,100
ds_read_b128 a[232:235], v9 offset:29184
Mvaa 224,236,104
buffer_load_dwordx4 v5, s[12:15], s33 offen offset:256 nt lds
Mvaa 228,236,108
s_waitcnt lgkmcnt(4)
ds_read_b128 a[236:239], v9 offset:32768
s_add_u32 s33, s33, 6144
Mvaa 232,240,104
s_sub_u32 s45, s33, 98304
s_min_u32 s33, s33, s45
s_add_u32 m0, s38, 155648
Mvaa 236,240,108
ds_read_b128 a[240:243], v9 offset:33280
Mvaa 240,244,104
Mvaa 244,244,108
s_waitcnt lgkmcnt(3)
ds_read_b128 a[244:247], v9 offset:36864
Mvaa 248,224,104
buffer_load_dwordx4 v4, s[8:11], s32 offen nt lds
Mvaa 252,224,108
s_add_u32 m0, s38, 143232
ds_read_b128 a[224:227], v9 offset:37376
v_mfma_f32_16x16x32_bf16 v[48:51], a[228:231], v[176:179], 0
v_mfma_f32_16x16x32_bf16 v[56:59], a[228:231], v[180:183], 0
s_waitcnt lgkmcnt(3)
ds_read_b128 a[228:231], v9 offset:30720
Mvav 48,232,184
Mvav 56,232,188
ds_read_b128 a[232:235], v9 offset:31232
Mvav 48,236,192
buffer_load_dwordx4 v4, s[8:11], s32 offen offset:128 nt lds
Mvav 56,236,196
s_waitcnt lgkmcnt(3)
ds_read_b128 a[236:239], v9 offset:34816
s_add_u32 m0, s38, 134912
Mvav 48,240,200
Mvav 56,240,204
ds_read_b128 a[240:243], v9 offset:35328
Mvav 48,244,208
Mvav 56,244,212
s_waitcnt lgkmcnt(3)
ds_read_b128 a[244:247], v9 offset:38912
Mvav 48,224,216
buffer_load_dwordx4 v4, s[8:11], s32 offen offset:256 nt lds
Mvav 56,224,220
s_add_u32 s32, s32, 6144
ds_read_b128 a[224:227], v9 offset:39424
s_sub_u32 s45, s32, 98304
v_mfma_f32_16x16x32_bf16 v[52:55], a[228:231], v[176:179], 0
s_min_u32 s32, s32, s45
v_exp_f32 v24, v48
v_mfma_f32_16x16x32_bf16 v[60:63], a[228:231], v[180:183], 0
s_waitcnt lgkmcnt(3)
TR 228,19,40960
TR 230,19,43008
Mvav 52,232,184
s_add_u32 m0, s38, 23808
v_exp_f32 v25, v49
Mvav 60,232,188
TR 232,20,40960
TR 234,20,43008
Mvav 52,236,192
buffer_load_dwordx4 v6, s[16:19], s64 offen offset:768 lds
Mvav 60,236,196
s_waitcnt lgkmcnt(5)
TR 236,19,28672
TR 238,19,30720
Mvav 52,240,200
s_add_u32 m0, s38, 40192
v_exp_f32 v26, v50
Mvav 60,240,204
TR 240,20,28672
TR 242,20,30720
Mvav 52,244,208
buffer_load_dwordx4 v6, s[16:19], s65 offen offset:768 lds
Mvav 60,244,212
s_waitcnt lgkmcnt(6)
TR 244,19,16384
TR 246,19,18432
Mvav 52,224,216
s_add_u32 m0, s38, 44288
v_cvt_pk_bf16_f32 v40, v24, v25
Mvav 60,224,220
TR 224,20,16384
TR 226,20,18432
Mvaa 224,228,112
buffer_load_dwordx4 v6, s[16:19], s69 offen offset:768 lds
Mvaa 228,228,116
s_waitcnt lgkmcnt(6)
TR 228,19,4096
TR 230,19,6144
Mvaa 232,232,112
v_exp_f32 v27, v51
Mvaa 236,232,116
TR 232,20,4096
TR 234,20,6144
Mvaa 224,236,120
v_exp_f32 v24, v56
Mvaa 228,236,124
s_waitcnt lgkmcnt(6)
TR 236,19,8192
TR 238,19,10240
Mvaa 232,240,120
v_cvt_pk_bf16_f32 v41, v26, v27
Mvaa 236,240,124
v_exp_f32 v25, v57
Mvaa 224,244,128
v_exp_f32 v26, v58
Mvaa 228,244,132
s_waitcnt lgkmcnt(4)
TR 244,20,8192
TR 246,20,10240
Mvaa 232,224,128
v_cvt_pk_bf16_f32 v44, v24, v25
Mvaa 236,224,132
TR 224,15,12288
TR 226,15,14336
Mvaa 224,228,136
v_exp_f32 v27, v59
Mvaa 228,228,140
s_waitcnt lgkmcnt(4)
TR 228,16,12288
TR 230,16,14336
Mvaa 232,232,136
s_barrier
Mvaa 236,232,140
TR 232,15,4096
TR 234,15,6144
Mvaa 224,236,144
v_exp_f32 v24, v52
Mvaa 228,236,148
s_waitcnt lgkmcnt(6)
TR 236,16,4096
TR 238,16,6144
Mvav 32,252,28
v_cvt_pk_bf16_f32 v45, v26, v27
Mvav 36,252,0
TR 240,15,4608
TR 242,15,6656
Mvaa 232,244,144
v_exp_f32 v25, v53
Mvaa 236,244,148
s_waitcnt lgkmcnt(6)
TR 244,16,4608
TR 246,16,6656
Mvaa 224,224,152
v_max_f32 v33, v32, v36
v_cmp_nge_f32 vcc, s39, v33
Mvaa 228,224,156
TR 224,15,20480
TR 226,15,22528
Mvaa 232,228,152
v_mul_f32 v224, s40, v224
v_mul_f32 v225, s40, v225
Mvaa 236,228,156
s_waitcnt lgkmcnt(6)
TR 228,16,20480
TR 230,16,22528
s_cbranch_vccnz Lr7
Lb7:
Mvav 80,232,28
s_add_u32 m0, s38, 28672
v_mul_f32 v226, s40, v226
v_mul_f32 v227, s40, v227
Mvav 84,232,0
TR 232,15,20992
TR 234,15,23040
Mvav 88,236,28
buffer_load_dwordx4 v5, s[12:15], s33 offen nt lds
Mvav 92,236,0
s_waitcnt lgkmcnt(6)
TR 236,16,20992
TR 238,16,23040
Mvav 96,240,28
s_add_u32 m0, s38, 32640
v_mul_f32 v232, s40, v232
v_mul_f32 v233, s40, v233
Mvav 100,240,0
TR 240,19,61440
TR 242,19,63488
Mvav 104,244,28
v_mul_f32 v234, s40, v234
v_mul_f32 v235, s40, v235
Mvav 108,244,0
s_waitcnt lgkmcnt(6)
TR 244,20,61440
TR 246,20,63488
Mvav 112,224,28
buffer_load_dwordx4 v5, s[12:15], s33 offen offset:128 nt lds
Mvav 116,224,0
s_add_u32 m0, s38, 36608
TR 224,19,61952
TR 226,19,64000
Mvav 120,228,28
v_cvt_pk_bf16_f32 v224, v224, v225
v_cvt_pk_bf16_f32 v225, v226, v227
Mvav 124,228,0
s_waitcnt lgkmcnt(6)
TR 228,20,61952
TR 230,20,64000
Mvav 128,232,28
v_cvt_pk_bf16_f32 v226, v232, v233
v_cvt_pk_bf16_f32 v227, v234, v235
Mvav 132,232,0
TR 232,19,41472
TR 234,19,43520
Mvav 136,236,28
buffer_load_dwordx4 v5, s[12:15], s33 offen offset:256 nt lds
Mvav 140,236,0
s_waitcnt lgkmcnt(6)
TR 236,20,41472
TR 238,20,43520
Mvav 144,240,28
s_add_u32 s33, s33, 6144
v_permlane16_swap_b32 v224, v226
v_permlane16_swap_b32 v225, v227
Mvav 148,240,0
s_sub_u32 s45, s33, 98304
TR 240,19,29184
TR 242,19,31232
Mvav 152,244,28
s_min_u32 s33, s33, s45
v_accvgpr_write_b32 a192, v224
v_accvgpr_write_b32 a193, v225
Mvav 156,244,0
s_waitcnt lgkmcnt(6)
TR 244,20,29184
TR 246,20,31232
Mvav 160,224,28
s_add_u32 m0, s38, 49152
v_accvgpr_write_b32 a194, v226
v_accvgpr_write_b32 a195, v227
Mvav 164,224,0
TR 224,19,16896
TR 226,19,18944
Mvav 168,228,28
buffer_load_dwordx4 v4, s[8:11], s32 offen nt lds
Mvav 172,228,0
s_waitcnt lgkmcnt(6)
TR 228,20,16896
TR 230,20,18944
Mvaa 240,232,112
s_add_u32 m0, s38, 53120
v_mul_f32 v228, s40, v228
v_mul_f32 v229, s40, v229
Mvaa 244,232,116
TR 232,19,4608
TR 234,19,6656
Mvaa 248,236,112
v_mul_f32 v230, s40, v230
v_mul_f32 v231, s40, v231
Mvaa 252,236,116
s_waitcnt lgkmcnt(6)
TR 236,20,4608
TR 238,20,6656
Mvaa 240,240,120
buffer_load_dwordx4 v4, s[8:11], s32 offen offset:128 nt lds
Mvaa 244,240,124
s_add_u32 m0, s38, 57088
TR 240,19,8704
TR 242,19,10752
Mvaa 248,244,120
v_mul_f32 v236, s40, v236
v_mul_f32 v237, s40, v237
Mvaa 252,244,124
s_waitcnt lgkmcnt(6)
TR 244,20,8704
TR 246,20,10752
Mvaa 240,224,128
v_mul_f32 v238, s40, v238
v_mul_f32 v239, s40, v239
Mvaa 244,224,132
TR 224,15,12800
TR 226,15,14848
Mvaa 248,228,128
buffer_load_dwordx4 v4, s[8:11], s32 offen offset:256 nt lds
Mvaa 252,228,132
s_waitcnt vmcnt(6) lgkmcnt(6)
TR 228,16,12800
TR 230,16,14848
Mvaa 240,232,136
s_barrier
Mvaa 244,232,140
s_add_u32 s32, s32, 6144
ds_read_b128 a[232:235], v11 offset:49152
v_cvt_pk_bf16_f32 v228, v228, v229
Mvaa 248,236,136
s_sub_u32 s45, s32, 98304
v_cvt_pk_bf16_f32 v229, v230, v231
v_cvt_pk_bf16_f32 v230, v236, v237
Mvaa 252,236,140
s_waitcnt lgkmcnt(5)
ds_read_b128 a[236:239], v11 offset:49664
v_cvt_pk_bf16_f32 v231, v238, v239
Mvaa 240,240,144
s_min_u32 s32, s32, s45
v_permlane16_swap_b32 v228, v230
v_permlane16_swap_b32 v229, v231
Mvaa 244,240,148
s_add_u32 m0, s38, 158976
ds_read_b128 a[240:243], v11 offset:32768
v_accvgpr_write_b32 a196, v228
Mvaa 248,244,144
buffer_load_dwordx4 v6, s[16:19], s70 offen offset:768 lds
Mvaa 252,244,148
s_waitcnt lgkmcnt(3)
ds_read_b128 a[244:247], v11 offset:33280
v_accvgpr_write_b32 a197, v229
Mvaa 240,224,152
v_accvgpr_write_b32 a198, v230
v_accvgpr_write_b32 a199, v231
Mvaa 244,224,156
ds_read_b128 a[224:227], v9 offset:8192
v_cvt_pk_bf16_f32 v42, v24, v25
Mvaa 248,228,152
v_exp_f32 v26, v54
Mvaa 252,228,156
s_waitcnt lgkmcnt(3)
Tc7:
s_cbranch_execz Tdone1
ds_read_b128 a[228:231], v9 offset:8704
v_mul_f32 v240, s40, v240
v_mfma_f32_16x16x32_bf16 v[64:67], a[232:235], v[176:179], 0
v_exp_f32 v27, v55
v_mfma_f32_16x16x32_bf16 v[72:75], a[232:235], v[180:183], 0
ds_read_b128 a[232:235], v11 offset:51200
v_cvt_pk_bf16_f32 v43, v26, v27
Mvav 64,236,184
v_exp_f32 v24, v60
Mvav 72,236,188
s_waitcnt lgkmcnt(3)
ds_read_b128 a[236:239], v11 offset:51712
v_mul_f32 v241, s40, v241
Mvav 64,240,192
v_exp_f32 v25, v61
Mvav 72,240,196
ds_read_b128 a[240:243], v11 offset:34816
v_cvt_pk_bf16_f32 v46, v24, v25
Mvav 64,244,200
v_exp_f32 v26, v62
Mvav 72,244,204
s_waitcnt lgkmcnt(3)
ds_read_b128 a[244:247], v11 offset:35328
v_mul_f32 v242, s40, v242
Mvav 64,224,208
v_exp_f32 v27, v63
Mvav 72,224,212
ds_read_b128 a[224:227], v9 offset:10240
v_cvt_pk_bf16_f32 v47, v26, v27
Mvav 64,228,216
v_mul_f32 v243, s40, v243
v_mul_f32 v248, s40, v248
Mvav 72,228,220
s_waitcnt lgkmcnt(3)
ds_read_b128 a[228:231], v9 offset:10752
v_mul_f32 v249, s40, v249
v_mfma_f32_16x16x32_bf16 v[68:71], a[232:235], v[176:179], 0
v_mul_f32 v250, s40, v250
v_mul_f32 v251, s40, v251
v_mfma_f32_16x16x32_bf16 v[76:79], a[232:235], v[180:183], 0
TR 232,15,24576
TR 234,15,26624
Mvav 68,236,184
v_cvt_pk_bf16_f32 v240, v240, v241
v_cvt_pk_bf16_f32 v241, v242, v243
Mvav 76,236,188
s_waitcnt lgkmcnt(4)
TR 236,16,24576
TR 238,16,26624
Mvav 68,240,192
v_cvt_pk_bf16_f32 v242, v248, v249
v_cvt_pk_bf16_f32 v243, v250, v251
Mvav 76,240,196
TR 240,15,40960
TR 242,15,43008
Mvav 68,244,200
v_permlane16_swap_b32 v240, v242
v_permlane16_swap_b32 v241, v243
Mvav 76,244,204
s_waitcnt lgkmcnt(6)
TR 244,16,40960
TR 246,16,43008
Mvav 68,224,208
s_add_u32 m0, s38, 138496
v_accvgpr_write_b32 a200, v240
v_accvgpr_write_b32 a201, v241
Mvav 76,224,212
TR 224,19,20480
TR 226,19,22528
Mvav 68,228,216
buffer_load_dwordx4 v6, s[16:19], s71 offen offset:768 lds
Mvav 76,228,220
s_waitcnt lgkmcnt(6)
TR 228,20,20480
TR 230,20,22528
v_mfma_f32_16x16x32_bf16 v[224:227], a[232:235], a[0:3], 0
s_add_u32 m0, s38, 126208
v_accvgpr_write_b32 a202, v242
v_accvgpr_write_b32 a203, v243
v_mfma_f32_16x16x32_bf16 v[228:231], a[232:235], a[4:7], 0
TR 232,19,24576
TR 234,19,26624
v_mfma_f32_16x16x32_bf16 v[232:235], a[236:239], a[0:3], 0
buffer_load_dwordx4 v6, s[16:19], s72 offen offset:768 lds
v_mfma_f32_16x16x32_bf16 v[236:239], a[236:239], a[4:7], 0
s_waitcnt lgkmcnt(6)
TR 236,20,24576
TR 238,20,26624
Mvaa 224,240,8
s_add_u32 m0, s38, 113920
v_mul_f32 v244, s40, v244
v_mul_f32 v245, s40, v245
Mvaa 228,240,12
TR 240,19,12288
TR 242,19,14336
Mvaa 232,244,8
buffer_load_dwordx4 v6, s[16:19], s73 offen offset:768 lds
Mvaa 236,244,12
s_waitcnt lgkmcnt(6)
v_mul_f32 v246, s40, v246
v_mul_f32 v247, s40, v247
Mvaa 224,224,16
s_add_u32 m0, s38, 3328
v_mul_f32 v252, s40, v252
v_mul_f32 v253, s40, v253
Mvaa 228,224,20
TR 224,20,12288
TR 226,20,14336
Mvaa 232,228,16
buffer_load_dwordx4 v6, s[16:19], s74 offen offset:768 lds
Mvaa 236,228,20
s_waitcnt lgkmcnt(4)
TR 228,15,45056
TR 230,15,47104
Mvaa 224,232,24
v_mul_f32 v254, s40, v254
v_mul_f32 v255, s40, v255
Mvaa 228,232,28
TR 232,16,45056
TR 234,16,47104
Mvaa 232,236,24
s_barrier
Mvaa 236,236,28
s_waitcnt lgkmcnt(6)
TR 236,15,0
TR 238,15,2048
Mvaa 224,240,32
v_cvt_pk_bf16_f32 v244, v244, v245
v_cvt_pk_bf16_f32 v245, v246, v247
Mvaa 228,240,36
TR 240,16,0
TR 242,16,2048
Mvav 32,252,40
v_cvt_pk_bf16_f32 v246, v252, v253
v_cvt_pk_bf16_f32 v247, v254, v255
Mvav 36,252,44
s_waitcnt lgkmcnt(6)
TR 244,15,512
TR 246,15,2560
Mvaa 232,224,32
v_permlane16_swap_b32 v244, v246
v_permlane16_swap_b32 v245, v247
Mvaa 236,224,36
TR 224,16,512
TR 226,16,2560
Mvaa 224,228,40
v_max_f32 v33, v32, v36
v_cmp_nge_f32 vcc, s39, v33
Mvaa 228,228,44
s_waitcnt lgkmcnt(6)
TR 228,15,16384
TR 230,15,18432
Mvaa 232,232,40
v_accvgpr_write_b32 a204, v244
v_accvgpr_write_b32 a205, v245
Mvaa 236,232,44
TR 232,16,16384
TR 234,16,18432
s_cbranch_vccnz Lr8
Lb8:
Mvav 80,236,40
v_accvgpr_write_b32 a206, v246
v_accvgpr_write_b32 a207, v247
Mvav 84,236,44
s_waitcnt lgkmcnt(6)
TR 236,15,16896
TR 238,15,18944
Mvav 88,240,40
v_exp_f32 v24, v64
Mvav 92,240,44
TR 240,16,16896
TR 242,16,18944
Mvav 96,244,40
s_add_u32 m0, s38, 146688
v_exp_f32 v25, v65
Mvav 100,244,44
s_waitcnt lgkmcnt(6)
TR 244,19,53248
TR 246,19,55296
Mvav 104,224,40
buffer_load_dwordx4 v6, s[16:19], s75 offen offset:768 lds
Mvav 108,224,44
s_add_u32 m0, s38, 130304
TR 224,20,53248
TR 226,20,55296
Mvav 112,228,40
v_exp_f32 v26, v66
Mvav 116,228,44
s_waitcnt lgkmcnt(6)
TR 228,19,53760
TR 230,19,55808
Mvav 120,232,40
buffer_load_dwordx4 v6, s[16:19], s76 offen offset:768 lds
Mvav 124,232,44
s_add_u32 m0, s38, 102400
TR 232,20,53760
TR 234,20,55808
Mvav 128,236,40
v_cvt_pk_bf16_f32 v28, v24, v25
Mvav 132,236,44
s_waitcnt lgkmcnt(6)
TR 236,15,25088
TR 238,15,27136
Mvav 136,240,40
v_exp_f32 v27, v67
Mvav 140,240,44
TR 240,16,25088
TR 242,16,27136
Mvav 144,244,40
buffer_load_dwordx4 v5, s[12:15], s33 offen nt lds
Mvav 148,244,44
s_waitcnt lgkmcnt(6)
TR 244,15,41472
TR 246,15,43520
Mvav 152,224,40
s_add_u32 m0, s38, 106368
v_exp_f32 v24, v72
Mvav 156,224,44
TR 224,16,41472
TR 226,16,43520
Mvav 160,228,40
v_cvt_pk_bf16_f32 v29, v26, v27
Mvav 164,228,44
s_waitcnt lgkmcnt(6)
TR 228,19,20992
TR 230,19,23040
Mvav 168,232,40
buffer_load_dwordx4 v5, s[12:15], s33 offen offset:128 nt lds
Mvav 172,232,44
s_add_u32 m0, s38, 7936
TR 232,20,20992
TR 234,20,23040
v_mfma_f32_16x16x32_bf16 v[240:243], a[236:239], a[0:3], 0
v_exp_f32 v25, v73
v_mfma_f32_16x16x32_bf16 v[244:247], a[236:239], a[4:7], 0
s_waitcnt lgkmcnt(6)
TR 236,19,25088
TR 238,19,27136
v_mfma_f32_16x16x32_bf16 v[248:251], a[240:243], a[0:3], 0
v_exp_f32 v26, v74
v_mfma_f32_16x16x32_bf16 v[252:255], a[240:243], a[4:7], 0
TR 240,20,25088
TR 242,20,27136
Mvaa 240,244,8
buffer_load_dwordx4 v5, s[12:15], s33 offen offset:256 nt lds
Mvaa 244,244,12
s_waitcnt lgkmcnt(6)
TR 244,19,12800
TR 246,19,14848
Mvaa 248,224,8
s_add_u32 s33, s33, 6144
v_cvt_pk_bf16_f32 v0, v24, v25
s_sub_u32 s45, s33, 98304
Mvaa 252,224,12
s_min_u32 s33, s33, s45
TR 224,20,12800
TR 226,20,14848
Mvaa 240,228,16
s_add_u32 m0, s38, 12288
v_exp_f32 v27, v75
Mvaa 244,228,20
s_waitcnt lgkmcnt(6)
TR 228,15,45568
TR 230,15,47616
Mvaa 248,232,16
buffer_load_dwordx4 v4, s[8:11], s32 offen nt lds
Mvaa 252,232,20
s_waitcnt vmcnt(8)
TR 232,16,45568
TR 234,16,47616
Mvaa 240,236,24
s_barrier
Mvaa 244,236,28
s_waitcnt lgkmcnt(6)
ds_read_b128 a[236:239], v11 offset:57344
v_cvt_pk_bf16_f32 v1, v26, v27
Mvaa 248,240,24
s_add_u32 m0, s38, 151424
v_exp_f32 v24, v68
Mvaa 252,240,28
ds_read_b128 a[240:243], v11 offset:57856
Mvaa 240,244,32
buffer_load_dwordx4 v4, s[8:11], s32 offen offset:128 nt lds
Mvaa 244,244,36
s_waitcnt lgkmcnt(4)
ds_read_b128 a[244:247], v11 offset:45056
s_add_u32 m0, s38, 118528
Mvaa 248,224,32
v_exp_f32 v25, v69
Mvaa 252,224,36
ds_read_b128 a[224:227], v11 offset:45568
v_cvt_pk_bf16_f32 v30, v24, v25
Mvaa 240,228,40
v_exp_f32 v26, v70
Mvaa 244,228,44
s_waitcnt lgkmcnt(3)
ds_read_b128 a[228:231], v11 offset:36864
Mvaa 248,232,40
buffer_load_dwordx4 v4, s[8:11], s32 offen offset:256 nt lds
Mvaa 252,232,44
s_add_u32 s32, s32, 6144
ds_read_b128 a[232:235], v11 offset:37376
s_sub_u32 s45, s32, 98304
v_mfma_f32_16x16x32_bf16 v[48:51], a[236:239], v[176:179], 0
s_min_u32 s32, s32, s45
v_exp_f32 v27, v71
v_mfma_f32_16x16x32_bf16 v[56:59], a[236:239], v[180:183], 0
s_waitcnt lgkmcnt(3)
ds_read_b128 a[236:239], v11 offset:59392
v_cvt_pk_bf16_f32 v31, v26, v27
Mvav 48,240,184
s_add_u32 s43, s77, 768
v_exp_f32 v24, v76
Mvav 56,240,188
s_add_u32 m0, s38, 0
ds_read_b128 a[240:243], v11 offset:59904
Mvav 48,244,192
buffer_load_dwordx4 v6, s[16:19], s43 offen lds
Mvav 56,244,196
s_waitcnt lgkmcnt(3)
ds_read_b128 a[244:247], v11 offset:47104
Mvav 48,224,200
v_exp_f32 v25, v77
Mvav 56,224,204
ds_read_b128 a[224:227], v11 offset:47616
v_cvt_pk_bf16_f32 v2, v24, v25
Mvav 48,228,208
v_exp_f32 v26, v78
Mvav 56,228,212
s_waitcnt lgkmcnt(3)
ds_read_b128 a[228:231], v11 offset:38912
Mvav 48,232,216
v_exp_f32 v27, v79
Mvav 56,232,220
ds_read_b128 a[232:235], v11 offset:39424
v_cvt_pk_bf16_f32 v3, v26, v27
v_mfma_f32_16x16x32_bf16 v[52:55], a[236:239], v[176:179], 0
v_exp_f32 v24, v48
v_mfma_f32_16x16x32_bf16 v[60:63], a[236:239], v[180:183], 0
s_waitcnt lgkmcnt(3)
TR 236,19,61440
TR 238,19,63488
Mvav 52,240,184
v_exp_f32 v25, v49
Mvav 60,240,188
TR 240,20,61440
TR 242,20,63488
Mvav 52,244,192
v_exp_f32 v26, v50
Mvav 60,244,196
s_waitcnt lgkmcnt(5)
TR 244,19,61952
TR 246,19,64000
Mvav 52,224,200
v_cvt_pk_bf16_f32 v40, v24, v25
Mvav 60,224,204
TR 224,20,61952
TR 226,20,64000
Mvav 52,228,208
v_exp_f32 v27, v51
Mvav 60,228,212
s_waitcnt lgkmcnt(6)
TR 228,19,40960
TR 230,19,43008
Mvav 52,232,216
v_exp_f32 v24, v56
Mvav 60,232,220
TR 232,20,40960
TR 234,20,43008
Mvaa 224,236,48
v_cvt_pk_bf16_f32 v41, v26, v27
Mvaa 228,236,52
s_waitcnt lgkmcnt(6)
TR 236,19,41472
TR 238,19,43520
Mvaa 232,240,48
v_exp_f32 v25, v57
Mvaa 236,240,52
TR 240,20,41472
TR 242,20,43520
Mvaa 240,244,48
v_exp_f32 v26, v58
Mvaa 244,244,52
s_waitcnt lgkmcnt(6)
TR 244,19,28672
TR 246,19,30720
Mvaa 248,224,48
v_cvt_pk_bf16_f32 v44, v24, v25
s_add_u32 m0, s38, 15616
Mvaa 252,224,52
buffer_load_dwordx4 v6, s[16:19], s78 offen offset:768 lds
Mvaa 224,228,56
s_add_u32 m0, s38, 19712
v_exp_f32 v27, v59
Mvaa 228,228,60
s_waitcnt lgkmcnt(4)
TR 228,20,28672
TR 230,20,30720
Mvaa 232,232,56
v_exp_f32 v24, v52
Mvaa 236,232,60
TR 232,19,29184
TR 234,19,31232
Mvaa 240,236,56
buffer_load_dwordx4 v6, s[16:19], s79 offen offset:768 lds
Mvaa 244,236,60
s_waitcnt vmcnt(11) lgkmcnt(4)
TR 236,20,29184
TR 238,20,31232
Mvaa 248,240,56
s_barrier
Mvaa 252,240,60
s_add_u32 m0, s38, 158976
TR 240,15,28672
TR 242,15,30720
Mvaa 224,244,64
buffer_load_dwordx4 v6, s[16:19], s80 offen offset:768 lds
Mvaa 228,244,68
s_waitcnt lgkmcnt(6)
TR 244,16,28672
TR 246,16,30720
Mvav 32,252,28
s_add_u32 m0, s38, 154880
v_cvt_pk_bf16_f32 v45, v26, v27
Mvav 36,252,0
TR 224,15,29184
TR 226,15,31232
Mvaa 232,228,64
buffer_load_dwordx4 v6, s[16:19], s81 offen offset:768 lds
Mvaa 236,228,68
s_waitcnt lgkmcnt(6)
TR 228,16,29184
TR 230,16,31232
Mvaa 240,232,64
s_add_u32 m0, s38, 142592
v_max_f32 v33, v32, v36
v_cmp_nge_f32 vcc, s39, v33
Mvaa 244,232,68
TR 232,15,32768
TR 234,15,34816
Mvaa 248,236,64
buffer_load_dwordx4 v6, s[16:19], s82 offen offset:768 lds
Mvaa 252,236,68
s_waitcnt lgkmcnt(6)
TR 236,16,32768
TR 238,16,34816
s_cbranch_vccnz Lr9
Lb9:
Mvav 80,240,28
s_add_u32 m0, s38, 134400
v_exp_f32 v25, v53
Mvav 84,240,0
TR 240,15,33280
TR 242,15,35328
Mvav 88,244,28
buffer_load_dwordx4 v6, s[16:19], s83 offen offset:768 lds
Mvav 92,244,0
s_waitcnt lgkmcnt(6)
TR 244,16,33280
TR 246,16,35328
Mvav 96,224,28
s_add_u32 m0, s38, 139264
v_exp_f32 v26, v54
Mvav 100,224,0
TR 224,15,36864
TR 226,15,38912
Mvav 104,228,28
v_cvt_pk_bf16_f32 v42, v24, v25
Mvav 108,228,0
s_waitcnt lgkmcnt(6)
TR 228,16,36864
TR 230,16,38912
Mvav 112,232,28
buffer_load_dwordx4 v5, s[12:15], s33 offen nt lds
Mvav 116,232,0
s_add_u32 m0, s38, 122752
TR 232,15,37376
TR 234,15,39424
Mvav 120,236,28
v_exp_f32 v27, v55
Mvav 124,236,0
s_waitcnt lgkmcnt(6)
TR 236,16,37376
TR 238,16,39424
Mvav 128,240,28
v_cvt_pk_bf16_f32 v43, v26, v27
Mvav 132,240,0
TR 240,19,16384
TR 242,19,18432
Mvav 136,244,28
buffer_load_dwordx4 v5, s[12:15], s33 offen offset:128 nt lds
Mvav 140,244,0
s_waitcnt lgkmcnt(6)
TR 244,20,16384
TR 246,20,18432
Mvav 144,224,28
s_add_u32 m0, s38, 110336
v_exp_f32 v24, v60
Mvav 148,224,0
TR 224,19,16896
TR 226,19,18944
Mvav 152,228,28
v_exp_f32 v25, v61
Mvav 156,228,0
s_waitcnt lgkmcnt(6)
TR 228,20,16896
TR 230,20,18944
Mvav 160,232,28
buffer_load_dwordx4 v5, s[12:15], s33 offen offset:256 nt lds
Mvav 164,232,0
s_add_u32 s33, s33, 6144
TR 232,15,4096
TR 234,15,6144
Mvav 168,236,28
s_sub_u32 s45, s33, 98304
v_exp_f32 v26, v62
Mvav 172,236,0
s_waitcnt lgkmcnt(6)
TR 236,16,4096
TR 238,16,6144
Mvaa 224,240,72
s_min_u32 s33, s33, s45
v_cvt_pk_bf16_f32 v46, v24, v25
s_add_u32 m0, s38, 24576
Mvaa 228,240,76
TR 240,15,4608
TR 242,15,6656
Mvaa 232,244,72
buffer_load_dwordx4 v4, s[8:11], s32 offen nt lds
Mvaa 236,244,76
s_waitcnt vmcnt(10) lgkmcnt(6)
TR 244,16,4608
TR 246,16,6656
Mvaa 240,224,72
s_barrier
Mvaa 244,224,76
s_add_u32 m0, s38, 126848
ds_read_b128 a[224:227], v10 offset:0
Mvaa 248,228,72
v_exp_f32 v27, v63
Mvaa 252,228,76
s_waitcnt lgkmcnt(5)
ds_read_b128 a[228:231], v10 offset:512
v_cvt_pk_bf16_f32 v47, v26, v27
Mvaa 224,232,80
buffer_load_dwordx4 v4, s[8:11], s32 offen offset:128 nt lds
Mvaa 228,232,84
s_add_u32 m0, s38, 28416
ds_read_b128 a[232:235], v10 offset:4096
Mvaa 232,236,80
Mvaa 236,236,84
s_waitcnt lgkmcnt(3)
ds_read_b128 a[236:239], v10 offset:4608
Mvaa 240,240,80
Mvaa 244,240,84
ds_read_b128 a[240:243], v10 offset:8192
Mvaa 248,244,80
buffer_load_dwordx4 v4, s[8:11], s32 offen offset:256 nt lds
Mvaa 252,244,84
s_waitcnt lgkmcnt(3)
ds_read_b128 a[244:247], v10 offset:8704
s_add_u32 s32, s32, 6144
v_mfma_f32_16x16x32_bf16 v[64:67], a[224:227], v[176:179], 0
s_sub_u32 s45, s32, 98304
s_min_u32 s32, s32, s45
s_add_u32 m0, s38, 31872
v_mfma_f32_16x16x32_bf16 v[72:75], a[224:227], v[180:183], 0
ds_read_b128 a[224:227], v10 offset:2048
Mvav 64,228,184
buffer_load_dwordx4 v6, s[16:19], s64 offen offset:896 lds
Mvav 72,228,188
s_waitcnt lgkmcnt(3)
ds_read_b128 a[228:231], v10 offset:2560
Mvav 64,232,192
Tc8:
s_cbranch_execz Tdone2
Mvav 72,232,196
ds_read_b128 a[232:235], v10 offset:6144
Mvav 64,236,200
Mvav 72,236,204
s_waitcnt lgkmcnt(3)
ds_read_b128 a[236:239], v10 offset:6656
Mvav 64,240,208
Mvav 72,240,212
ds_read_b128 a[240:243], v10 offset:10240
Mvav 64,244,216
Mvav 72,244,220
s_waitcnt lgkmcnt(3)
ds_read_b128 a[244:247], v10 offset:10752
v_mfma_f32_16x16x32_bf16 v[68:71], a[224:227], v[176:179], 0
v_exp_f32 v24, v64
v_mfma_f32_16x16x32_bf16 v[76:79], a[224:227], v[180:183], 0
TR 224,19,49152
TR 226,19,51200
Mvav 68,228,184
s_add_u32 m0, s38, 35968
v_exp_f32 v25, v65
Mvav 76,228,188
s_waitcnt lgkmcnt(4)
TR 228,20,49152
TR 230,20,51200
Mvav 68,232,192
buffer_load_dwordx4 v6, s[16:19], s66 offen offset:896 lds
Mvav 76,232,196
TR 232,19,49664
TR 234,19,51712
Mvav 68,236,200
v_exp_f32 v26, v66
Mvav 76,236,204
s_waitcnt lgkmcnt(6)
TR 236,20,49664
TR 238,20,51712
Mvav 68,240,208
v_cvt_pk_bf16_f32 v28, v24, v25
Mvav 76,240,212
TR 240,19,32768
TR 242,19,34816
Mvav 68,244,216
v_exp_f32 v27, v67
Mvav 76,244,220
s_waitcnt lgkmcnt(6)
TR 244,20,32768
TR 246,20,34816
Mvaa 224,224,88
v_exp_f32 v24, v72
Mvaa 228,224,92
TR 224,19,33280
TR 226,19,35328
Mvaa 232,228,88
v_cvt_pk_bf16_f32 v29, v26, v27
Mvaa 236,228,92
s_waitcnt lgkmcnt(6)
TR 228,20,33280
TR 230,20,35328
Mvaa 240,232,88
v_exp_f32 v25, v73
Mvaa 244,232,92
TR 232,15,0
TR 234,15,2048
Mvaa 248,236,88
v_exp_f32 v26, v74
Mvaa 252,236,92
s_waitcnt lgkmcnt(6)
v_cvt_pk_bf16_f32 v0, v24, v25
s_add_u32 m0, s38, 40064
Mvaa 224,240,96
buffer_load_dwordx4 v6, s[16:19], s67 offen offset:896 lds
Mvaa 228,240,100
s_add_u32 m0, s38, 44160
TR 240,16,0
TR 242,16,2048
Mvaa 232,244,96
v_exp_f32 v27, v75
Mvaa 236,244,100
s_waitcnt lgkmcnt(4)
TR 244,15,512
TR 246,15,2560
Mvaa 240,224,96
buffer_load_dwordx4 v6, s[16:19], s68 offen offset:896 lds
Mvaa 244,224,100
s_waitcnt vmcnt(10)
TR 224,16,512
TR 226,16,2560
Mvaa 248,228,96
s_barrier
Mvaa 252,228,100
s_waitcnt lgkmcnt(6)
TR 228,19,4096
TR 230,19,6144
Mvaa 224,232,104
s_add_u32 m0, s38, 146560
v_exp_f32 v24, v68
Mvaa 228,232,108
TR 232,20,4096
TR 234,20,6144
Mvav 32,252,40
buffer_load_dwordx4 v6, s[16:19], s69 offen offset:896 lds
Mvav 36,252,44
s_waitcnt lgkmcnt(6)
TR 236,19,4608
TR 238,19,6656
Mvaa 232,240,104
v_cvt_pk_bf16_f32 v1, v26, v27
Mvaa 236,240,108
TR 240,20,4608
TR 242,20,6656
Mvaa 240,244,104
v_max_f32 v33, v32, v36
v_cmp_nge_f32 vcc, s39, v33
Mvaa 244,244,108
s_waitcnt lgkmcnt(6)
TR 244,19,8192
TR 246,19,10240
Mvaa 248,224,104
v_exp_f32 v25, v69
Mvaa 252,224,108
TR 224,20,8192
TR 226,20,10240
s_cbranch_vccnz Lr10
Lb10:
Mvav 80,228,40
v_exp_f32 v26, v70
Mvav 84,228,44
s_waitcnt lgkmcnt(6)
TR 228,19,8704
TR 230,19,10752
Mvav 88,232,40
s_add_u32 m0, s38, 130176
v_cvt_pk_bf16_f32 v30, v24, v25
Mvav 92,232,44
TR 232,20,8704
TR 234,20,10752
Mvav 96,236,40
buffer_load_dwordx4 v6, s[16:19], s65 offen offset:896 lds
Mvav 100,236,44
s_waitcnt lgkmcnt(6)
TR 236,15,8192
TR 238,15,10240
Mvav 104,240,40
v_exp_f32 v27, v71
Mvav 108,240,44
TR 240,16,8192
TR 242,16,10240
Mvav 112,244,40
v_cvt_pk_bf16_f32 v31, v26, v27
Mvav 116,244,44
s_waitcnt lgkmcnt(6)
TR 244,15,8704
TR 246,15,10752
Mvav 120,224,40
v_exp_f32 v24, v76
Mvav 124,224,44
TR 224,16,8704
TR 226,16,10752
Mvav 128,228,40
v_exp_f32 v25, v77
Mvav 132,228,44
s_waitcnt lgkmcnt(6)
TR 228,15,16384
TR 230,15,18432
Mvav 136,232,40
s_add_u32 m0, s38, 114688
v_exp_f32 v26, v78
Mvav 140,232,44
TR 232,16,16384
TR 234,16,18432
Mvav 144,236,40
buffer_load_dwordx4 v5, s[12:15], s33 offen nt lds
Mvav 148,236,44
s_waitcnt lgkmcnt(6)
TR 236,15,20480
TR 238,15,22528
Mvav 152,240,40
s_add_u32 m0, s38, 3968
v_cvt_pk_bf16_f32 v2, v24, v25
Mvav 156,240,44
TR 240,16,20480
TR 242,16,22528
Mvav 160,244,40
v_exp_f32 v27, v79
Mvav 164,244,44
s_waitcnt lgkmcnt(6)
TR 244,19,61440
TR 246,19,63488
Mvav 168,224,40
buffer_load_dwordx4 v5, s[12:15], s33 offen offset:128 nt lds
Mvav 172,224,44
s_add_u32 m0, s38, 48896
TR 224,20,61440
TR 226,20,63488
Mvaa 224,228,112
v_cvt_pk_bf16_f32 v3, v26, v27
Mvaa 228,228,116
s_waitcnt lgkmcnt(6)
TR 228,19,57344
TR 230,19,59392
Mvaa 232,232,112
Mvaa 236,232,116
TR 232,20,57344
TR 234,20,59392
Mvaa 224,236,120
buffer_load_dwordx4 v5, s[12:15], s33 offen offset:256 nt lds
Mvaa 228,236,124
s_waitcnt lgkmcnt(6)
TR 236,19,45056
TR 238,19,47104
Mvaa 232,240,120
s_add_u32 s33, s33, 6144
s_sub_u32 s45, s33, 98304
s_min_u32 s33, s33, s45
Mvaa 236,240,124
s_add_u32 m0, s38, 53248
TR 240,20,45056
TR 242,20,47104
Mvaa 224,244,128
Mvaa 228,244,132
s_waitcnt lgkmcnt(6)
TR 244,19,36864
TR 246,19,38912
Mvaa 232,224,128
buffer_load_dwordx4 v4, s[8:11], s32 offen nt lds
Mvaa 236,224,132
TR 224,20,36864
TR 226,20,38912
Mvaa 224,228,136
s_barrier
Mvaa 228,228,140
s_waitcnt lgkmcnt(6)
ds_read_b128 a[228:231], v9 offset:12288
s_add_u32 m0, s38, 102272
Mvaa 232,232,136
Mvaa 236,232,140
ds_read_b128 a[232:235], v9 offset:12800
Mvaa 224,236,144
buffer_load_dwordx4 v4, s[8:11], s32 offen offset:128 nt lds
Mvaa 228,236,148
s_waitcnt lgkmcnt(4)
ds_read_b128 a[236:239], v11 offset:53248
s_add_u32 m0, s38, 106240
Mvaa 232,240,144
Mvaa 236,240,148
ds_read_b128 a[240:243], v11 offset:53760
Mvaa 224,244,152
Mvaa 228,244,156
s_waitcnt lgkmcnt(3)
ds_read_b128 a[244:247], v11 offset:20480
Mvaa 232,224,152
buffer_load_dwordx4 v4, s[8:11], s32 offen offset:256 nt lds
Mvaa 236,224,156
s_add_u32 s32, s32, 6144
ds_read_b128 a[224:227], v11 offset:20992
v_mul_f32 v224, s40, v224
v_mfma_f32_16x16x32_bf16 v[48:51], a[228:231], v[176:179], 0
s_sub_u32 s45, s32, 98304
v_mul_f32 v225, s40, v225
v_mul_f32 v226, s40, v226
v_mfma_f32_16x16x32_bf16 v[56:59], a[228:231], v[180:183], 0
s_waitcnt lgkmcnt(3)
ds_read_b128 a[228:231], v9 offset:14336
v_mul_f32 v227, s40, v227
Mvav 48,232,184
s_min_u32 s32, s32, s45
v_mul_f32 v232, s40, v232
v_mul_f32 v233, s40, v233
Mvav 56,232,188
ds_read_b128 a[232:235], v9 offset:14848
v_mul_f32 v234, s40, v234
Mvav 48,236,192
v_mul_f32 v235, s40, v235
v_cvt_pk_bf16_f32 v224, v224, v225
Mvav 56,236,196
s_waitcnt lgkmcnt(3)
ds_read_b128 a[236:239], v11 offset:55296
v_cvt_pk_bf16_f32 v225, v226, v227
Mvav 48,240,200
v_cvt_pk_bf16_f32 v226, v232, v233
v_cvt_pk_bf16_f32 v227, v234, v235
Mvav 56,240,204
ds_read_b128 a[240:243], v11 offset:55808
v_permlane16_swap_b32 v224, v226
Mvav 48,244,208
v_permlane16_swap_b32 v225, v227
v_accvgpr_write_b32 a208, v224
Mvav 56,244,212
s_waitcnt lgkmcnt(3)
ds_read_b128 a[244:247], v11 offset:22528
v_accvgpr_write_b32 a209, v225
Mvav 48,224,216
v_accvgpr_write_b32 a210, v226
v_accvgpr_write_b32 a211, v227
Mvav 56,224,220
ds_read_b128 a[224:227], v11 offset:23040
v_mul_f32 v228, s40, v228
v_mfma_f32_16x16x32_bf16 v[52:55], a[228:231], v[176:179], 0
v_mul_f32 v229, s40, v229
v_mul_f32 v230, s40, v230
v_mfma_f32_16x16x32_bf16 v[60:63], a[228:231], v[180:183], 0
s_waitcnt lgkmcnt(3)
TR 228,15,16896
TR 230,15,18944
Mvav 52,232,184
s_add_u32 s43, s70, 896
v_mul_f32 v231, s40, v231
v_mul_f32 v236, s40, v236
Mvav 60,232,188
s_add_u32 m0, s38, 0
TR 232,16,16896
TR 234,16,18944
Mvav 52,236,192
buffer_load_dwordx4 v6, s[16:19], s43 offen lds
Mvav 60,236,196
s_waitcnt lgkmcnt(5)
TR 236,15,20992
TR 238,15,23040
Mvav 52,240,200
v_mul_f32 v237, s40, v237
v_mul_f32 v238, s40, v238
Mvav 60,240,204
TR 240,16,20992
TR 242,16,23040
Mvav 52,244,208
v_mul_f32 v239, s40, v239
v_cvt_pk_bf16_f32 v228, v228, v229
Mvav 60,244,212
s_waitcnt lgkmcnt(6)
TR 244,19,61952
TR 246,19,64000
Mvav 52,224,216
v_cvt_pk_bf16_f32 v229, v230, v231
v_cvt_pk_bf16_f32 v230, v236, v237
Mvav 60,224,220
TR 224,20,61952
TR 226,20,64000
Mvaa 240,228,112
v_cvt_pk_bf16_f32 v231, v238, v239
v_permlane16_swap_b32 v228, v230
Mvaa 244,228,116
s_waitcnt lgkmcnt(6)
TR 228,19,57856
TR 230,19,59904
Mvaa 248,232,112
v_permlane16_swap_b32 v229, v231
v_accvgpr_write_b32 a212, v228
Mvaa 252,232,116
TR 232,20,57856
TR 234,20,59904
Mvaa 240,236,120
v_accvgpr_write_b32 a213, v229
v_accvgpr_write_b32 a214, v230
Mvaa 244,236,124
s_waitcnt lgkmcnt(6)
TR 236,19,45568
TR 238,19,47616
Mvaa 248,240,120
v_accvgpr_write_b32 a215, v231
Mvaa 252,240,124
v_exp_f32 v24, v48
Mvaa 240,244,128
v_exp_f32 v25, v49
Mvaa 244,244,132
s_waitcnt lgkmcnt(4)
TR 244,20,45568
TR 246,20,47616
Mvaa 248,224,128
s_add_u32 m0, s38, 7296
v_exp_f32 v26, v50
Mvaa 252,224,132
TR 224,19,37376
TR 226,19,39424
Mvaa 240,228,136
buffer_load_dwordx4 v6, s[16:19], s71 offen offset:896 lds
Mvaa 244,228,140
s_waitcnt vmcnt(8) lgkmcnt(4)
TR 228,20,37376
TR 230,20,39424
Mvaa 248,232,136
s_barrier
Mvaa 252,232,140
s_add_u32 m0, s38, 158848
TR 232,19,40960
TR 234,19,43008
Mvaa 240,236,144
buffer_load_dwordx4 v6, s[16:19], s72 offen offset:896 lds
Mvaa 244,236,148
s_waitcnt lgkmcnt(6)
TR 236,20,40960
TR 238,20,43008
Mvav 32,252,28
v_cvt_pk_bf16_f32 v40, v24, v25
Mvav 36,252,0
TR 240,19,41472
TR 242,19,43520
Mvaa 248,244,144
v_exp_f32 v27, v51
Mvaa 252,244,148
s_waitcnt lgkmcnt(6)
TR 244,20,41472
TR 246,20,43520
Mvaa 240,224,152
v_max_f32 v33, v32, v36
v_cmp_nge_f32 vcc, s39, v33
Mvaa 244,224,156
TR 224,19,24576
TR 226,19,26624
Mvaa 248,228,152
v_mul_f32 v240, s40, v240
v_mul_f32 v241, s40, v241
Mvaa 252,228,156
s_waitcnt lgkmcnt(6)
TR 228,20,24576
TR 230,20,26624
s_cbranch_vccnz Lr11
Lb11:
Mvav 80,232,28
v_mul_f32 v242, s40, v242
v_mul_f32 v243, s40, v243
Mvav 84,232,0
TR 232,19,25088
TR 234,19,27136
Mvav 88,236,28
v_mul_f32 v248, s40, v248
v_mul_f32 v249, s40, v249
Mvav 92,236,0
s_waitcnt lgkmcnt(6)
TR 236,20,25088
TR 238,20,27136
Mvav 96,240,28
v_mul_f32 v250, s40, v250
v_mul_f32 v251, s40, v251
Mvav 100,240,0
TR 240,19,12288
TR 242,19,14336
Mvav 104,244,28
v_cvt_pk_bf16_f32 v240, v240, v241
v_cvt_pk_bf16_f32 v241, v242, v243
Mvav 108,244,0
s_waitcnt lgkmcnt(6)
TR 244,20,12288
TR 246,20,14336
Mvav 112,224,28
v_cvt_pk_bf16_f32 v242, v248, v249
v_cvt_pk_bf16_f32 v243, v250, v251
Mvav 116,224,0
TR 224,19,12800
TR 226,19,14848
Mvav 120,228,28
v_permlane16_swap_b32 v240, v242
v_permlane16_swap_b32 v241, v243
Mvav 124,228,0
s_waitcnt lgkmcnt(6)
TR 228,20,12800
TR 230,20,14848
Mvav 128,232,28
s_add_u32 m0, s38, 150656
v_accvgpr_write_b32 a216, v240
v_accvgpr_write_b32 a217, v241
Mvav 132,232,0
TR 232,15,32768
TR 234,15,34816
Mvav 136,236,28
buffer_load_dwordx4 v6, s[16:19], s73 offen offset:896 lds
Mvav 140,236,0
s_waitcnt lgkmcnt(6)
TR 236,16,32768
TR 238,16,34816
Mvav 144,240,28
s_add_u32 m0, s38, 155648
v_accvgpr_write_b32 a218, v242
v_accvgpr_write_b32 a219, v243
Mvav 148,240,0
TR 240,19,32768
TR 242,19,34816
Mvav 152,244,28
v_mul_f32 v244, s40, v244
v_mul_f32 v245, s40, v245
Mvav 156,244,0
s_waitcnt lgkmcnt(6)
TR 244,20,32768
TR 246,20,34816
Mvav 160,224,28
buffer_load_dwordx4 v5, s[12:15], s33 offen nt lds
Mvav 164,224,0
s_add_u32 m0, s38, 118656
TR 224,15,36864
TR 226,15,38912
Mvav 168,228,28
v_mul_f32 v246, s40, v246
v_mul_f32 v247, s40, v247
Mvav 172,228,0
s_waitcnt lgkmcnt(6)
TR 228,16,36864
TR 230,16,38912
v_mfma_f32_16x16x32_bf16 v[224:227], a[232:235], a[0:3], 0
v_mul_f32 v252, s40, v252
v_mul_f32 v253, s40, v253
v_mfma_f32_16x16x32_bf16 v[228:231], a[232:235], a[4:7], 0
TR 232,15,40960
TR 234,15,43008
v_mfma_f32_16x16x32_bf16 v[232:235], a[236:239], a[0:3], 0
buffer_load_dwordx4 v5, s[12:15], s33 offen offset:128 nt lds
v_mfma_f32_16x16x32_bf16 v[236:239], a[236:239], a[4:7], 0
s_waitcnt lgkmcnt(6)
TR 236,16,40960
TR 238,16,43008
Mvaa 224,240,8
s_add_u32 m0, s38, 12032
v_mul_f32 v254, s40, v254
v_mul_f32 v255, s40, v255
Mvaa 228,240,12
TR 240,15,45056
TR 242,15,47104
Mvaa 232,244,8
v_cvt_pk_bf16_f32 v244, v244, v245
v_cvt_pk_bf16_f32 v245, v246, v247
Mvaa 236,244,12
s_waitcnt lgkmcnt(6)
TR 244,16,45056
TR 246,16,47104
Mvaa 224,224,16
buffer_load_dwordx4 v5, s[12:15], s33 offen offset:256 nt lds
Mvaa 228,224,20
s_add_u32 s33, s33, 6144
TR 224,19,49152
TR 226,19,51200
Mvaa 232,228,16
s_sub_u32 s45, s33, 98304
v_cvt_pk_bf16_f32 v246, v252, v253
v_cvt_pk_bf16_f32 v247, v254, v255
Mvaa 236,228,20
s_waitcnt lgkmcnt(6)
TR 228,20,49152
TR 230,20,51200
Mvaa 224,232,24
s_barrier
Mvaa 228,232,28
s_min_u32 s33, s33, s45
ds_read_b128 a[232:235], v9 offset:24576
v_permlane16_swap_b32 v244, v246
Mvaa 232,236,24
s_add_u32 m0, s38, 143360
v_permlane16_swap_b32 v245, v247
v_accvgpr_write_b32 a220, v244
Mvaa 236,236,28
s_waitcnt lgkmcnt(5)
ds_read_b128 a[236:239], v9 offset:25088
v_accvgpr_write_b32 a221, v245
Mvaa 224,240,32
buffer_load_dwordx4 v4, s[8:11], s32 offen nt lds
Mvaa 228,240,36
s_add_u32 m0, s38, 135040
ds_read_b128 a[240:243], v11 offset:28672
v_accvgpr_write_b32 a222, v246
Mvaa 232,244,32
v_accvgpr_write_b32 a223, v247
v_cvt_pk_bf16_f32 v41, v26, v27
Mvaa 236,244,36
s_waitcnt lgkmcnt(3)
ds_read_b128 a[244:247], v11 offset:29184
Mvaa 224,224,40
v_exp_f32 v24, v56
Mvaa 228,224,44
ds_read_b128 a[224:227], v9 offset:28672
Mvaa 232,228,40
buffer_load_dwordx4 v4, s[8:11], s32 offen offset:128 nt lds
Mvaa 236,228,44
s_waitcnt lgkmcnt(3)
ds_read_b128 a[228:231], v9 offset:29184
s_add_u32 m0, s38, 139008
v_mfma_f32_16x16x32_bf16 v[64:67], a[232:235], v[176:179], 0
v_exp_f32 v25, v57
v_mfma_f32_16x16x32_bf16 v[72:75], a[232:235], v[180:183], 0
ds_read_b128 a[232:235], v9 offset:26624
Tc9:
s_cbranch_execz Tdone2
s_cmpk_eq_u32 s88, 12
s_cselect_b64 exec, 0, -1
s_cbranch_execz Tc12
Tr12:
s_mov_b64 exec, -1
v_cvt_pk_bf16_f32 v44, v24, v25
Mvav 64,236,184
v_exp_f32 v26, v58
Mvav 72,236,188
s_waitcnt lgkmcnt(3)
ds_read_b128 a[236:239], v9 offset:27136
Mvav 64,240,192
buffer_load_dwordx4 v4, s[8:11], s32 offen offset:256 nt lds
Mvav 72,240,196
s_add_u32 s32, s32, 6144
ds_read_b128 a[240:243], v11 offset:30720
s_sub_u32 s45, s32, 98304
Mvav 64,244,200
s_min_u32 s32, s32, s45
v_add_u32 v4, 196608, v4
s_add_u32 m0, s38, 121984
Mvav 72,244,204
s_waitcnt lgkmcnt(3)
ds_read_b128 a[244:247], v11 offset:31232
Mvav 64,224,208
buffer_load_dwordx4 v6, s[16:19], s74 offen offset:896 lds
Mvav 72,224,212
ds_read_b128 a[224:227], v9 offset:30720
Mvav 64,228,216
v_exp_f32 v27, v59
Mvav 72,228,220
s_waitcnt lgkmcnt(3)
ds_read_b128 a[228:231], v9 offset:31232
v_cvt_pk_bf16_f32 v45, v26, v27
v_mfma_f32_16x16x32_bf16 v[68:71], a[232:235], v[176:179], 0
v_exp_f32 v24, v52
v_mfma_f32_16x16x32_bf16 v[76:79], a[232:235], v[180:183], 0
TR 232,15,33280
TR 234,15,35328
Mvav 68,236,184
v_exp_f32 v25, v53
Mvav 76,236,188
s_waitcnt lgkmcnt(4)
TR 236,16,33280
TR 238,16,35328
Mvav 68,240,192
v_exp_f32 v26, v54
Mvav 76,240,196
TR 240,19,33280
TR 242,19,35328
Mvav 68,244,200
v_cvt_pk_bf16_f32 v42, v24, v25
Mvav 76,244,204
s_waitcnt lgkmcnt(6)
TR 244,20,33280
TR 246,20,35328
Mvav 68,224,208
v_exp_f32 v27, v55
Mvav 76,224,212
TR 224,15,37376
TR 226,15,39424
Mvav 68,228,216
v_cvt_pk_bf16_f32 v43, v26, v27
Mvav 76,228,220
s_waitcnt lgkmcnt(6)
TR 228,16,37376
TR 230,16,39424
v_mfma_f32_16x16x32_bf16 v[240:243], a[232:235], a[0:3], 0
v_exp_f32 v24, v60
v_mfma_f32_16x16x32_bf16 v[244:247], a[232:235], a[4:7], 0
TR 232,15,41472
TR 234,15,43520
v_mfma_f32_16x16x32_bf16 v[248:251], a[236:239], a[0:3], 0
v_exp_f32 v25, v61
v_mfma_f32_16x16x32_bf16 v[252:255], a[236:239], a[4:7], 0
s_waitcnt lgkmcnt(6)
TR 236,16,41472
TR 238,16,43520
Mvaa 240,240,8
v_exp_f32 v26, v62
Mvaa 244,240,12
TR 240,15,45568
TR 242,15,47616
Mvaa 248,244,8
v_cvt_pk_bf16_f32 v46, v24, v25
Mvaa 252,244,12
s_waitcnt lgkmcnt(6)
v_exp_f32 v27, v63
Mvaa 240,224,16
v_cvt_pk_bf16_f32 v47, v26, v27
Mvaa 244,224,20
TR 224,16,45568
TR 226,16,47616
Mvaa 248,228,16
v_exp_f32 v24, v64
Mvaa 252,228,20
s_waitcnt lgkmcnt(4)
TR 228,19,49664
TR 230,19,51712
Mvaa 240,232,24
s_add_u32 m0, s38, 109696
v_exp_f32 v25, v65
Mvaa 244,232,28
s_waitcnt vmcnt(8)
TR 232,20,49664
TR 234,20,51712
Mvaa 248,236,24
s_barrier
Mvaa 252,236,28
s_waitcnt lgkmcnt(6)
TR 236,19,16384
TR 238,19,18432
Mvaa 240,240,32
buffer_load_dwordx4 v6, s[16:19], s75 offen offset:896 lds
Mvaa 244,240,36
s_add_u32 m0, s38, 126080
TR 240,20,16384
TR 242,20,18432
Mvav 32,252,40
v_exp_f32 v26, v66
Mvav 36,252,44
s_waitcnt lgkmcnt(6)
TR 244,19,16896
TR 246,19,18944
Mvaa 248,224,32
buffer_load_dwordx4 v6, s[16:19], s76 offen offset:896 lds
Mvaa 252,224,36
s_add_u32 m0, s38, 130176
TR 224,20,16896
TR 226,20,18944
Mvaa 240,228,40
v_max_f32 v33, v32, v36
v_cmp_nge_f32 vcc, s39, v33
Mvaa 244,228,44
s_waitcnt lgkmcnt(6)
TR 228,15,4096
TR 230,15,6144
Mvaa 248,232,40
buffer_load_dwordx4 v6, s[16:19], s77 offen offset:896 lds
Mvaa 252,232,44
TR 232,16,4096
TR 234,16,6144
s_cbranch_vccnz Lr12
Lb12:
Mvav 80,236,40
v_cvt_pk_bf16_f32 v28, v24, v25
Mvav 84,236,44
s_waitcnt lgkmcnt(6)
TR 236,15,4608
TR 238,15,6656
Mvav 88,240,40
v_exp_f32 v27, v67
Mvav 92,240,44
TR 240,16,4608
TR 242,16,6656
Mvav 96,244,40
s_add_u32 m0, s38, 15488
v_exp_f32 v24, v72
Mvav 100,244,44
s_waitcnt lgkmcnt(6)
TR 244,17,0
TR 246,17,2048
Mvav 104,224,40
buffer_load_dwordx4 v6, s[16:19], s78 offen offset:896 lds
Mvav 108,224,44
s_add_u32 m0, s38, 19584
TR 224,18,0
TR 226,18,2048
Mvav 112,228,40
v_cvt_pk_bf16_f32 v29, v26, v27
Mvav 116,228,44
s_waitcnt lgkmcnt(6)
TR 228,17,512
TR 230,17,2560
Mvav 120,232,40
buffer_load_dwordx4 v6, s[16:19], s79 offen offset:896 lds
Mvav 124,232,44
s_add_u32 m0, s38, 23680
TR 232,18,512
TR 234,18,2560
Mvav 128,236,40
v_exp_f32 v25, v73
Mvav 132,236,44
s_waitcnt lgkmcnt(6)
TR 236,15,0
TR 238,15,2048
Mvav 136,240,40
buffer_load_dwordx4 v6, s[16:19], s80 offen offset:896 lds
Mvav 140,240,44
s_add_u32 m0, s38, 27776
TR 240,16,0
TR 242,16,2048
Mvav 144,244,40
v_exp_f32 v26, v74
Mvav 148,244,44
s_waitcnt lgkmcnt(6)
TR 244,15,512
TR 246,15,2560
Mvav 152,224,40
buffer_load_dwordx4 v6, s[16:19], s81 offen offset:896 lds
Mvav 156,224,44
s_add_u32 m0, s38, 31872
TR 224,16,512
TR 226,16,2560
Mvav 160,228,40
v_cvt_pk_bf16_f32 v0, v24, v25
Mvav 164,228,44
s_waitcnt lgkmcnt(6)
TR 228,15,8192
TR 230,15,10240
Mvav 168,232,40
buffer_load_dwordx4 v6, s[16:19], s82 offen offset:896 lds
Mvav 172,232,44
s_add_u32 m0, s38, 36864
TR 232,16,8192
TR 234,16,10240
Mvaa 224,236,48
v_exp_f32 v27, v75
Mvaa 228,236,52
s_waitcnt lgkmcnt(6)
TR 236,15,8704
TR 238,15,10752
Mvaa 232,240,48
v_exp_f32 v24, v68
Mvaa 236,240,52
TR 240,16,8704
TR 242,16,10752
Mvaa 240,244,48
buffer_load_dwordx4 v5, s[12:15], s33 offen nt lds
Mvaa 244,244,52
s_waitcnt lgkmcnt(6)
TR 244,19,61440
TR 246,19,63488
Mvaa 248,224,48
s_add_u32 m0, s38, 40832
v_cvt_pk_bf16_f32 v1, v26, v27
Mvaa 252,224,52
TR 224,20,61440
TR 226,20,63488
Mvaa 224,228,56
v_exp_f32 v25, v69
Mvaa 228,228,60
s_waitcnt lgkmcnt(6)
TR 228,19,61952
TR 230,19,64000
Mvaa 232,232,56
buffer_load_dwordx4 v5, s[12:15], s33 offen offset:128 nt lds
Mvaa 236,232,60
s_waitcnt vmcnt(10)
TR 232,20,61952
TR 234,20,64000
Mvaa 240,236,56
s_barrier
Mvaa 244,236,60
s_waitcnt lgkmcnt(6)
ds_read_b128 a[236:239], v10 offset:4096
v_cvt_pk_bf16_f32 v30, v24, v25
Mvaa 248,240,56
s_add_u32 m0, s38, 147200
v_exp_f32 v26, v70
Mvaa 252,240,60
ds_read_b128 a[240:243], v10 offset:4608
Mvaa 224,244,64
buffer_load_dwordx4 v5, s[12:15], s33 offen offset:256 nt lds
Mvaa 228,244,68
s_waitcnt lgkmcnt(4)
ds_read_b128 a[244:247], v11 offset:4096
s_add_u32 s33, s33, 6144
Mvaa 232,224,64
s_sub_u32 s45, s33, 98304
v_exp_f32 v27, v71
Mvaa 236,224,68
s_min_u32 s33, s33, s45
ds_read_b128 a[224:227], v11 offset:4608
v_cvt_pk_bf16_f32 v31, v26, v27
Mvaa 240,228,64
s_add_u32 m0, s38, 114688
v_exp_f32 v24, v76
Mvaa 244,228,68
s_waitcnt lgkmcnt(3)
ds_read_b128 a[228:231], v11 offset:8192
Mvaa 248,232,64
buffer_load_dwordx4 v5, s[12:15], s33 offen nt lds
Mvaa 252,232,68
s_add_u32 s43, s33, 128
ds_read_b128 a[232:235], v11 offset:8704
s_add_u32 m0, s38, 0
v_mfma_f32_16x16x32_bf16 v[48:51], a[236:239], v[176:179], 0
v_exp_f32 v25, v77
v_mfma_f32_16x16x32_bf16 v[56:59], a[236:239], v[180:183], 0
s_waitcnt lgkmcnt(3)
ds_read_b128 a[236:239], v10 offset:6144
v_cvt_pk_bf16_f32 v2, v24, v25
Mvav 48,240,184
v_exp_f32 v26, v78
Mvav 56,240,188
ds_read_b128 a[240:243], v10 offset:6656
Mvav 48,244,192
buffer_load_dwordx4 v5, s[12:15], s43 offen nt lds
Mvav 56,244,196
s_waitcnt lgkmcnt(3)
ds_read_b128 a[244:247], v11 offset:6144
s_add_u32 m0, s38, 3840
Mvav 48,224,200
v_exp_f32 v27, v79
Mvav 56,224,204
ds_read_b128 a[224:227], v11 offset:6656
v_cvt_pk_bf16_f32 v3, v26, v27
Mvav 48,228,208
Mvav 56,228,212
s_waitcnt lgkmcnt(3)
ds_read_b128 a[228:231], v11 offset:10240
Mvav 48,232,216
buffer_load_dwordx4 v5, s[12:15], s33 offen offset:256 nt lds
Mvav 56,232,220
s_add_u32 s33, s33, 6144
ds_read_b128 a[232:235], v11 offset:10752
s_sub_u32 s45, s33, 98304
v_mfma_f32_16x16x32_bf16 v[52:55], a[236:239], v[176:179], 0
s_min_u32 s33, s33, s45
v_add_u32 v5, 196608, v5
s_add_u32 m0, s38, 44160
v_mfma_f32_16x16x32_bf16 v[60:63], a[236:239], v[180:183], 0
s_waitcnt lgkmcnt(3)
TR 236,19,53248
TR 238,19,55296
Mvav 52,240,184
buffer_load_dwordx4 v6, s[16:19], s83 offen offset:896 lds
Mvav 60,240,188
TR 240,20,53248
TR 242,20,55296
Mvav 52,244,192
v_exp_f32 v24, v48
Mvav 60,244,196
s_waitcnt lgkmcnt(5)
TR 244,19,53760
TR 246,19,55808
Mvav 52,224,200
v_exp_f32 v25, v49
Mvav 60,224,204
TR 224,20,53760
TR 226,20,55808
Mvav 52,228,208
v_exp_f32 v26, v50
Mvav 60,228,212
s_waitcnt lgkmcnt(6)
TR 228,19,24576
TR 230,19,26624
Mvav 52,232,216
v_cvt_pk_bf16_f32 v40, v24, v25
Mvav 60,232,220
v_exp_f32 v27, v51
Mvaa 224,236,72
v_exp_f32 v24, v56
Mvaa 228,236,76
s_waitcnt lgkmcnt(4)
TR 236,20,24576
TR 238,20,26624
Mvaa 232,240,72
v_cvt_pk_bf16_f32 v41, v26, v27
Mvaa 236,240,76
TR 240,19,25088
TR 242,19,27136
Mvaa 240,244,72
v_exp_f32 v25, v57
Mvaa 244,244,76
s_waitcnt vmcnt(12) lgkmcnt(4)
TR 244,20,25088
TR 246,20,27136
Mvaa 248,224,72
s_barrier
Mvaa 252,224,76
TR 224,19,57344
TR 226,19,59392
Mvaa 224,228,80
v_exp_f32 v26, v58
Mvaa 228,228,84
s_waitcnt lgkmcnt(6)
TR 228,20,57344
TR 230,20,59392
Mvav 32,252,28
v_cvt_pk_bf16_f32 v44, v24, v25
Mvav 36,252,0
TR 232,19,57856
TR 234,19,59904
Mvaa 232,236,80
v_exp_f32 v27, v59
Mvaa 236,236,84
s_waitcnt lgkmcnt(6)
TR 236,20,57856
TR 238,20,59904
Mvaa 240,240,80
v_max_f32 v33, v32, v36
v_cmp_nge_f32 vcc, s39, v33
Mvaa 244,240,84
TR 240,19,20480
TR 242,19,22528
Mvaa 248,244,80
v_exp_f32 v24, v52
Mvaa 252,244,84
s_waitcnt lgkmcnt(6)
TR 244,20,20480
TR 246,20,22528
s_cbranch_vccnz Lr13
Lb13:
Mvav 80,224,28
v_cvt_pk_bf16_f32 v45, v26, v27
Mvav 84,224,0
TR 224,19,20992
TR 226,19,23040
Mvav 88,228,28
v_exp_f32 v25, v53
Mvav 92,228,0
s_waitcnt lgkmcnt(6)
TR 228,20,20992
TR 230,20,23040
Mvav 96,232,28
v_exp_f32 v26, v54
Mvav 100,232,0
TR 232,15,12288
TR 234,15,14336
Mvav 104,236,28
v_cvt_pk_bf16_f32 v42, v24, v25
Mvav 108,236,0
s_waitcnt lgkmcnt(6)
TR 236,16,12288
TR 238,16,14336
Mvav 112,240,28
v_exp_f32 v27, v55
Mvav 116,240,0
TR 240,15,12800
TR 242,15,14848
Mvav 120,244,28
v_cvt_pk_bf16_f32 v43, v26, v27
Mvav 124,244,0
s_waitcnt lgkmcnt(6)
TR 244,16,12800
TR 246,16,14848
Mvav 128,224,28
v_exp_f32 v24, v60
Mvav 132,224,0
TR 224,19,12288
TR 226,19,14336
Mvav 136,228,28
v_exp_f32 v25, v61
Mvav 140,228,0
s_waitcnt lgkmcnt(6)
TR 228,20,12288
TR 230,20,14336
Mvav 144,232,28
v_exp_f32 v26, v62
Mvav 148,232,0
TR 232,19,12800
TR 234,19,14848
Mvav 152,236,28
v_cvt_pk_bf16_f32 v46, v24, v25
Mvav 156,236,0
s_waitcnt lgkmcnt(6)
TR 236,20,12800
TR 238,20,14848
Mvav 160,240,28
v_exp_f32 v27, v63
Mvav 164,240,0
TR 240,19,28672
TR 242,19,30720
Mvav 168,244,28
v_cvt_pk_bf16_f32 v47, v26, v27
Mvav 172,244,0
s_waitcnt lgkmcnt(6)
TR 244,20,28672
TR 246,20,30720
Mvaa 224,224,88
Mvaa 228,224,92
TR 224,19,29184
TR 226,19,31232
Mvaa 232,228,88
Mvaa 236,228,92
s_waitcnt lgkmcnt(6)
TR 228,20,29184
TR 230,20,31232
Mvaa 240,232,88
Mvaa 244,232,92
TR 232,19,32768
TR 234,19,34816
Mvaa 248,236,88
Mvaa 252,236,92
s_waitcnt lgkmcnt(6)
TR 236,20,32768
TR 238,20,34816
Mvaa 224,240,96
Mvaa 228,240,100
TR 240,19,33280
TR 242,19,35328
Mvaa 232,244,96
Mvaa 236,244,100
s_waitcnt vmcnt(0) lgkmcnt(6)
TR 244,20,33280
TR 246,20,35328
Mvaa 240,224,96
s_barrier
Mvaa 244,224,100
ds_read_b128 a[224:227], v11 offset:45056
s_add_u32 m0, s38, 117760
Mvaa 248,228,96
Mvaa 252,228,100
s_waitcnt lgkmcnt(5)
ds_read_b128 a[228:231], v11 offset:45568
Mvaa 224,232,104
buffer_load_dwordx4 v6, s[16:19], s66 offen offset:1024 lds
Mvaa 228,232,108
s_add_u32 m0, s38, 121856
ds_read_b128 a[232:235], v11 offset:36864
Mvaa 232,236,104
Mvaa 236,236,108
s_waitcnt lgkmcnt(3)
ds_read_b128 a[236:239], v11 offset:37376
Mvaa 240,240,104
buffer_load_dwordx4 v6, s[16:19], s67 offen offset:1024 lds
Mvaa 244,240,108
s_add_u32 m0, s38, 109568
ds_read_b128 a[240:243], v11 offset:40960
Mvaa 248,244,104
Mvaa 252,244,108
s_waitcnt lgkmcnt(3)
ds_read_b128 a[244:247], v11 offset:41472
v_mfma_f32_16x16x32_bf16 v[64:67], a[224:227], v[176:179], 0
buffer_load_dwordx4 v6, s[16:19], s68 offen offset:1024 lds
v_mfma_f32_16x16x32_bf16 v[72:75], a[224:227], v[180:183], 0
s_add_u32 m0, s38, 101376
ds_read_b128 a[224:227], v11 offset:47104
Mvav 64,228,184
Mvav 72,228,188
s_waitcnt lgkmcnt(3)
ds_read_b128 a[228:231], v11 offset:47616
Mvav 64,232,192
buffer_load_dwordx4 v6, s[16:19], s69 offen offset:1024 lds
Mvav 72,232,196
s_add_u32 m0, s38, 105472
ds_read_b128 a[232:235], v11 offset:38912
Mvav 64,236,200
Mvav 72,236,204
s_waitcnt lgkmcnt(3)
ds_read_b128 a[236:239], v11 offset:39424
Mvav 64,240,208
buffer_load_dwordx4 v6, s[16:19], s70 offen offset:1024 lds
Mvav 72,240,212
s_add_u32 m0, s38, 8192
ds_read_b128 a[240:243], v11 offset:43008
Mvav 64,244,216
Mvav 72,244,220
s_waitcnt lgkmcnt(3)
ds_read_b128 a[244:247], v11 offset:43520
v_mfma_f32_16x16x32_bf16 v[68:71], a[224:227], v[176:179], 0
v_exp_f32 v24, v64
v_mfma_f32_16x16x32_bf16 v[76:79], a[224:227], v[180:183], 0
TR 224,15,16384
TR 226,15,18432
Mvav 68,228,184
buffer_load_dwordx4 v4, s[8:11], s32 offen nt lds
Mvav 76,228,188
s_waitcnt lgkmcnt(4)
TR 228,16,16384
TR 230,16,18432
Mvav 68,232,192
s_add_u32 m0, s38, 12160
v_exp_f32 v25, v65
Mvav 76,232,196
TR 232,15,20480
TR 234,15,22528
Mvav 68,236,200
v_exp_f32 v26, v66
Mvav 76,236,204
s_waitcnt lgkmcnt(6)
Tc10:
s_cbranch_execz Tdone2
s_cmpk_eq_u32 s88, 13
s_cselect_b64 exec, 0, -1
s_cbranch_execz Tc13
Tr13:
s_mov_b64 exec, -1
TR 236,16,20480
TR 238,16,22528
Mvav 68,240,208
buffer_load_dwordx4 v4, s[8:11], s32 offen offset:128 nt lds
Mvav 76,240,212
s_add_u32 m0, s38, 48896
TR 240,15,24576
TR 242,15,26624
Mvav 68,244,216
v_cvt_pk_bf16_f32 v28, v24, v25
Mvav 76,244,220
s_waitcnt lgkmcnt(6)
TR 244,16,24576
TR 246,16,26624
Mvaa 224,224,112
v_exp_f32 v27, v67
Mvaa 228,224,116
TR 224,15,28672
TR 226,15,30720
Mvaa 232,228,112
buffer_load_dwordx4 v4, s[8:11], s32 offen offset:256 nt lds
Mvaa 236,228,116
s_waitcnt lgkmcnt(6)
TR 228,16,28672
TR 230,16,30720
Mvaa 224,232,120
s_add_u32 s32, s32, 6144
v_exp_f32 v24, v72
Mvaa 228,232,124
s_sub_u32 s45, s32, 98304
TR 232,15,32768
TR 234,15,34816
Mvaa 232,236,120
s_min_u32 s32, s32, s45
v_cvt_pk_bf16_f32 v29, v26, v27
s_add_u32 m0, s38, 53248
Mvaa 236,236,124
s_waitcnt lgkmcnt(6)
v_exp_f32 v25, v73
Mvaa 224,240,128
buffer_load_dwordx4 v4, s[8:11], s32 offen nt lds
Mvaa 228,240,132
s_add_u32 m0, s38, 57216
TR 240,16,32768
TR 242,16,34816
Mvaa 232,244,128
v_exp_f32 v26, v74
Mvaa 236,244,132
s_waitcnt lgkmcnt(4)
TR 244,15,45056
TR 246,15,47104
Mvaa 224,224,136
v_cvt_pk_bf16_f32 v0, v24, v25
Mvaa 228,224,140
TR 224,16,45056
TR 226,16,47104
Mvaa 232,228,136
s_barrier
Mvaa 236,228,140
s_waitcnt lgkmcnt(6)
TR 228,15,36864
TR 230,15,38912
Mvaa 224,232,144
buffer_load_dwordx4 v4, s[8:11], s32 offen offset:128 nt lds
Mvaa 228,232,148
s_add_u32 m0, s38, 143104
TR 232,16,36864
TR 234,16,38912
Mvav 32,252,40
v_exp_f32 v27, v75
Mvav 36,252,44
s_waitcnt lgkmcnt(6)
TR 236,15,37376
TR 238,15,39424
Mvaa 232,240,144
v_exp_f32 v24, v68
Mvaa 236,240,148
TR 240,16,37376
TR 242,16,39424
Mvaa 224,244,152
buffer_load_dwordx4 v4, s[8:11], s32 offen offset:256 nt lds
Mvaa 228,244,156
s_waitcnt lgkmcnt(6)
TR 244,15,40960
TR 246,15,43008
Mvaa 232,224,152
s_add_u32 s32, s32, 6144
v_max_f32 v33, v32, v36
v_cmp_nge_f32 vcc, s39, v33
Mvaa 236,224,156
s_sub_u32 s45, s32, 98304
TR 224,16,40960
TR 226,16,43008
s_cbranch_vccnz Lr14
Lb14:
Mvav 80,228,40
s_min_u32 s32, s32, s45
v_cvt_pk_bf16_f32 v1, v26, v27
v_mul_f32 v224, s40, v224
Mvav 84,228,44
s_waitcnt lgkmcnt(6)
TR 228,15,41472
TR 230,15,43520
Mvav 88,232,40
s_add_u32 m0, s38, 134144
v_exp_f32 v25, v69
Mvav 92,232,44
TR 232,16,41472
TR 234,16,43520
Mvav 96,236,40
buffer_load_dwordx4 v6, s[16:19], s64 offen offset:1024 lds
Mvav 100,236,44
s_waitcnt lgkmcnt(6)
TR 236,19,49152
TR 238,19,51200
Mvav 104,240,40
s_add_u32 m0, s38, 138240
v_exp_f32 v26, v70
Mvav 108,240,44
TR 240,20,49152
TR 242,20,51200
Mvav 112,244,40
buffer_load_dwordx4 v6, s[16:19], s65 offen offset:1024 lds
Mvav 116,244,44
s_waitcnt lgkmcnt(6)
TR 244,19,49664
TR 246,19,51712
Mvav 120,224,40
s_add_u32 m0, s38, 125952
v_cvt_pk_bf16_f32 v30, v24, v25
v_mul_f32 v225, s40, v225
Mvav 124,224,44
TR 224,20,49664
TR 226,20,51712
Mvav 128,228,40
buffer_load_dwordx4 v6, s[16:19], s71 offen offset:1024 lds
Mvav 132,228,44
s_waitcnt lgkmcnt(6)
TR 228,15,16896
TR 230,15,18944
Mvav 136,232,40
v_exp_f32 v27, v71
Mvav 140,232,44
TR 232,16,16896
TR 234,16,18944
Mvav 144,236,40
v_cvt_pk_bf16_f32 v31, v26, v27
v_mul_f32 v226, s40, v226
Mvav 148,236,44
s_waitcnt lgkmcnt(6)
TR 236,15,20992
TR 238,15,23040
Mvav 152,240,40
v_exp_f32 v24, v76
Mvav 156,240,44
TR 240,16,20992
TR 242,16,23040
Mvav 160,244,40
v_exp_f32 v25, v77
Mvav 164,244,44
s_waitcnt lgkmcnt(6)
TR 244,15,25088
TR 246,15,27136
Mvav 168,224,40
v_exp_f32 v26, v78
Mvav 172,224,44
TR 224,16,25088
TR 226,16,27136
Mvaa 240,228,112
v_cvt_pk_bf16_f32 v2, v24, v25
v_mul_f32 v227, s40, v227
Mvaa 244,228,116
s_waitcnt lgkmcnt(6)
TR 228,15,29184
TR 230,15,31232
Mvaa 248,232,112
v_exp_f32 v27, v79
Mvaa 252,232,116
TR 232,16,29184
TR 234,16,31232
Mvaa 240,236,120
s_add_u32 m0, s38, 130048
v_cvt_pk_bf16_f32 v3, v26, v27
v_mul_f32 v232, s40, v232
Mvaa 244,236,124
s_waitcnt lgkmcnt(6)
TR 236,15,33280
TR 238,15,35328
Mvaa 248,240,120
buffer_load_dwordx4 v6, s[16:19], s72 offen offset:1024 lds
Mvaa 252,240,124
s_add_u32 m0, s38, 60416
v_mul_f32 v233, s40, v233
v_mul_f32 v234, s40, v234
Mvaa 240,244,128
v_mul_f32 v235, s40, v235
v_cvt_pk_bf16_f32 v224, v224, v225
Mvaa 244,244,132
s_waitcnt lgkmcnt(4)
TR 244,16,33280
TR 246,16,35328
Mvaa 248,224,128
buffer_load_dwordx4 v6, s[16:19], s73 offen offset:1024 lds
Mvaa 252,224,132
s_add_u32 m0, s38, 64512
TR 224,15,45568
TR 226,15,47616
Mvaa 240,228,136
v_cvt_pk_bf16_f32 v225, v226, v227
v_cvt_pk_bf16_f32 v226, v232, v233
Mvaa 244,228,140
s_waitcnt lgkmcnt(4)
TR 228,16,45568
TR 230,16,47616
Mvaa 248,232,136
s_barrier
Mvaa 252,232,140
TR 232,19,16384
TR 234,19,18432
Mvaa 240,236,144
buffer_load_dwordx4 v6, s[16:19], s74 offen offset:1024 lds
Mvaa 244,236,148
s_waitcnt lgkmcnt(6)
TR 236,20,16384
TR 238,20,18432
Mvav 32,252,28
s_add_u32 m0, s38, 146432
v_cvt_pk_bf16_f32 v227, v234, v235
v_permlane16_swap_b32 v224, v226
Mvav 36,252,0
TR 240,19,16896
TR 242,19,18944
Mvaa 248,244,144
buffer_load_dwordx4 v6, s[16:19], s75 offen offset:1024 lds
Mvaa 252,244,148
s_waitcnt lgkmcnt(6)
TR 244,20,16896
TR 246,20,18944
Mvaa 240,224,152
s_add_u32 m0, s38, 15360
v_max_f32 v33, v32, v36
v_cmp_nge_f32 vcc, s39, v33
Mvaa 244,224,156
TR 224,15,0
TR 226,15,2048
Mvaa 248,228,152
buffer_load_dwordx4 v6, s[16:19], s76 offen offset:1024 lds
Mvaa 252,228,156
s_waitcnt lgkmcnt(6)
TR 228,16,0
TR 230,16,2048
s_cbranch_vccnz Lr15
Lb15:
Mvav 80,232,28
s_add_u32 m0, s38, 19456
v_permlane16_swap_b32 v225, v227
v_accvgpr_write_b32 a248, v224
Mvav 84,232,0
TR 232,15,512
TR 234,15,2560
Mvav 88,236,28
buffer_load_dwordx4 v6, s[16:19], s77 offen offset:1024 lds
Mvav 92,236,0
s_waitcnt lgkmcnt(6)
TR 236,16,512
TR 238,16,2560
Mvav 96,240,28
s_add_u32 m0, s38, 23552
v_accvgpr_write_b32 a249, v225
v_accvgpr_write_b32 a250, v226
Mvav 100,240,0
TR 240,15,4096
TR 242,15,6144
Mvav 104,244,28
buffer_load_dwordx4 v6, s[16:19], s78 offen offset:1024 lds
Mvav 108,244,0
s_waitcnt lgkmcnt(6)
TR 244,16,4096
TR 246,16,6144
Mvav 112,224,28
s_add_u32 m0, s38, 28672
v_accvgpr_write_b32 a251, v227
v_mul_f32 v228, s40, v228
Mvav 116,224,0
TR 224,15,4608
TR 226,15,6656
Mvav 120,228,28
v_mul_f32 v229, s40, v229
v_mul_f32 v230, s40, v230
Mvav 124,228,0
s_waitcnt vmcnt(7) lgkmcnt(6)
TR 228,16,4608
TR 230,16,6656
Mvav 128,232,28
s_barrier
Mvav 132,232,0
ds_read_b128 a[232:235], v9 offset:8192
v_mul_f32 v231, s40, v231
Mvav 136,236,28
buffer_load_dwordx4 v5, s[12:15], s33 offen nt lds
Mvav 140,236,0
s_waitcnt lgkmcnt(5)
ds_read_b128 a[236:239], v9 offset:8704
v_mul_f32 v236, s40, v236
Mvav 144,240,28
s_add_u32 m0, s38, 114560
v_mul_f32 v237, s40, v237
v_mul_f32 v238, s40, v238
Mvav 148,240,0
ds_read_b128 a[240:243], v9 offset:12288
v_mul_f32 v239, s40, v239
Mvav 152,244,28
v_cvt_pk_bf16_f32 v228, v228, v229
v_cvt_pk_bf16_f32 v229, v230, v231
Mvav 156,244,0
s_waitcnt lgkmcnt(3)
ds_read_b128 a[244:247], v9 offset:12800
v_cvt_pk_bf16_f32 v230, v236, v237
Mvav 160,224,28
buffer_load_dwordx4 v5, s[12:15], s33 offen offset:128 nt lds
Mvav 164,224,0
s_add_u32 m0, s38, 32512
ds_read_b128 a[224:227], v10 offset:0
v_cvt_pk_bf16_f32 v231, v238, v239
Mvav 168,228,28
v_permlane16_swap_b32 v228, v230
v_permlane16_swap_b32 v229, v231
Mvav 172,228,0
s_waitcnt lgkmcnt(3)
ds_read_b128 a[228:231], v10 offset:512
ds_write_b128 v13, v[228:231] offset:61440
v_mfma_f32_16x16x32_bf16 v[48:51], a[232:235], a[160:163], 0
v_mul_f32 v240, s40, v240
v_mul_f32 v241, s40, v241
v_mfma_f32_16x16x32_bf16 v[56:59], a[232:235], a[164:167], 0
ds_read_b128 a[232:235], v9 offset:10240
v_mul_f32 v242, s40, v242
Mvaa 48,236,168
buffer_load_dwordx4 v5, s[12:15], s33 offen offset:256 nt lds
Mvaa 56,236,172
s_waitcnt lgkmcnt(4)
ds_read_b128 a[236:239], v9 offset:10752
v_mul_f32 v243, s40, v243
Mvaa 48,240,176
s_add_u32 s33, s33, 6144
v_mul_f32 v248, s40, v248
v_mul_f32 v249, s40, v249
Mvaa 56,240,180
s_sub_u32 s45, s33, 98304
ds_read_b128 a[240:243], v9 offset:14336
v_mul_f32 v250, s40, v250
Mvaa 48,244,184
s_min_u32 s33, s33, s45
v_mul_f32 v251, s40, v251
v_cvt_pk_bf16_f32 v240, v240, v241
Mvaa 56,244,188
s_waitcnt lgkmcnt(4)
ds_read_b128 a[244:247], v9 offset:14848
v_cvt_pk_bf16_f32 v241, v242, v243
Mvaa 48,224,192
s_add_u32 m0, s38, 36864
v_cvt_pk_bf16_f32 v242, v248, v249
v_cvt_pk_bf16_f32 v243, v250, v251
Mvaa 56,224,196
ds_read_b128 a[224:227], v10 offset:2048
v_permlane16_swap_b32 v240, v242
Mvaa 48,228,200
buffer_load_dwordx4 v4, s[8:11], s32 offen nt lds
Mvaa 56,228,204
s_waitcnt lgkmcnt(3)
ds_read_b128 a[228:231], v10 offset:2560
v_permlane16_swap_b32 v241, v243
v_mfma_f32_16x16x32_bf16 v[52:55], a[232:235], a[160:163], 0
s_add_u32 m0, s38, 40832
ds_write_b128 v13, v[240:243] offset:57344
v_mul_f32 v244, s40, v244
v_mfma_f32_16x16x32_bf16 v[60:63], a[232:235], a[164:167], 0
TR 232,19,36864
TR 234,19,38912
Mvaa 52,236,168
v_mul_f32 v245, s40, v245
v_mul_f32 v246, s40, v246
Mvaa 60,236,172
s_waitcnt lgkmcnt(5)
TR 236,20,36864
TR 238,20,38912
Mvaa 52,240,176
buffer_load_dwordx4 v4, s[8:11], s32 offen offset:128 nt lds
Mvaa 60,240,180
s_add_u32 m0, s38, 44800
TR 240,19,40960
TR 242,19,43008
Mvaa 52,244,184
v_mul_f32 v247, s40, v247
v_mul_f32 v252, s40, v252
Mvaa 60,244,188
s_waitcnt lgkmcnt(7)
TR 244,20,40960
TR 246,20,43008
Mvaa 52,224,192
v_mul_f32 v253, s40, v253
v_mul_f32 v254, s40, v254
Mvaa 60,224,196
TR 224,19,20480
TR 226,19,22528
Mvaa 52,228,200
buffer_load_dwordx4 v4, s[8:11], s32 offen offset:256 nt lds
Mvaa 60,228,204
s_waitcnt lgkmcnt(6)
TR 228,20,20480
TR 230,20,22528
v_mfma_f32_16x16x32_bf16 v[224:227], a[232:235], a[0:3], 0
s_add_u32 s32, s32, 6144
v_mul_f32 v255, s40, v255
v_cvt_pk_bf16_f32 v244, v244, v245
v_mfma_f32_16x16x32_bf16 v[228:231], a[232:235], a[4:7], 0
s_sub_u32 s45, s32, 98304
TR 232,19,24576
TR 234,19,26624
v_mfma_f32_16x16x32_bf16 v[232:235], a[236:239], a[0:3], 0
s_min_u32 s32, s32, s45
v_cvt_pk_bf16_f32 v245, v246, v247
v_cvt_pk_bf16_f32 v246, v252, v253
v_mfma_f32_16x16x32_bf16 v[236:239], a[236:239], a[4:7], 0
s_waitcnt lgkmcnt(6)
TR 236,20,24576
TR 238,20,26624
Mvaa 224,240,8
s_add_u32 m0, s38, 68608
v_cvt_pk_bf16_f32 v247, v254, v255
v_permlane16_swap_b32 v244, v246
Mvaa 228,240,12
TR 240,19,12288
TR 242,19,14336
Mvaa 232,244,8
buffer_load_dwordx4 v6, s[16:19], s79 offen offset:1024 lds
Mvaa 236,244,12
s_waitcnt lgkmcnt(6)
TR 244,20,12288
TR 246,20,14336
Mvaa 224,224,16
v_permlane16_swap_b32 v245, v247
ds_write_b128 v13, v[244:247] offset:53248
Mvaa 228,224,20
TR 224,19,4096
TR 226,19,6144
Mvaa 232,228,16
v_rcp_f32 v12, v32
Mvaa 236,228,20
s_waitcnt lgkmcnt(7)
TR 228,20,4096
TR 230,20,6144
Mvaa 224,232,24
v_exp_f32 v24, v48
Mvaa 228,232,28
TR 232,19,37376
TR 234,19,39424
Mvaa 232,236,24
v_exp_f32 v25, v49
Mvaa 236,236,28
s_waitcnt lgkmcnt(7)
TR 236,20,37376
TR 238,20,39424
Mvaa 224,240,32
v_exp_f32 v26, v50
Mvaa 228,240,36
TR 240,19,41472
TR 242,19,43520
Mvaa 232,244,32
v_cvt_pk_bf16_f32 v40, v24, v25
v_mul_f32 v80, v12, v80
Mvaa 236,244,36
s_waitcnt lgkmcnt(6)
TR 244,20,41472
TR 246,20,43520
Mvaa 224,224,40
v_exp_f32 v27, v51
Mvaa 228,224,44
TR 224,19,20992
TR 226,19,23040
Mvaa 232,228,40
v_exp_f32 v24, v56
Mvaa 236,228,44
s_waitcnt lgkmcnt(6)
TR 228,20,20992
TR 230,20,23040
v_mfma_f32_16x16x32_bf16 v[240:243], a[232:235], a[0:3], 0
v_cvt_pk_bf16_f32 v41, v26, v27
v_mul_f32 v81, v12, v81
v_mfma_f32_16x16x32_bf16 v[244:247], a[232:235], a[4:7], 0
TR 232,19,25088
TR 234,19,27136
v_mfma_f32_16x16x32_bf16 v[248:251], a[236:239], a[0:3], 0
v_exp_f32 v25, v57
v_mfma_f32_16x16x32_bf16 v[252:255], a[236:239], a[4:7], 0
s_waitcnt lgkmcnt(6)
TR 236,20,25088
TR 238,20,27136
Mvaa 240,240,8
s_add_u32 m0, s38, 72704
v_exp_f32 v26, v58
Mvaa 244,240,12
TR 240,19,12800
TR 242,19,14848
Mvaa 248,244,8
buffer_load_dwordx4 v6, s[16:19], s80 offen offset:1024 lds
Mvaa 252,244,12
s_waitcnt lgkmcnt(6)
TR 244,20,12800
TR 246,20,14848
Mvaa 240,224,16
s_add_u32 m0, s38, 76800
v_cvt_pk_bf16_f32 v44, v24, v25
v_mul_f32 v82, v12, v82
Mvaa 244,224,20
TR 224,19,4608
TR 226,19,6656
Mvaa 248,228,16
buffer_load_dwordx4 v6, s[16:19], s81 offen offset:1024 lds
Mvaa 252,228,20
s_waitcnt lgkmcnt(6)
TR 228,20,4608
TR 230,20,6656
Mvaa 240,232,24
s_add_u32 m0, s38, 80896
v_exp_f32 v27, v59
Mvaa 244,232,28
TR 232,19,8192
TR 234,19,10240
Mvaa 248,236,24
buffer_load_dwordx4 v6, s[16:19], s82 offen offset:1024 lds
Mvaa 252,236,28
s_waitcnt lgkmcnt(6)
TR 236,20,8192
TR 238,20,10240
Mvaa 240,240,32
s_add_u32 m0, s38, 84992
v_exp_f32 v24, v52
Mvaa 244,240,36
TR 240,19,8704
TR 242,19,10752
Mvaa 248,244,32
buffer_load_dwordx4 v6, s[16:19], s83 offen offset:1024 lds
Mvaa 252,244,36
s_waitcnt lgkmcnt(6)
TR 244,20,8704
TR 246,20,10752
Mvaa 240,224,40
s_add_u32 m0, s38, 90112
v_cvt_pk_bf16_f32 v45, v26, v27
v_mul_f32 v83, v12, v83
Mvaa 244,224,44
TR 224,19,28672
TR 226,19,30720
Mvaa 248,228,40
v_exp_f32 v25, v53
Mvaa 252,228,44
s_waitcnt lgkmcnt(6)
TR 228,20,28672
TR 230,20,30720
Mvaa 224,232,48
buffer_load_dwordx4 v5, s[12:15], s33 offen nt lds
Mvaa 228,232,52
s_add_u32 m0, s38, 118656
TR 232,19,29184
TR 234,19,31232
Mvaa 232,236,48
v_exp_f32 v26, v54
Mvaa 236,236,52
s_waitcnt vmcnt(5) lgkmcnt(6)
TR 236,20,29184
TR 238,20,31232
Mvaa 240,240,48
s_barrier
Mvaa 244,240,52
ds_read_b128 a[240:243], v10 offset:4096
Tc11:
s_cbranch_execz Tdone2
s_cmpk_eq_u32 s88, 14
s_cselect_b64 exec, 0, -1
s_cbranch_execz Tc14
Tr14:
s_mov_b64 exec, -1
v_cvt_pk_bf16_f32 v42, v24, v25
Mvaa 248,244,48
buffer_load_dwordx4 v5, s[12:15], s33 offen offset:128 nt lds
Mvaa 252,244,52
s_waitcnt lgkmcnt(5)
ds_read_b128 a[244:247], v10 offset:4608
v_cvt_pk_bf16_f32 v176, v80, v81
Mvaa 224,224,56
s_add_u32 m0, s38, 122624
v_exp_f32 v27, v55
Mvaa 228,224,60
ds_read_b128 a[224:227], v10 offset:8192
v_cvt_pk_bf16_f32 v43, v26, v27
Mvaa 232,228,56
v_rcp_f32 v8, v36
Mvaa 236,228,60
s_waitcnt lgkmcnt(3)
ds_read_b128 a[228:231], v10 offset:8704
v_cvt_pk_bf16_f32 v177, v82, v83
Mvaa 240,232,56
buffer_load_dwordx4 v5, s[12:15], s33 offen offset:256 nt lds
Mvaa 244,232,60
s_add_u32 s33, s33, 6144
ds_read_b128 a[232:235], v11 offset:45056
v_mul_f32 v84, v8, v84
Mvaa 248,236,56
s_sub_u32 s45, s33, 98304
v_exp_f32 v24, v60
Mvaa 252,236,60
s_waitcnt lgkmcnt(3)
ds_read_b128 a[236:239], v11 offset:45568
v_mul_f32 v85, v8, v85
v_mfma_f32_16x16x32_bf16 v[64:67], a[240:243], a[160:163], 0
s_min_u32 s33, s33, s45
v_exp_f32 v25, v61
v_mfma_f32_16x16x32_bf16 v[72:75], a[240:243], a[164:167], 0
s_add_u32 m0, s38, 110592
ds_read_b128 a[240:243], v10 offset:6144
v_cvt_pk_bf16_f32 v46, v24, v25
Mvaa 64,244,168
buffer_load_dwordx4 v4, s[8:11], s32 offen nt lds
Mvaa 72,244,172
s_waitcnt lgkmcnt(3)
ds_read_b128 a[244:247], v10 offset:6656
v_mul_f32 v86, v8, v86
Mvaa 64,224,176
s_add_u32 m0, s38, 102272
v_exp_f32 v26, v62
Mvaa 72,224,180
ds_read_b128 a[224:227], v10 offset:10240
v_mul_f32 v87, v8, v87
Mvaa 64,228,184
v_exp_f32 v27, v63
Mvaa 72,228,188
s_waitcnt lgkmcnt(3)
ds_read_b128 a[228:231], v10 offset:10752
v_cvt_pk_bf16_f32 v47, v26, v27
Mvaa 64,232,192
buffer_load_dwordx4 v4, s[8:11], s32 offen offset:128 nt lds
Mvaa 72,232,196
s_add_u32 s43, s32, 256
ds_read_b128 a[232:235], v11 offset:47104
v_cvt_pk_bf16_f32 v180, v84, v85
Mvaa 64,236,200
s_add_u32 m0, s38, 0
v_cvt_pk_bf16_f32 v181, v86, v87
v_mul_f32 v88, v12, v88
Mvaa 72,236,204
s_waitcnt lgkmcnt(3)
ds_read_b128 a[236:239], v11 offset:47616
v_mul_f32 v89, v12, v89
v_mfma_f32_16x16x32_bf16 v[68:71], a[240:243], a[160:163], 0
v_mul_f32 v90, v12, v90
v_mul_f32 v91, v12, v91
v_mfma_f32_16x16x32_bf16 v[76:79], a[240:243], a[164:167], 0
TR 240,19,32768
TR 242,19,34816
Mvaa 68,244,168
buffer_load_dwordx4 v4, s[8:11], s43 offen nt lds
Mvaa 76,244,172
s_waitcnt lgkmcnt(4)
TR 244,20,32768
TR 246,20,34816
Mvaa 68,224,176
s_add_u32 s32, s32, 6144
v_cvt_pk_bf16_f32 v178, v88, v89
v_cvt_pk_bf16_f32 v179, v90, v91
Mvaa 76,224,180
s_sub_u32 s45, s32, 98304
TR 224,19,33280
TR 226,19,35328
Mvaa 68,228,184
s_min_u32 s32, s32, s45
v_mul_f32 v92, v8, v92
v_mul_f32 v93, v8, v93
Mvaa 76,228,188
s_waitcnt lgkmcnt(6)
TR 228,20,33280
TR 230,20,35328
Mvaa 68,232,192
v_mul_f32 v94, v8, v94
v_mul_f32 v95, v8, v95
Mvaa 76,232,196
TR 232,17,12288
TR 234,17,14336
Mvaa 68,236,200
v_cvt_pk_bf16_f32 v182, v92, v93
v_cvt_pk_bf16_f32 v183, v94, v95
Mvaa 76,236,204
s_waitcnt lgkmcnt(6)
TR 236,18,12288
TR 238,18,14336
Mvaa 224,240,64
v_mul_f32 v96, v12, v96
v_mul_f32 v97, v12, v97
Mvaa 228,240,68
TR 240,17,12800
TR 242,17,14848
Mvaa 232,244,64
v_mul_f32 v98, v12, v98
v_mul_f32 v99, v12, v99
Mvaa 236,244,68
s_waitcnt lgkmcnt(6)
TR 244,18,12800
TR 246,18,14848
Mvaa 240,224,64
v_cvt_pk_bf16_f32 v184, v96, v97
v_cvt_pk_bf16_f32 v185, v98, v99
Mvaa 244,224,68
TR 224,17,16384
TR 226,17,18432
Mvaa 248,228,64
v_mul_f32 v100, v8, v100
v_mul_f32 v101, v8, v101
Mvaa 252,228,68
s_waitcnt lgkmcnt(6)
TR 228,18,16384
TR 230,18,18432
Mvaa 224,232,72
v_mul_f32 v102, v8, v102
v_mul_f32 v103, v8, v103
Mvaa 228,232,76
TR 232,17,16896
TR 234,17,18944
Mvaa 232,236,72
v_cvt_pk_bf16_f32 v188, v100, v101
v_cvt_pk_bf16_f32 v189, v102, v103
Mvaa 236,236,76
s_waitcnt lgkmcnt(6)
TR 236,18,16896
TR 238,18,18944
Mvaa 240,240,72
v_mul_f32 v104, v12, v104
v_mul_f32 v105, v12, v105
Mvaa 244,240,76
TR 240,19,49152
TR 242,19,51200
Mvaa 248,244,72
s_add_u32 m0, s38, 2944
v_mul_f32 v106, v12, v106
v_mul_f32 v107, v12, v107
Mvaa 252,244,76
s_waitcnt lgkmcnt(6)
TR 244,20,49152
TR 246,20,51200
Mvaa 224,224,80
buffer_load_dwordx4 v6, s[16:19], s66 offen offset:1152 lds
Mvaa 228,224,84
TR 224,19,49664
TR 226,19,51712
Mvaa 232,228,80
v_cvt_pk_bf16_f32 v186, v104, v105
v_cvt_pk_bf16_f32 v187, v106, v107
Mvaa 236,228,84
s_waitcnt lgkmcnt(6)
TR 228,20,49664
TR 230,20,51712
Mvaa 240,232,80
v_mul_f32 v108, v8, v108
v_mul_f32 v109, v8, v109
Mvaa 244,232,84
TR 232,15,16384
TR 234,15,18432
Mvaa 248,236,80
v_mul_f32 v110, v8, v110
v_mul_f32 v111, v8, v111
Mvaa 252,236,84
s_waitcnt lgkmcnt(6)
TR 236,16,16384
TR 238,16,18432
Mvaa 224,240,88
s_add_u32 m0, s38, 7040
v_cvt_pk_bf16_f32 v190, v108, v109
v_cvt_pk_bf16_f32 v191, v110, v111
Mvaa 228,240,92
TR 240,15,16896
TR 242,15,18944
Mvaa 232,244,88
buffer_load_dwordx4 v6, s[16:19], s67 offen offset:1152 lds
Mvaa 236,244,92
s_waitcnt lgkmcnt(6)
TR 244,16,16896
TR 246,16,18944
Mvaa 240,224,88
v_mul_f32 v112, v12, v112
v_mul_f32 v113, v12, v113
Mvaa 244,224,92
TR 224,15,20480
TR 226,15,22528
Mvaa 248,228,88
v_mul_f32 v114, v12, v114
v_mul_f32 v115, v12, v115
Mvaa 252,228,92
s_waitcnt lgkmcnt(6)
TR 228,16,20480
TR 230,16,22528
Mvaa 224,232,96
v_cvt_pk_bf16_f32 v192, v112, v113
v_cvt_pk_bf16_f32 v193, v114, v115
Mvaa 228,232,100
TR 232,15,20992
TR 234,15,23040
Mvaa 232,236,96
v_mul_f32 v116, v8, v116
v_mul_f32 v117, v8, v117
Mvaa 236,236,100
s_waitcnt lgkmcnt(6)
TR 236,16,20992
TR 238,16,23040
Mvaa 240,240,96
v_mul_f32 v118, v8, v118
v_mul_f32 v119, v8, v119
Mvaa 244,240,100
TR 240,15,24576
TR 242,15,26624
Mvaa 248,244,96
v_cvt_pk_bf16_f32 v196, v116, v117
v_cvt_pk_bf16_f32 v197, v118, v119
Mvaa 252,244,100
s_waitcnt lgkmcnt(6)
v_mul_f32 v120, v12, v120
v_mul_f32 v121, v12, v121
Mvaa 224,224,104
v_mul_f32 v122, v12, v122
v_mul_f32 v123, v12, v123
Mvaa 228,224,108
TR 224,16,24576
TR 226,16,26624
Mvaa 232,228,104
v_cvt_pk_bf16_f32 v194, v120, v121
v_cvt_pk_bf16_f32 v195, v122, v123
Mvaa 236,228,108
s_waitcnt lgkmcnt(4)
TR 228,17,20480
TR 230,17,22528
Mvaa 240,232,104
v_mul_f32 v124, v8, v124
v_mul_f32 v125, v8, v125
Mvaa 244,232,108
s_waitcnt vmcnt(8)
TR 232,18,20480
TR 234,18,22528
Mvaa 248,236,104
s_barrier
Mvaa 252,236,108
s_waitcnt lgkmcnt(6)
TR 236,15,28672
TR 238,15,30720
Mvaa 224,240,112
v_mul_f32 v126, v8, v126
v_mul_f32 v127, v8, v127
Mvaa 228,240,116
TR 240,16,28672
TR 242,16,30720
v_mfma_f32_16x16x32_bf16 v[32:35], a[252:255], v[40:43], 0
v_cvt_pk_bf16_f32 v198, v124, v125
v_cvt_pk_bf16_f32 v199, v126, v127
v_mfma_f32_16x16x32_bf16 v[36:39], a[252:255], v[44:47], 0
s_waitcnt lgkmcnt(6)
TR 244,15,29184
TR 246,15,31232
Mvaa 232,224,112
s_add_u32 m0, s38, 125824
v_mul_f32 v128, v12, v128
v_mul_f32 v129, v12, v129
Mvaa 236,224,116
TR 224,16,29184
TR 226,16,31232
Mvaa 224,228,120
buffer_load_dwordx4 v6, s[16:19], s64 offen offset:1152 lds
Mvaa 228,228,124
s_waitcnt lgkmcnt(6)
TR 228,19,16384
TR 230,19,18432
Mvaa 232,232,120
s_add_u32 m0, s38, 129920
s_mov_b32 s39, 0x4b800000
v_min_f32 v33, v32, v36
v_mul_f32 v130, v12, v130
Mvaa 236,232,124
TR 232,20,16384
TR 234,20,18432
v_rcp_f32 v33, v33
s_nop 0
v_max3_f32 v33, v33, v32, v36
v_cmp_nge_f32 vcc, s39, v33
s_cbranch_vccnz Lr16
Lb16:
v_mfma_f32_16x16x32_bf16 v[80:83], a[236:239], v[40:43], 0
buffer_load_dwordx4 v6, s[16:19], s65 offen offset:1152 lds
v_mfma_f32_16x16x32_bf16 v[84:87], a[236:239], v[44:47], 0
s_waitcnt lgkmcnt(6)
TR 236,19,16896
TR 238,19,18944
v_mfma_f32_16x16x32_bf16 v[88:91], a[240:243], v[40:43], 0
s_add_u32 m0, s38, 105344
v_mul_f32 v131, v12, v131
v_cvt_pk_bf16_f32 v200, v128, v129
v_mfma_f32_16x16x32_bf16 v[92:95], a[240:243], v[44:47], 0
TR 240,20,16896
TR 242,20,18944
v_mfma_f32_16x16x32_bf16 v[96:99], a[244:247], v[40:43], 0
buffer_load_dwordx4 v6, s[16:19], s68 offen offset:1152 lds
v_mfma_f32_16x16x32_bf16 v[100:103], a[244:247], v[44:47], 0
s_waitcnt lgkmcnt(6)
TR 244,15,32768
TR 246,15,34816
v_mfma_f32_16x16x32_bf16 v[104:107], a[224:227], v[40:43], 0
s_add_u32 m0, s38, 12288
v_cvt_pk_bf16_f32 v201, v130, v131
v_mul_f32 v132, v8, v132
v_mfma_f32_16x16x32_bf16 v[108:111], a[224:227], v[44:47], 0
TR 224,16,32768
TR 226,16,34816
v_mfma_f32_16x16x32_bf16 v[112:115], a[228:231], v[40:43], 0
v_mul_f32 v133, v8, v133
v_mul_f32 v134, v8, v134
v_mfma_f32_16x16x32_bf16 v[116:119], a[228:231], v[44:47], 0
s_waitcnt lgkmcnt(6)
TR 228,15,33280
TR 230,15,35328
v_mfma_f32_16x16x32_bf16 v[120:123], a[232:235], v[40:43], 0
buffer_load_dwordx4 v5, s[12:15], s33 offen nt lds
v_mfma_f32_16x16x32_bf16 v[124:127], a[232:235], v[44:47], 0
s_add_u32 m0, s38, 16256
TR 232,16,33280
TR 234,16,35328
v_mfma_f32_16x16x32_bf16 v[128:131], a[236:239], v[40:43], 0
v_mul_f32 v135, v8, v135
v_cvt_pk_bf16_f32 v204, v132, v133
v_cvt_pk_bf16_f32 v205, v134, v135
v_mfma_f32_16x16x32_bf16 v[132:135], a[236:239], v[44:47], 0
s_waitcnt lgkmcnt(6)
TR 236,17,24576
TR 238,17,26624
v_mul_f32 v136, v12, v136
v_mul_f32 v137, v12, v137
v_pk_mul_f32 v[138:139], v[138:139], v[12:13] op_sel_hi:[1,0]
v_cvt_pk_bf16_f32 v202, v136, v137
v_cvt_pk_bf16_f32 v203, v138, v139
v_mfma_f32_16x16x32_bf16 v[136:139], a[240:243], v[40:43], 0
v_mul_f32 v140, v8, v140
v_mul_f32 v141, v8, v141
v_mul_f32 v142, v8, v142
v_mul_f32 v143, v8, v143
v_cvt_pk_bf16_f32 v206, v140, v141
v_cvt_pk_bf16_f32 v207, v142, v143
v_mfma_f32_16x16x32_bf16 v[140:143], a[240:243], v[44:47], 0
TR 240,18,24576
TR 242,18,26624
v_mul_f32 v144, v12, v144
v_mul_f32 v145, v12, v145
v_pk_mul_f32 v[146:147], v[146:147], v[12:13] op_sel_hi:[1,0]
v_cvt_pk_bf16_f32 v208, v144, v145
v_cvt_pk_bf16_f32 v209, v146, v147
v_mfma_f32_16x16x32_bf16 v[144:147], a[244:247], v[40:43], 0
buffer_load_dwordx4 v5, s[12:15], s33 offen offset:128 nt lds
v_mul_f32 v148, v8, v148
v_mul_f32 v149, v8, v149
v_mul_f32 v150, v8, v150
v_mul_f32 v151, v8, v151
v_cvt_pk_bf16_f32 v212, v148, v149
v_cvt_pk_bf16_f32 v213, v150, v151
v_mfma_f32_16x16x32_bf16 v[148:151], a[244:247], v[44:47], 0
s_waitcnt lgkmcnt(6)
TR 244,17,28672
TR 246,17,30720
v_mul_f32 v152, v12, v152
v_mul_f32 v153, v12, v153
v_pk_mul_f32 v[154:155], v[154:155], v[12:13] op_sel_hi:[1,0]
v_cvt_pk_bf16_f32 v210, v152, v153
v_cvt_pk_bf16_f32 v211, v154, v155
v_mfma_f32_16x16x32_bf16 v[152:155], a[224:227], v[40:43], 0
s_add_u32 m0, s38, 20224
v_mul_f32 v156, v8, v156
v_mul_f32 v157, v8, v157
v_mul_f32 v158, v8, v158
v_mul_f32 v159, v8, v159
v_cvt_pk_bf16_f32 v214, v156, v157
v_cvt_pk_bf16_f32 v215, v158, v159
v_mfma_f32_16x16x32_bf16 v[156:159], a[224:227], v[44:47], 0
TR 224,18,28672
TR 226,18,30720
v_mul_f32 v160, v12, v160
v_mul_f32 v161, v12, v161
v_pk_mul_f32 v[162:163], v[162:163], v[12:13] op_sel_hi:[1,0]
v_cvt_pk_bf16_f32 v216, v160, v161
v_cvt_pk_bf16_f32 v217, v162, v163
v_mfma_f32_16x16x32_bf16 v[160:163], a[228:231], v[40:43], 0
v_mul_f32 v164, v8, v164
v_mul_f32 v165, v8, v165
v_mul_f32 v166, v8, v166
v_mul_f32 v167, v8, v167
v_cvt_pk_bf16_f32 v220, v164, v165
v_cvt_pk_bf16_f32 v221, v166, v167
v_mfma_f32_16x16x32_bf16 v[164:167], a[228:231], v[44:47], 0
s_waitcnt lgkmcnt(6)
TR 228,17,32768
TR 230,17,34816
v_mul_f32 v168, v12, v168
v_mul_f32 v169, v12, v169
v_pk_mul_f32 v[170:171], v[170:171], v[12:13] op_sel_hi:[1,0]
v_cvt_pk_bf16_f32 v218, v168, v169
v_cvt_pk_bf16_f32 v219, v170, v171
v_mfma_f32_16x16x32_bf16 v[168:171], a[232:235], v[40:43], 0
buffer_load_dwordx4 v5, s[12:15], s33 offen offset:256 nt lds
v_mul_f32 v172, v8, v172
v_mul_f32 v173, v8, v173
v_mul_f32 v174, v8, v174
v_mul_f32 v175, v8, v175
v_cvt_pk_bf16_f32 v222, v172, v173
v_cvt_pk_bf16_f32 v223, v174, v175
v_mfma_f32_16x16x32_bf16 v[172:175], a[232:235], v[44:47], 0
s_add_u32 s33, s33, 6144
TR 232,18,32768
TR 234,18,34816
Mvaa 224,236,128
s_sub_u32 s45, s33, 98304
v_exp_f32 v24, v64
Mvaa 228,236,132
s_waitcnt lgkmcnt(6)
TR 236,17,36864
TR 238,17,38912
Mvaa 232,240,128
s_min_u32 s33, s33, s45
v_exp_f32 v25, v65
Mvaa 236,240,132
s_add_u32 m0, s38, 49152
TR 240,18,36864
TR 242,18,38912
Mvaa 224,244,136
buffer_load_dwordx4 v4, s[8:11], s32 offen nt lds
Mvaa 228,244,140
s_waitcnt lgkmcnt(6)
TR 244,15,25088
TR 246,15,27136
Mvaa 232,224,136
s_add_u32 m0, s38, 53120
v_exp_f32 v26, v66
Mvaa 236,224,140
TR 224,16,25088
TR 226,16,27136
Mvaa 224,228,144
v_cvt_pk_bf16_f32 v28, v24, v25
Mvaa 228,228,148
s_waitcnt lgkmcnt(6)
TR 228,17,20992
TR 230,17,23040
Mvaa 232,232,144
buffer_load_dwordx4 v4, s[8:11], s32 offen offset:128 nt lds
Mvaa 236,232,148
TR 232,18,20992
TR 234,18,23040
Mvaa 224,236,152
s_barrier
Mvaa 228,236,156
s_waitcnt lgkmcnt(6)
ds_read_b128 a[236:239], v9 offset:36864
s_add_u32 m0, s38, 114432
Mvaa 232,240,152
v_exp_f32 v27, v67
Mvaa 236,240,156
ds_read_b128 a[240:243], v9 offset:37376
v_cvt_pk_bf16_f32 v29, v26, v27
Mvaa 240,244,112
buffer_load_dwordx4 v4, s[8:11], s32 offen offset:256 nt lds
Mvaa 244,244,116
s_waitcnt lgkmcnt(4)
ds_read_b128 a[244:247], v9 offset:40960
v_mul_f32 v224, s40, v224
Mvaa 248,224,112
s_add_u32 s32, s32, 6144
v_exp_f32 v24, v72
Mvaa 252,224,116
s_sub_u32 s45, s32, 98304
ds_read_b128 a[224:227], v9 offset:41472
v_mul_f32 v225, s40, v225
Mvaa 240,228,120
s_min_u32 s32, s32, s45
v_exp_f32 v25, v73
Mvaa 244,228,124
s_waitcnt lgkmcnt(3)
ds_read_b128 a[228:231], v9 offset:45056
v_cvt_pk_bf16_f32 v0, v24, v25
Mvaa 248,232,120
s_add_u32 m0, s38, 27520
v_exp_f32 v26, v74
Mvaa 252,232,124
ds_read_b128 a[232:235], v9 offset:45568
v_mul_f32 v226, s40, v226
v_mfma_f32_16x16x32_bf16 v[48:51], a[236:239], a[160:163], 0
buffer_load_dwordx4 v6, s[16:19], s69 offen offset:1152 lds
v_mfma_f32_16x16x32_bf16 v[56:59], a[236:239], a[164:167], 0
s_waitcnt lgkmcnt(3)
ds_read_b128 a[236:239], v9 offset:38912
v_mul_f32 v227, s40, v227
Mvaa 48,240,168
v_exp_f32 v27, v75
Mvaa 56,240,172
ds_read_b128 a[240:243], v9 offset:39424
v_cvt_pk_bf16_f32 v1, v26, v27
Mvaa 48,244,176
v_exp_f32 v24, v68
Mvaa 56,244,180
s_waitcnt lgkmcnt(3)
ds_read_b128 a[244:247], v9 offset:43008
v_mul_f32 v232, s40, v232
Mvaa 48,224,184
v_exp_f32 v25, v69
Mvaa 56,224,188
ds_read_b128 a[224:227], v9 offset:43520
v_cvt_pk_bf16_f32 v30, v24, v25
Mvaa 48,228,192
v_exp_f32 v26, v70
Mvaa 56,228,196
s_waitcnt lgkmcnt(3)
ds_read_b128 a[228:231], v9 offset:47104
v_mul_f32 v233, s40, v233
Mvaa 48,232,200
v_exp_f32 v27, v71
Mvaa 56,232,204
ds_read_b128 a[232:235], v9 offset:47616
v_cvt_pk_bf16_f32 v31, v26, v27
v_mfma_f32_16x16x32_bf16 v[52:55], a[236:239], a[160:163], 0
v_exp_f32 v24, v76
v_mfma_f32_16x16x32_bf16 v[60:63], a[236:239], a[164:167], 0
s_waitcnt lgkmcnt(3)
TR 236,17,25088
TR 238,17,27136
Mvaa 52,240,168
v_exp_f32 v25, v77
Mvaa 60,240,172
TR 240,18,25088
TR 242,18,27136
Mvaa 52,244,176
v_exp_f32 v26, v78
Mvaa 60,244,180
s_waitcnt lgkmcnt(5)
TR 244,17,29184
TR 246,17,31232
Mvaa 52,224,184
v_cvt_pk_bf16_f32 v2, v24, v25
v_mul_f32 v234, s40, v234
Mvaa 60,224,188
TR 224,18,29184
TR 226,18,31232
Mvaa 52,228,192
v_exp_f32 v27, v79
Mvaa 60,228,196
s_waitcnt lgkmcnt(6)
TR 228,17,33280
TR 230,17,35328
Mvaa 52,232,200
v_cvt_pk_bf16_f32 v3, v26, v27
v_mul_f32 v235, s40, v235
Mvaa 60,232,204
v_cvt_pk_bf16_f32 v224, v224, v225
v_cvt_pk_bf16_f32 v225, v226, v227
Mvaa 240,236,128
v_cvt_pk_bf16_f32 v226, v232, v233
v_cvt_pk_bf16_f32 v227, v234, v235
Mvaa 244,236,132
s_waitcnt lgkmcnt(4)
TR 236,18,33280
TR 238,18,35328
Mvaa 248,240,128
s_add_u32 m0, s38, 31616
v_permlane16_swap_b32 v224, v226
v_permlane16_swap_b32 v225, v227
Mvaa 252,240,132
TR 240,17,37376
TR 242,17,39424
Mvaa 240,244,136
buffer_load_dwordx4 v6, s[16:19], s70 offen offset:1152 lds
Mvaa 244,244,140
Tc12:
s_cbranch_execz Tr12
s_cmpk_eq_u32 s88, 15
s_cselect_b64 exec, 0, -1
s_cbranch_execz Tc15
Tr15:
s_mov_b64 exec, -1
s_waitcnt vmcnt(9) lgkmcnt(4)
TR 244,18,37376
TR 246,18,39424
Mvaa 248,224,136
s_barrier
Mvaa 252,224,140
s_add_u32 m0, s38, 23424
TR 224,17,40960
TR 226,17,43008
Mvaa 240,228,144
buffer_load_dwordx4 v6, s[16:19], s71 offen offset:1152 lds
Mvaa 244,228,148
s_waitcnt lgkmcnt(6)
TR 228,18,40960
TR 230,18,43008
Mvav 32,252,28
ds_write_b128 v13, v[224:227] offset:49152
v_mul_f32 v228, s40, v228
Mvav 36,252,0
TR 232,17,41472
TR 234,17,43520
Mvaa 248,236,144
v_mul_f32 v229, s40, v229
v_mul_f32 v230, s40, v230
Mvaa 252,236,148
s_waitcnt lgkmcnt(7)
TR 236,18,41472
TR 238,18,43520
Mvaa 240,240,152
v_max_f32 v33, v32, v36
v_cmp_nge_f32 vcc, s39, v33
Mvaa 244,240,156
TR 240,19,20480
TR 242,19,22528
Mvaa 248,244,152
v_mul_f32 v231, s40, v231
v_mul_f32 v236, s40, v236
Mvaa 252,244,156
s_waitcnt lgkmcnt(7)
TR 244,20,20480
TR 246,20,22528
s_cbranch_vccnz Lr17
Lb17:
Mvav 80,224,28
v_mul_f32 v237, s40, v237
v_mul_f32 v238, s40, v238
Mvav 84,224,0
TR 224,19,20992
TR 226,19,23040
Mvav 88,228,28
v_mul_f32 v239, s40, v239
v_cvt_pk_bf16_f32 v228, v228, v229
Mvav 92,228,0
s_waitcnt lgkmcnt(6)
TR 228,20,20992
TR 230,20,23040
Mvav 96,232,28
s_add_u32 m0, s38, 35712
v_cvt_pk_bf16_f32 v229, v230, v231
v_cvt_pk_bf16_f32 v230, v236, v237
Mvav 100,232,0
TR 232,19,24576
TR 234,19,26624
Mvav 104,236,28
buffer_load_dwordx4 v6, s[16:19], s72 offen offset:1152 lds
Mvav 108,236,0
s_waitcnt lgkmcnt(6)
TR 236,20,24576
TR 238,20,26624
Mvav 112,240,28
s_add_u32 m0, s38, 40960
v_cvt_pk_bf16_f32 v231, v238, v239
v_permlane16_swap_b32 v228, v230
Mvav 116,240,0
TR 240,19,25088
TR 242,19,27136
Mvav 120,244,28
v_permlane16_swap_b32 v229, v231
ds_write_b128 v13, v[228:231] offset:45056
Mvav 124,244,0
s_waitcnt lgkmcnt(7)
TR 244,20,25088
TR 246,20,27136
Mvav 128,224,28
buffer_load_dwordx4 v5, s[12:15], s33 offen nt lds
Mvav 132,224,0
s_add_u32 m0, s38, 44928
TR 224,19,28672
TR 226,19,30720
Mvav 136,228,28
v_mul_f32 v240, s40, v240
v_mul_f32 v241, s40, v241
Mvav 140,228,0
s_waitcnt lgkmcnt(7)
TR 228,20,28672
TR 230,20,30720
Mvav 144,232,28
v_mul_f32 v242, s40, v242
v_mul_f32 v243, s40, v243
Mvav 148,232,0
TR 232,19,32768
TR 234,19,34816
Mvav 152,236,28
buffer_load_dwordx4 v5, s[12:15], s33 offen offset:128 nt lds
Mvav 156,236,0
s_waitcnt lgkmcnt(6)
TR 236,20,32768
TR 238,20,34816
Mvav 160,240,28
s_add_u32 m0, s38, 57088
v_mul_f32 v248, s40, v248
v_mul_f32 v249, s40, v249
Mvav 164,240,0
TR 240,15,4096
TR 242,15,6144
Mvav 168,244,28
v_mul_f32 v250, s40, v250
v_mul_f32 v251, s40, v251
Mvav 172,244,0
s_waitcnt lgkmcnt(6)
TR 244,16,4096
TR 246,16,6144
v_mfma_f32_16x16x32_bf16 v[224:227], a[224:227], a[0:3], 0
buffer_load_dwordx4 v5, s[12:15], s33 offen offset:256 nt lds
v_mfma_f32_16x16x32_bf16 v[228:231], a[224:227], a[4:7], 0
s_add_u32 s33, s33, 6144
TR 224,15,8192
TR 226,15,10240
v_mfma_f32_16x16x32_bf16 v[232:235], a[228:231], a[0:3], 0
s_sub_u32 s45, s33, 98304
v_cvt_pk_bf16_f32 v240, v240, v241
v_cvt_pk_bf16_f32 v241, v242, v243
v_mfma_f32_16x16x32_bf16 v[236:239], a[228:231], a[4:7], 0
s_waitcnt vmcnt(6) lgkmcnt(6)
TR 228,16,8192
TR 230,16,10240
Mvaa 224,232,8
s_barrier
Mvaa 228,232,12
s_min_u32 s33, s33, s45
ds_read_b128 a[232:235], v11 offset:12288
v_cvt_pk_bf16_f32 v242, v248, v249
Mvaa 232,236,8
s_add_u32 m0, s38, 118784
v_cvt_pk_bf16_f32 v243, v250, v251
v_permlane16_swap_b32 v240, v242
Mvaa 236,236,12
s_waitcnt lgkmcnt(5)
ds_read_b128 a[236:239], v11 offset:12800
v_permlane16_swap_b32 v241, v243
Mvaa 224,240,16
buffer_load_dwordx4 v4, s[8:11], s32 offen nt lds
Mvaa 228,240,20
s_add_u32 m0, s38, 122752
ds_read_b128 a[240:243], v11 offset:4096
ds_write_b128 v13, v[240:243] offset:40960
Mvaa 232,244,16
v_mul_f32 v244, s40, v244
v_mul_f32 v245, s40, v245
Mvaa 236,244,20
s_waitcnt lgkmcnt(4)
ds_read_b128 a[244:247], v11 offset:4608
v_mul_f32 v246, s40, v246
Mvaa 224,224,24
v_mul_f32 v247, s40, v247
v_mul_f32 v252, s40, v252
Mvaa 228,224,28
ds_read_b128 a[224:227], v9 offset:0
v_mul_f32 v253, s40, v253
Mvaa 232,228,24
buffer_load_dwordx4 v4, s[8:11], s32 offen offset:128 nt lds
Mvaa 236,228,28
s_waitcnt lgkmcnt(4)
ds_read_b128 a[228:231], v9 offset:512
v_mul_f32 v254, s40, v254
v_mfma_f32_16x16x32_bf16 v[64:67], a[232:235], a[160:163], 0
s_add_u32 m0, s38, 61184
v_mul_f32 v255, s40, v255
v_cvt_pk_bf16_f32 v244, v244, v245
v_mfma_f32_16x16x32_bf16 v[72:75], a[232:235], a[164:167], 0
ds_read_b128 a[232:235], v11 offset:14336
v_cvt_pk_bf16_f32 v245, v246, v247
Mvaa 64,236,168
v_cvt_pk_bf16_f32 v246, v252, v253
v_cvt_pk_bf16_f32 v247, v254, v255
Mvaa 72,236,172
s_waitcnt lgkmcnt(3)
ds_read_b128 a[236:239], v11 offset:14848
v_permlane16_swap_b32 v244, v246
Mvaa 64,240,176
buffer_load_dwordx4 v4, s[8:11], s32 offen offset:256 nt lds
Mvaa 72,240,180
s_add_u32 s32, s32, 6144
ds_read_b128 a[240:243], v11 offset:6144
v_permlane16_swap_b32 v245, v247
Mvaa 64,244,184
s_sub_u32 s45, s32, 98304
ds_write_b128 v13, v[244:247] offset:36864
s_min_u32 s32, s32, s45
Mvaa 72,244,188
s_waitcnt lgkmcnt(4)
ds_read_b128 a[244:247], v11 offset:6656
s_add_u32 m0, s38, 64384
Mvaa 64,224,192
buffer_load_dwordx4 v6, s[16:19], s73 offen offset:1152 lds
Mvaa 72,224,196
ds_read_b128 a[224:227], v9 offset:2048
Mvaa 64,228,200
v_exp_f32 v24, v48
Mvaa 72,228,204
s_waitcnt lgkmcnt(4)
ds_read_b128 a[228:231], v9 offset:2560
v_mfma_f32_16x16x32_bf16 v[68:71], a[232:235], a[160:163], 0
v_exp_f32 v25, v49
v_mfma_f32_16x16x32_bf16 v[76:79], a[232:235], a[164:167], 0
TR 232,19,8192
TR 234,19,10240
Mvaa 68,236,168
v_exp_f32 v26, v50
Mvaa 76,236,172
s_waitcnt lgkmcnt(4)
TR 236,20,8192
TR 238,20,10240
Mvaa 68,240,176
v_cvt_pk_bf16_f32 v40, v24, v25
Mvaa 76,240,180
TR 240,15,28672
TR 242,15,30720
Mvaa 68,244,184
v_exp_f32 v27, v51
Mvaa 76,244,188
s_waitcnt lgkmcnt(6)
TR 244,16,28672
TR 246,16,30720
Mvaa 68,224,192
v_exp_f32 v24, v56
Mvaa 76,224,196
TR 224,19,29184
TR 226,19,31232
Mvaa 68,228,200
v_cvt_pk_bf16_f32 v41, v26, v27
Mvaa 76,228,204
s_waitcnt lgkmcnt(6)
TR 228,20,29184
TR 230,20,31232
Mvaa 224,232,32
v_exp_f32 v25, v57
Mvaa 228,232,36
TR 232,19,33280
TR 234,19,35328
Mvaa 232,236,32
v_exp_f32 v26, v58
Mvaa 236,236,36
s_waitcnt lgkmcnt(6)
TR 236,20,33280
TR 238,20,35328
Mvaa 224,240,40
v_cvt_pk_bf16_f32 v44, v24, v25
Mvaa 228,240,44
TR 240,15,4608
TR 242,15,6656
Mvaa 232,244,40
v_exp_f32 v27, v59
Mvaa 236,244,44
s_waitcnt lgkmcnt(6)
v_exp_f32 v24, v52
v_mfma_f32_16x16x32_bf16 v[240:243], a[224:227], a[0:3], 0
v_cvt_pk_bf16_f32 v45, v26, v27
v_mfma_f32_16x16x32_bf16 v[244:247], a[224:227], a[4:7], 0
TR 224,16,4608
TR 226,16,6656
v_mfma_f32_16x16x32_bf16 v[248:251], a[228:231], a[0:3], 0
v_exp_f32 v25, v53
v_mfma_f32_16x16x32_bf16 v[252:255], a[228:231], a[4:7], 0
s_waitcnt lgkmcnt(4)
TR 228,15,8704
TR 230,15,10752
Mvaa 240,232,8
s_add_u32 m0, s38, 68480
v_exp_f32 v26, v54
Mvaa 244,232,12
s_waitcnt vmcnt(8)
TR 232,16,8704
TR 234,16,10752
Mvaa 248,236,8
s_barrier
Mvaa 252,236,12
s_waitcnt lgkmcnt(6)
TR 236,15,12288
TR 238,15,14336
Mvaa 240,240,16
buffer_load_dwordx4 v6, s[16:19], s74 offen offset:1152 lds
Mvaa 244,240,20
s_add_u32 m0, s38, 125824
TR 240,16,12288
TR 242,16,14336
v_cvt_pk_bf16_f32 v42, v24, v25
v_exp_f32 v27, v55
s_nop 0
v_cvt_pk_bf16_f32 v43, v26, v27
s_nop 1
Mvav 32,252,40
v_exp_f32 v24, v60
v_exp_f32 v25, v61
v_exp_f32 v26, v62
v_cvt_pk_bf16_f32 v46, v24, v25
v_exp_f32 v27, v63
s_nop 0
v_cvt_pk_bf16_f32 v47, v26, v27
s_nop 1
Mvav 36,252,44
s_waitcnt lgkmcnt(6)
TR 244,15,12800
TR 246,15,14848
Mvaa 248,224,16
buffer_load_dwordx4 v6, s[16:19], s75 offen offset:1152 lds
Mvaa 252,224,20
TR 224,16,12800
TR 226,16,14848
Mvaa 240,228,24
s_add_u32 m0, s38, 129920
v_max_f32 v33, v32, v36
v_cmp_nge_f32 vcc, s39, v33
Mvaa 244,228,28
s_waitcnt lgkmcnt(6)
TR 228,15,16384
TR 230,15,18432
Mvaa 248,232,24
buffer_load_dwordx4 v6, s[16:19], s76 offen offset:1152 lds
Mvaa 252,232,28
s_add_u32 m0, s38, 109440
TR 232,16,16384
TR 234,16,18432
s_cbranch_vccnz Lr18
Lb18:
Mvav 80,236,40
v_exp_f32 v24, v64
Mvav 84,236,44
s_waitcnt lgkmcnt(6)
TR 236,15,16896
TR 238,15,18944
Mvav 88,240,40
buffer_load_dwordx4 v6, s[16:19], s77 offen offset:1152 lds
Mvav 92,240,44
s_add_u32 m0, s38, 101248
TR 240,16,16896
TR 242,16,18944
Mvav 96,244,40
v_exp_f32 v25, v65
Mvav 100,244,44
s_waitcnt lgkmcnt(6)
TR 244,15,20480
TR 246,15,22528
Mvav 104,224,40
buffer_load_dwordx4 v6, s[16:19], s78 offen offset:1152 lds
Mvav 108,224,44
s_add_u32 s43, s79, 1152
TR 224,16,20480
TR 226,16,22528
Mvav 112,228,40
s_add_u32 m0, s38, 0
v_exp_f32 v26, v66
Mvav 116,228,44
s_waitcnt lgkmcnt(6)
TR 228,15,20992
TR 230,15,23040
Mvav 120,232,40
buffer_load_dwordx4 v6, s[16:19], s43 offen lds
Mvav 124,232,44
s_add_u32 m0, s38, 73728
TR 232,16,20992
TR 234,16,23040
Mvav 128,236,40
v_cvt_pk_bf16_f32 v28, v24, v25
Mvav 132,236,44
s_waitcnt lgkmcnt(6)
TR 236,19,8704
TR 238,19,10752
Mvav 136,240,40
v_exp_f32 v27, v67
Mvav 140,240,44
TR 240,20,8704
TR 242,20,10752
Mvav 144,244,40
buffer_load_dwordx4 v5, s[12:15], s33 offen nt lds
Mvav 148,244,44
s_waitcnt lgkmcnt(6)
TR 244,15,29184
TR 246,15,31232
Mvav 152,224,40
s_add_u32 m0, s38, 77696
v_exp_f32 v24, v72
Mvav 156,224,44
TR 224,16,29184
TR 226,16,31232
Mvav 160,228,40
v_cvt_pk_bf16_f32 v29, v26, v27
Mvav 164,228,44
s_waitcnt lgkmcnt(6)
TR 228,15,32768
TR 230,15,34816
Mvav 168,232,40
buffer_load_dwordx4 v5, s[12:15], s33 offen offset:128 nt lds
Mvav 172,232,44
s_add_u32 m0, s38, 81664
TR 232,16,32768
TR 234,16,34816
Mvaa 240,236,32
v_exp_f32 v25, v73
Mvaa 244,236,36
s_waitcnt lgkmcnt(6)
TR 236,15,33280
TR 238,15,35328
Mvaa 248,240,32
v_exp_f32 v26, v74
Mvaa 252,240,36
TR 240,16,33280
TR 242,16,35328
Mvaa 240,244,40
buffer_load_dwordx4 v5, s[12:15], s33 offen offset:256 nt lds
Mvaa 244,244,44
s_waitcnt lgkmcnt(6)
TR 244,15,24576
TR 246,15,26624
Mvaa 248,224,40
s_add_u32 s33, s33, 6144
v_cvt_pk_bf16_f32 v0, v24, v25
s_sub_u32 s45, s33, 98304
Mvaa 252,224,44
s_min_u32 s33, s33, s45
TR 224,16,24576
TR 226,16,26624
Mvaa 224,228,48
s_add_u32 m0, s38, 86016
v_exp_f32 v27, v75
Mvaa 228,228,52
s_waitcnt lgkmcnt(6)
TR 228,15,25088
TR 230,15,27136
Mvaa 232,232,48
buffer_load_dwordx4 v4, s[8:11], s32 offen nt lds
Mvaa 236,232,52
s_waitcnt vmcnt(10)
TR 232,16,25088
TR 234,16,27136
Mvaa 240,236,48
s_barrier
Mvaa 244,236,52
s_waitcnt lgkmcnt(6)
ds_read_b128 a[236:239], v10 offset:0
v_cvt_pk_bf16_f32 v1, v26, v27
Mvaa 248,240,48
s_add_u32 m0, s38, 106368
v_exp_f32 v24, v68
Mvaa 252,240,52
ds_read_b128 a[240:243], v10 offset:512
Mvaa 224,244,56
buffer_load_dwordx4 v4, s[8:11], s32 offen offset:128 nt lds
Mvaa 228,244,60
s_waitcnt lgkmcnt(4)
ds_read_b128 a[244:247], v10 offset:4096
s_add_u32 m0, s38, 3840
Mvaa 232,224,56
v_exp_f32 v25, v69
Mvaa 236,224,60
ds_read_b128 a[224:227], v10 offset:4608
v_cvt_pk_bf16_f32 v30, v24, v25
Mvaa 240,228,56
v_exp_f32 v26, v70
Mvaa 244,228,60
s_waitcnt lgkmcnt(3)
ds_read_b128 a[228:231], v11 offset:16384
Mvaa 248,232,56
buffer_load_dwordx4 v4, s[8:11], s32 offen offset:256 nt lds
Mvaa 252,232,60
s_add_u32 s32, s32, 6144
ds_read_b128 a[232:235], v11 offset:16896
s_sub_u32 s45, s32, 98304
v_mfma_f32_16x16x32_bf16 v[48:51], a[236:239], a[160:163], 0
s_min_u32 s32, s32, s45
v_exp_f32 v27, v71
v_mfma_f32_16x16x32_bf16 v[56:59], a[236:239], a[164:167], 0
s_waitcnt lgkmcnt(3)
ds_read_b128 a[236:239], v10 offset:2048
v_cvt_pk_bf16_f32 v31, v26, v27
Mvaa 48,240,168
s_add_u32 m0, s38, 7040
v_exp_f32 v24, v76
Mvaa 56,240,172
ds_read_b128 a[240:243], v10 offset:2560
Mvaa 48,244,176
buffer_load_dwordx4 v6, s[16:19], s80 offen offset:1152 lds
Mvaa 56,244,180
s_waitcnt lgkmcnt(3)
ds_read_b128 a[244:247], v10 offset:6144
Mvaa 48,224,184
v_exp_f32 v25, v77
Mvaa 56,224,188
ds_read_b128 a[224:227], v10 offset:6656
v_cvt_pk_bf16_f32 v2, v24, v25
Mvaa 48,228,192
v_exp_f32 v26, v78
Mvaa 56,228,196
s_waitcnt lgkmcnt(3)
ds_read_b128 a[228:231], v11 offset:18432
Mvaa 48,232,200
v_exp_f32 v27, v79
Mvaa 56,232,204
ds_read_b128 a[232:235], v11 offset:18944
v_cvt_pk_bf16_f32 v3, v26, v27
v_mfma_f32_16x16x32_bf16 v[52:55], a[236:239], a[160:163], 0
v_exp_f32 v24, v48
v_mfma_f32_16x16x32_bf16 v[60:63], a[236:239], a[164:167], 0
s_waitcnt lgkmcnt(3)
TR 236,15,36864
TR 238,15,38912
Mvaa 52,240,168
v_exp_f32 v25, v49
Mvaa 60,240,172
TR 240,16,36864
TR 242,16,38912
Mvaa 52,244,176
v_exp_f32 v26, v50
Mvaa 60,244,180
s_waitcnt lgkmcnt(5)
TR 244,15,37376
TR 246,15,39424
Mvaa 52,224,184
v_cvt_pk_bf16_f32 v40, v24, v25
Mvaa 60,224,188
TR 224,16,37376
TR 226,16,39424
Mvaa 52,228,192
v_exp_f32 v27, v51
Mvaa 60,228,196
s_waitcnt lgkmcnt(6)
TR 228,17,16384
TR 230,17,18432
Mvaa 52,232,200
v_exp_f32 v24, v56
Mvaa 60,232,204
v_cvt_pk_bf16_f32 v41, v26, v27
Mvaa 224,236,64
v_exp_f32 v25, v57
Mvaa 228,236,68
s_waitcnt lgkmcnt(4)
TR 236,18,16384
TR 238,18,18432
Mvaa 232,240,64
v_exp_f32 v26, v58
Mvaa 236,240,68
TR 240,17,16896
TR 242,17,18944
Mvaa 240,244,64
v_cvt_pk_bf16_f32 v44, v24, v25
Mvaa 244,244,68
s_waitcnt vmcnt(11) lgkmcnt(4)
TR 244,18,16896
TR 246,18,18944
Mvaa 248,224,64
s_barrier
Mvaa 252,224,68
s_add_u32 m0, s38, 113536
TR 224,15,40960
TR 226,15,43008
Mvaa 224,228,72
buffer_load_dwordx4 v6, s[16:19], s81 offen offset:1152 lds
Mvaa 228,228,76
s_waitcnt lgkmcnt(6)
TR 228,16,40960
TR 230,16,43008
Mvav 32,252,28
s_add_u32 m0, s38, 11136
v_exp_f32 v27, v59
Mvav 36,252,0
TR 232,15,41472
TR 234,15,43520
Mvaa 232,236,72
buffer_load_dwordx4 v6, s[16:19], s82 offen offset:1152 lds
Mvaa 236,236,76
s_waitcnt lgkmcnt(6)
Tc13:
s_cbranch_execz Tr13
s_cmpk_eq_u32 s88, 16
s_cselect_b64 exec, 0, -1
s_cbranch_execz Tc16
Tr16:
s_mov_b64 exec, -1
TR 236,16,41472
TR 238,16,43520
Mvaa 240,240,72
s_add_u32 m0, s38, 15232
v_max_f32 v33, v32, v36
v_cmp_nge_f32 vcc, s39, v33
Mvaa 244,240,76
TR 240,15,45056
TR 242,15,47104
Mvaa 248,244,72
buffer_load_dwordx4 v6, s[16:19], s83 offen offset:1152 lds
Mvaa 252,244,76
s_waitcnt lgkmcnt(6)
TR 244,16,45056
TR 246,16,47104
s_cbranch_vccnz Lr19
Lb19:
Mvav 80,224,28
v_exp_f32 v24, v52
Mvav 84,224,0
TR 224,15,45568
TR 226,15,47616
Mvav 88,228,28
v_cvt_pk_bf16_f32 v45, v26, v27
Mvav 92,228,0
s_waitcnt lgkmcnt(6)
TR 228,16,45568
TR 230,16,47616
Mvav 96,232,28
v_exp_f32 v25, v53
Mvav 100,232,0
TR 232,17,8192
TR 234,17,10240
Mvav 104,236,28
v_exp_f32 v26, v54
Mvav 108,236,0
s_waitcnt lgkmcnt(6)
TR 236,18,8192
TR 238,18,10240
Mvav 112,240,28
v_cvt_pk_bf16_f32 v42, v24, v25
Mvav 116,240,0
TR 240,17,8704
TR 242,17,10752
Mvav 120,244,28
v_exp_f32 v27, v55
Mvav 124,244,0
s_waitcnt lgkmcnt(6)
TR 244,18,8704
TR 246,18,10752
Mvav 128,224,28
v_cvt_pk_bf16_f32 v43, v26, v27
Mvav 132,224,0
TR 224,17,20480
TR 226,17,22528
Mvav 136,228,28
v_exp_f32 v24, v60
Mvav 140,228,0
s_waitcnt lgkmcnt(6)
TR 228,18,20480
TR 230,18,22528
Mvav 144,232,28
v_exp_f32 v25, v61
Mvav 148,232,0
TR 232,17,20992
TR 234,17,23040
Mvav 152,236,28
v_exp_f32 v26, v62
Mvav 156,236,0
s_waitcnt lgkmcnt(6)
TR 236,18,20992
TR 238,18,23040
Mvav 160,240,28
s_add_u32 m0, s38, 20480
v_cvt_pk_bf16_f32 v46, v24, v25
Mvav 164,240,0
TR 240,19,28672
TR 242,19,30720
Mvav 168,244,28
buffer_load_dwordx4 v5, s[12:15], s33 offen nt lds
Mvav 172,244,0
s_waitcnt lgkmcnt(6)
TR 244,20,28672
TR 246,20,30720
Mvaa 224,224,80
s_add_u32 m0, s38, 24448
v_exp_f32 v27, v63
Mvaa 228,224,84
TR 224,19,29184
TR 226,19,31232
Mvaa 232,228,80
v_cvt_pk_bf16_f32 v47, v26, v27
Mvaa 236,228,84
s_waitcnt vmcnt(11) lgkmcnt(6)
TR 228,20,29184
TR 230,20,31232
Mvaa 240,232,80
s_barrier
Mvaa 244,232,84
ds_read_b128 a[232:235], v11 offset:20480
Mvaa 248,236,80
buffer_load_dwordx4 v5, s[12:15], s33 offen offset:128 nt lds
Mvaa 252,236,84
s_waitcnt lgkmcnt(5)
ds_read_b128 a[236:239], v11 offset:20992
s_add_u32 m0, s38, 28416
Mvaa 224,240,88
Mvaa 228,240,92
ds_read_b128 a[240:243], v11 offset:24576
Mvaa 232,244,88
Mvaa 236,244,92
s_waitcnt lgkmcnt(3)
ds_read_b128 a[244:247], v11 offset:25088
Mvaa 240,224,88
buffer_load_dwordx4 v5, s[12:15], s33 offen offset:256 nt lds
Mvaa 244,224,92
s_add_u32 s33, s33, 6144
ds_read_b128 a[224:227], v10 offset:12288
s_sub_u32 s45, s33, 98304
Mvaa 248,228,88
s_min_u32 s33, s33, s45
s_add_u32 m0, s38, 32768
Mvaa 252,228,92
s_waitcnt lgkmcnt(3)
ds_read_b128 a[228:231], v10 offset:12800
v_mfma_f32_16x16x32_bf16 v[64:67], a[232:235], a[160:163], 0
v_mfma_f32_16x16x32_bf16 v[72:75], a[232:235], a[164:167], 0
ds_read_b128 a[232:235], v11 offset:22528
Mvaa 64,236,168
buffer_load_dwordx4 v4, s[8:11], s32 offen nt lds
Mvaa 72,236,172
s_waitcnt lgkmcnt(3)
ds_read_b128 a[236:239], v11 offset:23040
s_add_u32 m0, s38, 36736
Mvaa 64,240,176
Mvaa 72,240,180
ds_read_b128 a[240:243], v11 offset:26624
Mvaa 64,244,184
Mvaa 72,244,188
s_waitcnt lgkmcnt(3)
ds_read_b128 a[244:247], v11 offset:27136
Mvaa 64,224,192
buffer_load_dwordx4 v4, s[8:11], s32 offen offset:128 nt lds
Mvaa 72,224,196
s_add_u32 m0, s38, 40704
ds_read_b128 a[224:227], v10 offset:14336
Mvaa 64,228,200
Mvaa 72,228,204
s_waitcnt lgkmcnt(3)
ds_read_b128 a[228:231], v10 offset:14848
v_mfma_f32_16x16x32_bf16 v[68:71], a[232:235], a[160:163], 0
v_exp_f32 v24, v64
v_mfma_f32_16x16x32_bf16 v[76:79], a[232:235], a[164:167], 0
TR 232,19,32768
TR 234,19,34816
Mvaa 68,236,168
buffer_load_dwordx4 v4, s[8:11], s32 offen offset:256 nt lds
Mvaa 76,236,172
s_waitcnt lgkmcnt(4)
TR 236,20,32768
TR 238,20,34816
Mvaa 68,240,176
s_add_u32 s32, s32, 6144
v_exp_f32 v25, v65
Mvaa 76,240,180
s_sub_u32 s45, s32, 98304
TR 240,19,33280
TR 242,19,35328
Mvaa 68,244,184
s_min_u32 s32, s32, s45
v_exp_f32 v26, v66
Mvaa 76,244,188
s_waitcnt lgkmcnt(6)
TR 244,20,33280
TR 246,20,35328
Mvaa 68,224,192
s_add_u32 m0, s38, 43776
v_cvt_pk_bf16_f32 v28, v24, v25
Mvaa 76,224,196
TR 224,19,12288
TR 226,19,14336
Mvaa 68,228,200
buffer_load_dwordx4 v6, s[16:19], s66 offen offset:1280 lds
Mvaa 76,228,204
s_waitcnt lgkmcnt(6)
TR 228,20,12288
TR 230,20,14336
Mvaa 224,232,96
v_exp_f32 v27, v67
Mvaa 228,232,100
TR 232,19,12800
TR 234,19,14848
Mvaa 232,236,96
v_exp_f32 v24, v72
Mvaa 236,236,100
s_waitcnt lgkmcnt(6)
TR 236,20,12800
TR 238,20,14848
Mvaa 240,240,96
v_cvt_pk_bf16_f32 v29, v26, v27
Mvaa 244,240,100
TR 240,19,4096
TR 242,19,6144
Mvaa 248,244,96
v_exp_f32 v25, v73
Mvaa 252,244,100
s_waitcnt lgkmcnt(6)
v_exp_f32 v26, v74
Mvaa 224,224,104
v_cvt_pk_bf16_f32 v0, v24, v25
Mvaa 228,224,108
TR 224,20,4096
TR 226,20,6144
Mvaa 232,228,104
v_exp_f32 v27, v75
Mvaa 236,228,108
s_waitcnt lgkmcnt(4)
TR 228,15,0
TR 230,15,2048
Mvaa 240,232,104
v_exp_f32 v24, v68
Mvaa 244,232,108
s_waitcnt vmcnt(7)
TR 232,16,0
TR 234,16,2048
Mvaa 248,236,104
s_barrier
Mvaa 252,236,108
s_waitcnt lgkmcnt(6)
TR 236,17,24576
TR 238,17,26624
Mvaa 224,240,112
v_cvt_pk_bf16_f32 v1, v26, v27
Mvaa 228,240,116
TR 240,18,24576
TR 242,18,26624
Mvav 32,252,40
v_exp_f32 v25, v69
Mvav 36,252,44
s_waitcnt lgkmcnt(6)
TR 244,17,25088
TR 246,17,27136
Mvaa 232,224,112
s_add_u32 m0, s38, 109312
v_exp_f32 v26, v70
Mvaa 236,224,116
TR 224,18,25088
TR 226,18,27136
Mvaa 224,228,120
buffer_load_dwordx4 v6, s[16:19], s64 offen offset:1280 lds
Mvaa 228,228,124
s_waitcnt lgkmcnt(6)
TR 228,17,28672
TR 230,17,30720
Mvaa 232,232,120
s_add_u32 m0, s38, 47872
v_max_f32 v33, v32, v36
v_cmp_nge_f32 vcc, s39, v33
Mvaa 236,232,124
TR 232,18,28672
TR 234,18,30720
s_cbranch_vccnz Lr20
Lb20:
Mvav 80,236,40
buffer_load_dwordx4 v6, s[16:19], s65 offen offset:1280 lds
Mvav 84,236,44
s_waitcnt lgkmcnt(6)
TR 236,17,29184
TR 238,17,31232
Mvav 88,240,40
s_add_u32 m0, s38, 51968
v_cvt_pk_bf16_f32 v30, v24, v25
Mvav 92,240,44
TR 240,18,29184
TR 242,18,31232
Mvav 96,244,40
buffer_load_dwordx4 v6, s[16:19], s67 offen offset:1280 lds
Mvav 100,244,44
s_waitcnt lgkmcnt(6)
TR 244,17,32768
TR 246,17,34816
Mvav 104,224,40
s_add_u32 m0, s38, 56064
v_exp_f32 v27, v71
Mvav 108,224,44
TR 224,18,32768
TR 226,18,34816
Mvav 112,228,40
buffer_load_dwordx4 v6, s[16:19], s68 offen offset:1280 lds
Mvav 116,228,44
s_waitcnt lgkmcnt(6)
TR 228,17,33280
TR 230,17,35328
Mvav 120,232,40
s_add_u32 m0, s38, 60160
v_cvt_pk_bf16_f32 v31, v26, v27
Mvav 124,232,44
TR 232,18,33280
TR 234,18,35328
Mvav 128,236,40
buffer_load_dwordx4 v6, s[16:19], s69 offen offset:1280 lds
Mvav 132,236,44
s_waitcnt lgkmcnt(6)
TR 236,15,8192
TR 238,15,10240
Mvav 136,240,40
v_exp_f32 v24, v76
Mvav 140,240,44
TR 240,16,8192
TR 242,16,10240
Mvav 144,244,40
v_exp_f32 v25, v77
Mvav 148,244,44
s_waitcnt lgkmcnt(6)
TR 244,19,16384
TR 246,19,18432
Mvav 152,224,40
v_exp_f32 v26, v78
Mvav 156,224,44
TR 224,20,16384
TR 226,20,18432
Mvav 160,228,40
v_cvt_pk_bf16_f32 v2, v24, v25
Mvav 164,228,44
s_waitcnt lgkmcnt(6)
TR 228,15,12288
TR 230,15,14336
Mvav 168,232,40
v_exp_f32 v27, v79
Mvav 172,232,44
TR 232,16,12288
TR 234,16,14336
Mvaa 224,236,128
v_cvt_pk_bf16_f32 v3, v26, v27
Mvaa 228,236,132
s_waitcnt lgkmcnt(6)
TR 236,15,16384
TR 238,15,18432
Mvaa 232,240,128
s_add_u32 m0, s38, 65536
Mvaa 236,240,132
TR 240,16,16384
TR 242,16,18432
Mvaa 224,244,136
Mvaa 228,244,140
s_waitcnt lgkmcnt(6)
TR 244,19,4608
TR 246,19,6656
Mvaa 232,224,136
buffer_load_dwordx4 v5, s[12:15], s33 offen nt lds
Mvaa 236,224,140
s_add_u32 m0, s38, 69504
TR 224,20,4608
TR 226,20,6656
Mvaa 224,228,144
Mvaa 228,228,148
s_waitcnt lgkmcnt(6)
TR 228,15,512
TR 230,15,2560
Mvaa 232,232,144
Mvaa 236,232,148
TR 232,16,512
TR 234,16,2560
Mvaa 224,236,152
s_barrier
Mvaa 228,236,156
s_waitcnt lgkmcnt(6)
ds_read_b128 a[236:239], v10 offset:36864
Mvaa 232,240,152
buffer_load_dwordx4 v5, s[12:15], s33 offen offset:128 nt lds
Mvaa 236,240,156
s_add_u32 m0, s38, 73472
ds_read_b128 a[240:243], v10 offset:37376
v_mul_f32 v224, s40, v224
Mvaa 240,244,112
v_mul_f32 v225, s40, v225
v_mul_f32 v226, s40, v226
Mvaa 244,244,116
s_waitcnt lgkmcnt(4)
ds_read_b128 a[244:247], v11 offset:8192
v_mul_f32 v227, s40, v227
Mvaa 248,224,112
v_mul_f32 v232, s40, v232
v_mul_f32 v233, s40, v233
Mvaa 252,224,116
ds_read_b128 a[224:227], v11 offset:8704
v_mul_f32 v234, s40, v234
Mvaa 240,228,120
buffer_load_dwordx4 v5, s[12:15], s33 offen offset:256 nt lds
Mvaa 244,228,124
s_waitcnt lgkmcnt(3)
ds_read_b128 a[228:231], v9 offset:4096
v_mul_f32 v235, s40, v235
Mvaa 248,232,120
s_add_u32 s33, s33, 6144
v_cvt_pk_bf16_f32 v224, v224, v225
v_cvt_pk_bf16_f32 v225, v226, v227
Mvaa 252,232,124
s_sub_u32 s45, s33, 98304
ds_read_b128 a[232:235], v9 offset:4608
v_cvt_pk_bf16_f32 v226, v232, v233
v_mfma_f32_16x16x32_bf16 v[48:51], a[236:239], a[160:163], 0
s_min_u32 s33, s33, s45
v_cvt_pk_bf16_f32 v227, v234, v235
v_permlane16_swap_b32 v224, v226
v_mfma_f32_16x16x32_bf16 v[56:59], a[236:239], a[164:167], 0
s_waitcnt lgkmcnt(3)
ds_read_b128 a[236:239], v10 offset:38912
v_permlane16_swap_b32 v225, v227
Mvaa 48,240,168
s_add_u32 m0, s38, 77824
ds_write_b128 v13, v[224:227] offset:32768
v_mul_f32 v228, s40, v228
Mvaa 56,240,172
ds_read_b128 a[240:243], v10 offset:39424
v_mul_f32 v229, s40, v229
Mvaa 48,244,176
buffer_load_dwordx4 v4, s[8:11], s32 offen nt lds
Mvaa 56,244,180
s_waitcnt lgkmcnt(4)
ds_read_b128 a[244:247], v11 offset:10240
v_mul_f32 v230, s40, v230
Mvaa 48,224,184
s_add_u32 m0, s38, 81792
v_mul_f32 v231, s40, v231
v_mul_f32 v236, s40, v236
Mvaa 56,224,188
ds_read_b128 a[224:227], v11 offset:10752
v_mul_f32 v237, s40, v237
Mvaa 48,228,192
v_mul_f32 v238, s40, v238
v_mul_f32 v239, s40, v239
Mvaa 56,228,196
s_waitcnt lgkmcnt(4)
ds_read_b128 a[228:231], v9 offset:6144
v_cvt_pk_bf16_f32 v228, v228, v229
Mvaa 48,232,200
buffer_load_dwordx4 v4, s[8:11], s32 offen offset:128 nt lds
Mvaa 56,232,204
s_add_u32 m0, s38, 89856
ds_read_b128 a[232:235], v9 offset:6656
v_cvt_pk_bf16_f32 v229, v230, v231
v_mfma_f32_16x16x32_bf16 v[52:55], a[236:239], a[160:163], 0
v_cvt_pk_bf16_f32 v230, v236, v237
v_cvt_pk_bf16_f32 v231, v238, v239
v_mfma_f32_16x16x32_bf16 v[60:63], a[236:239], a[164:167], 0
s_waitcnt lgkmcnt(3)
TR 236,15,8704
TR 238,15,10752
Mvaa 52,240,168
v_permlane16_swap_b32 v228, v230
v_permlane16_swap_b32 v229, v231
Mvaa 60,240,172
TR 240,16,8704
TR 242,16,10752
Mvaa 52,244,176
buffer_load_dwordx4 v4, s[8:11], s32 offen offset:256 nt lds
Mvaa 60,244,180
s_waitcnt lgkmcnt(5)
TR 244,19,16896
TR 246,19,18944
Mvaa 52,224,184
s_add_u32 s32, s32, 6144
ds_write_b128 v13, v[228:231] offset:28672
s_sub_u32 s45, s32, 98304
Mvaa 60,224,188
s_min_u32 s32, s32, s45
TR 224,20,16896
TR 226,20,18944
Mvaa 52,228,192
s_add_u32 m0, s38, 92928
v_exp_f32 v24, v48
Mvaa 60,228,196
s_waitcnt lgkmcnt(7)
TR 228,15,12800
TR 230,15,14848
Mvaa 52,232,200
buffer_load_dwordx4 v6, s[16:19], s70 offen offset:1280 lds
Mvaa 60,232,204
v_exp_f32 v25, v49
Mvaa 240,236,128
v_exp_f32 v26, v50
Mvaa 244,236,132
s_waitcnt lgkmcnt(5)
TR 236,16,12800
TR 238,16,14848
Mvaa 248,240,128
v_cvt_pk_bf16_f32 v40, v24, v25
Mvaa 252,240,132
TR 240,15,16896
TR 242,15,18944
Mvaa 240,244,136
v_exp_f32 v27, v51
Mvaa 244,244,140
s_waitcnt vmcnt(9) lgkmcnt(4)
TR 244,16,16896
TR 246,16,18944
Mvaa 248,224,136
s_barrier
Mvaa 252,224,140
TR 224,15,20480
TR 226,15,22528
Mvaa 240,228,144
v_exp_f32 v24, v56
Mvaa 244,228,148
s_waitcnt lgkmcnt(6)
TR 228,16,20480
TR 230,16,22528
Mvav 32,252,28
v_cvt_pk_bf16_f32 v41, v26, v27
Mvav 36,252,0
TR 232,15,20992
TR 234,15,23040
Mvaa 248,236,144
v_exp_f32 v25, v57
Mvaa 252,236,148
s_waitcnt lgkmcnt(6)
TR 236,16,20992
TR 238,16,23040
Mvaa 240,240,152
v_max_f32 v33, v32, v36
v_cmp_nge_f32 vcc, s39, v33
Mvaa 244,240,156
TR 240,15,24576
TR 242,15,26624
Mvaa 248,244,152
v_mul_f32 v240, s40, v240
v_mul_f32 v241, s40, v241
Mvaa 252,244,156
s_waitcnt lgkmcnt(6)
TR 244,16,24576
TR 246,16,26624
s_cbranch_vccnz Lr21
Lb21:
Mvav 80,224,28
v_mul_f32 v242, s40, v242
v_mul_f32 v243, s40, v243
Mvav 84,224,0
TR 224,15,25088
TR 226,15,27136
Mvav 88,228,28
v_mul_f32 v248, s40, v248
v_mul_f32 v249, s40, v249
Mvav 92,228,0
s_waitcnt lgkmcnt(6)
TR 228,16,25088
TR 230,16,27136
Mvav 96,232,28
v_mul_f32 v250, s40, v250
v_mul_f32 v251, s40, v251
Mvav 100,232,0
s_add_u32 m0, s38, 113408
TR 232,15,28672
TR 234,15,30720
Mvav 104,236,28
buffer_load_dwordx4 v6, s[16:19], s71 offen offset:1280 lds
Mvav 108,236,0
s_waitcnt lgkmcnt(6)
TR 236,16,28672
TR 238,16,30720
Mvav 112,240,28
s_add_u32 m0, s38, 101120
v_cvt_pk_bf16_f32 v240, v240, v241
v_cvt_pk_bf16_f32 v241, v242, v243
Mvav 116,240,0
TR 240,15,29184
TR 242,15,31232
Mvav 120,244,28
buffer_load_dwordx4 v6, s[16:19], s72 offen offset:1280 lds
Mvav 124,244,0
s_waitcnt lgkmcnt(6)
TR 244,16,29184
TR 246,16,31232
Mvav 128,224,28
s_add_u32 m0, s38, 105216
Tc14:
s_cbranch_execz Tr14
s_cmpk_eq_u32 s88, 17
s_cselect_b64 exec, 0, -1
s_cbranch_execz Tc17
Tr17:
s_mov_b64 exec, -1
v_cvt_pk_bf16_f32 v242, v248, v249
v_cvt_pk_bf16_f32 v243, v250, v251
Mvav 132,224,0
TR 224,19,12288
TR 226,19,14336
Mvav 136,228,28
buffer_load_dwordx4 v6, s[16:19], s73 offen offset:1280 lds
Mvav 140,228,0
s_waitcnt lgkmcnt(6)
TR 228,20,12288
TR 230,20,14336
Mvav 144,232,28
v_permlane16_swap_b32 v240, v242
v_permlane16_swap_b32 v241, v243
Mvav 148,232,0
TR 232,17,0
TR 234,17,2048
Mvav 152,236,28
ds_write_b128 v13, v[240:243] offset:24576
v_mul_f32 v244, s40, v244
Mvav 156,236,0
s_waitcnt lgkmcnt(7)
TR 236,18,0
TR 238,18,2048
Mvav 160,240,28
v_mul_f32 v245, s40, v245
v_mul_f32 v246, s40, v246
Mvav 164,240,0
TR 240,15,45056
TR 242,15,47104
Mvav 168,244,28
v_mul_f32 v247, s40, v247
v_mul_f32 v252, s40, v252
Mvav 172,244,0
s_waitcnt lgkmcnt(7)
TR 244,16,45056
TR 246,16,47104
v_mfma_f32_16x16x32_bf16 v[224:227], a[224:227], a[0:3], 0
v_mul_f32 v253, s40, v253
v_mul_f32 v254, s40, v254
v_mfma_f32_16x16x32_bf16 v[228:231], a[224:227], a[4:7], 0
TR 224,17,4096
TR 226,17,6144
v_mfma_f32_16x16x32_bf16 v[232:235], a[228:231], a[0:3], 0
v_mul_f32 v255, s40, v255
v_cvt_pk_bf16_f32 v244, v244, v245
v_mfma_f32_16x16x32_bf16 v[236:239], a[228:231], a[4:7], 0
s_waitcnt vmcnt(10) lgkmcnt(6)
TR 228,18,4096
TR 230,18,6144
Mvaa 224,232,8
s_barrier
Mvaa 228,232,12
ds_read_b128 a[232:235], v9 offset:32768
v_cvt_pk_bf16_f32 v245, v246, v247
Mvaa 232,236,8
v_cvt_pk_bf16_f32 v246, v252, v253
v_cvt_pk_bf16_f32 v247, v254, v255
Mvaa 236,236,12
s_waitcnt lgkmcnt(5)
ds_read_b128 a[236:239], v9 offset:33280
v_permlane16_swap_b32 v244, v246
Mvaa 224,240,16
v_permlane16_swap_b32 v245, v247
ds_write_b128 v13, v[244:247] offset:20480
Mvaa 228,240,20
ds_read_b128 a[240:243], v9 offset:36864
v_cvt_pk_bf16_f32 v44, v24, v25
Mvaa 232,244,16
s_add_u32 m0, s38, 0
v_exp_f32 v26, v58
Mvaa 236,244,20
s_waitcnt lgkmcnt(4)
ds_read_b128 a[244:247], v9 offset:37376
Mvaa 224,224,24
buffer_load_dwordx4 v5, s[12:15], s33 offen nt lds
Mvaa 228,224,28
s_add_u32 m0, s38, 3968
ds_read_b128 a[224:227], v9 offset:40960
Mvaa 232,228,24
v_exp_f32 v27, v59
Mvaa 236,228,28
s_waitcnt lgkmcnt(4)
ds_read_b128 a[228:231], v9 offset:41472
v_cvt_pk_bf16_f32 v45, v26, v27
v_mfma_f32_16x16x32_bf16 v[64:67], a[232:235], a[160:163], 0
v_exp_f32 v24, v52
v_mfma_f32_16x16x32_bf16 v[72:75], a[232:235], a[164:167], 0
ds_read_b128 a[232:235], v9 offset:34816
Mvaa 64,236,168
buffer_load_dwordx4 v5, s[12:15], s33 offen offset:128 nt lds
Mvaa 72,236,172
s_waitcnt lgkmcnt(3)
ds_read_b128 a[236:239], v9 offset:35328
s_add_u32 m0, s38, 7936
Mvaa 64,240,176
v_exp_f32 v25, v53
Mvaa 72,240,180
ds_read_b128 a[240:243], v9 offset:38912
v_cvt_pk_bf16_f32 v42, v24, v25
Mvaa 64,244,184
v_exp_f32 v26, v54
Mvaa 72,244,188
s_waitcnt lgkmcnt(3)
ds_read_b128 a[244:247], v9 offset:39424
Mvaa 64,224,192
buffer_load_dwordx4 v5, s[12:15], s33 offen offset:256 nt lds
Mvaa 72,224,196
s_add_u32 s33, s33, 6144
ds_read_b128 a[224:227], v9 offset:43008
s_sub_u32 s45, s33, 98304
Mvaa 64,228,200
s_min_u32 s33, s33, s45
v_exp_f32 v27, v55
Mvaa 72,228,204
s_waitcnt lgkmcnt(3)
ds_read_b128 a[228:231], v9 offset:43520
v_cvt_pk_bf16_f32 v43, v26, v27
v_mfma_f32_16x16x32_bf16 v[68:71], a[232:235], a[160:163], 0
s_add_u32 m0, s38, 12288
v_exp_f32 v24, v60
v_mfma_f32_16x16x32_bf16 v[76:79], a[232:235], a[164:167], 0
TR 232,17,8192
TR 234,17,10240
Mvaa 68,236,168
buffer_load_dwordx4 v4, s[8:11], s32 offen nt lds
Mvaa 76,236,172
s_waitcnt lgkmcnt(4)
TR 236,18,8192
TR 238,18,10240
Mvaa 68,240,176
s_add_u32 m0, s38, 16256
v_exp_f32 v25, v61
Mvaa 76,240,180
TR 240,17,12288
TR 242,17,14336
Mvaa 68,244,184
v_exp_f32 v26, v62
Mvaa 76,244,188
s_waitcnt lgkmcnt(6)
TR 244,18,12288
TR 246,18,14336
Mvaa 68,224,192
buffer_load_dwordx4 v4, s[8:11], s32 offen offset:128 nt lds
Mvaa 76,224,196
s_add_u32 m0, s38, 20224
TR 224,19,12800
TR 226,19,14848
Mvaa 68,228,200
v_cvt_pk_bf16_f32 v46, v24, v25
Mvaa 76,228,204
s_waitcnt lgkmcnt(6)
TR 228,20,12800
TR 230,20,14848
Mvaa 224,232,32
v_exp_f32 v27, v63
Mvaa 228,232,36
TR 232,17,512
TR 234,17,2560
Mvaa 232,236,32
buffer_load_dwordx4 v4, s[8:11], s32 offen offset:256 nt lds
Mvaa 236,236,36
s_waitcnt lgkmcnt(6)
TR 236,18,512
TR 238,18,2560
Mvaa 224,240,40
s_add_u32 s32, s32, 6144
v_cvt_pk_bf16_f32 v47, v26, v27
s_sub_u32 s45, s32, 98304
Mvaa 228,240,44
s_min_u32 s32, s32, s45
TR 240,15,45568
TR 242,15,47616
Mvaa 232,244,40
s_add_u32 m0, s38, 23168
v_exp_f32 v24, v64
Mvaa 236,244,44
s_waitcnt lgkmcnt(6)
v_exp_f32 v25, v65
v_mfma_f32_16x16x32_bf16 v[240:243], a[224:227], a[0:3], 0
buffer_load_dwordx4 v6, s[16:19], s64 offen offset:1408 lds
v_mfma_f32_16x16x32_bf16 v[244:247], a[224:227], a[4:7], 0
s_add_u32 m0, s38, 27392
TR 224,16,45568
TR 226,16,47616
v_mfma_f32_16x16x32_bf16 v[248:251], a[228:231], a[0:3], 0
v_exp_f32 v26, v66
v_mfma_f32_16x16x32_bf16 v[252:255], a[228:231], a[4:7], 0
s_waitcnt lgkmcnt(4)
TR 228,17,4608
TR 230,17,6656
Mvaa 240,232,8
buffer_load_dwordx4 v6, s[16:19], s74 offen offset:1280 lds
Mvaa 244,232,12
s_waitcnt vmcnt(10)
TR 232,18,4608
TR 234,18,6656
Mvaa 248,236,8
s_barrier
Mvaa 252,236,12
s_waitcnt lgkmcnt(6)
TR 236,17,16384
TR 238,17,18432
Mvaa 240,240,16
v_cvt_pk_bf16_f32 v28, v24, v25
Mvaa 244,240,20
TR 240,18,16384
TR 242,18,18432
Mvav 32,252,40
v_exp_f32 v27, v67
Mvav 36,252,44
s_waitcnt lgkmcnt(6)
TR 244,17,16896
TR 246,17,18944
Mvaa 248,224,16
v_exp_f32 v24, v72
Mvaa 252,224,20
TR 224,18,16896
TR 226,18,18944
Mvaa 240,228,24
v_max_f32 v33, v32, v36
v_cmp_nge_f32 vcc, s39, v33
Mvaa 244,228,28
s_waitcnt lgkmcnt(6)
TR 228,17,20480
TR 230,17,22528
Mvaa 248,232,24
v_cvt_pk_bf16_f32 v29, v26, v27
Mvaa 252,232,28
TR 232,18,20480
TR 234,18,22528
s_cbranch_vccnz Lr22
Lb22:
Mvav 80,236,40
v_exp_f32 v25, v73
Mvav 84,236,44
s_waitcnt lgkmcnt(6)
TR 236,17,20992
TR 238,17,23040
Mvav 88,240,40
v_exp_f32 v26, v74
Mvav 92,240,44
TR 240,18,20992
TR 242,18,23040
Mvav 96,244,40
v_cvt_pk_bf16_f32 v0, v24, v25
Mvav 100,244,44
s_waitcnt lgkmcnt(6)
TR 244,17,24576
TR 246,17,26624
Mvav 104,224,40
v_exp_f32 v27, v75
Mvav 108,224,44
TR 224,18,24576
TR 226,18,26624
Mvav 112,228,40
v_exp_f32 v24, v68
Mvav 116,228,44
s_waitcnt lgkmcnt(6)
TR 228,17,25088
TR 230,17,27136
Mvav 120,232,40
v_cvt_pk_bf16_f32 v1, v26, v27
Mvav 124,232,44
TR 232,18,25088
TR 234,18,27136
Mvav 128,236,40
s_add_u32 m0, s38, 109312
v_exp_f32 v25, v69
Mvav 132,236,44
s_waitcnt lgkmcnt(6)
TR 236,17,8704
TR 238,17,10752
Mvav 136,240,40
buffer_load_dwordx4 v6, s[16:19], s75 offen offset:1280 lds
Mvav 140,240,44
s_add_u32 m0, s38, 31488
TR 240,18,8704
TR 242,18,10752
Mvav 144,244,40
v_exp_f32 v26, v70
Mvav 148,244,44
s_waitcnt lgkmcnt(6)
TR 244,17,12800
TR 246,17,14848
Mvav 152,224,40
buffer_load_dwordx4 v6, s[16:19], s76 offen offset:1280 lds
Mvav 156,224,44
s_add_u32 m0, s38, 35584
TR 224,18,12800
TR 226,18,14848
Mvav 160,228,40
v_cvt_pk_bf16_f32 v30, v24, v25
Mvav 164,228,44
s_waitcnt lgkmcnt(6)
TR 228,17,45056
TR 230,17,47104
Mvav 168,232,40
buffer_load_dwordx4 v6, s[16:19], s77 offen offset:1280 lds
Mvav 172,232,44
s_add_u32 m0, s38, 39680
TR 232,18,45056
TR 234,18,47104
Mvaa 240,236,32
v_exp_f32 v27, v71
Mvaa 244,236,36
s_waitcnt lgkmcnt(6)
TR 236,17,45568
TR 238,17,47616
Mvaa 248,240,32
buffer_load_dwordx4 v6, s[16:19], s78 offen offset:1280 lds
Mvaa 252,240,36
s_add_u32 m0, s38, 47872
TR 240,18,45568
TR 242,18,47616
Mvaa 240,244,40
v_cvt_pk_bf16_f32 v31, v26, v27
Mvaa 244,244,44
s_waitcnt lgkmcnt(6)
TR 244,19,16384
TR 246,19,18432
Mvaa 248,224,40
buffer_load_dwordx4 v6, s[16:19], s79 offen offset:1280 lds
Mvaa 252,224,44
TR 224,20,16384
TR 226,20,18432
Mvaa 224,228,48
v_exp_f32 v24, v76
Mvaa 228,228,52
s_waitcnt lgkmcnt(6)
TR 228,19,16896
TR 230,19,18944
Mvaa 232,232,48
v_exp_f32 v25, v77
Mvaa 236,232,52
s_waitcnt vmcnt(13)
TR 232,20,16896
TR 234,20,18944
Mvaa 240,236,48
s_barrier
Mvaa 244,236,52
s_waitcnt lgkmcnt(6)
ds_read_b128 a[236:239], v10 offset:28672
v_cvt_pk_bf16_f32 v2, v24, v25
Mvaa 248,240,48
v_exp_f32 v26, v78
Mvaa 252,240,52
ds_read_b128 a[240:243], v10 offset:29184
Mvaa 224,244,56
v_exp_f32 v27, v79
Mvaa 228,244,60
s_waitcnt lgkmcnt(4)
ds_read_b128 a[244:247], v10 offset:32768
v_cvt_pk_bf16_f32 v3, v26, v27
Mvaa 232,224,56
Mvaa 236,224,60
ds_read_b128 a[224:227], v10 offset:33280
Mvaa 240,228,56
Mvaa 244,228,60
s_waitcnt lgkmcnt(3)
ds_read_b128 a[228:231], v10 offset:40960
s_add_u32 m0, s38, 43776
Mvaa 248,232,56
Mvaa 252,232,60
ds_read_b128 a[232:235], v10 offset:41472
v_mfma_f32_16x16x32_bf16 v[48:51], a[236:239], a[160:163], 0
buffer_load_dwordx4 v6, s[16:19], s80 offen offset:1280 lds
v_mfma_f32_16x16x32_bf16 v[56:59], a[236:239], a[164:167], 0
s_waitcnt lgkmcnt(3)
ds_read_b128 a[236:239], v10 offset:30720
s_add_u32 m0, s38, 51968
Mvaa 48,240,168
Mvaa 56,240,172
ds_read_b128 a[240:243], v10 offset:31232
Mvaa 48,244,176
buffer_load_dwordx4 v6, s[16:19], s81 offen offset:1280 lds
Mvaa 56,244,180
s_waitcnt lgkmcnt(3)
ds_read_b128 a[244:247], v10 offset:34816
s_add_u32 m0, s38, 56064
Mvaa 48,224,184
Mvaa 56,224,188
ds_read_b128 a[224:227], v10 offset:35328
Mvaa 48,228,192
buffer_load_dwordx4 v6, s[16:19], s82 offen offset:1280 lds
Mvaa 56,228,196
s_waitcnt lgkmcnt(3)
ds_read_b128 a[228:231], v10 offset:43008
s_add_u32 m0, s38, 61440
Mvaa 48,232,200
Mvaa 56,232,204
ds_read_b128 a[232:235], v10 offset:43520
v_mfma_f32_16x16x32_bf16 v[52:55], a[236:239], a[160:163], 0
v_exp_f32 v24, v48
v_mfma_f32_16x16x32_bf16 v[60:63], a[236:239], a[164:167], 0
s_waitcnt lgkmcnt(3)
TR 236,19,4096
TR 238,19,6144
Mvaa 52,240,168
buffer_load_dwordx4 v5, s[12:15], s33 offen nt lds
Mvaa 60,240,172
s_add_u32 m0, s38, 65408
TR 240,20,4096
TR 242,20,6144
Mvaa 52,244,176
v_exp_f32 v25, v49
Mvaa 60,244,180
s_waitcnt lgkmcnt(5)
TR 244,19,4608
TR 246,19,6656
Mvaa 52,224,184
v_exp_f32 v26, v50
Mvaa 60,224,188
TR 224,20,4608
TR 226,20,6656
Mvaa 52,228,192
buffer_load_dwordx4 v5, s[12:15], s33 offen offset:128 nt lds
Mvaa 60,228,196
s_waitcnt lgkmcnt(6)
TR 228,19,8192
TR 230,19,10240
Mvaa 52,232,200
s_add_u32 m0, s38, 69376
v_cvt_pk_bf16_f32 v40, v24, v25
Mvaa 60,232,204
v_exp_f32 v27, v51
Mvaa 224,236,64
v_exp_f32 v24, v56
Mvaa 228,236,68
s_waitcnt lgkmcnt(4)
TR 236,20,8192
TR 238,20,10240
Mvaa 232,240,64
buffer_load_dwordx4 v5, s[12:15], s33 offen offset:256 nt lds
Mvaa 236,240,68
s_add_u32 s33, s33, 6144
TR 240,19,8704
TR 242,19,10752
Mvaa 240,244,64
s_sub_u32 s45, s33, 98304
v_cvt_pk_bf16_f32 v41, v26, v27
s_min_u32 s33, s33, s45
Mvaa 244,244,68
s_waitcnt vmcnt(10) lgkmcnt(4)
TR 244,20,8704
TR 246,20,10752
Mvaa 248,224,64
s_barrier
Mvaa 252,224,68
s_add_u32 m0, s38, 102400
TR 224,15,0
TR 226,15,2048
Mvaa 224,228,72
buffer_load_dwordx4 v4, s[8:11], s32 offen nt lds
Mvaa 228,228,76
s_waitcnt lgkmcnt(6)
TR 228,16,0
TR 230,16,2048
Mvav 32,252,28
s_add_u32 m0, s38, 73600
v_exp_f32 v25, v57
Mvav 36,252,0
TR 232,15,512
TR 234,15,2560
Mvaa 232,236,72
v_exp_f32 v26, v58
Mvaa 236,236,76
s_waitcnt lgkmcnt(6)
TR 236,16,512
TR 238,16,2560
Mvaa 240,240,72
buffer_load_dwordx4 v4, s[8:11], s32 offen offset:128 nt lds
Mvaa 244,240,76
s_add_u32 m0, s38, 77568
TR 240,15,4096
TR 242,15,6144
Mvaa 248,244,72
v_max_f32 v33, v32, v36
v_cmp_nge_f32 vcc, s39, v33
Mvaa 252,244,76
s_waitcnt lgkmcnt(6)
TR 244,16,4096
TR 246,16,6144
s_cbranch_vccnz Lr23
Lb23:
Mvav 80,224,28
v_cvt_pk_bf16_f32 v44, v24, v25
Mvav 84,224,0
TR 224,15,4608
TR 226,15,6656
Mvav 88,228,28
buffer_load_dwordx4 v4, s[8:11], s32 offen offset:256 nt lds
Mvav 92,228,0
s_waitcnt lgkmcnt(6)
TR 228,16,4608
TR 230,16,6656
Mvav 96,232,28
s_add_u32 s32, s32, 6144
v_exp_f32 v27, v59
Mvav 100,232,0
s_sub_u32 s45, s32, 98304
TR 232,15,8192
TR 234,15,10240
Mvav 104,236,28
s_min_u32 s32, s32, s45
v_exp_f32 v24, v52
Mvav 108,236,0
s_waitcnt lgkmcnt(6)
TR 236,16,8192
TR 238,16,10240
Mvav 112,240,28
s_add_u32 m0, s38, 80640
v_cvt_pk_bf16_f32 v45, v26, v27
Mvav 116,240,0
TR 240,15,8704
TR 242,15,10752
Mvav 120,244,28
buffer_load_dwordx4 v6, s[16:19], s83 offen offset:1280 lds
Mvav 124,244,0
s_waitcnt lgkmcnt(6)
TR 244,16,8704
TR 246,16,10752
Mvav 128,224,28
v_exp_f32 v25, v53
Mvav 132,224,0
TR 224,15,28672
TR 226,15,30720
Mvav 136,228,28
v_exp_f32 v26, v54
Mvav 140,228,0
s_waitcnt lgkmcnt(6)
TR 228,16,28672
TR 230,16,30720
Mvav 144,232,28
v_cvt_pk_bf16_f32 v42, v24, v25
Mvav 148,232,0
TR 232,15,29184
TR 234,15,31232
Mvav 152,236,28
v_exp_f32 v27, v55
Mvav 156,236,0
s_waitcnt lgkmcnt(6)
TR 236,16,29184
TR 238,16,31232
Mvav 160,240,28
v_cvt_pk_bf16_f32 v43, v26, v27
Mvav 164,240,0
TR 240,19,12288
TR 242,19,14336
Mvav 168,244,28
v_exp_f32 v24, v60
Mvav 172,244,0
s_waitcnt lgkmcnt(6)
TR 244,20,12288
TR 246,20,14336
Mvaa 224,224,80
v_exp_f32 v25, v61
Mvaa 228,224,84
TR 224,19,12800
TR 226,19,14848
Mvaa 232,228,80
v_exp_f32 v26, v62
Mvaa 236,228,84
s_waitcnt vmcnt(10) lgkmcnt(6)
TR 228,20,12800
TR 230,20,14848
Mvaa 240,232,80
s_barrier
Mvaa 244,232,84
ds_read_b128 a[232:235], v9 offset:12288
v_cvt_pk_bf16_f32 v46, v24, v25
Mvaa 248,236,80
Tc15:
s_cbranch_execz Tr15
s_cmpk_eq_u32 s88, 18
s_cselect_b64 exec, 0, -1
s_cbranch_execz Tc18
Tr18:
s_mov_b64 exec, -1
v_exp_f32 v27, v63
Mvaa 252,236,84
s_waitcnt lgkmcnt(5)
ds_read_b128 a[236:239], v9 offset:12800
v_cvt_pk_bf16_f32 v47, v26, v27
Mvaa 224,240,88
Mvaa 228,240,92
ds_read_b128 a[240:243], v9 offset:16384
Mvaa 232,244,88
Mvaa 236,244,92
s_waitcnt lgkmcnt(3)
ds_read_b128 a[244:247], v9 offset:16896
s_add_u32 m0, s38, 0
Mvaa 240,224,88
buffer_load_dwordx4 v5, s[12:15], s33 offen nt lds
Mvaa 244,224,92
s_add_u32 m0, s38, 3968
ds_read_b128 a[224:227], v9 offset:20480
Mvaa 248,228,88
Mvaa 252,228,92
s_waitcnt lgkmcnt(3)
ds_read_b128 a[228:231], v9 offset:20992
v_mfma_f32_16x16x32_bf16 v[64:67], a[232:235], a[160:163], 0
v_mfma_f32_16x16x32_bf16 v[72:75], a[232:235], a[164:167], 0
ds_read_b128 a[232:235], v9 offset:14336
Mvaa 64,236,168
buffer_load_dwordx4 v5, s[12:15], s33 offen offset:128 nt lds
Mvaa 72,236,172
s_waitcnt lgkmcnt(3)
ds_read_b128 a[236:239], v9 offset:14848
s_add_u32 m0, s38, 7936
Mvaa 64,240,176
Mvaa 72,240,180
ds_read_b128 a[240:243], v9 offset:18432
Mvaa 64,244,184
Mvaa 72,244,188
s_waitcnt lgkmcnt(3)
ds_read_b128 a[244:247], v9 offset:18944
Mvaa 64,224,192
buffer_load_dwordx4 v5, s[12:15], s33 offen offset:256 nt lds
Mvaa 72,224,196
s_add_u32 s33, s33, 6144
ds_read_b128 a[224:227], v9 offset:22528
s_sub_u32 s45, s33, 98304
Mvaa 64,228,200
s_min_u32 s33, s33, s45
s_add_u32 m0, s38, 86016
Mvaa 72,228,204
s_waitcnt lgkmcnt(3)
ds_read_b128 a[228:231], v9 offset:23040
v_mfma_f32_16x16x32_bf16 v[68:71], a[232:235], a[160:163], 0
v_exp_f32 v24, v64
v_mfma_f32_16x16x32_bf16 v[76:79], a[232:235], a[164:167], 0
TR 232,15,32768
TR 234,15,34816
Mvaa 68,236,168
buffer_load_dwordx4 v4, s[8:11], s32 offen nt lds
Mvaa 76,236,172
s_waitcnt lgkmcnt(4)
TR 236,16,32768
TR 238,16,34816
Mvaa 68,240,176
s_add_u32 m0, s38, 89984
v_exp_f32 v25, v65
Mvaa 76,240,180
TR 240,15,33280
TR 242,15,35328
Mvaa 68,244,184
v_exp_f32 v26, v66
Mvaa 76,244,188
s_waitcnt lgkmcnt(6)
TR 244,16,33280
TR 246,16,35328
Mvaa 68,224,192
buffer_load_dwordx4 v4, s[8:11], s32 offen offset:128 nt lds
Mvaa 76,224,196
s_add_u32 m0, s38, 93952
TR 224,15,36864
TR 226,15,38912
Mvaa 68,228,200
v_cvt_pk_bf16_f32 v28, v24, v25
Mvaa 76,228,204
s_waitcnt lgkmcnt(6)
TR 228,16,36864
TR 230,16,38912
Mvaa 224,232,96
v_exp_f32 v27, v67
Mvaa 228,232,100
TR 232,15,37376
TR 234,15,39424
Mvaa 232,236,96
buffer_load_dwordx4 v4, s[8:11], s32 offen offset:256 nt lds
Mvaa 236,236,100
s_waitcnt lgkmcnt(6)
TR 236,16,37376
TR 238,16,39424
Mvaa 240,240,96
s_add_u32 s32, s32, 6144
v_exp_f32 v24, v72
Mvaa 244,240,100
s_sub_u32 s45, s32, 98304
TR 240,15,40960
TR 242,15,43008
Mvaa 248,244,96
s_min_u32 s32, s32, s45
v_cvt_pk_bf16_f32 v29, v26, v27
s_add_u32 m0, s38, 96896
Mvaa 252,244,100
s_waitcnt lgkmcnt(6)
v_exp_f32 v25, v73
Mvaa 224,224,104
buffer_load_dwordx4 v6, s[16:19], s65 offen offset:1408 lds
Mvaa 228,224,108
s_add_u32 m0, s38, 10880
TR 224,16,40960
TR 226,16,43008
Mvaa 232,228,104
v_exp_f32 v26, v74
Mvaa 236,228,108
s_waitcnt lgkmcnt(4)
TR 228,17,0
TR 230,17,2048
Mvaa 240,232,104
v_cvt_pk_bf16_f32 v0, v24, v25
Mvaa 244,232,108
s_waitcnt vmcnt(7)
TR 232,18,0
TR 234,18,2048
Mvaa 248,236,104
s_barrier
Mvaa 252,236,108
s_waitcnt lgkmcnt(6)
TR 236,17,12288
TR 238,17,14336
Mvaa 224,240,112
buffer_load_dwordx4 v6, s[16:19], s66 offen offset:1408 lds
Mvaa 228,240,116
TR 240,18,12288
TR 242,18,14336
Mvav 32,252,40
v_exp_f32 v27, v75
Mvav 36,252,44
s_waitcnt lgkmcnt(6)
TR 244,17,12800
TR 246,17,14848
Mvaa 232,224,112
v_exp_f32 v24, v68
Mvaa 236,224,116
TR 224,18,12800
TR 226,18,14848
Mvaa 224,228,120
v_max_f32 v33, v32, v36
v_cmp_nge_f32 vcc, s39, v33
Mvaa 228,228,124
s_waitcnt lgkmcnt(6)
TR 228,17,16384
TR 230,17,18432
Mvaa 232,232,120
v_cvt_pk_bf16_f32 v1, v26, v27
Mvaa 236,232,124
TR 232,18,16384
TR 234,18,18432
s_cbranch_vccnz Lr24
Lb24:
Mvav 80,236,40
v_exp_f32 v25, v69
Mvav 84,236,44
s_waitcnt lgkmcnt(6)
TR 236,17,16896
TR 238,17,18944
Mvav 88,240,40
v_exp_f32 v26, v70
Mvav 92,240,44
TR 240,18,16896
TR 242,18,18944
Mvav 96,244,40
v_cvt_pk_bf16_f32 v30, v24, v25
Mvav 100,244,44
s_waitcnt lgkmcnt(6)
TR 244,17,20480
TR 246,17,22528
Mvav 104,224,40
v_exp_f32 v27, v71
Mvav 108,224,44
TR 224,18,20480
TR 226,18,22528
Mvav 112,228,40
v_cvt_pk_bf16_f32 v31, v26, v27
Mvav 116,228,44
s_waitcnt lgkmcnt(6)
TR 228,17,20992
TR 230,17,23040
Mvav 120,232,40
v_exp_f32 v24, v76
Mvav 124,232,44
TR 232,18,20992
TR 234,18,23040
Mvav 128,236,40
v_exp_f32 v25, v77
Mvav 132,236,44
s_waitcnt lgkmcnt(6)
TR 236,15,45056
TR 238,15,47104
Mvav 136,240,40
s_add_u32 m0, s38, 14976
v_exp_f32 v26, v78
Mvav 140,240,44
TR 240,16,45056
TR 242,16,47104
Mvav 144,244,40
buffer_load_dwordx4 v6, s[16:19], s67 offen offset:1408 lds
Mvav 148,244,44
s_waitcnt lgkmcnt(6)
TR 244,17,4096
TR 246,17,6144
Mvav 152,224,40
s_add_u32 m0, s38, 19072
v_cvt_pk_bf16_f32 v2, v24, v25
Mvav 156,224,44
TR 224,18,4096
TR 226,18,6144
Mvav 160,228,40
buffer_load_dwordx4 v6, s[16:19], s68 offen offset:1408 lds
Mvav 164,228,44
s_waitcnt lgkmcnt(6)
TR 228,17,8192
TR 230,17,10240
Mvav 168,232,40
s_add_u32 m0, s38, 27264
v_exp_f32 v27, v79
Mvav 172,232,44
TR 232,18,8192
TR 234,18,10240
Mvaa 224,236,128
buffer_load_dwordx4 v6, s[16:19], s69 offen offset:1408 lds
Mvaa 228,236,132
s_waitcnt lgkmcnt(6)
TR 236,17,32768
TR 238,17,34816
Mvaa 232,240,128
v_cvt_pk_bf16_f32 v3, v26, v27
Mvaa 236,240,132
TR 240,18,32768
TR 242,18,34816
Mvaa 224,244,136
Mvaa 228,244,140
s_waitcnt lgkmcnt(6)
TR 244,15,41472
TR 246,15,43520
Mvaa 232,224,136
Mvaa 236,224,140
TR 224,16,41472
TR 226,16,43520
Mvaa 224,228,144
Mvaa 228,228,148
s_waitcnt lgkmcnt(6)
TR 228,17,512
TR 230,17,2560
Mvaa 232,232,144
Mvaa 236,232,148
TR 232,18,512
TR 234,18,2560
Mvaa 224,236,152
s_barrier
Mvaa 228,236,156
s_waitcnt lgkmcnt(6)
ds_read_b128 a[236:239], v11 offset:4096
s_add_u32 m0, s38, 31360
Mvaa 232,240,152
v_mul_f32 v224, s40, v224
v_mul_f32 v225, s40, v225
Mvaa 236,240,156
ds_read_b128 a[240:243], v11 offset:4608
v_mul_f32 v226, s40, v226
Mvaa 240,244,112
buffer_load_dwordx4 v6, s[16:19], s70 offen offset:1408 lds
Mvaa 244,244,116
s_waitcnt lgkmcnt(4)
ds_read_b128 a[244:247], v10 offset:24576
v_mul_f32 v227, s40, v227
Mvaa 248,224,112
v_mul_f32 v232, s40, v232
v_mul_f32 v233, s40, v233
Mvaa 252,224,116
ds_read_b128 a[224:227], v10 offset:25088
v_mul_f32 v234, s40, v234
Mvaa 240,228,120
v_mul_f32 v235, s40, v235
v_cvt_pk_bf16_f32 v224, v224, v225
Mvaa 244,228,124
s_waitcnt lgkmcnt(3)
ds_read_b128 a[228:231], v10 offset:28672
v_cvt_pk_bf16_f32 v225, v226, v227
Mvaa 248,232,120
v_cvt_pk_bf16_f32 v226, v232, v233
v_cvt_pk_bf16_f32 v227, v234, v235
Mvaa 252,232,124
ds_read_b128 a[232:235], v10 offset:29184
v_permlane16_swap_b32 v224, v226
v_mfma_f32_16x16x32_bf16 v[48:51], a[236:239], a[160:163], 0
v_permlane16_swap_b32 v225, v227
ds_write_b128 v13, v[224:227] offset:16384
v_mfma_f32_16x16x32_bf16 v[56:59], a[236:239], a[164:167], 0
s_waitcnt lgkmcnt(4)
ds_read_b128 a[236:239], v11 offset:6144
v_mul_f32 v228, s40, v228
Mvaa 48,240,168
v_mul_f32 v229, s40, v229
v_mul_f32 v230, s40, v230
Mvaa 56,240,172
ds_read_b128 a[240:243], v11 offset:6656
v_mul_f32 v231, s40, v231
Mvaa 48,244,176
v_mul_f32 v236, s40, v236
v_mul_f32 v237, s40, v237
Mvaa 56,244,180
s_waitcnt lgkmcnt(4)
ds_read_b128 a[244:247], v10 offset:26624
v_mul_f32 v238, s40, v238
Mvaa 48,224,184
v_mul_f32 v239, s40, v239
v_cvt_pk_bf16_f32 v228, v228, v229
Mvaa 56,224,188
ds_read_b128 a[224:227], v10 offset:27136
v_cvt_pk_bf16_f32 v229, v230, v231
Mvaa 48,228,192
v_cvt_pk_bf16_f32 v230, v236, v237
v_cvt_pk_bf16_f32 v231, v238, v239
Mvaa 56,228,196
s_waitcnt lgkmcnt(3)
ds_read_b128 a[228:231], v10 offset:30720
v_permlane16_swap_b32 v228, v230
Mvaa 48,232,200
s_add_u32 m0, s38, 36864
v_permlane16_swap_b32 v229, v231
ds_write_b128 v13, v[228:231] offset:12288
Mvaa 56,232,204
ds_read_b128 a[232:235], v10 offset:31232
v_mfma_f32_16x16x32_bf16 v[52:55], a[236:239], a[160:163], 0
buffer_load_dwordx4 v5, s[12:15], s33 offen nt lds
v_mfma_f32_16x16x32_bf16 v[60:63], a[236:239], a[164:167], 0
s_waitcnt lgkmcnt(4)
TR 236,15,45568
TR 238,15,47616
Mvaa 52,240,168
s_add_u32 m0, s38, 61312
v_exp_f32 v24, v48
Mvaa 60,240,172
TR 240,16,45568
TR 242,16,47616
Mvaa 52,244,176
v_exp_f32 v25, v49
Mvaa 60,244,180
s_waitcnt lgkmcnt(6)
TR 244,17,4608
TR 246,17,6656
Mvaa 52,224,184
buffer_load_dwordx4 v5, s[12:15], s33 offen offset:128 nt lds
Mvaa 60,224,188
s_add_u32 m0, s38, 65280
TR 224,18,4608
TR 226,18,6656
Mvaa 52,228,192
v_exp_f32 v26, v50
Mvaa 60,228,196
s_waitcnt lgkmcnt(6)
TR 228,17,8704
TR 230,17,10752
Mvaa 52,232,200
v_cvt_pk_bf16_f32 v40, v24, v25
Mvaa 60,232,204
v_exp_f32 v27, v51
Mvaa 240,236,128
buffer_load_dwordx4 v5, s[12:15], s33 offen offset:256 nt lds
Mvaa 244,236,132
s_waitcnt lgkmcnt(4)
TR 236,18,8704
TR 238,18,10752
Mvaa 248,240,128
s_add_u32 s33, s33, 6144
v_exp_f32 v24, v56
Mvaa 252,240,132
s_sub_u32 s45, s33, 98304
TR 240,17,33280
TR 242,17,35328
Mvaa 240,244,136
s_min_u32 s33, s33, s45
v_cvt_pk_bf16_f32 v41, v26, v27
s_add_u32 m0, s38, 40960
Mvaa 244,244,140
s_waitcnt vmcnt(6) lgkmcnt(4)
TR 244,18,33280
TR 246,18,35328
Mvaa 248,224,136
s_barrier
Mvaa 252,224,140
TR 224,15,0
TR 226,15,2048
Mvaa 240,228,144
buffer_load_dwordx4 v4, s[8:11], s32 offen nt lds
Mvaa 244,228,148
s_waitcnt lgkmcnt(6)
TR 228,16,0
TR 230,16,2048
Mvav 32,252,28
s_add_u32 m0, s38, 44928
v_exp_f32 v25, v57
Mvav 36,252,0
TR 232,15,512
TR 234,15,2560
Mvaa 248,236,144
v_exp_f32 v26, v58
Mvaa 252,236,148
s_waitcnt lgkmcnt(6)
TR 236,16,512
TR 238,16,2560
Mvaa 240,240,152
buffer_load_dwordx4 v4, s[8:11], s32 offen offset:128 nt lds
Mvaa 244,240,156
s_add_u32 m0, s38, 48896
TR 240,15,4096
TR 242,15,6144
Mvaa 248,244,152
v_max_f32 v33, v32, v36
v_cmp_nge_f32 vcc, s39, v33
Mvaa 252,244,156
s_waitcnt lgkmcnt(6)
TR 244,16,4096
TR 246,16,6144
s_cbranch_vccnz Lr25
Lb25:
Mvav 80,224,28
v_mul_f32 v240, s40, v240
v_mul_f32 v241, s40, v241
Mvav 84,224,0
TR 224,15,4608
TR 226,15,6656
Mvav 88,228,28
buffer_load_dwordx4 v4, s[8:11], s32 offen offset:256 nt lds
Mvav 92,228,0
s_waitcnt lgkmcnt(6)
TR 228,16,4608
TR 230,16,6656
Mvav 96,232,28
s_add_u32 s32, s32, 6144
v_mul_f32 v242, s40, v242
v_mul_f32 v243, s40, v243
Mvav 100,232,0
s_sub_u32 s45, s32, 98304
TR 232,15,8192
TR 234,15,10240
Mvav 104,236,28
s_min_u32 s32, s32, s45
v_mul_f32 v248, s40, v248
v_mul_f32 v249, s40, v249
Mvav 108,236,0
s_waitcnt lgkmcnt(6)
TR 236,16,8192
TR 238,16,10240
Mvav 112,240,28
s_add_u32 m0, s38, 51840
v_mul_f32 v250, s40, v250
v_mul_f32 v251, s40, v251
Mvav 116,240,0
TR 240,15,8704
TR 242,15,10752
Mvav 120,244,28
buffer_load_dwordx4 v6, s[16:19], s71 offen offset:1408 lds
Mvav 124,244,0
s_waitcnt lgkmcnt(6)
TR 244,16,8704
TR 246,16,10752
Mvav 128,224,28
v_cvt_pk_bf16_f32 v240, v240, v241
v_cvt_pk_bf16_f32 v241, v242, v243
Mvav 132,224,0
TR 224,15,24576
TR 226,15,26624
Mvav 136,228,28
v_cvt_pk_bf16_f32 v242, v248, v249
v_cvt_pk_bf16_f32 v243, v250, v251
Mvav 140,228,0
s_waitcnt lgkmcnt(6)
TR 228,16,24576
TR 230,16,26624
Mvav 144,232,28
v_permlane16_swap_b32 v240, v242
v_permlane16_swap_b32 v241, v243
Mvav 148,232,0
TR 232,19,0
TR 234,19,2048
Mvav 152,236,28
ds_write_b128 v13, v[240:243] offset:8192
v_mul_f32 v244, s40, v244
Mvav 156,236,0
s_waitcnt lgkmcnt(7)
TR 236,20,0
TR 238,20,2048
Mvav 160,240,28
v_mul_f32 v245, s40, v245
v_mul_f32 v246, s40, v246
Mvav 164,240,0
TR 240,15,12288
TR 242,15,14336
Mvav 168,244,28
v_mul_f32 v247, s40, v247
v_mul_f32 v252, s40, v252
Mvav 172,244,0
s_waitcnt lgkmcnt(7)
TR 244,16,12288
TR 246,16,14336
v_mfma_f32_16x16x32_bf16 v[224:227], a[224:227], a[0:3], 0
v_mul_f32 v253, s40, v253
v_mul_f32 v254, s40, v254
v_mfma_f32_16x16x32_bf16 v[228:231], a[224:227], a[4:7], 0
TR 224,15,16384
TR 226,15,18432
v_mfma_f32_16x16x32_bf16 v[232:235], a[228:231], a[0:3], 0
v_mul_f32 v255, s40, v255
v_cvt_pk_bf16_f32 v244, v244, v245
v_mfma_f32_16x16x32_bf16 v[236:239], a[228:231], a[4:7], 0
s_waitcnt vmcnt(8) lgkmcnt(6)
TR 228,16,16384
TR 230,16,18432
Mvaa 224,232,8
s_barrier
Mvaa 228,232,12
ds_read_b128 a[232:235], v10 offset:36864
v_cvt_pk_bf16_f32 v245, v246, v247
Mvaa 232,236,8
v_cvt_pk_bf16_f32 v246, v252, v253
v_cvt_pk_bf16_f32 v247, v254, v255
Mvaa 236,236,12
s_waitcnt lgkmcnt(5)
ds_read_b128 a[236:239], v10 offset:37376
v_permlane16_swap_b32 v244, v246
Mvaa 224,240,16
v_permlane16_swap_b32 v245, v247
ds_write_b128 v13, v[244:247] offset:4096
Mvaa 228,240,20
ds_read_b128 a[240:243], v10 offset:40960
v_cvt_pk_bf16_f32 v44, v24, v25
Mvaa 232,244,16
v_exp_f32 v27, v59
Mvaa 236,244,20
s_waitcnt lgkmcnt(4)
ds_read_b128 a[244:247], v10 offset:41472
v_cvt_pk_bf16_f32 v45, v26, v27
Mvaa 224,224,24
s_add_u32 s43, s72, 1408
v_exp_f32 v24, v52
Mvaa 228,224,28
s_add_u32 m0, s38, 0
ds_read_b128 a[224:227], v10 offset:45056
Mvaa 232,228,24
buffer_load_dwordx4 v6, s[16:19], s43 offen lds
Mvaa 236,228,28
s_waitcnt lgkmcnt(4)
ds_read_b128 a[228:231], v10 offset:45568
s_add_u32 m0, s38, 2688
v_mfma_f32_16x16x32_bf16 v[64:67], a[232:235], a[160:163], 0
v_exp_f32 v25, v53
v_mfma_f32_16x16x32_bf16 v[72:75], a[232:235], a[164:167], 0
ds_read_b128 a[232:235], v10 offset:38912
v_cvt_pk_bf16_f32 v42, v24, v25
Mvaa 64,236,168
buffer_load_dwordx4 v6, s[16:19], s73 offen offset:1408 lds
Mvaa 72,236,172
s_waitcnt lgkmcnt(3)
ds_read_b128 a[236:239], v10 offset:39424
s_add_u32 m0, s38, 8192
Mvaa 64,240,176
v_exp_f32 v26, v54
Mvaa 72,240,180
ds_read_b128 a[240:243], v10 offset:43008
Mvaa 64,244,184
v_exp_f32 v27, v55
Mvaa 72,244,188
s_waitcnt lgkmcnt(3)
Tc16:
s_cbranch_execz Tr16
s_cmpk_eq_u32 s88, 19
s_cselect_b64 exec, 0, -1
s_cbranch_execz Tv19
Tr19:
s_mov_b64 exec, -1
ds_read_b128 a[244:247], v10 offset:43520
v_cvt_pk_bf16_f32 v43, v26, v27
Mvaa 64,224,192
buffer_load_dwordx4 v5, s[12:15], s33 offen nt lds
Mvaa 72,224,196
s_add_u32 m0, s38, 57216
ds_read_b128 a[224:227], v10 offset:47104
Mvaa 64,228,200
v_exp_f32 v24, v60
Mvaa 72,228,204
s_waitcnt lgkmcnt(3)
ds_read_b128 a[228:231], v10 offset:47616
v_mfma_f32_16x16x32_bf16 v[68:71], a[232:235], a[160:163], 0
v_exp_f32 v25, v61
v_mfma_f32_16x16x32_bf16 v[76:79], a[232:235], a[164:167], 0
TR 232,15,20480
TR 234,15,22528
Mvaa 68,236,168
buffer_load_dwordx4 v5, s[12:15], s33 offen offset:128 nt lds
Mvaa 76,236,172
s_waitcnt lgkmcnt(4)
TR 236,16,20480
TR 238,16,22528
Mvaa 68,240,176
s_add_u32 m0, s38, 69376
v_exp_f32 v26, v62
Mvaa 76,240,180
TR 240,15,28672
TR 242,15,30720
Mvaa 68,244,184
v_cvt_pk_bf16_f32 v46, v24, v25
Mvaa 76,244,188
s_waitcnt lgkmcnt(6)
TR 244,16,28672
TR 246,16,30720
Mvaa 68,224,192
buffer_load_dwordx4 v5, s[12:15], s33 offen offset:256 nt lds
Mvaa 76,224,196
s_add_u32 s33, s33, 6144
TR 224,15,25088
TR 226,15,27136
Mvaa 68,228,200
s_sub_u32 s45, s33, 98304
v_exp_f32 v27, v63
Mvaa 76,228,204
s_waitcnt lgkmcnt(6)
v_cvt_pk_bf16_f32 v47, v26, v27
s_min_u32 s33, s33, s45
Mvaa 224,232,32
s_add_u32 m0, s38, 73728
v_exp_f32 v24, v64
Mvaa 228,232,36
TR 232,16,25088
TR 234,16,27136
Mvaa 232,236,32
buffer_load_dwordx4 v4, s[8:11], s32 offen nt lds
Mvaa 236,236,36
s_waitcnt lgkmcnt(4)
TR 236,19,512
TR 238,19,2560
Mvaa 224,240,40
s_add_u32 m0, s38, 77696
v_exp_f32 v25, v65
Mvaa 228,240,44
s_waitcnt vmcnt(10)
TR 240,20,512
TR 242,20,2560
Mvaa 232,244,40
s_barrier
Mvaa 236,244,44
s_waitcnt lgkmcnt(6)
TR 244,15,36864
TR 246,15,38912
v_mfma_f32_16x16x32_bf16 v[240:243], a[224:227], a[0:3], 0
buffer_load_dwordx4 v4, s[8:11], s32 offen offset:128 nt lds
v_mfma_f32_16x16x32_bf16 v[244:247], a[224:227], a[4:7], 0
s_add_u32 m0, s38, 81664
TR 224,16,36864
TR 226,16,38912
Mvav 32,252,40
v_exp_f32 v26, v66
Mvav 36,252,44
s_waitcnt lgkmcnt(6)
TR 228,15,37376
TR 230,15,39424
v_mfma_f32_16x16x32_bf16 v[248:251], a[232:235], a[0:3], 0
v_cvt_pk_bf16_f32 v28, v24, v25
v_mfma_f32_16x16x32_bf16 v[252:255], a[232:235], a[4:7], 0
TR 232,16,37376
TR 234,16,39424
Mvaa 240,236,8
buffer_load_dwordx4 v4, s[8:11], s32 offen offset:256 nt lds
Mvaa 244,236,12
s_waitcnt lgkmcnt(6)
TR 236,17,12288
TR 238,17,14336
Mvaa 248,240,8
s_add_u32 s32, s32, 6144
v_max_f32 v33, v32, v36
v_cmp_nge_f32 vcc, s39, v33
Mvaa 252,240,12
s_sub_u32 s45, s32, 98304
TR 240,18,12288
TR 242,18,14336
s_cbranch_vccnz Lr26
Lb26:
Mvav 80,244,40
s_min_u32 s32, s32, s45
ds_read_b128 a[0:3], v13 offset:61440
ds_read_b128 a[4:7], v13 offset:57344
Mvav 84,244,44
s_waitcnt lgkmcnt(8)
TR 244,17,12800
TR 246,17,14848
Mvav 88,224,40
s_add_u32 m0, s38, 84608
ds_read_b128 a[8:11], v13 offset:53248
ds_read_b128 a[12:15], v13 offset:49152
Mvav 92,224,44
TR 224,18,12800
TR 226,18,14848
Mvav 96,228,40
buffer_load_dwordx4 v6, s[16:19], s74 offen offset:1408 lds
Mvav 100,228,44
s_waitcnt lgkmcnt(10)
TR 228,17,16384
TR 230,17,18432
Mvav 104,232,40
v_exp_f32 v27, v67
Mvav 108,232,44
TR 232,18,16384
TR 234,18,18432
Mvav 112,236,40
v_exp_f32 v24, v72
Mvav 116,236,44
s_waitcnt lgkmcnt(8)
TR 236,17,16896
TR 238,17,18944
Mvav 120,240,40
v_cvt_pk_bf16_f32 v29, v26, v27
Mvav 124,240,44
TR 240,18,16896
TR 242,18,18944
Mvav 128,244,40
v_exp_f32 v25, v73
Mvav 132,244,44
s_waitcnt lgkmcnt(6)
TR 244,15,12800
TR 246,15,14848
Mvav 136,224,40
v_exp_f32 v26, v74
Mvav 140,224,44
TR 224,16,12800
TR 226,16,14848
Mvav 144,228,40
v_cvt_pk_bf16_f32 v0, v24, v25
Mvav 148,228,44
s_waitcnt lgkmcnt(6)
TR 228,15,16896
TR 230,15,18944
Mvav 152,232,40
v_exp_f32 v27, v75
Mvav 156,232,44
TR 232,16,16896
TR 234,16,18944
Mvav 160,236,40
v_exp_f32 v24, v68
Mvav 164,236,44
s_waitcnt lgkmcnt(6)
TR 236,15,20992
TR 238,15,23040
Mvav 168,240,40
v_cvt_pk_bf16_f32 v1, v26, v27
Mvav 172,240,44
TR 240,16,20992
TR 242,16,23040
Mvaa 240,244,16
v_exp_f32 v25, v69
Mvaa 244,244,20
s_waitcnt lgkmcnt(6)
TR 244,15,29184
TR 246,15,31232
Mvaa 248,224,16
v_exp_f32 v26, v70
Mvaa 252,224,20
TR 224,16,29184
TR 226,16,31232
Mvaa 240,228,24
ds_read_b128 a[16:19], v13 offset:45056
ds_read_b128 a[20:23], v13 offset:40960
Mvaa 244,228,28
s_waitcnt lgkmcnt(8)
TR 228,15,32768
TR 230,15,34816
Mvaa 248,232,24
s_add_u32 m0, s38, 88704
v_cvt_pk_bf16_f32 v30, v24, v25
Mvaa 252,232,28
TR 232,16,32768
TR 234,16,34816
Mvaa 240,236,32
buffer_load_dwordx4 v6, s[16:19], s75 offen offset:1408 lds
Mvaa 244,236,36
s_waitcnt lgkmcnt(8)
TR 236,15,33280
TR 238,15,35328
Mvaa 248,240,32
s_add_u32 m0, s38, 92800
ds_read_b128 a[24:27], v13 offset:36864
ds_read_b128 a[28:31], v13 offset:32768
Mvaa 252,240,36
s_waitcnt vmcnt(9)
TR 240,16,33280
TR 242,16,35328
Mvaa 240,244,40
s_barrier
Mvaa 244,244,44
s_waitcnt lgkmcnt(8)
ds_read_b128 a[244:247], v9 offset:40960
ds_read_b128 a[32:35], v13 offset:28672
Mvaa 248,224,40
buffer_load_dwordx4 v6, s[16:19], s76 offen offset:1408 lds
Mvaa 252,224,44
s_add_u32 m0, s38, 10880
ds_read_b128 a[224:227], v9 offset:41472
ds_read_b128 a[36:39], v13 offset:24576
Mvaa 224,228,48
ds_read_b128 a[40:43], v13 offset:20480
ds_read_b128 a[44:47], v13 offset:16384
Mvaa 228,228,52
s_waitcnt lgkmcnt(10)
ds_read_b128 a[228:231], v9 offset:45056
Mvaa 232,232,48
buffer_load_dwordx4 v6, s[16:19], s77 offen offset:1408 lds
Mvaa 236,232,52
s_add_u32 m0, s38, 14976
ds_read_b128 a[232:235], v9 offset:45568
Mvaa 240,236,48
v_exp_f32 v27, v71
Mvaa 244,236,52
s_waitcnt lgkmcnt(7)
ds_read_b128 a[236:239], v10 offset:0
v_cvt_pk_bf16_f32 v31, v26, v27
Mvaa 248,240,48
buffer_load_dwordx4 v6, s[16:19], s78 offen offset:1408 lds
Mvaa 252,240,52
s_add_u32 m0, s38, 19072
ds_read_b128 a[240:243], v10 offset:512
ds_read_b128 a[48:51], v13 offset:12288
v_mfma_f32_16x16x32_bf16 v[48:51], a[244:247], a[160:163], 0
v_exp_f32 v24, v76
v_mfma_f32_16x16x32_bf16 v[56:59], a[244:247], a[164:167], 0
s_waitcnt lgkmcnt(4)
ds_read_b128 a[244:247], v9 offset:43008
ds_read_b128 a[52:55], v13 offset:8192
Mvaa 48,224,168
buffer_load_dwordx4 v6, s[16:19], s79 offen offset:1408 lds
Mvaa 56,224,172
s_add_u32 m0, s38, 23168
ds_read_b128 a[224:227], v9 offset:43520
Mvaa 48,228,176
v_exp_f32 v25, v77
Mvaa 56,228,180
s_waitcnt lgkmcnt(5)
ds_read_b128 a[228:231], v9 offset:47104
v_cvt_pk_bf16_f32 v2, v24, v25
Mvaa 48,232,184
buffer_load_dwordx4 v6, s[16:19], s80 offen offset:1408 lds
Mvaa 56,232,188
s_add_u32 m0, s38, 35456
ds_read_b128 a[232:235], v9 offset:47616
Mvaa 48,236,192
v_exp_f32 v26, v78
Mvaa 56,236,196
s_waitcnt lgkmcnt(4)
ds_read_b128 a[236:239], v10 offset:2048
Mvaa 48,240,200
buffer_load_dwordx4 v6, s[16:19], s81 offen offset:1408 lds
Mvaa 56,240,204
s_add_u32 m0, s38, 61440
ds_read_b128 a[240:243], v10 offset:2560
v_mfma_f32_16x16x32_bf16 v[52:55], a[244:247], a[160:163], 0
v_exp_f32 v27, v79
v_mfma_f32_16x16x32_bf16 v[60:63], a[244:247], a[164:167], 0
s_waitcnt lgkmcnt(3)
TR 244,17,4096
TR 246,17,6144
Mvaa 52,224,168
v_cvt_pk_bf16_f32 v3, v26, v27
Mvaa 60,224,172
TR 224,18,4096
TR 226,18,6144
Mvaa 52,228,176
buffer_load_dwordx4 v5, s[12:15], s33 offen nt lds
Mvaa 60,228,180
s_waitcnt lgkmcnt(5)
TR 228,17,4608
TR 230,17,6656
Mvaa 52,232,184
s_add_u32 m0, s38, 65408
v_exp_f32 v24, v48
Mvaa 60,232,188
TR 232,18,4608
TR 234,18,6656
Mvaa 52,236,192
v_exp_f32 v25, v49
Mvaa 60,236,196
s_waitcnt lgkmcnt(6)
TR 236,15,0
TR 238,15,2048
Mvaa 52,240,200
buffer_load_dwordx4 v5, s[12:15], s33 offen offset:128 nt lds
Mvaa 60,240,204
s_add_u32 m0, s38, 98048
v_exp_f32 v26, v50
Mvaa 224,244,56
v_cvt_pk_bf16_f32 v40, v24, v25
Mvaa 228,244,60
s_waitcnt lgkmcnt(4)
TR 244,16,0
TR 246,16,2048
Mvaa 232,224,56
v_exp_f32 v27, v51
Mvaa 236,224,60
TR 224,15,512
TR 226,15,2560
Mvaa 240,228,56
buffer_load_dwordx4 v5, s[12:15], s33 offen offset:256 nt lds
Mvaa 244,228,60
s_waitcnt vmcnt(10) lgkmcnt(4)
TR 228,16,512
TR 230,16,2560
Mvaa 248,232,56
s_barrier
Mvaa 252,232,60
s_add_u32 s33, s33, 6144
TR 232,15,8192
TR 234,15,10240
Mvaa 224,236,64
s_sub_u32 s45, s33, 98304
ds_read_b128 a[56:59], v13 offset:4096
v_cvt_pk_bf16_f32 v41, v26, v27
Mvaa 228,236,68
s_waitcnt lgkmcnt(7)
TR 236,16,8192
TR 238,16,10240
Mvav 32,252,28
s_min_u32 s33, s33, s45
v_exp_f32 v24, v56
Mvav 36,252,0
s_add_u32 m0, s38, 159744
TR 240,15,8704
TR 242,15,10752
Mvaa 232,244,64
buffer_load_dwordx4 v4, s[8:11], s32 offen nt lds
Mvaa 236,244,68
s_waitcnt lgkmcnt(7)
TR 244,16,8704
TR 246,16,10752
Mvaa 240,224,64
s_add_u32 m0, s38, 151424
v_max_f32 v33, v32, v36
v_cmp_nge_f32 vcc, s39, v33
Mvaa 244,224,68
TR 224,17,8192
TR 226,17,10240
Mvaa 248,228,64
v_exp_f32 v25, v57
Mvaa 252,228,68
s_waitcnt lgkmcnt(6)
TR 228,18,8192
TR 230,18,10240
s_cbranch_vccnz Lr27
Lb27:
Mvav 80,232,28
buffer_load_dwordx4 v4, s[8:11], s32 offen offset:128 nt lds
Mvav 84,232,0
s_add_u32 m0, s38, 155392
TR 232,17,8704
TR 234,17,10752
Mvav 88,236,28
v_exp_f32 v26, v58
Mvav 92,236,0
s_waitcnt lgkmcnt(6)
TR 236,18,8704
TR 238,18,10752
Mvav 96,240,28
v_cvt_pk_bf16_f32 v44, v24, v25
Mvav 100,240,0
TR 240,17,20480
TR 242,17,22528
Mvav 104,244,28
buffer_load_dwordx4 v4, s[8:11], s32 offen offset:256 nt lds
Mvav 108,244,0
s_waitcnt lgkmcnt(6)
TR 244,18,20480
TR 246,18,22528
Mvav 112,224,28
s_add_u32 s32, s32, 6144
v_exp_f32 v27, v59
Mvav 116,224,0
s_sub_u32 s45, s32, 98304
TR 224,17,20992
TR 226,17,23040
Mvav 120,228,28
s_min_u32 s32, s32, s45
v_exp_f32 v24, v52
Mvav 124,228,0
s_waitcnt lgkmcnt(6)
TR 228,18,20992
TR 230,18,23040
Mvav 128,232,28
s_add_u32 m0, s38, 146048
v_cvt_pk_bf16_f32 v45, v26, v27
Mvav 132,232,0
TR 232,15,4096
TR 234,15,6144
Mvav 136,236,28
buffer_load_dwordx4 v6, s[16:19], s82 offen offset:1408 lds
Mvav 140,236,0
s_waitcnt lgkmcnt(6)
TR 236,16,4096
TR 238,16,6144
Mvav 144,240,28
v_exp_f32 v25, v53
Mvav 148,240,0
TR 240,15,4608
TR 242,15,6656
Mvav 152,244,28
v_exp_f32 v26, v54
Mvav 156,244,0
s_waitcnt lgkmcnt(6)
TR 244,16,4608
TR 246,16,6656
Mvav 160,224,28
v_cvt_pk_bf16_f32 v42, v24, v25
Mvav 164,224,0
TR 224,17,36864
TR 226,17,38912
Mvav 168,228,28
v_exp_f32 v27, v55
Mvav 172,228,0
s_waitcnt lgkmcnt(6)
TR 228,18,36864
TR 230,18,38912
Mvaa 224,232,72
v_cvt_pk_bf16_f32 v43, v26, v27
Mvaa 228,232,76
TR 232,17,37376
TR 234,17,39424
Mvaa 232,236,72
v_exp_f32 v24, v60
Mvaa 236,236,76
s_waitcnt vmcnt(12) lgkmcnt(6)
TR 236,18,37376
TR 238,18,39424
Mvaa 240,240,72
s_barrier
Mvaa 244,240,76
ds_read_b128 a[240:243], v10 offset:24576
Mvaa 248,244,72
v_exp_f32 v25, v61
Mvaa 252,244,76
s_waitcnt lgkmcnt(5)
ds_read_b128 a[244:247], v10 offset:25088
v_cvt_pk_bf16_f32 v46, v24, v25
Mvaa 224,224,80
v_exp_f32 v26, v62
Mvaa 228,224,84
ds_read_b128 a[224:227], v10 offset:28672
Mvaa 232,228,80
v_exp_f32 v27, v63
Mvaa 236,228,84
s_waitcnt lgkmcnt(3)
ds_read_b128 a[228:231], v10 offset:29184
v_cvt_pk_bf16_f32 v47, v26, v27
Mvaa 240,232,80
s_add_u32 m0, s38, 141952
Mvaa 244,232,84
ds_read_b128 a[232:235], v10 offset:32768
Mvaa 248,236,80
buffer_load_dwordx4 v6, s[16:19], s83 offen offset:1408 lds
Mvaa 252,236,84
s_waitcnt lgkmcnt(3)
ds_read_b128 a[236:239], v10 offset:33280
s_add_u32 m0, s38, 135168
v_mfma_f32_16x16x32_bf16 v[64:67], a[240:243], a[160:163], 0
v_mfma_f32_16x16x32_bf16 v[72:75], a[240:243], a[164:167], 0
ds_read_b128 a[240:243], v10 offset:26624
Mvaa 64,244,168
Mvaa 72,244,172
s_waitcnt lgkmcnt(3)
ds_read_b128 a[244:247], v10 offset:27136
Mvaa 64,224,176
buffer_load_dwordx4 v5, s[12:15], s33 offen nt lds
Mvaa 72,224,180
s_add_u32 m0, s38, 139136
ds_read_b128 a[224:227], v10 offset:30720
Mvaa 64,228,184
Mvaa 72,228,188
s_waitcnt lgkmcnt(3)
ds_read_b128 a[228:231], v10 offset:31232
Mvaa 64,232,192
Mvaa 72,232,196
ds_read_b128 a[232:235], v10 offset:34816
Mvaa 64,236,200
buffer_load_dwordx4 v5, s[12:15], s33 offen offset:128 nt lds
Mvaa 72,236,204
s_waitcnt lgkmcnt(3)
ds_read_b128 a[236:239], v10 offset:35328
s_add_u32 m0, s38, 126720
v_mfma_f32_16x16x32_bf16 v[68:71], a[240:243], a[160:163], 0
v_exp_f32 v24, v64
v_mfma_f32_16x16x32_bf16 v[76:79], a[240:243], a[164:167], 0
TR 240,17,40960
TR 242,17,43008
Mvaa 68,244,168
v_exp_f32 v25, v65
Mvaa 76,244,172
s_waitcnt lgkmcnt(4)
TR 244,18,40960
TR 246,18,43008
Mvaa 68,224,176
buffer_load_dwordx4 v5, s[12:15], s33 offen offset:256 nt lds
Mvaa 76,224,180
s_add_u32 s33, s33, 6144
TR 224,17,41472
TR 226,17,43520
Mvaa 68,228,184
s_sub_u32 s45, s33, 98304
v_exp_f32 v26, v66
Mvaa 76,228,188
s_waitcnt lgkmcnt(6)
TR 228,18,41472
TR 230,18,43520
Mvaa 68,232,192
s_min_u32 s33, s33, s45
v_cvt_pk_bf16_f32 v28, v24, v25
s_add_u32 m0, s38, 131072
Mvaa 76,232,196
TR 232,17,45056
TR 234,17,47104
Mvaa 68,236,200
buffer_load_dwordx4 v4, s[8:11], s32 offen nt lds
Mvaa 76,236,204
s_waitcnt lgkmcnt(6)
v_exp_f32 v27, v67
Mvaa 224,240,88
s_add_u32 m0, s38, 118656
v_exp_f32 v24, v72
Mvaa 228,240,92
TR 240,18,45056
TR 242,18,47104
Mvaa 232,244,88
v_cvt_pk_bf16_f32 v29, v26, v27
Mvaa 236,244,92
s_waitcnt lgkmcnt(4)
TR 244,17,45568
TR 246,17,47616
Mvaa 240,224,88
buffer_load_dwordx4 v4, s[8:11], s32 offen offset:128 nt lds
Mvaa 244,224,92
s_waitcnt vmcnt(10)
TR 224,18,45568
TR 226,18,47616
Tc17:
s_cbranch_execz Tr17
s_cmpk_eq_u32 s88, 20
s_cselect_b64 exec, 0, -1
s_cbranch_execz Tv20
Tr20:
s_mov_b64 exec, -1
Mvaa 248,228,88
s_barrier
Mvaa 252,228,92
s_waitcnt lgkmcnt(6)
TR 228,17,12288
TR 230,17,14336
Mvaa 224,232,96
s_add_u32 m0, s38, 122624
v_exp_f32 v25, v73
Mvaa 228,232,100
TR 232,18,12288
TR 234,18,14336
Mvav 32,252,40
buffer_load_dwordx4 v4, s[8:11], s32 offen offset:256 nt lds
Mvav 36,252,44
s_waitcnt lgkmcnt(6)
TR 236,17,12800
TR 238,17,14848
Mvaa 232,240,96
s_add_u32 s32, s32, 6144
v_exp_f32 v26, v74
Mvaa 236,240,100
s_sub_u32 s45, s32, 98304
TR 240,18,12800
TR 242,18,14848
Mvaa 240,244,96
s_min_u32 s32, s32, s45
v_add_u32 v4, 196608, v4
v_max_f32 v33, v32, v36
Mvaa 244,244,100
s_waitcnt lgkmcnt(6)
TR 244,17,16384
TR 246,17,18432
Mvaa 248,224,96
s_add_u32 m0, s38, 110592
v_cmp_nge_f32 vcc, s39, v33
v_cvt_pk_bf16_f32 v0, v24, v25
Mvaa 252,224,100
TR 224,18,16384
TR 226,18,18432
s_cbranch_vccnz Lr28
Lb28:
Mvav 80,228,40
buffer_load_dwordx4 v7, s[20:23], s53 offen lds
Mvav 84,228,44
s_waitcnt lgkmcnt(6)
TR 228,17,16896
TR 230,17,18944
Mvav 88,232,40
v_exp_f32 v27, v75
Mvav 92,232,44
TR 232,18,16896
TR 234,18,18944
Mvav 96,236,40
v_exp_f32 v24, v68
Mvav 100,236,44
s_waitcnt lgkmcnt(6)
TR 236,19,0
TR 238,19,2048
Mvav 104,240,40
v_cvt_pk_bf16_f32 v1, v26, v27
Mvav 108,240,44
TR 240,20,0
TR 242,20,2048
Mvav 112,244,40
v_exp_f32 v25, v69
Mvav 116,244,44
s_waitcnt lgkmcnt(6)
TR 244,19,512
TR 246,19,2560
Mvav 120,224,40
v_exp_f32 v26, v70
Mvav 124,224,44
TR 224,20,512
TR 226,20,2560
Mvav 128,228,40
v_cvt_pk_bf16_f32 v30, v24, v25
Mvav 132,228,44
s_waitcnt lgkmcnt(6)
TR 228,15,12288
TR 230,15,14336
Mvav 136,232,40
v_exp_f32 v27, v71
Mvav 140,232,44
TR 232,16,12288
TR 234,16,14336
Mvav 144,236,40
v_cvt_pk_bf16_f32 v31, v26, v27
Mvav 148,236,44
s_waitcnt lgkmcnt(6)
TR 236,15,12800
TR 238,15,14848
Mvav 152,240,40
v_exp_f32 v24, v76
Mvav 156,240,44
TR 240,16,12800
TR 242,16,14848
Mvav 160,244,40
v_exp_f32 v25, v77
Mvav 164,244,44
s_waitcnt lgkmcnt(6)
TR 244,15,16384
TR 246,15,18432
Mvav 168,224,40
v_exp_f32 v26, v78
Mvav 172,224,44
TR 224,16,16384
TR 226,16,18432
Mvaa 224,228,104
v_cvt_pk_bf16_f32 v2, v24, v25
Mvaa 228,228,108
s_waitcnt lgkmcnt(6)
TR 228,15,20480
TR 230,15,22528
Mvaa 232,232,104
s_add_u32 s43, s53, 40960
v_exp_f32 v27, v79
Mvaa 236,232,108
s_add_u32 m0, s38, 114688
TR 232,16,20480
TR 234,16,22528
Mvaa 240,236,104
buffer_load_dwordx4 v7, s[20:23], s43 offen lds
Mvaa 244,236,108
s_waitcnt lgkmcnt(6)
TR 236,15,24576
TR 238,15,26624
Mvaa 248,240,104
s_add_u32 s43, s53, 81920
v_cvt_pk_bf16_f32 v3, v26, v27
s_add_u32 m0, s38, 102400
Mvaa 252,240,108
TR 240,16,24576
TR 242,16,26624
Mvaa 224,244,112
buffer_load_dwordx4 v7, s[20:23], s43 offen lds
Mvaa 228,244,116
s_waitcnt lgkmcnt(6)
TR 244,15,36864
TR 246,15,38912
Mvaa 232,224,112
s_add_u32 m0, s38, 106496
Mvaa 236,224,116
s_waitcnt vmcnt(9)
TR 224,16,36864
TR 226,16,38912
Mvaa 224,228,120
s_barrier
Mvaa 228,228,124
s_waitcnt lgkmcnt(6)
ds_read_b128 a[228:231], v11 offset:61440
Mvaa 232,232,120
buffer_load_dwordx4 v5, s[12:15], s33 offen nt lds
Mvaa 236,232,124
s_add_u32 s43, s33, 128
ds_read_b128 a[232:235], v11 offset:61952
s_add_u32 m0, s38, 0
Mvaa 224,236,128
Mvaa 228,236,132
s_waitcnt lgkmcnt(4)
ds_read_b128 a[236:239], v11 offset:53248
Mvaa 232,240,128
Mvaa 236,240,132
ds_read_b128 a[240:243], v11 offset:53760
Mvaa 224,244,136
buffer_load_dwordx4 v5, s[12:15], s43 offen nt lds
Mvaa 228,244,140
s_waitcnt lgkmcnt(3)
ds_read_b128 a[244:247], v11 offset:57344
s_add_u32 m0, s38, 3840
Mvaa 232,224,136
Mvaa 236,224,140
ds_read_b128 a[224:227], v11 offset:57856
v_mfma_f32_16x16x32_bf16 v[48:51], a[228:231], a[160:163], 0
v_mfma_f32_16x16x32_bf16 v[56:59], a[228:231], a[164:167], 0
s_waitcnt lgkmcnt(3)
ds_read_b128 a[228:231], v11 offset:63488
Mvaa 48,232,168
buffer_load_dwordx4 v5, s[12:15], s33 offen offset:256 nt lds
Mvaa 56,232,172
s_add_u32 s33, s33, 6144
ds_read_b128 a[232:235], v11 offset:64000
s_sub_u32 s45, s33, 98304
Mvaa 48,236,176
s_min_u32 s33, s33, s45
s_add_u32 m0, s38, 8192
Mvaa 56,236,180
s_waitcnt lgkmcnt(3)
ds_read_b128 a[236:239], v11 offset:55296
Mvaa 48,240,184
Mvaa 56,240,188
ds_read_b128 a[240:243], v11 offset:55808
Mvaa 48,244,192
buffer_load_dwordx4 v5, s[12:15], s33 offen nt lds
Mvaa 56,244,196
s_waitcnt lgkmcnt(3)
ds_read_b128 a[244:247], v11 offset:59392
s_add_u32 m0, s38, 12160
Mvaa 48,224,200
Mvaa 56,224,204
ds_read_b128 a[224:227], v11 offset:59904
v_mfma_f32_16x16x32_bf16 v[52:55], a[228:231], a[160:163], 0
v_exp_f32 v24, v48
v_mfma_f32_16x16x32_bf16 v[60:63], a[228:231], a[164:167], 0
s_waitcnt lgkmcnt(3)
TR 228,19,49152
TR 230,19,51200
Mvaa 52,232,168
buffer_load_dwordx4 v5, s[12:15], s33 offen offset:128 nt lds
Mvaa 60,232,172
s_add_u32 m0, s38, 28416
TR 232,20,49152
TR 234,20,51200
Mvaa 52,236,176
v_exp_f32 v25, v49
Mvaa 60,236,180
s_waitcnt lgkmcnt(5)
TR 236,19,45056
TR 238,19,47104
Mvaa 52,240,184
v_exp_f32 v26, v50
Mvaa 60,240,188
TR 240,20,45056
TR 242,20,47104
Mvaa 52,244,192
buffer_load_dwordx4 v5, s[12:15], s33 offen offset:256 nt lds
Mvaa 60,244,196
s_waitcnt lgkmcnt(6)
TR 244,15,16896
TR 246,15,18944
Mvaa 52,224,200
s_add_u32 s33, s33, 6144
v_cvt_pk_bf16_f32 v40, v24, v25
s_sub_u32 s45, s33, 98304
Mvaa 60,224,204
s_min_u32 s33, s33, s45
v_add_u32 v5, 196608, v5
s_add_u32 s43, s53, 122880
Mvaa 224,228,144
s_add_u32 m0, s38, 32768
v_exp_f32 v27, v51
Mvaa 228,228,148
s_waitcnt lgkmcnt(4)
TR 228,16,16896
TR 230,16,18944
Mvaa 232,232,144
buffer_load_dwordx4 v7, s[20:23], s43 offen lds
Mvaa 236,232,148
TR 232,15,20992
TR 234,15,23040
Mvaa 224,236,152
v_exp_f32 v24, v56
Mvaa 228,236,156
s_waitcnt vmcnt(13) lgkmcnt(4)
TR 236,16,20992
TR 238,16,23040
Mvaa 232,240,152
s_barrier
Mvaa 236,240,156
TR 240,19,36864
TR 242,19,38912
Mvaa 240,244,112
v_mul_f32 v224, s40, v224
v_mul_f32 v225, s40, v225
Mvaa 244,244,116
s_waitcnt lgkmcnt(6)
TR 244,20,36864
TR 246,20,38912
Mvav 32,252,28
v_mul_f32 v226, s40, v226
v_mul_f32 v227, s40, v227
Mvav 36,252,0
TR 224,19,37376
TR 226,19,39424
Mvaa 248,228,112
v_mul_f32 v232, s40, v232
v_mul_f32 v233, s40, v233
Mvaa 252,228,116
s_waitcnt lgkmcnt(6)
TR 228,20,37376
TR 230,20,39424
Mvaa 240,232,120
v_max_f32 v33, v32, v36
v_cmp_nge_f32 vcc, s39, v33
Mvaa 244,232,124
TR 232,19,40960
TR 234,19,43008
Mvaa 248,236,120
v_mul_f32 v234, s40, v234
v_mul_f32 v235, s40, v235
Mvaa 252,236,124
s_waitcnt lgkmcnt(6)
TR 236,20,40960
TR 238,20,43008
s_cbranch_vccnz Lr29
Lb29:
Mvav 80,240,28
v_cvt_pk_bf16_f32 v224, v224, v225
v_cvt_pk_bf16_f32 v225, v226, v227
Mvav 84,240,0
TR 240,19,41472
TR 242,19,43520
Mvav 88,244,28
v_cvt_pk_bf16_f32 v226, v232, v233
v_cvt_pk_bf16_f32 v227, v234, v235
Mvav 92,244,0
s_waitcnt lgkmcnt(6)
TR 244,20,41472
TR 246,20,43520
Mvav 96,224,28
v_permlane16_swap_b32 v224, v226
v_permlane16_swap_b32 v225, v227
Mvav 100,224,0
TR 224,19,28672
TR 226,19,30720
Mvav 104,228,28
v_accvgpr_write_b32 a60, v224
v_accvgpr_write_b32 a61, v225
Mvav 108,228,0
s_waitcnt lgkmcnt(6)
TR 228,20,28672
TR 230,20,30720
Mvav 112,232,28
v_accvgpr_write_b32 a62, v226
v_accvgpr_write_b32 a63, v227
Mvav 116,232,0
TR 232,19,29184
TR 234,19,31232
Mvav 120,236,28
v_mul_f32 v228, s40, v228
v_mul_f32 v229, s40, v229
Mvav 124,236,0
s_waitcnt lgkmcnt(6)
TR 236,20,29184
TR 238,20,31232
Mvav 128,240,28
s_add_u32 s43, s53, 163840
v_mul_f32 v230, s40, v230
v_mul_f32 v231, s40, v231
Mvav 132,240,0
s_add_u32 m0, s38, 159744
TR 240,15,25088
TR 242,15,27136
Mvav 136,244,28
buffer_load_dwordx4 v7, s[20:23], s43 offen lds
Mvav 140,244,0
s_waitcnt lgkmcnt(6)
TR 244,16,25088
TR 246,16,27136
Mvav 144,224,28
s_add_u32 s43, s53, 204800
v_mul_f32 v236, s40, v236
v_mul_f32 v237, s40, v237
Mvav 148,224,0
s_add_u32 m0, s38, 151552
TR 224,15,37376
TR 226,15,39424
Mvav 152,228,28
buffer_load_dwordx4 v7, s[20:23], s43 offen lds
Mvav 156,228,0
s_waitcnt lgkmcnt(6)
TR 228,16,37376
TR 230,16,39424
Mvav 160,232,28
v_mul_f32 v238, s40, v238
v_mul_f32 v239, s40, v239
Mvav 164,232,0
TR 232,19,49664
TR 234,19,51712
Mvav 168,236,28
v_cvt_pk_bf16_f32 v228, v228, v229
v_cvt_pk_bf16_f32 v229, v230, v231
Mvav 172,236,0
s_waitcnt lgkmcnt(6)
TR 236,20,49664
TR 238,20,51712
Mvaa 240,240,128
v_cvt_pk_bf16_f32 v230, v236, v237
v_cvt_pk_bf16_f32 v231, v238, v239
Mvaa 244,240,132
TR 240,19,45568
TR 242,19,47616
Mvaa 248,244,128
v_permlane16_swap_b32 v228, v230
v_permlane16_swap_b32 v229, v231
Mvaa 252,244,132
s_waitcnt vmcnt(9) lgkmcnt(6)
TR 244,20,45568
TR 246,20,47616
Mvaa 240,224,136
s_barrier
Mvaa 244,224,140
ds_read_b128 a[224:227], v11 offset:32768
v_accvgpr_write_b32 a64, v228
Mvaa 248,228,136
s_add_u32 s43, s53, 245760
v_accvgpr_write_b32 a65, v229
v_accvgpr_write_b32 a66, v230
Mvaa 252,228,140
s_waitcnt lgkmcnt(5)
ds_read_b128 a[228:231], v11 offset:33280
v_accvgpr_write_b32 a67, v231
Mvaa 240,232,144
s_add_u32 m0, s38, 155648
v_cvt_pk_bf16_f32 v41, v26, v27
Mvaa 244,232,148
ds_read_b128 a[232:235], v11 offset:20480
Mvaa 248,236,144
buffer_load_dwordx4 v7, s[20:23], s43 offen lds
Mvaa 252,236,148
s_waitcnt lgkmcnt(3)
ds_read_b128 a[236:239], v11 offset:20992
s_add_u32 s43, s53, 286720
Mvaa 240,240,152
s_add_u32 m0, s38, 135168
v_exp_f32 v25, v57
Mvaa 244,240,156
ds_read_b128 a[240:243], v11 offset:24576
v_cvt_pk_bf16_f32 v44, v24, v25
Mvaa 248,244,152
buffer_load_dwordx4 v7, s[20:23], s43 offen lds
Mvaa 252,244,156
s_waitcnt lgkmcnt(3)
ds_read_b128 a[244:247], v11 offset:25088
v_mul_f32 v240, s40, v240
v_mfma_f32_16x16x32_bf16 v[64:67], a[224:227], a[160:163], 0
s_add_u32 s43, s53, 327680
v_mul_f32 v241, s40, v241
v_mul_f32 v242, s40, v242
v_mfma_f32_16x16x32_bf16 v[72:75], a[224:227], a[164:167], 0
s_add_u32 m0, s38, 139264
ds_read_b128 a[224:227], v11 offset:34816
v_mul_f32 v243, s40, v243
Mvaa 64,228,168
buffer_load_dwordx4 v7, s[20:23], s43 offen lds
Mvaa 72,228,172
s_waitcnt lgkmcnt(3)
ds_read_b128 a[228:231], v11 offset:35328
v_mul_f32 v248, s40, v248
Mvaa 64,232,176
s_add_u32 s43, s53, 368640
v_mul_f32 v249, s40, v249
v_mul_f32 v250, s40, v250
Mvaa 72,232,180
s_add_u32 m0, s38, 126976
ds_read_b128 a[232:235], v11 offset:22528
v_mul_f32 v251, s40, v251
Mvaa 64,236,184
buffer_load_dwordx4 v7, s[20:23], s43 offen lds
Mvaa 72,236,188
s_waitcnt lgkmcnt(3)
ds_read_b128 a[236:239], v11 offset:23040
v_cvt_pk_bf16_f32 v240, v240, v241
Mvaa 64,240,192
s_add_u32 s43, s53, 409600
v_cvt_pk_bf16_f32 v241, v242, v243
v_cvt_pk_bf16_f32 v242, v248, v249
Mvaa 72,240,196
s_add_u32 m0, s38, 16384
ds_read_b128 a[240:243], v11 offset:26624
v_cvt_pk_bf16_f32 v243, v250, v251
Mvaa 64,244,200
buffer_load_dwordx4 v7, s[20:23], s43 offen lds
Mvaa 72,244,204
s_waitcnt lgkmcnt(3)
ds_read_b128 a[244:247], v11 offset:27136
v_permlane16_swap_b32 v240, v242
v_mfma_f32_16x16x32_bf16 v[68:71], a[224:227], a[160:163], 0
s_add_u32 m0, s38, 20480
v_permlane16_swap_b32 v241, v243
v_accvgpr_write_b32 a68, v240
v_mfma_f32_16x16x32_bf16 v[76:79], a[224:227], a[164:167], 0
TR 224,19,12288
TR 226,19,14336
Mvaa 68,228,168
v_accvgpr_write_b32 a69, v241
v_accvgpr_write_b32 a70, v242
Mvaa 76,228,172
s_waitcnt lgkmcnt(4)
TR 228,20,12288
TR 230,20,14336
Mvaa 68,232,176
buffer_load_dwordx4 v4, s[8:11], s32 offen nt lds
Mvaa 76,232,180
s_add_u32 m0, s38, 24448
TR 232,19,16384
TR 234,19,18432
Mvaa 68,236,184
v_accvgpr_write_b32 a71, v243
v_mul_f32 v244, s40, v244
Mvaa 76,236,188
s_waitcnt lgkmcnt(6)
TR 236,20,16384
TR 238,20,18432
Mvaa 68,240,192
v_mul_f32 v245, s40, v245
v_mul_f32 v246, s40, v246
Mvaa 76,240,196
TR 240,19,12800
TR 242,19,14848
Mvaa 68,244,200
buffer_load_dwordx4 v4, s[8:11], s32 offen offset:128 nt lds
Mvaa 76,244,204
s_waitcnt lgkmcnt(6)
TR 244,20,12800
TR 246,20,14848
v_mfma_f32_16x16x32_bf16 v[224:227], a[224:227], v[176:179], 0
s_add_u32 m0, s38, 40704
v_mul_f32 v247, s40, v247
v_mul_f32 v252, s40, v252
v_mfma_f32_16x16x32_bf16 v[228:231], a[224:227], v[180:183], 0
TR 224,19,16896
TR 226,19,18944
v_mfma_f32_16x16x32_bf16 v[232:235], a[228:231], v[176:179], 0
v_mul_f32 v253, s40, v253
v_mul_f32 v254, s40, v254
v_mfma_f32_16x16x32_bf16 v[236:239], a[228:231], v[180:183], 0
s_waitcnt lgkmcnt(6)
TR 228,20,16896
TR 230,20,18944
Mvav 224,232,184
buffer_load_dwordx4 v4, s[8:11], s32 offen offset:256 nt lds
Mvav 228,232,188
s_add_u32 s32, s32, 6144
TR 232,19,4096
TR 234,19,6144
Mvav 232,236,184
s_sub_u32 s45, s32, 98304
v_mul_f32 v255, s40, v255
v_cvt_pk_bf16_f32 v244, v244, v245
Mvav 236,236,188
s_waitcnt lgkmcnt(6)
v_cvt_pk_bf16_f32 v245, v246, v247
v_cvt_pk_bf16_f32 v246, v252, v253
v_mfma_f32_16x16x32_bf16 v[240:243], a[240:243], v[176:179], 0
s_min_u32 s32, s32, s45
v_cvt_pk_bf16_f32 v247, v254, v255
v_permlane16_swap_b32 v244, v246
s_nop 0
v_permlane16_swap_b32 v245, v247
v_accvgpr_write_b32 a72, v244
v_accvgpr_write_b32 a73, v245
v_accvgpr_write_b32 a74, v246
v_accvgpr_write_b32 a75, v247
v_mfma_f32_16x16x32_bf16 v[244:247], a[240:243], v[180:183], 0
s_add_u32 m0, s38, 45056
TR 240,20,4096
TR 242,20,6144
v_mfma_f32_16x16x32_bf16 v[248:251], a[244:247], v[176:179], 0
buffer_load_dwordx4 v4, s[8:11], s32 offen nt lds
v_mfma_f32_16x16x32_bf16 v[252:255], a[244:247], v[180:183], 0
s_waitcnt lgkmcnt(4)
TR 244,19,4608
TR 246,19,6656
Mvav 240,224,184
s_add_u32 m0, s38, 49024
v_exp_f32 v26, v58
Mvav 244,224,188
s_waitcnt vmcnt(9)
TR 224,20,4608
TR 226,20,6656
Mvav 248,228,184
s_barrier
Mvav 252,228,188
s_waitcnt lgkmcnt(6)
TR 228,19,8192
TR 230,19,10240
Mvav 224,232,192
buffer_load_dwordx4 v4, s[8:11], s32 offen offset:128 nt lds
Mvav 228,232,196
s_add_u32 m0, s38, 143104
TR 232,20,8192
TR 234,20,10240
Tc18:
s_cbranch_execz Tr18
s_cmpk_eq_u32 s88, 21
s_cselect_b64 exec, 0, -1
s_cbranch_execz Tv21
Tr21:
s_mov_b64 exec, -1
v_exp_f32 v27, v59
v_exp_f32 v24, v52
v_cvt_pk_bf16_f32 v45, v26, v27
v_exp_f32 v25, v53
v_exp_f32 v26, v54
v_cvt_pk_bf16_f32 v42, v24, v25
v_exp_f32 v27, v55
s_nop 0
v_cvt_pk_bf16_f32 v43, v26, v27
s_nop 1
Mvav 32,252,40
v_exp_f32 v24, v60
v_exp_f32 v25, v61
v_exp_f32 v26, v62
v_cvt_pk_bf16_f32 v46, v24, v25
v_exp_f32 v27, v63
s_nop 0
v_cvt_pk_bf16_f32 v47, v26, v27
s_nop 1
Mvav 36,252,44
s_waitcnt lgkmcnt(6)
TR 236,19,8704
TR 238,19,10752
Mvav 232,240,192
v_exp_f32 v24, v64
Mvav 236,240,196
TR 240,20,8704
TR 242,20,10752
Mvav 240,244,192
buffer_load_dwordx4 v4, s[8:11], s32 offen offset:256 nt lds
Mvav 244,244,196
s_waitcnt lgkmcnt(6)
TR 244,15,0
TR 246,15,2048
Mvav 248,224,192
s_add_u32 s32, s32, 6144
v_max_f32 v33, v32, v36
v_cmp_nge_f32 vcc, s39, v33
Mvav 252,224,196
s_sub_u32 s45, s32, 98304
TR 224,16,0
TR 226,16,2048
s_cbranch_vccnz Lr30
Lb30:
Mvav 80,228,40
s_min_u32 s32, s32, s45
v_exp_f32 v25, v65
Mvav 84,228,44
s_waitcnt lgkmcnt(6)
TR 228,15,512
TR 230,15,2560
Mvav 88,232,40
s_add_u32 s43, s53, 450560
v_exp_f32 v26, v66
Mvav 92,232,44
s_add_u32 m0, s38, 147456
TR 232,16,512
TR 234,16,2560
Mvav 96,236,40
buffer_load_dwordx4 v7, s[20:23], s43 offen lds
Mvav 100,236,44
s_waitcnt lgkmcnt(6)
TR 236,15,4096
TR 238,15,6144
Mvav 104,240,40
v_cvt_pk_bf16_f32 v28, v24, v25
Mvav 108,240,44
TR 240,16,4096
TR 242,16,6144
Mvav 112,244,40
v_exp_f32 v27, v67
Mvav 116,244,44
s_waitcnt lgkmcnt(6)
TR 244,15,4608
TR 246,15,6656
Mvav 120,224,40
v_exp_f32 v24, v72
Mvav 124,224,44
TR 224,16,4608
TR 226,16,6656
Mvav 128,228,40
v_cvt_pk_bf16_f32 v29, v26, v27
Mvav 132,228,44
s_waitcnt lgkmcnt(6)
TR 228,15,32768
TR 230,15,34816
Mvav 136,232,40
v_exp_f32 v25, v73
Mvav 140,232,44
TR 232,16,32768
TR 234,16,34816
Mvav 144,236,40
v_exp_f32 v26, v74
Mvav 148,236,44
s_waitcnt lgkmcnt(6)
TR 236,15,33280
TR 238,15,35328
Mvav 152,240,40
v_cvt_pk_bf16_f32 v0, v24, v25
Mvav 156,240,44
TR 240,16,33280
TR 242,16,35328
Mvav 160,244,40
v_exp_f32 v27, v75
Mvav 164,244,44
s_waitcnt lgkmcnt(6)
TR 244,19,61440
TR 246,19,63488
Mvav 168,224,40
v_exp_f32 v24, v68
Mvav 172,224,44
TR 224,20,61440
TR 226,20,63488
Mvav 224,228,200
v_cvt_pk_bf16_f32 v1, v26, v27
Mvav 228,228,204
s_waitcnt lgkmcnt(6)
TR 228,19,61952
TR 230,19,64000
Mvav 232,232,200
v_exp_f32 v25, v69
Mvav 236,232,204
TR 232,20,61952
TR 234,20,64000
Mvav 240,236,200
v_exp_f32 v26, v70
Mvav 244,236,204
s_waitcnt lgkmcnt(6)
TR 236,19,53248
TR 238,19,55296
Mvav 248,240,200
s_add_u32 m0, s38, 131072
v_cvt_pk_bf16_f32 v30, v24, v25
Mvav 252,240,204
buffer_load_dwordx4 v7, s[20:23], s54 offen lds
Mvav 224,244,208
s_add_u32 s43, s54, 40960
v_exp_f32 v27, v71
Mvav 228,244,212
s_waitcnt lgkmcnt(4)
TR 244,20,53248
TR 246,20,55296
Mvav 232,224,208
s_add_u32 m0, s38, 118784
v_cvt_pk_bf16_f32 v31, v26, v27
Mvav 236,224,212
TR 224,19,53760
TR 226,19,55808
Mvav 240,228,208
buffer_load_dwordx4 v7, s[20:23], s43 offen lds
Mvav 244,228,212
s_waitcnt lgkmcnt(4)
TR 228,20,53760
TR 230,20,55808
Mvav 248,232,208
s_barrier
Mvav 252,232,212
s_add_u32 s43, s54, 81920
TR 232,15,8192
TR 234,15,10240
Mvav 224,236,216
s_add_u32 m0, s38, 159744
v_exp_f32 v24, v76
Mvav 228,236,220
s_waitcnt lgkmcnt(6)
TR 236,16,8192
TR 238,16,10240
Mvav 32,252,28
buffer_load_dwordx4 v7, s[20:23], s43 offen lds
v_exp_f32 v25, v77
v_exp_f32 v26, v78
v_cvt_pk_bf16_f32 v2, v24, v25
v_exp_f32 v27, v79
s_nop 0
v_cvt_pk_bf16_f32 v3, v26, v27
s_nop 1
Mvav 36,252,0
s_add_u32 s43, s54, 122880
TR 240,15,8704
TR 242,15,10752
Mvav 232,244,216
s_add_u32 m0, s38, 122880
Mvav 236,244,220
s_waitcnt lgkmcnt(6)
TR 244,16,8704
TR 246,16,10752
Mvav 240,224,216
buffer_load_dwordx4 v7, s[20:23], s43 offen lds
Mvav 244,224,220
s_add_u32 s43, s54, 163840
TR 224,15,12288
TR 226,15,14336
Mvav 248,228,216
s_add_u32 m0, s38, 110592
v_max_f32 v33, v32, v36
v_cmp_nge_f32 vcc, s39, v33
Mvav 252,228,220
s_waitcnt lgkmcnt(6)
TR 228,16,12288
TR 230,16,14336
s_cbranch_vccnz Lr31
Lb31:
Mvav 80,232,28
buffer_load_dwordx4 v7, s[20:23], s43 offen lds
Mvav 84,232,0
s_add_u32 m0, s38, 114688
TR 232,15,12800
TR 234,15,14848
Mvav 88,236,28
v_rcp_f32 v12, v32
Mvav 92,236,0
s_waitcnt lgkmcnt(6)
TR 236,16,12800
TR 238,16,14848
Mvav 96,240,28
v_mul_f32 v80, v12, v80
v_mul_f32 v81, v12, v81
Mvav 100,240,0
TR 240,15,28672
TR 242,15,30720
Mvav 104,244,28
buffer_load_dwordx4 v5, s[12:15], s33 offen nt lds
Mvav 108,244,0
s_waitcnt lgkmcnt(6)
TR 244,16,28672
TR 246,16,30720
Mvav 112,224,28
s_add_u32 m0, s38, 102272
v_mul_f32 v82, v12, v82
v_mul_f32 v83, v12, v83
Mvav 116,224,0
TR 224,15,29184
TR 226,15,31232
Mvav 120,228,28
v_mul_f32 v88, v12, v88
v_mul_f32 v89, v12, v89
Mvav 124,228,0
s_waitcnt vmcnt(6) lgkmcnt(6)
TR 228,16,29184
TR 230,16,31232
Mvav 128,232,28
s_barrier
Mvav 132,232,0
ds_read_b128 a[232:235], v9 offset:20480
v_mul_f32 v90, v12, v90
Mvav 136,236,28
buffer_load_dwordx4 v5, s[12:15], s33 offen offset:128 nt lds
Mvav 140,236,0
s_waitcnt lgkmcnt(5)
ds_read_b128 a[236:239], v9 offset:20992
v_mul_f32 v91, v12, v91
Mvav 144,240,28
s_add_u32 m0, s38, 151296
v_cvt_pk_bf16_f32 v80, v80, v81
v_cvt_pk_bf16_f32 v81, v82, v83
Mvav 148,240,0
ds_read_b128 a[240:243], v9 offset:24576
v_cvt_pk_bf16_f32 v82, v88, v89
Mvav 152,244,28
v_cvt_pk_bf16_f32 v83, v90, v91
v_accvgpr_write_b32 a160, v80
Mvav 156,244,0
s_waitcnt lgkmcnt(3)
ds_read_b128 a[244:247], v9 offset:25088
v_accvgpr_write_b32 a161, v81
Mvav 160,224,28
buffer_load_dwordx4 v5, s[12:15], s33 offen offset:256 nt lds
Mvav 164,224,0
s_add_u32 s33, s33, 6144
ds_read_b128 a[224:227], v9 offset:40960
v_accvgpr_write_b32 a162, v82
Mvav 168,228,28
s_sub_u32 s45, s33, 98304
v_accvgpr_write_b32 a163, v83
v_mul_f32 v96, v12, v96
Mvav 172,228,0
s_waitcnt lgkmcnt(3)
ds_read_b128 a[228:231], v9 offset:41472
v_mul_f32 v97, v12, v97
v_mfma_f32_16x16x32_bf16 v[48:51], a[232:235], a[208:211], 0
s_min_u32 s33, s33, s45
v_rcp_f32 v8, v36
v_mfma_f32_16x16x32_bf16 v[56:59], a[232:235], a[212:215], 0
s_add_u32 m0, s38, 106496
ds_read_b128 a[232:235], v9 offset:22528
v_mul_f32 v84, v8, v84
Mvaa 48,236,216
buffer_load_dwordx4 v4, s[8:11], s32 offen nt lds
Mvaa 56,236,220
s_waitcnt lgkmcnt(3)
ds_read_b128 a[236:239], v9 offset:23040
v_mul_f32 v85, v8, v85
Mvaa 48,240,248
s_add_u32 s43, s32, 128
v_mul_f32 v86, v8, v86
v_mul_f32 v87, v8, v87
Mvaa 56,240,0
s_add_u32 m0, s38, 0
ds_read_b128 a[240:243], v9 offset:26624
v_mul_f32 v92, v8, v92
Mvaa 48,244,4
s_branch L_hop
.section .rodata,"a"
.p2align 6
.amdhsa_kernel attn_kernel
  .amdhsa_next_free_vgpr 512
  .amdhsa_next_free_sgpr 102
  .amdhsa_accum_offset 256
  .amdhsa_group_segment_fixed_size 0
  .amdhsa_kernarg_size 104
  .amdhsa_user_sgpr_count 2
  .amdhsa_user_sgpr_kernarg_segment_ptr 1
  .amdhsa_system_sgpr_workgroup_id_x 1
  .amdhsa_float_denorm_mode_32 3
.end_amdhsa_kernel
```
